```python
import torch

def _softmax(x, axis=-1):
    return torch.softmax(x, dim=axis)
def _gelu(x):
    return torch.nn.functional.gelu(x, approximate="tanh")
def _silu(x):
    return torch.nn.functional.silu(x)
def _sigmoid(x):
    return torch.sigmoid(x)
def _layernorm(x, axis=-1, eps=1e-5):
    m = x.mean(dim=axis, keepdim=True)
    v = x.var(dim=axis, keepdim=True, unbiased=False)
    return (x - m) / torch.sqrt(v + eps)
def _scatter_add(tgt, idx, src, axis=0):
    return tgt.clone().index_add_(axis, idx, src)
def _segment_sum(src, seg, n):
    out = torch.zeros((n,) + src.shape[1:], dtype=src.dtype)
    return out.index_add_(0, seg, src)
def _pad(x, pw):
    flat = tuple(v for pair in reversed(pw) for v in pair)
    return torch.nn.functional.pad(x, flat)

kernel_name = 'interleave_layers__sliding_local_dilated__dense_activation_squared_relu__prompt'

def setup_inputs():

    _w = (lambda a: (lambda t: t.to(torch.bfloat16) if t.is_floating_point() else t)(torch.as_tensor(a)))
    def _A_setup():
        B, S, D = 1, 2048, 640
        return {
            "x": _w((lambda *s: torch.randn(*s, dtype=torch.bfloat16) * 0.05)(B, S, D)),
            "wqkv": _w((lambda *s: torch.randn(*s, dtype=torch.bfloat16) * 0.05)(D, 3 * D)),
            "wo": _w((lambda *s: torch.randn(*s, dtype=torch.bfloat16) * 0.05)(D, D)),
        }
    _A_in = _A_setup()

    def _B_setup():
        B, S, D, F = 1, 2048, 640, 1536
        return {
            "x": _w((lambda *s: torch.randn(*s, dtype=torch.bfloat16) * 0.05)(B, S, D)),
            "w1": _w((lambda *s: torch.randn(*s, dtype=torch.bfloat16) * 0.05)(D, F)),
            "b1": _w((lambda *s: torch.randn(*s, dtype=torch.bfloat16) * 0.2)(F)),
            "w2": _w((lambda *s: torch.randn(*s, dtype=torch.bfloat16) * 0.05)(F, D)),
            "b2": _w((lambda *s: torch.randn(*s, dtype=torch.bfloat16) * 0.8)(D)),
        }
    _B_in = _B_setup()

    return {
        "A_x": _A_in["x"],
        "A_wqkv": _A_in["wqkv"],
        "A_wo": _A_in["wo"],
        "B_x": _B_in["x"],
        "B_w1": _B_in["w1"],
        "B_b1": _B_in["b1"],
        "B_w2": _B_in["w2"],
        "B_b2": _B_in["b2"],
    }

def reference(A_x, A_wqkv, A_wo, B_x, B_w1, B_b1, B_w2, B_b2):
    def _A_ref(x, wqkv, wo):
        B, S, D = x.shape
        H = 32; Dh = D // H
        W, dil = 8, 2
        qkv = (lambda x, *d: x.permute(*d))((x @ wqkv).reshape(B, S, 3, H, Dh), 2, 0, 3, 1, 4)
        q, k, v = qkv[0], qkv[1], qkv[2]
        scale = Dh ** -0.5
        pos = torch.arange(S)
        off = torch.arange(W) * dil
        idx = pos[:, None] - off[None, :]
        mask = idx >= 0
        idx_c = torch.where(mask, idx, 0).reshape(-1)
        kg = k[:, :, idx_c, :].reshape(B, H, S, W, Dh)
        vg = v[:, :, idx_c, :].reshape(B, H, S, W, Dh)
        logits = torch.einsum("bhsd,bhswd->bhsw", q, kg) * scale
        logits = torch.where(mask[None, None, :, :], logits, -1e9)
        attn = _softmax(logits, axis=-1)
        o = torch.einsum("bhsw,bhswd->bhsd", attn, vg)
        return (lambda x, *d: x.permute(*d))(o, 0, 2, 1, 3).reshape(B, S, D) @ wo

    def _B_ref(x, w1, b1, w2, b2):
        h = torch.einsum("bsd,df->bsf", x, w1) + b1
        zero = torch.zeros_like(h)
        r = torch.where(h > zero, h, zero)
        h = r * r
        out = torch.einsum("bsf,fd->bsd", h, w2) + b2
        return out

    x = A_x
    x = x + _A_ref(_layernorm(x, axis=-1), A_wqkv, A_wo)
    x = x + _B_ref(_layernorm(x, axis=-1), B_w1, B_b1, B_w2, B_b2)
    x = x + _A_ref(_layernorm(x, axis=-1), A_wqkv, A_wo)
    x = x + _B_ref(_layernorm(x, axis=-1), B_w1, B_b1, B_w2, B_b2)
    return x
```

```asm
; @launch kernel=prep_kernel grid=(256,1,1) block=(256,1,1) lds=36864
; @launch kernel=main_kernel grid=(256,1,1) block=(256,1,1) lds=163840
.amdgcn_target "amdgcn-amd-amdhsa--gfx950"
.text
.globl prep_kernel
.p2align 8
.type prep_kernel,@function
prep_kernel:
    s_cmp_ge_u32 s2, 256
    s_cbranch_scc0 prep_go
    s_endpgm
prep_go:
    s_load_dwordx16 s[16:31], s[0:1], 0x0
    s_load_dwordx2 s[4:5], s[0:1], 0x50
    v_lshrrev_b32 v1, 6, v0
    v_and_b32 v2, 63, v0
    v_readfirstlane_b32 s3, v1
    v_lshlrev_b32 v3, 4, v2
    s_getpc_b64 s[34:35]
prep_pc:
    s_mov_b32 s6, 19009536
    s_mov_b32 s7, 0x20000
    s_add_u32 s12, s34, prep_table-prep_pc
    s_addc_u32 s13, s35, 0
    s_mov_b32 s14, 9472
    s_mov_b32 s15, 0x20000
    s_add_u32 s36, s34, main_kernel-prep_pc
    s_addc_u32 s37, s35, 0
    s_mov_b32 s38, main_end-main_kernel
    s_mov_b32 s39, 0x20000
    s_mov_b32 s32, 0x3f803f80
    s_lshl_b32 s33, s3, 13
    s_and_b32 s8, s2, 7
    s_lshl_b32 s8, s8, 1
    s_lshr_b32 s9, s2, 7
    s_add_u32 s8, s8, s9
    s_bfe_u32 s9, s2, 0x40003
    v_lshrrev_b32 v8, 3, v2
    v_and_b32 v9, 7, v2
    v_lshlrev_b32 v9, 4, v9
    v_lshrrev_b32 v10, 4, v2
    v_and_b32 v11, 15, v2
    s_waitcnt lgkmcnt(0)
    s_lshl_b32 s84, s9, 2
    s_add_u32 s84, s84, s3
    s_mul_i32 s80, s84, 205
    s_lshr_b32 s80, s80, 10
    s_mul_i32 s81, s80, 5
    s_sub_u32 s81, s84, s81
    s_add_u32 s82, s80, 2
    s_and_b32 s82, s82, 3
    s_add_u32 s84, s80, 4
    s_cmp_gt_u32 s80, 3
    s_cselect_b32 s84, s82, s84
    s_lshl_b32 s82, s8, 3
    s_add_u32 s84, s84, s82
    s_mul_i32 s84, s84, 20480
    s_lshl_b32 s82, s81, 8
    s_add_u32 s84, s84, s82
    s_mov_b32 s48, s16
    s_mov_b32 s49, s17
    s_cmp_gt_u32 s80, 7
    s_cselect_b32 s50, 0, 2621440
    s_mov_b32 s51, 0x20000
    v_mul_u32_u24 v12, 1280, v11
    v_lshl_add_u32 v12, v10, 4, v12
    buffer_load_dwordx4 v[40:43], v12, s[48:51], s84 offen offset:0 nt
    buffer_load_dwordx4 v[44:47], v12, s[48:51], s84 offen offset:64 nt
    buffer_load_dwordx4 v[48:51], v12, s[48:51], s84 offen offset:128 nt
    buffer_load_dwordx4 v[52:55], v12, s[48:51], s84 offen offset:192 nt
    s_and_b32 s84, s80, 3
    s_lshl_b32 s82, s8, 2
    s_add_u32 s84, s84, s82
    s_lshr_b32 s82, s80, 2
    s_lshl_b32 s82, s82, 6
    s_add_u32 s84, s84, s82
    s_mul_i32 s82, s84, 20480
    s_lshl_b32 s83, s84, 10
    s_add_u32 s82, s82, 7372800
    s_add_u32 s83, s83, 16285696
    s_lshl_b32 s84, s81, 12
    s_add_u32 s82, s82, s84
    s_add_u32 s67, s2, 0
    s_mov_b32 s56, 4
    s_mov_b32 s57, 0
    s_mov_b32 s58, 0
    s_mov_b32 s59, 0
    s_mov_b32 s60, 0
    s_mov_b32 s61, 0
    s_mov_b32 s62, 0
    s_mov_b32 s64, 0
    s_mov_b32 s65, 0
    s_mov_b32 s66, 0
    s_mov_b32 s63, -1
    s_mov_b32 s40, s18
    s_mov_b32 s41, s19
    s_mov_b32 s42, 0
    s_mov_b32 s43, 0x20000
    s_cmp_ge_u32 s67, 150
    s_cbranch_scc1 p0n_100002
    s_mov_b32 s56, 0
    s_sub_u32 s67, s67, 0
    s_mul_i32 s58, s67, 2185
    s_lshr_b32 s58, s58, 16
    s_mul_i32 s57, s58, 30
    s_sub_u32 s57, s67, s57
    s_mov_b32 s63, s58
    s_lshl_b32 s58, s58, 2
    s_add_u32 s58, s58, s3
    s_mov_b32 s59, 3840
    s_mov_b32 s60, 0
    s_mov_b32 s61, 512
    s_mov_b32 s40, s18
    s_mov_b32 s41, s19
    s_mov_b32 s42, 2457600
    s_mov_b32 s64, 8
    s_mov_b32 s65, 0
    s_mov_b32 s66, 4
    s_mul_i32 s62, s58, 2048
    s_branch p0d_100001
p0n_100002:
    s_cmp_ge_u32 s67, 200
    s_cbranch_scc1 p0n_100003
    s_mov_b32 s56, 2
    s_sub_u32 s67, s67, 150
    s_mul_i32 s58, s67, 6554
    s_lshr_b32 s58, s58, 16
    s_mul_i32 s57, s58, 10
    s_sub_u32 s57, s67, s57
    s_lshl_b32 s58, s58, 2
    s_add_u32 s58, s58, s3
    s_mov_b32 s59, 1280
    s_mov_b32 s60, 6912
    s_mov_b32 s61, 256
    s_mov_b32 s40, s20
    s_mov_b32 s41, s21
    s_mov_b32 s42, 819200
    s_mov_b32 s64, 4
    s_mov_b32 s65, 20
    s_mov_b32 s66, 20
    s_mul_i32 s62, s58, 5120
    s_branch p0d_100001
p0n_100003:
    s_cmp_ge_u32 s67, 320
    s_cbranch_scc1 p0n_100004
    s_mov_b32 s56, 1
    s_sub_u32 s67, s67, 200
    s_mul_i32 s58, s67, 2731
    s_lshr_b32 s58, s58, 16
    s_mul_i32 s57, s58, 24
    s_sub_u32 s57, s67, s57
    s_mov_b32 s63, s58
    s_lshl_b32 s58, s58, 2
    s_add_u32 s58, s58, s3
    s_mov_b32 s59, 3072
    s_mov_b32 s60, 3840
    s_mov_b32 s61, 256
    s_mov_b32 s40, s24
    s_mov_b32 s41, s25
    s_mov_b32 s42, 1966080
    s_mov_b32 s64, 8
    s_mov_b32 s65, 0
    s_mov_b32 s66, 4
    s_lshr_b32 s62, s58, 1
    s_mul_i32 s62, s62, 3072
    s_and_b32 s67, s58, 1
    s_mul_i32 s67, s67, 30720
    s_add_u32 s62, s62, s67
    s_branch p0d_100001
p0n_100004:
p0d_100001:
    v_and_b32 v12, 3, v8
    v_lshrrev_b32 v13, 2, v8
    v_mad_u32_u24 v12, v13, s66, v12
    v_mad_u32_u24 v12, v12, s59, v9
    s_lshl_b32 s10, s58, 2
    s_add_u32 s10, s10, 0
    s_mul_i32 s11, s10, 205
    s_lshr_b32 s11, s11, 10
    s_mul_i32 s11, s11, s65
    s_mul_i32 s10, s10, s64
    s_add_u32 s10, s10, s11
    s_mul_i32 s10, s10, s59
    s_lshl_b32 s11, s57, 7
    s_add_u32 s10, s10, s11
    s_add_u32 m0, s33, 0
    s_nop 0
    buffer_load_dwordx4 v12, s[40:43], s10 offen nt lds
    s_lshl_b32 s10, s58, 2
    s_add_u32 s10, s10, 1
    s_mul_i32 s11, s10, 205
    s_lshr_b32 s11, s11, 10
    s_mul_i32 s11, s11, s65
    s_mul_i32 s10, s10, s64
    s_add_u32 s10, s10, s11
    s_mul_i32 s10, s10, s59
    s_lshl_b32 s11, s57, 7
    s_add_u32 s10, s10, s11
    s_add_u32 m0, s33, 1024
    s_nop 0
    buffer_load_dwordx4 v12, s[40:43], s10 offen nt lds
    s_lshl_b32 s10, s58, 2
    s_add_u32 s10, s10, 2
    s_mul_i32 s11, s10, 205
    s_lshr_b32 s11, s11, 10
    s_mul_i32 s11, s11, s65
    s_mul_i32 s10, s10, s64
    s_add_u32 s10, s10, s11
    s_mul_i32 s10, s10, s59
    s_lshl_b32 s11, s57, 7
    s_add_u32 s10, s10, s11
    s_add_u32 m0, s33, 2048
    s_nop 0
    buffer_load_dwordx4 v12, s[40:43], s10 offen nt lds
    s_lshl_b32 s10, s58, 2
    s_add_u32 s10, s10, 3
    s_mul_i32 s11, s10, 205
    s_lshr_b32 s11, s11, 10
    s_mul_i32 s11, s11, s65
    s_mul_i32 s10, s10, s64
    s_add_u32 s10, s10, s11
    s_mul_i32 s10, s10, s59
    s_lshl_b32 s11, s57, 7
    s_add_u32 s10, s10, s11
    s_add_u32 m0, s33, 3072
    s_nop 0
    buffer_load_dwordx4 v12, s[40:43], s10 offen nt lds
    s_cmp_eq_u32 s56, 0
    s_cselect_b64 s[52:53], -1, 0
    v_and_b32 v12, 3, v11
    v_lshl_add_u32 v14, v10, 2, v12
    v_lshrrev_b32 v13, 1, v10
    v_lshlrev_b32 v13, 2, v13
    v_add_u32 v12, v12, v13
    v_and_b32 v13, 1, v10
    v_lshl_add_u32 v12, v12, 1, v13
    v_cndmask_b32 v14, v12, v14, s[52:53]
    v_lshrrev_b32 v12, 2, v11
    v_lshl_add_u32 v15, v10, 2, v12
    v_lshrrev_b32 v13, 1, v10
    v_lshlrev_b32 v13, 2, v13
    v_add_u32 v12, v12, v13
    v_and_b32 v13, 1, v10
    v_lshl_add_u32 v12, v12, 1, v13
    v_cndmask_b32 v15, v12, v15, s[52:53]
    s_lshl_b32 s10, s57, 7
    s_add_u32 s10, s10, s60
    v_lshlrev_b32 v12, 3, v15
    buffer_load_dwordx2 v[16:17], v12, s[12:15], s10 offen
    v_lshrrev_b32 v12, 2, v11
    v_lshlrev_b32 v12, 7, v12
    v_lshl_add_u32 v14, v14, 3, v12
    v_add_u32 v14, s33, v14
    s_lshr_b32 s10, s2, 3
    s_lshl_b32 s10, s10, 2
    s_add_u32 s10, s10, s3
    s_lshl_b32 s10, s10, 10
    buffer_load_dword v63, v3, s[36:39], s10 offen
    v_mov_b32 v62, 0
    v_lshlrev_b32 v61, 2, v0
    s_lshl_b32 s10, s2, 8
    s_add_u32 s10, s10, 18681856
    v_cmp_gt_u32 vcc, 64, v0
    s_nop 0
    s_and_saveexec_b64 s[54:55], vcc
    s_cbranch_execz prep_nz
    buffer_store_dword v62, v61, s[4:7], s10 offen
prep_nz:
    s_mov_b64 exec, s[54:55]
    s_add_u32 s79, s2, 256
    s_mov_b32 s68, 4
    s_mov_b32 s69, 0
    s_mov_b32 s70, 0
    s_mov_b32 s71, 0
    s_mov_b32 s72, 0
    s_mov_b32 s73, 0
    s_mov_b32 s74, 0
    s_mov_b32 s76, 0
    s_mov_b32 s77, 0
    s_mov_b32 s78, 0
    s_mov_b32 s75, -1
    s_mov_b32 s44, s18
    s_mov_b32 s45, s19
    s_mov_b32 s46, 0
    s_mov_b32 s47, 0x20000
    s_cmp_ge_u32 s79, 320
    s_cbranch_scc1 p0n_100006
    s_mov_b32 s68, 1
    s_sub_u32 s79, s79, 200
    s_mul_i32 s70, s79, 2731
    s_lshr_b32 s70, s70, 16
    s_mul_i32 s69, s70, 24
    s_sub_u32 s69, s79, s69
    s_mov_b32 s75, s70
    s_lshl_b32 s70, s70, 2
    s_add_u32 s70, s70, s3
    s_mov_b32 s71, 3072
    s_mov_b32 s72, 3840
    s_mov_b32 s73, 256
    s_mov_b32 s44, s24
    s_mov_b32 s45, s25
    s_mov_b32 s46, 1966080
    s_mov_b32 s76, 8
    s_mov_b32 s77, 0
    s_mov_b32 s78, 4
    s_lshr_b32 s74, s70, 1
    s_mul_i32 s74, s74, 3072
    s_and_b32 s79, s70, 1
    s_mul_i32 s79, s79, 30720
    s_add_u32 s74, s74, s79
    s_branch p0d_100005
p0n_100006:
    s_cmp_ge_u32 s79, 440
    s_cbranch_scc1 p0n_100007
    s_mov_b32 s68, 3
    s_sub_u32 s79, s79, 320
    s_mul_i32 s70, s79, 6554
    s_lshr_b32 s70, s70, 16
    s_mul_i32 s69, s70, 10
    s_sub_u32 s69, s79, s69
    s_lshl_b32 s70, s70, 2
    s_add_u32 s70, s70, s3
    s_mov_b32 s71, 1280
    s_mov_b32 s72, 8192
    s_mov_b32 s73, 256
    s_mov_b32 s44, s28
    s_mov_b32 s45, s29
    s_mov_b32 s46, 1966080
    s_mov_b32 s76, 8
    s_mov_b32 s77, 0
    s_mov_b32 s78, 4
    s_mul_i32 s74, s70, 5120
    s_branch p0d_100005
p0n_100007:
p0d_100005:
    v_and_b32 v12, 3, v8
    v_lshrrev_b32 v13, 2, v8
    v_mad_u32_u24 v12, v13, s78, v12
    v_mad_u32_u24 v12, v12, s71, v9
    s_lshl_b32 s10, s70, 2
    s_add_u32 s10, s10, 0
    s_mul_i32 s11, s10, 205
    s_lshr_b32 s11, s11, 10
    s_mul_i32 s11, s11, s77
    s_mul_i32 s10, s10, s76
    s_add_u32 s10, s10, s11
    s_mul_i32 s10, s10, s71
    s_lshl_b32 s11, s69, 7
    s_add_u32 s10, s10, s11
    s_add_u32 m0, s33, 4096
    s_nop 0
    buffer_load_dwordx4 v12, s[44:47], s10 offen nt lds
    s_lshl_b32 s10, s70, 2
    s_add_u32 s10, s10, 1
    s_mul_i32 s11, s10, 205
    s_lshr_b32 s11, s11, 10
    s_mul_i32 s11, s11, s77
    s_mul_i32 s10, s10, s76
    s_add_u32 s10, s10, s11
    s_mul_i32 s10, s10, s71
    s_lshl_b32 s11, s69, 7
    s_add_u32 s10, s10, s11
    s_add_u32 m0, s33, 5120
    s_nop 0
    buffer_load_dwordx4 v12, s[44:47], s10 offen nt lds
    s_lshl_b32 s10, s70, 2
    s_add_u32 s10, s10, 2
    s_mul_i32 s11, s10, 205
    s_lshr_b32 s11, s11, 10
    s_mul_i32 s11, s11, s77
    s_mul_i32 s10, s10, s76
    s_add_u32 s10, s10, s11
    s_mul_i32 s10, s10, s71
    s_lshl_b32 s11, s69, 7
    s_add_u32 s10, s10, s11
    s_add_u32 m0, s33, 6144
    s_nop 0
    buffer_load_dwordx4 v12, s[44:47], s10 offen nt lds
    s_lshl_b32 s10, s70, 2
    s_add_u32 s10, s10, 3
    s_mul_i32 s11, s10, 205
    s_lshr_b32 s11, s11, 10
    s_mul_i32 s11, s11, s77
    s_mul_i32 s10, s10, s76
    s_add_u32 s10, s10, s11
    s_mul_i32 s10, s10, s71
    s_lshl_b32 s11, s69, 7
    s_add_u32 s10, s10, s11
    s_add_u32 m0, s33, 7168
    s_nop 0
    buffer_load_dwordx4 v12, s[44:47], s10 offen nt lds
    s_cmp_eq_u32 s68, 0
    s_cselect_b64 s[52:53], -1, 0
    v_and_b32 v12, 3, v11
    v_lshl_add_u32 v18, v10, 2, v12
    v_lshrrev_b32 v13, 1, v10
    v_lshlrev_b32 v13, 2, v13
    v_add_u32 v12, v12, v13
    v_and_b32 v13, 1, v10
    v_lshl_add_u32 v12, v12, 1, v13
    v_cndmask_b32 v18, v12, v18, s[52:53]
    v_lshrrev_b32 v12, 2, v11
    v_lshl_add_u32 v19, v10, 2, v12
    v_lshrrev_b32 v13, 1, v10
    v_lshlrev_b32 v13, 2, v13
    v_add_u32 v12, v12, v13
    v_and_b32 v13, 1, v10
    v_lshl_add_u32 v12, v12, 1, v13
    v_cndmask_b32 v19, v12, v19, s[52:53]
    s_lshl_b32 s10, s69, 7
    s_add_u32 s10, s10, s72
    v_lshlrev_b32 v12, 3, v19
    buffer_load_dwordx2 v[20:21], v12, s[12:15], s10 offen
    v_lshrrev_b32 v12, 2, v11
    v_lshlrev_b32 v12, 7, v12
    v_lshl_add_u32 v18, v18, 3, v12
    v_add_u32 v18, s33, v18
    s_waitcnt vmcnt(11)
    s_cmp_gt_u32 s80, 7
    s_cbranch_scc1 p0x_100008
    buffer_store_dwordx4 v[40:43], v3, s[4:7], s82 offen offset:0
    buffer_store_dwordx4 v[44:47], v3, s[4:7], s82 offen offset:1024
    buffer_store_dwordx4 v[48:51], v3, s[4:7], s82 offen offset:2048
    buffer_store_dwordx4 v[52:55], v3, s[4:7], s82 offen offset:3072
    v_dot2_f32_bf16 v56, v40, s32, 0
    v_dot2_f32_bf16 v57, v40, v40, 0
    v_dot2_f32_bf16 v56, v41, s32, v56
    v_dot2_f32_bf16 v57, v41, v41, v57
    v_dot2_f32_bf16 v56, v42, s32, v56
    v_dot2_f32_bf16 v57, v42, v42, v57
    v_dot2_f32_bf16 v56, v43, s32, v56
    v_dot2_f32_bf16 v57, v43, v43, v57
    v_dot2_f32_bf16 v56, v44, s32, v56
    v_dot2_f32_bf16 v57, v44, v44, v57
    v_dot2_f32_bf16 v56, v45, s32, v56
    v_dot2_f32_bf16 v57, v45, v45, v57
    v_dot2_f32_bf16 v56, v46, s32, v56
    v_dot2_f32_bf16 v57, v46, v46, v57
    v_dot2_f32_bf16 v56, v47, s32, v56
    v_dot2_f32_bf16 v57, v47, v47, v57
    v_dot2_f32_bf16 v56, v48, s32, v56
    v_dot2_f32_bf16 v57, v48, v48, v57
    v_dot2_f32_bf16 v56, v49, s32, v56
    v_dot2_f32_bf16 v57, v49, v49, v57
    v_dot2_f32_bf16 v56, v50, s32, v56
    v_dot2_f32_bf16 v57, v50, v50, v57
    v_dot2_f32_bf16 v56, v51, s32, v56
    v_dot2_f32_bf16 v57, v51, v51, v57
    v_dot2_f32_bf16 v56, v52, s32, v56
    v_dot2_f32_bf16 v57, v52, v52, v57
    v_dot2_f32_bf16 v56, v53, s32, v56
    v_dot2_f32_bf16 v57, v53, v53, v57
    v_dot2_f32_bf16 v56, v54, s32, v56
    v_dot2_f32_bf16 v57, v54, v54, v57
    v_dot2_f32_bf16 v56, v55, s32, v56
    v_dot2_f32_bf16 v57, v55, v55, v57
    s_nop 2
    v_permlane16_swap_b32 v56, v57
    v_add_f32 v56, v56, v57
    v_mov_b32 v57, v56
    s_nop 1
    v_permlane32_swap_b32 v56, v57
    v_add_f32 v56, v56, v57
    s_min_u32 s84, s81, 2
    s_add_u32 s84, s84, 5
    v_mov_b32 v58, s81
    v_mov_b32 v59, s84
    v_cmp_gt_u32 vcc, 32, v2
    s_nop 1
    v_cndmask_b32 v58, v59, v58, vcc
    v_cndmask_b32 v56, 0, v56, vcc
    v_lshrrev_b32 v59, 1, v58
    v_lshlrev_b32 v59, 8, v59
    v_and_b32 v58, 1, v58
    v_lshl_add_u32 v59, v58, 3, v59
    v_lshl_add_u32 v59, v11, 4, v59
    v_and_b32 v58, 1, v10
    v_lshl_add_u32 v59, v58, 2, v59
    buffer_store_dword v56, v59, s[4:7], s83 offen
p0x_100008:
    s_waitcnt vmcnt(6)
    ds_read_b64_tr_b16 v[24:25], v14 offset:0
    ds_read_b64_tr_b16 v[26:27], v14 offset:512
    ds_read_b64_tr_b16 v[28:29], v14 offset:1024
    ds_read_b64_tr_b16 v[30:31], v14 offset:1536
    ds_read_b64_tr_b16 v[32:33], v14 offset:2048
    ds_read_b64_tr_b16 v[34:35], v14 offset:2560
    ds_read_b64_tr_b16 v[36:37], v14 offset:3072
    ds_read_b64_tr_b16 v[38:39], v14 offset:3584
    v_and_b32 v12, 3, v11
    v_lshl_add_u32 v16, v12, 4, v16
    v_lshl_add_u32 v17, v12, 2, v17
    v_lshl_add_u32 v15, v15, 2, v12
    s_waitcnt lgkmcnt(0)
    s_cmp_eq_u32 s56, 4
    s_cbranch_scc1 p0s_100009
    buffer_store_dwordx4 v[24:27], v16, s[4:7], s62 offen
    s_add_u32 s62, s62, s61
    buffer_store_dwordx4 v[28:31], v16, s[4:7], s62 offen
    s_add_u32 s62, s62, s61
    buffer_store_dwordx4 v[32:35], v16, s[4:7], s62 offen
    s_add_u32 s62, s62, s61
    buffer_store_dwordx4 v[36:39], v16, s[4:7], s62 offen
    s_and_b32 s67, s56, 1
    s_cmp_eq_u32 s58, 0
    s_cselect_b32 s67, s67, 0
    s_cmp_eq_u32 s67, 0
    s_cbranch_scc1 p0b_100010
    s_cmp_eq_u32 s56, 1
    s_cselect_b32 s40, s26, s30
    s_cselect_b32 s41, s27, s31
    s_cselect_b32 s67, 384, 0
    s_mov_b32 s42, 1280
    s_cselect_b32 s42, 3072, s42
    s_lshl_b32 s57, s57, 7
    v_lshlrev_b32 v12, 1, v15
    buffer_load_ushort v12, v12, s[40:43], s57 offen
    s_waitcnt vmcnt(0)
    v_lshlrev_b32 v12, 16, v12
    buffer_store_dword v12, v17, s[4:7], s67 offen
p0b_100010:
p0s_100009:
    v_dot2_f32_bf16 v12, v24, s32, 0
    v_dot2_f32_bf16 v12, v25, s32, v12
    v_dot2_f32_bf16 v12, v26, s32, v12
    v_dot2_f32_bf16 v12, v27, s32, v12
    v_dot2_f32_bf16 v12, v28, s32, v12
    v_dot2_f32_bf16 v12, v29, s32, v12
    v_dot2_f32_bf16 v12, v30, s32, v12
    v_dot2_f32_bf16 v12, v31, s32, v12
    v_dot2_f32_bf16 v12, v32, s32, v12
    v_dot2_f32_bf16 v12, v33, s32, v12
    v_dot2_f32_bf16 v12, v34, s32, v12
    v_dot2_f32_bf16 v12, v35, s32, v12
    v_dot2_f32_bf16 v12, v36, s32, v12
    v_dot2_f32_bf16 v12, v37, s32, v12
    v_dot2_f32_bf16 v12, v38, s32, v12
    v_dot2_f32_bf16 v12, v39, s32, v12
    v_lshlrev_b32 v13, 2, v0
    s_nop 1
    ds_write_b32 v13, v12 offset:32768
    s_waitcnt lgkmcnt(0)
    s_barrier
    s_cmp_lt_i32 s63, 0
    s_cbranch_scc1 p0c_100011
    s_cmp_lg_u32 s3, 0
    s_cbranch_scc1 p0c_100011
    ds_read_b32 v25, v13 offset:33024
    ds_read_b32 v26, v13 offset:33280
    ds_read_b32 v27, v13 offset:33536
    s_waitcnt lgkmcnt(0)
    v_add_f32 v12, v12, v25
    v_add_f32 v26, v26, v27
    v_add_f32 v12, v12, v26
    s_lshl_b32 s63, s63, 15
    buffer_store_dword v12, v17, s[4:7], s63 offen
p0c_100011:
    s_waitcnt vmcnt(0)
    ds_read_b64_tr_b16 v[24:25], v18 offset:4096
    ds_read_b64_tr_b16 v[26:27], v18 offset:4608
    ds_read_b64_tr_b16 v[28:29], v18 offset:5120
    ds_read_b64_tr_b16 v[30:31], v18 offset:5632
    ds_read_b64_tr_b16 v[32:33], v18 offset:6144
    ds_read_b64_tr_b16 v[34:35], v18 offset:6656
    ds_read_b64_tr_b16 v[36:37], v18 offset:7168
    ds_read_b64_tr_b16 v[38:39], v18 offset:7680
    v_and_b32 v12, 3, v11
    v_lshl_add_u32 v20, v12, 4, v20
    v_lshl_add_u32 v21, v12, 2, v21
    v_lshl_add_u32 v19, v19, 2, v12
    s_waitcnt lgkmcnt(0)
    s_cmp_eq_u32 s68, 4
    s_cbranch_scc1 p0s_100012
    buffer_store_dwordx4 v[24:27], v20, s[4:7], s74 offen
    s_add_u32 s74, s74, s73
    buffer_store_dwordx4 v[28:31], v20, s[4:7], s74 offen
    s_add_u32 s74, s74, s73
    buffer_store_dwordx4 v[32:35], v20, s[4:7], s74 offen
    s_add_u32 s74, s74, s73
    buffer_store_dwordx4 v[36:39], v20, s[4:7], s74 offen
    s_and_b32 s79, s68, 1
    s_cmp_eq_u32 s70, 0
    s_cselect_b32 s79, s79, 0
    s_cmp_eq_u32 s79, 0
    s_cbranch_scc1 p0b_100013
    s_cmp_eq_u32 s68, 1
    s_cselect_b32 s44, s26, s30
    s_cselect_b32 s45, s27, s31
    s_cselect_b32 s79, 384, 0
    s_mov_b32 s46, 1280
    s_cselect_b32 s46, 3072, s46
    s_lshl_b32 s69, s69, 7
    v_lshlrev_b32 v12, 1, v19
    buffer_load_ushort v12, v12, s[44:47], s69 offen
    s_waitcnt vmcnt(0)
    v_lshlrev_b32 v12, 16, v12
    buffer_store_dword v12, v21, s[4:7], s79 offen
p0b_100013:
p0s_100012:
    v_dot2_f32_bf16 v12, v24, s32, 0
    v_dot2_f32_bf16 v12, v25, s32, v12
    v_dot2_f32_bf16 v12, v26, s32, v12
    v_dot2_f32_bf16 v12, v27, s32, v12
    v_dot2_f32_bf16 v12, v28, s32, v12
    v_dot2_f32_bf16 v12, v29, s32, v12
    v_dot2_f32_bf16 v12, v30, s32, v12
    v_dot2_f32_bf16 v12, v31, s32, v12
    v_dot2_f32_bf16 v12, v32, s32, v12
    v_dot2_f32_bf16 v12, v33, s32, v12
    v_dot2_f32_bf16 v12, v34, s32, v12
    v_dot2_f32_bf16 v12, v35, s32, v12
    v_dot2_f32_bf16 v12, v36, s32, v12
    v_dot2_f32_bf16 v12, v37, s32, v12
    v_dot2_f32_bf16 v12, v38, s32, v12
    v_dot2_f32_bf16 v12, v39, s32, v12
    v_lshlrev_b32 v13, 2, v0
    s_nop 1
    ds_write_b32 v13, v12 offset:33792
    s_waitcnt lgkmcnt(0)
    s_barrier
    s_cmp_lt_i32 s75, 0
    s_cbranch_scc1 p0c_100014
    s_cmp_lg_u32 s3, 0
    s_cbranch_scc1 p0c_100014
    ds_read_b32 v25, v13 offset:34048
    ds_read_b32 v26, v13 offset:34304
    ds_read_b32 v27, v13 offset:34560
    s_waitcnt lgkmcnt(0)
    v_add_f32 v12, v12, v25
    v_add_f32 v26, v26, v27
    v_add_f32 v12, v12, v26
    s_lshl_b32 s75, s75, 15
    buffer_store_dword v12, v21, s[4:7], s75 offen
p0c_100014:
    s_endpgm
.p2align 3
.type prep_table,@object
prep_table:
    .long 0xa080, 0x11a80a0, 0xa0c0, 0x11a80b0, 0xa100, 0x11a80c0, 0xa140, 0x11a80d0
    .long 0xa180, 0x11a80e0, 0xa1c0, 0x11a80f0, 0x14000, 0x11a8100, 0x14040, 0x11a8110
    .long 0x14080, 0x11a8120, 0x140c0, 0x11a8130, 0x32080, 0x11a88a0, 0x320c0, 0x11a88b0
    .long 0x32100, 0x11a88c0, 0x32140, 0x11a88d0, 0x32180, 0x11a88e0, 0x321c0, 0x11a88f0
    .long 0x3c000, 0x11a8900, 0x3c040, 0x11a8910, 0x3c080, 0x11a8920, 0x3c0c0, 0x11a8930
    .long 0x5a080, 0x11a90a0, 0x5a0c0, 0x11a90b0, 0x5a100, 0x11a90c0, 0x5a140, 0x11a90d0
    .long 0x5a180, 0x11a90e0, 0x5a1c0, 0x11a90f0, 0x64000, 0x11a9100, 0x64040, 0x11a9110
    .long 0x64080, 0x11a9120, 0x640c0, 0x11a9130, 0x82080, 0x11a98a0, 0x820c0, 0x11a98b0
    .long 0x82100, 0x11a98c0, 0x82140, 0x11a98d0, 0x82180, 0x11a98e0, 0x821c0, 0x11a98f0
    .long 0x8c000, 0x11a9900, 0x8c040, 0x11a9910, 0x8c080, 0x11a9920, 0x8c0c0, 0x11a9930
    .long 0xaa080, 0x11aa0a0, 0xaa0c0, 0x11aa0b0, 0xaa100, 0x11aa0c0, 0xaa140, 0x11aa0d0
    .long 0xaa180, 0x11aa0e0, 0xaa1c0, 0x11aa0f0, 0xb4000, 0x11aa100, 0xb4040, 0x11aa110
    .long 0xb4080, 0x11aa120, 0xb40c0, 0x11aa130, 0xd2080, 0x11aa8a0, 0xd20c0, 0x11aa8b0
    .long 0xd2100, 0x11aa8c0, 0xd2140, 0x11aa8d0, 0xd2180, 0x11aa8e0, 0xd21c0, 0x11aa8f0
    .long 0xdc000, 0x11aa900, 0xdc040, 0x11aa910, 0xdc080, 0x11aa920, 0xdc0c0, 0x11aa930
    .long 0xfa080, 0x11ab0a0, 0xfa0c0, 0x11ab0b0, 0xfa100, 0x11ab0c0, 0xfa140, 0x11ab0d0
    .long 0xfa180, 0x11ab0e0, 0xfa1c0, 0x11ab0f0, 0x104000, 0x11ab100, 0x104040, 0x11ab110
    .long 0x104080, 0x11ab120, 0x1040c0, 0x11ab130, 0x122080, 0x11ab8a0, 0x1220c0, 0x11ab8b0
    .long 0x122100, 0x11ab8c0, 0x122140, 0x11ab8d0, 0x122180, 0x11ab8e0, 0x1221c0, 0x11ab8f0
    .long 0x12c000, 0x11ab900, 0x12c040, 0x11ab910, 0x12c080, 0x11ab920, 0x12c0c0, 0x11ab930
    .long 0x14a080, 0x11ac0a0, 0x14a0c0, 0x11ac0b0, 0x14a100, 0x11ac0c0, 0x14a140, 0x11ac0d0
    .long 0x14a180, 0x11ac0e0, 0x14a1c0, 0x11ac0f0, 0x154000, 0x11ac100, 0x154040, 0x11ac110
    .long 0x154080, 0x11ac120, 0x1540c0, 0x11ac130, 0x172080, 0x11ac8a0, 0x1720c0, 0x11ac8b0
    .long 0x172100, 0x11ac8c0, 0x172140, 0x11ac8d0, 0x172180, 0x11ac8e0, 0x1721c0, 0x11ac8f0
    .long 0x17c000, 0x11ac900, 0x17c040, 0x11ac910, 0x17c080, 0x11ac920, 0x17c0c0, 0x11ac930
    .long 0x19a080, 0x11ad0a0, 0x19a0c0, 0x11ad0b0, 0x19a100, 0x11ad0c0, 0x19a140, 0x11ad0d0
    .long 0x19a180, 0x11ad0e0, 0x19a1c0, 0x11ad0f0, 0x1a4000, 0x11ad100, 0x1a4040, 0x11ad110
    .long 0x1a4080, 0x11ad120, 0x1a40c0, 0x11ad130, 0x1c2080, 0x11ad8a0, 0x1c20c0, 0x11ad8b0
    .long 0x1c2100, 0x11ad8c0, 0x1c2140, 0x11ad8d0, 0x1c2180, 0x11ad8e0, 0x1c21c0, 0x11ad8f0
    .long 0x1cc000, 0x11ad900, 0x1cc040, 0x11ad910, 0x1cc080, 0x11ad920, 0x1cc0c0, 0x11ad930
    .long 0x1ea080, 0x11ae0a0, 0x1ea0c0, 0x11ae0b0, 0x1ea100, 0x11ae0c0, 0x1ea140, 0x11ae0d0
    .long 0x1ea180, 0x11ae0e0, 0x1ea1c0, 0x11ae0f0, 0x1f4000, 0x11ae100, 0x1f4040, 0x11ae110
    .long 0x1f4080, 0x11ae120, 0x1f40c0, 0x11ae130, 0x212080, 0x11ae8a0, 0x2120c0, 0x11ae8b0
    .long 0x212100, 0x11ae8c0, 0x212140, 0x11ae8d0, 0x212180, 0x11ae8e0, 0x2121c0, 0x11ae8f0
    .long 0x21c000, 0x11ae900, 0x21c040, 0x11ae910, 0x21c080, 0x11ae920, 0x21c0c0, 0x11ae930
    .long 0x23a080, 0x11af0a0, 0x23a0c0, 0x11af0b0, 0x23a100, 0x11af0c0, 0x23a140, 0x11af0d0
    .long 0x23a180, 0x11af0e0, 0x23a1c0, 0x11af0f0, 0x244000, 0x11af100, 0x244040, 0x11af110
    .long 0x244080, 0x11af120, 0x2440c0, 0x11af130, 0x262080, 0x11af8a0, 0x2620c0, 0x11af8b0
    .long 0x262100, 0x11af8c0, 0x262140, 0x11af8d0, 0x262180, 0x11af8e0, 0x2621c0, 0x11af8f0
    .long 0x26c000, 0x11af900, 0x26c040, 0x11af910, 0x26c080, 0x11af920, 0x26c0c0, 0x11af930
    .long 0x0, 0x11a8000, 0x40, 0x11a8010, 0x80, 0x11a8020, 0xc0, 0x11a8030
    .long 0x100, 0x11a8040, 0x140, 0x11a8050, 0x180, 0x11a8060, 0x1c0, 0x11a8070
    .long 0xa000, 0x11a8080, 0xa040, 0x11a8090, 0x28000, 0x11a8800, 0x28040, 0x11a8810
    .long 0x28080, 0x11a8820, 0x280c0, 0x11a8830, 0x28100, 0x11a8840, 0x28140, 0x11a8850
    .long 0x28180, 0x11a8860, 0x281c0, 0x11a8870, 0x32000, 0x11a8880, 0x32040, 0x11a8890
    .long 0x50000, 0x11a9000, 0x50040, 0x11a9010, 0x50080, 0x11a9020, 0x500c0, 0x11a9030
    .long 0x50100, 0x11a9040, 0x50140, 0x11a9050, 0x50180, 0x11a9060, 0x501c0, 0x11a9070
    .long 0x5a000, 0x11a9080, 0x5a040, 0x11a9090, 0x78000, 0x11a9800, 0x78040, 0x11a9810
    .long 0x78080, 0x11a9820, 0x780c0, 0x11a9830, 0x78100, 0x11a9840, 0x78140, 0x11a9850
    .long 0x78180, 0x11a9860, 0x781c0, 0x11a9870, 0x82000, 0x11a9880, 0x82040, 0x11a9890
    .long 0xa0000, 0x11aa000, 0xa0040, 0x11aa010, 0xa0080, 0x11aa020, 0xa00c0, 0x11aa030
    .long 0xa0100, 0x11aa040, 0xa0140, 0x11aa050, 0xa0180, 0x11aa060, 0xa01c0, 0x11aa070
    .long 0xaa000, 0x11aa080, 0xaa040, 0x11aa090, 0xc8000, 0x11aa800, 0xc8040, 0x11aa810
    .long 0xc8080, 0x11aa820, 0xc80c0, 0x11aa830, 0xc8100, 0x11aa840, 0xc8140, 0x11aa850
    .long 0xc8180, 0x11aa860, 0xc81c0, 0x11aa870, 0xd2000, 0x11aa880, 0xd2040, 0x11aa890
    .long 0xf0000, 0x11ab000, 0xf0040, 0x11ab010, 0xf0080, 0x11ab020, 0xf00c0, 0x11ab030
    .long 0xf0100, 0x11ab040, 0xf0140, 0x11ab050, 0xf0180, 0x11ab060, 0xf01c0, 0x11ab070
    .long 0xfa000, 0x11ab080, 0xfa040, 0x11ab090, 0x118000, 0x11ab800, 0x118040, 0x11ab810
    .long 0x118080, 0x11ab820, 0x1180c0, 0x11ab830, 0x118100, 0x11ab840, 0x118140, 0x11ab850
    .long 0x118180, 0x11ab860, 0x1181c0, 0x11ab870, 0x122000, 0x11ab880, 0x122040, 0x11ab890
    .long 0x140000, 0x11ac000, 0x140040, 0x11ac010, 0x140080, 0x11ac020, 0x1400c0, 0x11ac030
    .long 0x140100, 0x11ac040, 0x140140, 0x11ac050, 0x140180, 0x11ac060, 0x1401c0, 0x11ac070
    .long 0x14a000, 0x11ac080, 0x14a040, 0x11ac090, 0x168000, 0x11ac800, 0x168040, 0x11ac810
    .long 0x168080, 0x11ac820, 0x1680c0, 0x11ac830, 0x168100, 0x11ac840, 0x168140, 0x11ac850
    .long 0x168180, 0x11ac860, 0x1681c0, 0x11ac870, 0x172000, 0x11ac880, 0x172040, 0x11ac890
    .long 0x190000, 0x11ad000, 0x190040, 0x11ad010, 0x190080, 0x11ad020, 0x1900c0, 0x11ad030
    .long 0x190100, 0x11ad040, 0x190140, 0x11ad050, 0x190180, 0x11ad060, 0x1901c0, 0x11ad070
    .long 0x19a000, 0x11ad080, 0x19a040, 0x11ad090, 0x1b8000, 0x11ad800, 0x1b8040, 0x11ad810
    .long 0x1b8080, 0x11ad820, 0x1b80c0, 0x11ad830, 0x1b8100, 0x11ad840, 0x1b8140, 0x11ad850
    .long 0x1b8180, 0x11ad860, 0x1b81c0, 0x11ad870, 0x1c2000, 0x11ad880, 0x1c2040, 0x11ad890
    .long 0x1e0000, 0x11ae000, 0x1e0040, 0x11ae010, 0x1e0080, 0x11ae020, 0x1e00c0, 0x11ae030
    .long 0x1e0100, 0x11ae040, 0x1e0140, 0x11ae050, 0x1e0180, 0x11ae060, 0x1e01c0, 0x11ae070
    .long 0x1ea000, 0x11ae080, 0x1ea040, 0x11ae090, 0x208000, 0x11ae800, 0x208040, 0x11ae810
    .long 0x208080, 0x11ae820, 0x2080c0, 0x11ae830, 0x208100, 0x11ae840, 0x208140, 0x11ae850
    .long 0x208180, 0x11ae860, 0x2081c0, 0x11ae870, 0x212000, 0x11ae880, 0x212040, 0x11ae890
    .long 0x230000, 0x11af000, 0x230040, 0x11af010, 0x230080, 0x11af020, 0x2300c0, 0x11af030
    .long 0x230100, 0x11af040, 0x230140, 0x11af050, 0x230180, 0x11af060, 0x2301c0, 0x11af070
    .long 0x23a000, 0x11af080, 0x23a040, 0x11af090, 0x258000, 0x11af800, 0x258040, 0x11af810
    .long 0x258080, 0x11af820, 0x2580c0, 0x11af830, 0x258100, 0x11af840, 0x258140, 0x11af850
    .long 0x258180, 0x11af860, 0x2581c0, 0x11af870, 0x262000, 0x11af880, 0x262040, 0x11af890
    .long 0x14100, 0x11a8140, 0x14140, 0x11a8150, 0x14180, 0x11a8160, 0x141c0, 0x11a8170
    .long 0x1e000, 0x11a8180, 0x1e040, 0x11a8190, 0x1e080, 0x11a81a0, 0x1e0c0, 0x11a81b0
    .long 0x1e100, 0x11a81c0, 0x1e140, 0x11a81d0, 0x3c100, 0x11a8940, 0x3c140, 0x11a8950
    .long 0x3c180, 0x11a8960, 0x3c1c0, 0x11a8970, 0x46000, 0x11a8980, 0x46040, 0x11a8990
    .long 0x46080, 0x11a89a0, 0x460c0, 0x11a89b0, 0x46100, 0x11a89c0, 0x46140, 0x11a89d0
    .long 0x64100, 0x11a9140, 0x64140, 0x11a9150, 0x64180, 0x11a9160, 0x641c0, 0x11a9170
    .long 0x6e000, 0x11a9180, 0x6e040, 0x11a9190, 0x6e080, 0x11a91a0, 0x6e0c0, 0x11a91b0
    .long 0x6e100, 0x11a91c0, 0x6e140, 0x11a91d0, 0x8c100, 0x11a9940, 0x8c140, 0x11a9950
    .long 0x8c180, 0x11a9960, 0x8c1c0, 0x11a9970, 0x96000, 0x11a9980, 0x96040, 0x11a9990
    .long 0x96080, 0x11a99a0, 0x960c0, 0x11a99b0, 0x96100, 0x11a99c0, 0x96140, 0x11a99d0
    .long 0xb4100, 0x11aa140, 0xb4140, 0x11aa150, 0xb4180, 0x11aa160, 0xb41c0, 0x11aa170
    .long 0xbe000, 0x11aa180, 0xbe040, 0x11aa190, 0xbe080, 0x11aa1a0, 0xbe0c0, 0x11aa1b0
    .long 0xbe100, 0x11aa1c0, 0xbe140, 0x11aa1d0, 0xdc100, 0x11aa940, 0xdc140, 0x11aa950
    .long 0xdc180, 0x11aa960, 0xdc1c0, 0x11aa970, 0xe6000, 0x11aa980, 0xe6040, 0x11aa990
    .long 0xe6080, 0x11aa9a0, 0xe60c0, 0x11aa9b0, 0xe6100, 0x11aa9c0, 0xe6140, 0x11aa9d0
    .long 0x104100, 0x11ab140, 0x104140, 0x11ab150, 0x104180, 0x11ab160, 0x1041c0, 0x11ab170
    .long 0x10e000, 0x11ab180, 0x10e040, 0x11ab190, 0x10e080, 0x11ab1a0, 0x10e0c0, 0x11ab1b0
    .long 0x10e100, 0x11ab1c0, 0x10e140, 0x11ab1d0, 0x12c100, 0x11ab940, 0x12c140, 0x11ab950
    .long 0x12c180, 0x11ab960, 0x12c1c0, 0x11ab970, 0x136000, 0x11ab980, 0x136040, 0x11ab990
    .long 0x136080, 0x11ab9a0, 0x1360c0, 0x11ab9b0, 0x136100, 0x11ab9c0, 0x136140, 0x11ab9d0
    .long 0x154100, 0x11ac140, 0x154140, 0x11ac150, 0x154180, 0x11ac160, 0x1541c0, 0x11ac170
    .long 0x15e000, 0x11ac180, 0x15e040, 0x11ac190, 0x15e080, 0x11ac1a0, 0x15e0c0, 0x11ac1b0
    .long 0x15e100, 0x11ac1c0, 0x15e140, 0x11ac1d0, 0x17c100, 0x11ac940, 0x17c140, 0x11ac950
    .long 0x17c180, 0x11ac960, 0x17c1c0, 0x11ac970, 0x186000, 0x11ac980, 0x186040, 0x11ac990
    .long 0x186080, 0x11ac9a0, 0x1860c0, 0x11ac9b0, 0x186100, 0x11ac9c0, 0x186140, 0x11ac9d0
    .long 0x1a4100, 0x11ad140, 0x1a4140, 0x11ad150, 0x1a4180, 0x11ad160, 0x1a41c0, 0x11ad170
    .long 0x1ae000, 0x11ad180, 0x1ae040, 0x11ad190, 0x1ae080, 0x11ad1a0, 0x1ae0c0, 0x11ad1b0
    .long 0x1ae100, 0x11ad1c0, 0x1ae140, 0x11ad1d0, 0x1cc100, 0x11ad940, 0x1cc140, 0x11ad950
    .long 0x1cc180, 0x11ad960, 0x1cc1c0, 0x11ad970, 0x1d6000, 0x11ad980, 0x1d6040, 0x11ad990
    .long 0x1d6080, 0x11ad9a0, 0x1d60c0, 0x11ad9b0, 0x1d6100, 0x11ad9c0, 0x1d6140, 0x11ad9d0
    .long 0x1f4100, 0x11ae140, 0x1f4140, 0x11ae150, 0x1f4180, 0x11ae160, 0x1f41c0, 0x11ae170
    .long 0x1fe000, 0x11ae180, 0x1fe040, 0x11ae190, 0x1fe080, 0x11ae1a0, 0x1fe0c0, 0x11ae1b0
    .long 0x1fe100, 0x11ae1c0, 0x1fe140, 0x11ae1d0, 0x21c100, 0x11ae940, 0x21c140, 0x11ae950
    .long 0x21c180, 0x11ae960, 0x21c1c0, 0x11ae970, 0x226000, 0x11ae980, 0x226040, 0x11ae990
    .long 0x226080, 0x11ae9a0, 0x2260c0, 0x11ae9b0, 0x226100, 0x11ae9c0, 0x226140, 0x11ae9d0
    .long 0x244100, 0x11af140, 0x244140, 0x11af150, 0x244180, 0x11af160, 0x2441c0, 0x11af170
    .long 0x24e000, 0x11af180, 0x24e040, 0x11af190, 0x24e080, 0x11af1a0, 0x24e0c0, 0x11af1b0
    .long 0x24e100, 0x11af1c0, 0x24e140, 0x11af1d0, 0x26c100, 0x11af940, 0x26c140, 0x11af950
    .long 0x26c180, 0x11af960, 0x26c1c0, 0x11af970, 0x276000, 0x11af980, 0x276040, 0x11af990
    .long 0x276080, 0x11af9a0, 0x2760c0, 0x11af9b0, 0x276100, 0x11af9c0, 0x276140, 0x11af9d0
    .long 0x348000, 0x11a81e0, 0x348400, 0x11a8220, 0x348040, 0x11a81f0, 0x348440, 0x11a8230
    .long 0x348080, 0x11a8200, 0x348480, 0x11a8240, 0x3480c0, 0x11a8210, 0x3484c0, 0x11a8250
    .long 0x348800, 0x11a8260, 0x357800, 0x11a8320, 0x348840, 0x11a8270, 0x357840, 0x11a8330
    .long 0x348880, 0x11a8280, 0x357880, 0x11a8340, 0x3488c0, 0x11a8290, 0x3578c0, 0x11a8350
    .long 0x357000, 0x11a82a0, 0x357400, 0x11a82e0, 0x357040, 0x11a82b0, 0x357440, 0x11a82f0
    .long 0x357080, 0x11a82c0, 0x357480, 0x11a8300, 0x3570c0, 0x11a82d0, 0x3574c0, 0x11a8310
    .long 0x366000, 0x11a89e0, 0x366400, 0x11a8a20, 0x366040, 0x11a89f0, 0x366440, 0x11a8a30
    .long 0x366080, 0x11a8a00, 0x366480, 0x11a8a40, 0x3660c0, 0x11a8a10, 0x3664c0, 0x11a8a50
    .long 0x366800, 0x11a8a60, 0x375800, 0x11a8b20, 0x366840, 0x11a8a70, 0x375840, 0x11a8b30
    .long 0x366880, 0x11a8a80, 0x375880, 0x11a8b40, 0x3668c0, 0x11a8a90, 0x3758c0, 0x11a8b50
    .long 0x375000, 0x11a8aa0, 0x375400, 0x11a8ae0, 0x375040, 0x11a8ab0, 0x375440, 0x11a8af0
    .long 0x375080, 0x11a8ac0, 0x375480, 0x11a8b00, 0x3750c0, 0x11a8ad0, 0x3754c0, 0x11a8b10
    .long 0x384000, 0x11a91e0, 0x384400, 0x11a9220, 0x384040, 0x11a91f0, 0x384440, 0x11a9230
    .long 0x384080, 0x11a9200, 0x384480, 0x11a9240, 0x3840c0, 0x11a9210, 0x3844c0, 0x11a9250
    .long 0x384800, 0x11a9260, 0x393800, 0x11a9320, 0x384840, 0x11a9270, 0x393840, 0x11a9330
    .long 0x384880, 0x11a9280, 0x393880, 0x11a9340, 0x3848c0, 0x11a9290, 0x3938c0, 0x11a9350
    .long 0x393000, 0x11a92a0, 0x393400, 0x11a92e0, 0x393040, 0x11a92b0, 0x393440, 0x11a92f0
    .long 0x393080, 0x11a92c0, 0x393480, 0x11a9300, 0x3930c0, 0x11a92d0, 0x3934c0, 0x11a9310
    .long 0x3a2000, 0x11a99e0, 0x3a2400, 0x11a9a20, 0x3a2040, 0x11a99f0, 0x3a2440, 0x11a9a30
    .long 0x3a2080, 0x11a9a00, 0x3a2480, 0x11a9a40, 0x3a20c0, 0x11a9a10, 0x3a24c0, 0x11a9a50
    .long 0x3a2800, 0x11a9a60, 0x3b1800, 0x11a9b20, 0x3a2840, 0x11a9a70, 0x3b1840, 0x11a9b30
    .long 0x3a2880, 0x11a9a80, 0x3b1880, 0x11a9b40, 0x3a28c0, 0x11a9a90, 0x3b18c0, 0x11a9b50
    .long 0x3b1000, 0x11a9aa0, 0x3b1400, 0x11a9ae0, 0x3b1040, 0x11a9ab0, 0x3b1440, 0x11a9af0
    .long 0x3b1080, 0x11a9ac0, 0x3b1480, 0x11a9b00, 0x3b10c0, 0x11a9ad0, 0x3b14c0, 0x11a9b10
    .long 0x3c0000, 0x11aa1e0, 0x3c0400, 0x11aa220, 0x3c0040, 0x11aa1f0, 0x3c0440, 0x11aa230
    .long 0x3c0080, 0x11aa200, 0x3c0480, 0x11aa240, 0x3c00c0, 0x11aa210, 0x3c04c0, 0x11aa250
    .long 0x3c0800, 0x11aa260, 0x3cf800, 0x11aa320, 0x3c0840, 0x11aa270, 0x3cf840, 0x11aa330
    .long 0x3c0880, 0x11aa280, 0x3cf880, 0x11aa340, 0x3c08c0, 0x11aa290, 0x3cf8c0, 0x11aa350
    .long 0x3cf000, 0x11aa2a0, 0x3cf400, 0x11aa2e0, 0x3cf040, 0x11aa2b0, 0x3cf440, 0x11aa2f0
    .long 0x3cf080, 0x11aa2c0, 0x3cf480, 0x11aa300, 0x3cf0c0, 0x11aa2d0, 0x3cf4c0, 0x11aa310
    .long 0x3de000, 0x11aa9e0, 0x3de400, 0x11aaa20, 0x3de040, 0x11aa9f0, 0x3de440, 0x11aaa30
    .long 0x3de080, 0x11aaa00, 0x3de480, 0x11aaa40, 0x3de0c0, 0x11aaa10, 0x3de4c0, 0x11aaa50
    .long 0x3de800, 0x11aaa60, 0x3ed800, 0x11aab20, 0x3de840, 0x11aaa70, 0x3ed840, 0x11aab30
    .long 0x3de880, 0x11aaa80, 0x3ed880, 0x11aab40, 0x3de8c0, 0x11aaa90, 0x3ed8c0, 0x11aab50
    .long 0x3ed000, 0x11aaaa0, 0x3ed400, 0x11aaae0, 0x3ed040, 0x11aaab0, 0x3ed440, 0x11aaaf0
    .long 0x3ed080, 0x11aaac0, 0x3ed480, 0x11aab00, 0x3ed0c0, 0x11aaad0, 0x3ed4c0, 0x11aab10
    .long 0x3fc000, 0x11ab1e0, 0x3fc400, 0x11ab220, 0x3fc040, 0x11ab1f0, 0x3fc440, 0x11ab230
    .long 0x3fc080, 0x11ab200, 0x3fc480, 0x11ab240, 0x3fc0c0, 0x11ab210, 0x3fc4c0, 0x11ab250
    .long 0x3fc800, 0x11ab260, 0x40b800, 0x11ab320, 0x3fc840, 0x11ab270, 0x40b840, 0x11ab330
    .long 0x3fc880, 0x11ab280, 0x40b880, 0x11ab340, 0x3fc8c0, 0x11ab290, 0x40b8c0, 0x11ab350
    .long 0x40b000, 0x11ab2a0, 0x40b400, 0x11ab2e0, 0x40b040, 0x11ab2b0, 0x40b440, 0x11ab2f0
    .long 0x40b080, 0x11ab2c0, 0x40b480, 0x11ab300, 0x40b0c0, 0x11ab2d0, 0x40b4c0, 0x11ab310
    .long 0x41a000, 0x11ab9e0, 0x41a400, 0x11aba20, 0x41a040, 0x11ab9f0, 0x41a440, 0x11aba30
    .long 0x41a080, 0x11aba00, 0x41a480, 0x11aba40, 0x41a0c0, 0x11aba10, 0x41a4c0, 0x11aba50
    .long 0x41a800, 0x11aba60, 0x429800, 0x11abb20, 0x41a840, 0x11aba70, 0x429840, 0x11abb30
    .long 0x41a880, 0x11aba80, 0x429880, 0x11abb40, 0x41a8c0, 0x11aba90, 0x4298c0, 0x11abb50
    .long 0x429000, 0x11abaa0, 0x429400, 0x11abae0, 0x429040, 0x11abab0, 0x429440, 0x11abaf0
    .long 0x429080, 0x11abac0, 0x429480, 0x11abb00, 0x4290c0, 0x11abad0, 0x4294c0, 0x11abb10
    .long 0x438000, 0x11ac1e0, 0x438400, 0x11ac220, 0x438040, 0x11ac1f0, 0x438440, 0x11ac230
    .long 0x438080, 0x11ac200, 0x438480, 0x11ac240, 0x4380c0, 0x11ac210, 0x4384c0, 0x11ac250
    .long 0x438800, 0x11ac260, 0x447800, 0x11ac320, 0x438840, 0x11ac270, 0x447840, 0x11ac330
    .long 0x438880, 0x11ac280, 0x447880, 0x11ac340, 0x4388c0, 0x11ac290, 0x4478c0, 0x11ac350
    .long 0x447000, 0x11ac2a0, 0x447400, 0x11ac2e0, 0x447040, 0x11ac2b0, 0x447440, 0x11ac2f0
    .long 0x447080, 0x11ac2c0, 0x447480, 0x11ac300, 0x4470c0, 0x11ac2d0, 0x4474c0, 0x11ac310
    .long 0x456000, 0x11ac9e0, 0x456400, 0x11aca20, 0x456040, 0x11ac9f0, 0x456440, 0x11aca30
    .long 0x456080, 0x11aca00, 0x456480, 0x11aca40, 0x4560c0, 0x11aca10, 0x4564c0, 0x11aca50
    .long 0x456800, 0x11aca60, 0x465800, 0x11acb20, 0x456840, 0x11aca70, 0x465840, 0x11acb30
    .long 0x456880, 0x11aca80, 0x465880, 0x11acb40, 0x4568c0, 0x11aca90, 0x4658c0, 0x11acb50
    .long 0x465000, 0x11acaa0, 0x465400, 0x11acae0, 0x465040, 0x11acab0, 0x465440, 0x11acaf0
    .long 0x465080, 0x11acac0, 0x465480, 0x11acb00, 0x4650c0, 0x11acad0, 0x4654c0, 0x11acb10
    .long 0x474000, 0x11ad1e0, 0x474400, 0x11ad220, 0x474040, 0x11ad1f0, 0x474440, 0x11ad230
    .long 0x474080, 0x11ad200, 0x474480, 0x11ad240, 0x4740c0, 0x11ad210, 0x4744c0, 0x11ad250
    .long 0x474800, 0x11ad260, 0x483800, 0x11ad320, 0x474840, 0x11ad270, 0x483840, 0x11ad330
    .long 0x474880, 0x11ad280, 0x483880, 0x11ad340, 0x4748c0, 0x11ad290, 0x4838c0, 0x11ad350
    .long 0x483000, 0x11ad2a0, 0x483400, 0x11ad2e0, 0x483040, 0x11ad2b0, 0x483440, 0x11ad2f0
    .long 0x483080, 0x11ad2c0, 0x483480, 0x11ad300, 0x4830c0, 0x11ad2d0, 0x4834c0, 0x11ad310
    .long 0x492000, 0x11ad9e0, 0x492400, 0x11ada20, 0x492040, 0x11ad9f0, 0x492440, 0x11ada30
    .long 0x492080, 0x11ada00, 0x492480, 0x11ada40, 0x4920c0, 0x11ada10, 0x4924c0, 0x11ada50
    .long 0x492800, 0x11ada60, 0x4a1800, 0x11adb20, 0x492840, 0x11ada70, 0x4a1840, 0x11adb30
    .long 0x492880, 0x11ada80, 0x4a1880, 0x11adb40, 0x4928c0, 0x11ada90, 0x4a18c0, 0x11adb50
    .long 0x4a1000, 0x11adaa0, 0x4a1400, 0x11adae0, 0x4a1040, 0x11adab0, 0x4a1440, 0x11adaf0
    .long 0x4a1080, 0x11adac0, 0x4a1480, 0x11adb00, 0x4a10c0, 0x11adad0, 0x4a14c0, 0x11adb10
    .long 0x4b0000, 0x11ae1e0, 0x4b0400, 0x11ae220, 0x4b0040, 0x11ae1f0, 0x4b0440, 0x11ae230
    .long 0x4b0080, 0x11ae200, 0x4b0480, 0x11ae240, 0x4b00c0, 0x11ae210, 0x4b04c0, 0x11ae250
    .long 0x4b0800, 0x11ae260, 0x4bf800, 0x11ae320, 0x4b0840, 0x11ae270, 0x4bf840, 0x11ae330
    .long 0x4b0880, 0x11ae280, 0x4bf880, 0x11ae340, 0x4b08c0, 0x11ae290, 0x4bf8c0, 0x11ae350
    .long 0x4bf000, 0x11ae2a0, 0x4bf400, 0x11ae2e0, 0x4bf040, 0x11ae2b0, 0x4bf440, 0x11ae2f0
    .long 0x4bf080, 0x11ae2c0, 0x4bf480, 0x11ae300, 0x4bf0c0, 0x11ae2d0, 0x4bf4c0, 0x11ae310
    .long 0x4ce000, 0x11ae9e0, 0x4ce400, 0x11aea20, 0x4ce040, 0x11ae9f0, 0x4ce440, 0x11aea30
    .long 0x4ce080, 0x11aea00, 0x4ce480, 0x11aea40, 0x4ce0c0, 0x11aea10, 0x4ce4c0, 0x11aea50
    .long 0x4ce800, 0x11aea60, 0x4dd800, 0x11aeb20, 0x4ce840, 0x11aea70, 0x4dd840, 0x11aeb30
    .long 0x4ce880, 0x11aea80, 0x4dd880, 0x11aeb40, 0x4ce8c0, 0x11aea90, 0x4dd8c0, 0x11aeb50
    .long 0x4dd000, 0x11aeaa0, 0x4dd400, 0x11aeae0, 0x4dd040, 0x11aeab0, 0x4dd440, 0x11aeaf0
    .long 0x4dd080, 0x11aeac0, 0x4dd480, 0x11aeb00, 0x4dd0c0, 0x11aead0, 0x4dd4c0, 0x11aeb10
    .long 0x4ec000, 0x11af1e0, 0x4ec400, 0x11af220, 0x4ec040, 0x11af1f0, 0x4ec440, 0x11af230
    .long 0x4ec080, 0x11af200, 0x4ec480, 0x11af240, 0x4ec0c0, 0x11af210, 0x4ec4c0, 0x11af250
    .long 0x4ec800, 0x11af260, 0x4fb800, 0x11af320, 0x4ec840, 0x11af270, 0x4fb840, 0x11af330
    .long 0x4ec880, 0x11af280, 0x4fb880, 0x11af340, 0x4ec8c0, 0x11af290, 0x4fb8c0, 0x11af350
    .long 0x4fb000, 0x11af2a0, 0x4fb400, 0x11af2e0, 0x4fb040, 0x11af2b0, 0x4fb440, 0x11af2f0
    .long 0x4fb080, 0x11af2c0, 0x4fb480, 0x11af300, 0x4fb0c0, 0x11af2d0, 0x4fb4c0, 0x11af310
    .long 0x50a000, 0x11af9e0, 0x50a400, 0x11afa20, 0x50a040, 0x11af9f0, 0x50a440, 0x11afa30
    .long 0x50a080, 0x11afa00, 0x50a480, 0x11afa40, 0x50a0c0, 0x11afa10, 0x50a4c0, 0x11afa50
    .long 0x50a800, 0x11afa60, 0x519800, 0x11afb20, 0x50a840, 0x11afa70, 0x519840, 0x11afb30
    .long 0x50a880, 0x11afa80, 0x519880, 0x11afb40, 0x50a8c0, 0x11afa90, 0x5198c0, 0x11afb50
    .long 0x519000, 0x11afaa0, 0x519400, 0x11afae0, 0x519040, 0x11afab0, 0x519440, 0x11afaf0
    .long 0x519080, 0x11afac0, 0x519480, 0x11afb00, 0x5190c0, 0x11afad0, 0x5194c0, 0x11afb10
    .long 0x280000, 0x0, 0x280400, 0x0, 0x280040, 0x0, 0x280440, 0x0
    .long 0x280080, 0x0, 0x280480, 0x0, 0x2800c0, 0x0, 0x2804c0, 0x0
    .long 0x280800, 0x0, 0x280c00, 0x0, 0x280840, 0x0, 0x280c40, 0x0
    .long 0x280880, 0x0, 0x280c80, 0x0, 0x2808c0, 0x0, 0x280cc0, 0x0
    .long 0x281000, 0x0, 0x29a000, 0x0, 0x281040, 0x0, 0x29a040, 0x0
    .long 0x281080, 0x0, 0x29a080, 0x0, 0x2810c0, 0x0, 0x29a0c0, 0x0
    .long 0x299000, 0x0, 0x299400, 0x0, 0x299040, 0x0, 0x299440, 0x0
    .long 0x299080, 0x0, 0x299480, 0x0, 0x2990c0, 0x0, 0x2994c0, 0x0
    .long 0x299800, 0x0, 0x299c00, 0x0, 0x299840, 0x0, 0x299c40, 0x0
    .long 0x299880, 0x0, 0x299c80, 0x0, 0x2998c0, 0x0, 0x299cc0, 0x0
    .long 0x2b2000, 0x0, 0x2b2400, 0x0, 0x2b2040, 0x0, 0x2b2440, 0x0
    .long 0x2b2080, 0x0, 0x2b2480, 0x0, 0x2b20c0, 0x0, 0x2b24c0, 0x0
    .long 0x2b2800, 0x0, 0x2b2c00, 0x0, 0x2b2840, 0x0, 0x2b2c40, 0x0
    .long 0x2b2880, 0x0, 0x2b2c80, 0x0, 0x2b28c0, 0x0, 0x2b2cc0, 0x0
    .long 0x2b3000, 0x0, 0x2cc000, 0x0, 0x2b3040, 0x0, 0x2cc040, 0x0
    .long 0x2b3080, 0x0, 0x2cc080, 0x0, 0x2b30c0, 0x0, 0x2cc0c0, 0x0
    .long 0x2cb000, 0x0, 0x2cb400, 0x0, 0x2cb040, 0x0, 0x2cb440, 0x0
    .long 0x2cb080, 0x0, 0x2cb480, 0x0, 0x2cb0c0, 0x0, 0x2cb4c0, 0x0
    .long 0x2cb800, 0x0, 0x2cbc00, 0x0, 0x2cb840, 0x0, 0x2cbc40, 0x0
    .long 0x2cb880, 0x0, 0x2cbc80, 0x0, 0x2cb8c0, 0x0, 0x2cbcc0, 0x0
    .long 0x2e4000, 0x0, 0x2e4400, 0x0, 0x2e4040, 0x0, 0x2e4440, 0x0
    .long 0x2e4080, 0x0, 0x2e4480, 0x0, 0x2e40c0, 0x0, 0x2e44c0, 0x0
    .long 0x2e4800, 0x0, 0x2e4c00, 0x0, 0x2e4840, 0x0, 0x2e4c40, 0x0
    .long 0x2e4880, 0x0, 0x2e4c80, 0x0, 0x2e48c0, 0x0, 0x2e4cc0, 0x0
    .long 0x2e5000, 0x0, 0x2fe000, 0x0, 0x2e5040, 0x0, 0x2fe040, 0x0
    .long 0x2e5080, 0x0, 0x2fe080, 0x0, 0x2e50c0, 0x0, 0x2fe0c0, 0x0
    .long 0x2fd000, 0x0, 0x2fd400, 0x0, 0x2fd040, 0x0, 0x2fd440, 0x0
    .long 0x2fd080, 0x0, 0x2fd480, 0x0, 0x2fd0c0, 0x0, 0x2fd4c0, 0x0
    .long 0x2fd800, 0x0, 0x2fdc00, 0x0, 0x2fd840, 0x0, 0x2fdc40, 0x0
    .long 0x2fd880, 0x0, 0x2fdc80, 0x0, 0x2fd8c0, 0x0, 0x2fdcc0, 0x0
    .long 0x316000, 0x0, 0x316400, 0x0, 0x316040, 0x0, 0x316440, 0x0
    .long 0x316080, 0x0, 0x316480, 0x0, 0x3160c0, 0x0, 0x3164c0, 0x0
    .long 0x316800, 0x0, 0x316c00, 0x0, 0x316840, 0x0, 0x316c40, 0x0
    .long 0x316880, 0x0, 0x316c80, 0x0, 0x3168c0, 0x0, 0x316cc0, 0x0
    .long 0x317000, 0x0, 0x330000, 0x0, 0x317040, 0x0, 0x330040, 0x0
    .long 0x317080, 0x0, 0x330080, 0x0, 0x3170c0, 0x0, 0x3300c0, 0x0
    .long 0x32f000, 0x0, 0x32f400, 0x0, 0x32f040, 0x0, 0x32f440, 0x0
    .long 0x32f080, 0x0, 0x32f480, 0x0, 0x32f0c0, 0x0, 0x32f4c0, 0x0
    .long 0x32f800, 0x0, 0x32fc00, 0x0, 0x32f840, 0x0, 0x32fc40, 0x0
    .long 0x32f880, 0x0, 0x32fc80, 0x0, 0x32f8c0, 0x0, 0x32fcc0, 0x0
    .long 0x528000, 0x11d0000, 0x528400, 0x11d0040, 0x528040, 0x11d0010, 0x528440, 0x11d0050
    .long 0x528080, 0x11d0020, 0x528480, 0x11d0060, 0x5280c0, 0x11d0030, 0x5284c0, 0x11d0070
    .long 0x528800, 0x11d0080, 0x528c00, 0x11d00c0, 0x528840, 0x11d0090, 0x528c40, 0x11d00d0
    .long 0x528880, 0x11d00a0, 0x528c80, 0x11d00e0, 0x5288c0, 0x11d00b0, 0x528cc0, 0x11d00f0
    .long 0x529000, 0x11d0100, 0x565000, 0x11d0300, 0x529040, 0x11d0110, 0x565040, 0x11d0310
    .long 0x529080, 0x11d0120, 0x565080, 0x11d0320, 0x5290c0, 0x11d0130, 0x5650c0, 0x11d0330
    .long 0x564000, 0x11d0200, 0x564400, 0x11d0240, 0x564040, 0x11d0210, 0x564440, 0x11d0250
    .long 0x564080, 0x11d0220, 0x564480, 0x11d0260, 0x5640c0, 0x11d0230, 0x5644c0, 0x11d0270
    .long 0x564800, 0x11d0280, 0x564c00, 0x11d02c0, 0x564840, 0x11d0290, 0x564c40, 0x11d02d0
    .long 0x564880, 0x11d02a0, 0x564c80, 0x11d02e0, 0x5648c0, 0x11d02b0, 0x564cc0, 0x11d02f0
    .long 0x5a0000, 0x11d0400, 0x5a0400, 0x11d0440, 0x5a0040, 0x11d0410, 0x5a0440, 0x11d0450
    .long 0x5a0080, 0x11d0420, 0x5a0480, 0x11d0460, 0x5a00c0, 0x11d0430, 0x5a04c0, 0x11d0470
    .long 0x5a0800, 0x11d0480, 0x5a0c00, 0x11d04c0, 0x5a0840, 0x11d0490, 0x5a0c40, 0x11d04d0
    .long 0x5a0880, 0x11d04a0, 0x5a0c80, 0x11d04e0, 0x5a08c0, 0x11d04b0, 0x5a0cc0, 0x11d04f0
    .long 0x5a1000, 0x11d0500, 0x5dd000, 0x11d0700, 0x5a1040, 0x11d0510, 0x5dd040, 0x11d0710
    .long 0x5a1080, 0x11d0520, 0x5dd080, 0x11d0720, 0x5a10c0, 0x11d0530, 0x5dd0c0, 0x11d0730
    .long 0x5dc000, 0x11d0600, 0x5dc400, 0x11d0640, 0x5dc040, 0x11d0610, 0x5dc440, 0x11d0650
    .long 0x5dc080, 0x11d0620, 0x5dc480, 0x11d0660, 0x5dc0c0, 0x11d0630, 0x5dc4c0, 0x11d0670
    .long 0x5dc800, 0x11d0680, 0x5dcc00, 0x11d06c0, 0x5dc840, 0x11d0690, 0x5dcc40, 0x11d06d0
    .long 0x5dc880, 0x11d06a0, 0x5dcc80, 0x11d06e0, 0x5dc8c0, 0x11d06b0, 0x5dccc0, 0x11d06f0
    .long 0x618000, 0x11d0800, 0x618400, 0x11d0840, 0x618040, 0x11d0810, 0x618440, 0x11d0850
    .long 0x618080, 0x11d0820, 0x618480, 0x11d0860, 0x6180c0, 0x11d0830, 0x6184c0, 0x11d0870
    .long 0x618800, 0x11d0880, 0x618c00, 0x11d08c0, 0x618840, 0x11d0890, 0x618c40, 0x11d08d0
    .long 0x618880, 0x11d08a0, 0x618c80, 0x11d08e0, 0x6188c0, 0x11d08b0, 0x618cc0, 0x11d08f0
    .long 0x619000, 0x11d0900, 0x655000, 0x11d0b00, 0x619040, 0x11d0910, 0x655040, 0x11d0b10
    .long 0x619080, 0x11d0920, 0x655080, 0x11d0b20, 0x6190c0, 0x11d0930, 0x6550c0, 0x11d0b30
    .long 0x654000, 0x11d0a00, 0x654400, 0x11d0a40, 0x654040, 0x11d0a10, 0x654440, 0x11d0a50
    .long 0x654080, 0x11d0a20, 0x654480, 0x11d0a60, 0x6540c0, 0x11d0a30, 0x6544c0, 0x11d0a70
    .long 0x654800, 0x11d0a80, 0x654c00, 0x11d0ac0, 0x654840, 0x11d0a90, 0x654c40, 0x11d0ad0
    .long 0x654880, 0x11d0aa0, 0x654c80, 0x11d0ae0, 0x6548c0, 0x11d0ab0, 0x654cc0, 0x11d0af0
    .long 0x690000, 0x11d0c00, 0x690400, 0x11d0c40, 0x690040, 0x11d0c10, 0x690440, 0x11d0c50
    .long 0x690080, 0x11d0c20, 0x690480, 0x11d0c60, 0x6900c0, 0x11d0c30, 0x6904c0, 0x11d0c70
    .long 0x690800, 0x11d0c80, 0x690c00, 0x11d0cc0, 0x690840, 0x11d0c90, 0x690c40, 0x11d0cd0
    .long 0x690880, 0x11d0ca0, 0x690c80, 0x11d0ce0, 0x6908c0, 0x11d0cb0, 0x690cc0, 0x11d0cf0
    .long 0x691000, 0x11d0d00, 0x6cd000, 0x11d0f00, 0x691040, 0x11d0d10, 0x6cd040, 0x11d0f10
    .long 0x691080, 0x11d0d20, 0x6cd080, 0x11d0f20, 0x6910c0, 0x11d0d30, 0x6cd0c0, 0x11d0f30
    .long 0x6cc000, 0x11d0e00, 0x6cc400, 0x11d0e40, 0x6cc040, 0x11d0e10, 0x6cc440, 0x11d0e50
    .long 0x6cc080, 0x11d0e20, 0x6cc480, 0x11d0e60, 0x6cc0c0, 0x11d0e30, 0x6cc4c0, 0x11d0e70
    .long 0x6cc800, 0x11d0e80, 0x6ccc00, 0x11d0ec0, 0x6cc840, 0x11d0e90, 0x6ccc40, 0x11d0ed0
    .long 0x6cc880, 0x11d0ea0, 0x6ccc80, 0x11d0ee0, 0x6cc8c0, 0x11d0eb0, 0x6cccc0, 0x11d0ef0
.size prep_table, 9472
.globl main_kernel
.p2align 8
.type main_kernel,@function
main_kernel:
    s_cmp_ge_u32 s2, 256
    s_cbranch_scc0 main_go
    s_endpgm
main_go:
    s_load_dwordx2 s[4:5], s[0:1], 0x50
    s_load_dwordx2 s[8:9], s[0:1], 0x40
    v_lshrrev_b32 v30, 6, v0
    v_and_b32 v160, 63, v0
    v_readfirstlane_b32 s24, v30
    v_lshlrev_b32 v1, 4, v160
    s_mov_b32 s6, 19009536
    s_mov_b32 s7, 0x20000
    s_mov_b32 s10, 2621440
    s_mov_b32 s11, 0x20000
    s_mov_b32 s14, 86016
    s_mov_b32 s15, 0x20000
    s_mov_b32 s18, 86016
    s_mov_b32 s19, 0x20000
    s_and_b32 s25, s2, 7
    s_lshl_b32 s25, s25, 1
    s_lshr_b32 s89, s2, 7
    s_add_u32 s25, s25, s89
    s_bfe_u32 s26, s2, 0x40003
    s_lshl_b32 s67, s25, 2
    s_mul_i32 s88, s25, 81920
    s_add_u32 s88, s88, 7368704
    s_lshl_b32 s84, s24, 10
    s_and_b32 s89, s24, 1
    s_mul_i32 s82, s89, 20480
    s_and_b32 s89, s84, 2048
    s_add_u32 s82, s82, s89
    s_lshl_b32 s92, s26, 2
    s_add_u32 s92, s92, s24
    s_mul_i32 s99, s92, 40960
    s_cmp_eq_u32 s24, 3
    s_cselect_b32 s90, 128, 0
    v_lshrrev_b32 v165, 1, v1
    v_and_b32 v165, v165, v1
    v_and_b32 v165, s90, v165
    v_sub_u32 v165, v1, v165
    v_add_u32 v2, 4096, v1
    v_add_u32 v3, 4096, v2
    s_add_u32 s93, s24, s67
    s_mul_i32 s93, s93, 49152
    s_mul_i32 s89, s26, 1280
    s_add_u32 s93, s93, s89
    s_add_u32 s93, s93, 9994240
    v_lshlrev_b32 v5, 2, v160
    v_mov_b32 v166, v0
    s_waitcnt lgkmcnt(0)
    s_add_u32 s12, s4, s88
    s_addc_u32 s13, s5, 0
    s_add_u32 s16, s12, 1310720
    s_addc_u32 s17, s13, 0
    buffer_load_dwordx4 a[0:3], v165, s[4:7], s99 offen offset:0
    buffer_load_dwordx4 a[4:7], v165, s[4:7], s99 offen offset:1024
    s_add_u32 m0, s82, 4096
    s_nop 0
    buffer_load_dwordx4 v1, s[12:15], m0 offen offset:0 sc1 lds
    s_add_u32 m0, s82, 5120
    s_nop 0
    buffer_load_dwordx4 v1, s[12:15], m0 offen offset:0 sc1 lds
    s_add_u32 m0, s82, 45056
    s_nop 0
    buffer_load_dwordx4 v1, s[12:15], m0 offen offset:0 sc1 lds
    s_add_u32 m0, s82, 46080
    s_nop 0
    buffer_load_dwordx4 v1, s[12:15], m0 offen offset:0 sc1 lds
    buffer_load_dwordx4 a[8:11], v165, s[4:7], s99 offen offset:2048
    buffer_load_dwordx4 a[12:15], v165, s[4:7], s99 offen offset:3072
    s_add_u32 s99, s99, 4096
    buffer_load_dwordx4 a[16:19], v165, s[4:7], s99 offen offset:0
    buffer_load_dwordx4 a[20:23], v165, s[4:7], s99 offen offset:1024
    buffer_load_dwordx4 a[24:27], v165, s[4:7], s99 offen offset:2048
    buffer_load_dwordx4 a[28:31], v165, s[4:7], s99 offen offset:3072
    s_and_b32 s27, s26, 7
    s_lshl_b32 s0, s24, 7
    s_mul_i32 s83, s24, 20480
    s_mul_i32 s61, s92, 30720
    s_add_u32 s61, s61, 3440640
    s_lshl_b32 s32, s92, 2
    s_lshr_b32 s68, s26, 3
    s_lshl_b32 s68, s68, 6
    s_add_u32 s68, s68, s67
    s_lshl_b32 s98, s67, 10
    s_add_u32 s98, s98, s84
    s_add_u32 s98, s98, 16285696
    s_add_u32 s99, s99, 4096
    buffer_load_dwordx4 a[32:35], v165, s[4:7], s99 offen offset:0
    s_getreg_b32 s100, hwreg(HW_REG_XCC_ID)
    s_and_b32 s100, s100, 15
    s_add_u32 s100, s100, 1
    s_lshl_b32 s91, s25, 7
    s_add_u32 s101, s91, 18685952
    s_lshl_b32 s91, s26, 2
    s_add_u32 s91, s91, s101
    v_mov_b32 v30, s100
    s_cmp_lg_u32 s24, 0
    s_cbranch_scc1 main_noxt
    s_mov_b64 exec, 1
    buffer_store_dword v30, off, s[4:7], s91 sc1
    s_mov_b64 exec, -1
main_noxt:
    v_and_b32 v161, 15, v160
    v_lshrrev_b32 v162, 4, v160
    v_lshrrev_b32 v163, 5, v160
    v_lshlrev_b32 v163, 8, v163
    buffer_load_dwordx4 a[36:39], v165, s[4:7], s99 offen offset:1024
    v_lshl_add_u32 v163, v161, 4, v163
    v_and_b32 v164, 1, v162
    s_mov_b32 s89, 20480
    v_mad_u32_u24 v9, v164, s89, v163
    v_add_u32 v9, 4096, v9
    s_lshl_b32 s89, s26, 11
    s_add_u32 s89, s89, 18513920
    s_lshl_b32 s90, s27, 9
    s_add_u32 s90, s90, 18676224
    v_lshlrev_b32 v196, 4, v166
    v_add_u32 v197, s89, v196
    v_add_u32 v198, s90, v196
    s_add_u32 m0, s82, 8192
    s_nop 0
    buffer_load_dwordx4 v1, s[12:15], m0 offen offset:0 sc1 lds
    v_mov_b32 v199, 0x7ffffff0
    v_cmp_gt_u32 vcc, 54, v166
    s_nop 1
    v_cndmask_b32 v200, v199, v197, vcc
    v_cmp_gt_u32 vcc, 78, v166
    s_nop 1
    v_cndmask_b32 v197, v199, v197, vcc
    v_subrev_u32 v201, 96, v166
    v_cmp_gt_u32 vcc, 20, v201
    s_nop 1
    v_cndmask_b32 v197, v197, v198, vcc
    s_mov_b32 s30, 0x3f803f80
    s_mov_b32 s63, 0x3ea52b5c
    s_mov_b32 s64, 0x3acccccd
    s_mov_b32 s65, 0x3727c5ac
    s_add_u32 m0, s82, 9216
    s_nop 0
    buffer_load_dwordx4 v1, s[12:15], m0 offen offset:0 sc1 lds
    s_mov_b32 s66, 0xf149f2ca
    s_mov_b32 s29, 400000
    s_mov_b32 s28, 0
    s_lshl_b64 s[40:41], 1, s24
    s_mov_b64 s[42:43], 0xffff
    s_lshl_b32 s89, s24, 4
    s_lshl_b64 s[34:35], s[42:43], s89
    s_mov_b32 s36, -1
    s_mov_b32 s37, 0
    s_mov_b32 s38, 0
    s_mov_b32 s39, -1
    s_lshl_b32 s31, s25, 8
    s_add_u32 m0, s82, 49152
    s_nop 0
    buffer_load_dwordx4 v1, s[12:15], m0 offen offset:0 sc1 lds
    s_add_u32 s31, s31, 18681856
    s_add_u32 s32, s32, s31
    s_lshl_b32 s89, s27, 2
    s_add_u32 s89, s89, s24
    s_mul_i32 s60, s89, 25600
    s_add_u32 s60, s60, 2621440
    s_mul_i32 s62, s89, 61440
    s_add_u32 s62, s62, 5406720
    s_and_b32 s90, s24, 1
    s_lshl_b32 s69, s90, 8
    s_lshl_b32 s90, s90, 1
    s_add_u32 s89, s90, 0
    s_add_u32 m0, s82, 50176
    s_nop 0
    buffer_load_dwordx4 v1, s[12:15], m0 offen offset:0 sc1 lds
    s_and_b32 s89, s89, 3
    s_mul_i32 s89, s89, 20480
    s_add_u32 s70, s89, s84
    s_add_u32 s89, s90, 1
    s_and_b32 s89, s89, 3
    s_mul_i32 s89, s89, 20480
    s_add_u32 s71, s89, s84
    s_add_u32 s89, s90, 2
    s_and_b32 s89, s89, 3
    s_mul_i32 s89, s89, 20480
    s_add_u32 s72, s89, s84
    s_add_u32 s89, s90, 3
    buffer_load_dwordx4 a[40:43], v165, s[4:7], s99 offen offset:2048
    s_and_b32 s89, s89, 3
    s_mul_i32 s89, s89, 20480
    s_add_u32 s73, s89, s84
    s_add_u32 s94, s90, s67
    s_mul_i32 s94, s94, 49152
    s_mul_i32 s89, s26, 3072
    s_add_u32 s94, s94, s89
    s_add_u32 s94, s94, 9994240
    s_mul_i32 s90, s84, 5
    s_mul_i32 s91, s84, 12
    s_add_u32 s89, s24, 0
    s_and_b32 s89, s89, 3
    buffer_load_dwordx4 a[44:47], v165, s[4:7], s99 offen offset:3072
    s_add_u32 s89, s89, s68
    s_mul_i32 s89, s89, 49152
    s_add_u32 s89, s89, 9994240
    s_add_u32 s74, s89, s90
    s_add_u32 s78, s89, s91
    s_add_u32 s89, s24, 1
    s_and_b32 s89, s89, 3
    s_add_u32 s89, s89, s68
    s_mul_i32 s89, s89, 49152
    s_add_u32 s89, s89, 9994240
    s_add_u32 s75, s89, s90
    s_add_u32 s79, s89, s91
    s_add_u32 s99, s99, 4096
    buffer_load_dwordx4 a[48:51], v165, s[4:7], s99 offen offset:0
    s_add_u32 s89, s24, 2
    s_and_b32 s89, s89, 3
    s_add_u32 s89, s89, s68
    s_mul_i32 s89, s89, 49152
    s_add_u32 s89, s89, 9994240
    s_add_u32 s76, s89, s90
    s_add_u32 s80, s89, s91
    s_add_u32 s89, s24, 3
    s_and_b32 s89, s89, 3
    s_add_u32 s89, s89, s68
    s_mul_i32 s89, s89, 49152
    s_add_u32 s89, s89, 9994240
    buffer_load_dwordx4 a[52:55], v165, s[4:7], s99 offen offset:1024
    s_add_u32 s77, s89, s90
    s_add_u32 s81, s89, s91
    s_lshr_b32 s89, s27, 1
    s_mul_i32 s89, s89, 5
    s_and_b32 s90, s27, 1
    s_add_u32 s91, s68, s24
    s_lshl_b32 s97, s91, 10
    s_add_u32 s97, s97, 16285696
    s_mul_i32 s91, s91, 20
    s_add_u32 s91, s91, s89
    s_lshl_b32 s91, s91, 10
    s_add_u32 s96, s91, 7374848
    buffer_load_dwordx4 a[56:59], v165, s[4:7], s99 offen offset:2048
    s_mul_i32 s89, s90, 3072
    s_add_u32 s95, s91, s89
    s_add_u32 s95, s95, 7372800
    s_lshl_b32 s90, s90, 3
    v_add_u32 v25, s90, v1
    s_lshr_b32 s89, s27, 1
    s_lshl_b32 s89, s89, 8
    s_add_u32 s89, s89, s90
    v_and_b32 v163, 1, v162
    v_lshlrev_b32 v163, 2, v163
    v_lshl_add_u32 v28, v161, 4, v163
    v_add_u32 v28, s89, v28
    buffer_load_dwordx4 a[60:63], v165, s[4:7], s99 offen offset:3072
    s_mov_b32 s89, 2048
    v_lshl_add_u32 v17, v161, 3, s89
    v_lshlrev_b32 v24, 4, v162
    v_add_u32 v33, s83, v2
    s_and_b32 s89, s24, 1
    s_lshr_b32 s90, s24, 1
    s_mul_i32 s91, s89, 41984
    v_add_u32 v6, s91, v2
    s_mul_i32 s91, s89, -39936
    s_add_u32 s91, s91, 40960
    v_add_u32 v7, s91, v2
    s_lshl_b32 s91, s90, 3
    v_add_u32 v26, s91, v1
    s_lshl_b32 s91, s90, 11
    v_add_u32 v27, s91, v1
    s_mul_i32 s91, s24, 6144
    s_add_u32 s91, s91, 106496
    v_add_u32 v18, s91, v1
    s_xor_b32 s91, s24, 1
    s_mul_i32 s91, s91, 6144
    s_add_u32 s91, s91, 106496
    v_add_u32 v19, s91, v1
    s_add_u32 s91, s24, 1
    s_and_b32 s91, s91, 3
    s_mul_i32 s91, s91, 15360
    s_add_u32 s91, s91, 86016
    v_add_u32 v20, s91, v1
    s_add_u32 s91, s24, 2
    s_and_b32 s91, s91, 3
    s_mul_i32 s91, s91, 15360
    s_add_u32 s91, s91, 91136
    v_add_u32 v21, s91, v1
    s_add_u32 s91, s24, 3
    s_and_b32 s91, s91, 3
    s_mul_i32 s91, s91, 15360
    s_add_u32 s91, s91, 96256
    v_add_u32 v22, s91, v1
    s_mul_i32 s91, s24, 15360
    s_add_u32 s91, s91, 86016
    v_add_u32 v23, s91, v1
    v_and_b32 v163, 31, v160
    v_mul_u32_u24 v163, 264, v163
    v_lshrrev_b32 v164, 5, v160
    v_lshl_add_u32 v8, v164, 3, v163
    s_lshl_b32 s91, s24, 6
    s_add_u32 s89, s91, 106496
    v_add_u32 v8, s89, v8
    v_mul_u32_u24 v163, 264, v161
    s_add_u32 s1, s24, 2
    s_and_b32 s1, s1, 3
    s_sub_u32 s1, s1, s24
    s_sub_u32 s1, s1, 4
    s_mul_i32 s1, s1, 4224
    v_mul_u32_u24 v4, 264, v162
    v_lshl_add_u32 v4, v161, 4, v4
    s_mul_i32 s89, s24, 1056
    s_add_u32 s89, s89, 106496
    v_add_u32 v4, s89, v4
    s_lshl_b32 s89, s25, 4
    s_add_u32 s89, s89, s26
    s_sub_u32 s90, s89, 16
    s_max_i32 s90, s90, s26
    s_lshl_b32 s85, s89, 12
    s_add_u32 s85, s85, s84
    s_add_u32 s85, s85, 16416768
    s_lshl_b32 s86, s90, 12
    s_add_u32 s86, s86, s84
    s_add_u32 s86, s86, 16416768
    s_lshl_b32 s87, s90, 7
    s_add_u32 s87, s87, 18714624
    s_lshl_b32 s3, s89, 7
    s_lshl_b32 s90, s24, 2
    s_add_u32 s3, s3, s90
    s_add_u32 s3, s3, 18714624
    s_mul_i32 s89, s24, 4224
    s_add_u32 s89, s89, 123392
    v_lshl_add_u32 v10, v162, 3, v163
    v_add_u32 v10, s89, v10
    v_add_u32 v11, 4224, v10
    v_lshrrev_b32 v163, 2, v160
    v_mul_u32_u24 v163, 264, v163
    v_and_b32 v164, 3, v160
    v_lshl_add_u32 v12, v164, 3, v163
    s_add_u32 s89, s89, 160
    v_add_u32 v12, s89, v12
    v_and_b32 v163, 1, v161
    v_cmp_eq_u32 s[44:45], 1, v163
    v_lshl_add_u32 v163, v162, 2, v163
    v_cmp_gt_u32 s[46:47], v163, v161
    v_add_u32 v163, 2, v163
    v_cmp_gt_u32 s[48:49], v163, v161
    v_cmp_eq_u32 s[50:51], 0, v162
    v_mov_b32 v163, 0xffff
    v_mov_b32 v164, 0xffff0000
    v_cndmask_b32 v163, v163, v164, s[44:45]
    v_cndmask_b32 v13, 0, v163, s[46:47]
    v_cndmask_b32 v15, v163, 0, s[46:47]
    v_cndmask_b32 v14, 0, v163, s[48:49]
    v_cndmask_b32 v16, v163, 0, s[48:49]
    s_xor_b32 s89, s24, 2
    s_or_b32 s89, s89, s25
    s_cmp_eq_u32 s89, 0
    s_cselect_b64 s[52:53], s[46:47], 0
    s_cselect_b64 s[54:55], s[48:49], 0
    s_cmp_lt_u32 s26, 8
    s_cbranch_scc0 main_typeb
prog_0:
    s_getpc_b64 s[20:21]
    s_mov_b32 s22, main_typeb-prog_0-4
    s_mov_b32 s23, 0x20000
    s_waitcnt vmcnt(18)
    s_barrier
    ds_read_b128 v[96:99], v9 offset:40960
    ds_read_b128 v[100:103], v9 offset:0
    ds_read_b128 v[104:107], v9 offset:41472
    ds_read_b128 v[108:111], v9 offset:512
    ds_read_b128 v[112:115], v9 offset:41984
    ds_read_b128 v[116:119], v9 offset:1024
    s_waitcnt lgkmcnt(4)
    v_mfma_f32_32x32x16_bf16 v[48:63], a[0:3], v[96:99], 0
    s_add_u32 s99, s99, 4096
    ds_read_b128 v[120:123], v9 offset:42496
    buffer_load_dwordx4 a[64:67], v165, s[4:7], s99 offen offset:0
    v_mfma_f32_32x32x16_bf16 v[64:79], a[0:3], v[100:103], 0
    s_waitcnt lgkmcnt(3)
    ds_read_b128 v[124:127], v9 offset:1536
    buffer_load_dwordx4 a[68:71], v165, s[4:7], s99 offen offset:1024
    v_mfma_f32_32x32x16_bf16 v[48:63], a[4:7], v[104:107], v[48:63]
    s_add_u32 m0, s82, 12288
    ds_read_b128 v[96:99], v9 offset:43008
    buffer_load_dwordx4 v1, s[12:15], m0 offen offset:0 sc1 lds
    v_mfma_f32_32x32x16_bf16 v[64:79], a[4:7], v[108:111], v[64:79]
    s_waitcnt lgkmcnt(3)
    ds_read_b128 v[100:103], v9 offset:2048
    s_add_u32 m0, s82, 13312
    s_nop 0
    buffer_load_dwordx4 v1, s[12:15], m0 offen offset:0 sc1 lds
    s_waitcnt vmcnt(20)
    v_mfma_f32_32x32x16_bf16 v[48:63], a[8:11], v[112:115], v[48:63]
    s_add_u32 m0, s82, 53248
    ds_read_b128 v[104:107], v9 offset:43520
    buffer_load_dwordx4 v1, s[12:15], m0 offen offset:0 sc1 lds
    v_mfma_f32_32x32x16_bf16 v[64:79], a[8:11], v[116:119], v[64:79]
    s_waitcnt lgkmcnt(3)
    ds_read_b128 v[108:111], v9 offset:2560
    v_mfma_f32_32x32x16_bf16 v[48:63], a[12:15], v[120:123], v[48:63]
    s_add_u32 m0, s82, 54272
    ds_read_b128 v[112:115], v9 offset:44032
    buffer_load_dwordx4 v1, s[12:15], m0 offen offset:0 sc1 lds
    v_mfma_f32_32x32x16_bf16 v[64:79], a[12:15], v[124:127], v[64:79]
    s_waitcnt lgkmcnt(3)
    ds_read_b128 v[116:119], v9 offset:3072
    buffer_load_dwordx4 a[72:75], v165, s[4:7], s99 offen offset:2048
    s_waitcnt vmcnt(21)
    v_mfma_f32_32x32x16_bf16 v[48:63], a[16:19], v[96:99], v[48:63]
    ds_read_b128 v[120:123], v9 offset:44544
    buffer_load_dwordx4 a[76:79], v165, s[4:7], s99 offen offset:3072
    v_mfma_f32_32x32x16_bf16 v[64:79], a[16:19], v[100:103], v[64:79]
    s_waitcnt lgkmcnt(3)
    ds_read_b128 v[124:127], v9 offset:3584
    s_add_u32 s99, s99, 4096
    buffer_load_dwordx4 a[80:83], v165, s[4:7], s99 offen offset:0
    v_mfma_f32_32x32x16_bf16 v[48:63], a[20:23], v[104:107], v[48:63]
    s_waitcnt vmcnt(15)
    s_barrier
    ds_read_b128 v[96:99], v9 offset:45056
    buffer_load_dwordx4 a[84:87], v165, s[4:7], s99 offen offset:1024
    v_mfma_f32_32x32x16_bf16 v[64:79], a[20:23], v[108:111], v[64:79]
    s_waitcnt lgkmcnt(3)
    ds_read_b128 v[100:103], v9 offset:4096
    v_mfma_f32_32x32x16_bf16 v[48:63], a[24:27], v[112:115], v[48:63]
    ds_read_b128 v[104:107], v9 offset:45568
    buffer_load_dwordx4 a[88:91], v165, s[4:7], s99 offen offset:2048
    v_mfma_f32_32x32x16_bf16 v[64:79], a[24:27], v[116:119], v[64:79]
    s_waitcnt lgkmcnt(3)
    ds_read_b128 v[108:111], v9 offset:4608
    buffer_load_dwordx4 a[92:95], v165, s[4:7], s99 offen offset:3072
    v_mfma_f32_32x32x16_bf16 v[48:63], a[28:31], v[120:123], v[48:63]
    ds_read_b128 v[112:115], v9 offset:46080
    buffer_load_dwordx4 v[176:179], v197, s[4:7], 0 offen
    v_mfma_f32_32x32x16_bf16 v[64:79], a[28:31], v[124:127], v[64:79]
    s_waitcnt lgkmcnt(3)
    ds_read_b128 v[116:119], v9 offset:5120
    s_mov_b32 s88, 32768
    buffer_load_dwordx4 v[180:183], v200, s[4:7], s88 offen
    v_mfma_f32_32x32x16_bf16 v[48:63], a[32:35], v[96:99], v[48:63]
    s_mov_b32 s88, 65536
    ds_read_b128 v[120:123], v9 offset:46592
    buffer_load_dwordx4 v[184:187], v200, s[4:7], s88 offen
    v_mfma_f32_32x32x16_bf16 v[64:79], a[32:35], v[100:103], v[64:79]
    s_waitcnt lgkmcnt(3)
    ds_read_b128 v[124:127], v9 offset:5632
    v_mfma_f32_32x32x16_bf16 v[48:63], a[36:39], v[104:107], v[48:63]
    s_mov_b32 s88, 98304
    ds_read_b128 v[96:99], v9 offset:47104
    buffer_load_dwordx4 v[188:191], v200, s[4:7], s88 offen
    v_mfma_f32_32x32x16_bf16 v[64:79], a[36:39], v[108:111], v[64:79]
    s_waitcnt lgkmcnt(3)
    ds_read_b128 v[100:103], v9 offset:6144
    s_mov_b32 s88, 131072
    buffer_load_dwordx4 v[192:195], v200, s[4:7], s88 offen
    s_waitcnt vmcnt(21)
    v_mfma_f32_32x32x16_bf16 v[48:63], a[40:43], v[112:115], v[48:63]
    s_add_u32 s88, s98, 0
    ds_read_b128 v[104:107], v9 offset:47616
    buffer_load_dwordx4 v[144:147], v1, s[4:7], s88 offen sc1
    v_mfma_f32_32x32x16_bf16 v[64:79], a[40:43], v[116:119], v[64:79]
    s_waitcnt lgkmcnt(3)
    ds_read_b128 v[108:111], v9 offset:6656
    s_add_u32 s88, s98, 65536
    buffer_load_dwordx4 v[148:151], v1, s[4:7], s88 offen sc1
    v_mfma_f32_32x32x16_bf16 v[48:63], a[44:47], v[120:123], v[48:63]
    s_add_u32 s99, s99, 4096
    ds_read_b128 v[112:115], v9 offset:48128
    buffer_load_dwordx4 a[96:99], v165, s[4:7], s99 offen offset:0
    v_mfma_f32_32x32x16_bf16 v[64:79], a[44:47], v[124:127], v[64:79]
    s_waitcnt lgkmcnt(3)
    ds_read_b128 v[116:119], v9 offset:7168
    s_waitcnt vmcnt(22)
    v_mfma_f32_32x32x16_bf16 v[48:63], a[48:51], v[96:99], v[48:63]
    ds_read_b128 v[120:123], v9 offset:48640
    buffer_load_dwordx4 a[100:103], v165, s[4:7], s99 offen offset:1024
    v_mfma_f32_32x32x16_bf16 v[64:79], a[48:51], v[100:103], v[64:79]
    s_waitcnt lgkmcnt(3)
    ds_read_b128 v[124:127], v9 offset:7680
    s_add_u32 m0, s82, 16384
    s_nop 0
    buffer_load_dwordx4 v1, s[12:15], m0 offen offset:0 sc1 lds
    v_mfma_f32_32x32x16_bf16 v[48:63], a[52:55], v[104:107], v[48:63]
    s_add_u32 m0, s82, 17408
    s_waitcnt vmcnt(16)
    s_barrier
    ds_read_b128 v[96:99], v9 offset:49152
    buffer_load_dwordx4 v1, s[12:15], m0 offen offset:0 sc1 lds
    v_mfma_f32_32x32x16_bf16 v[64:79], a[52:55], v[108:111], v[64:79]
    s_waitcnt lgkmcnt(3)
    ds_read_b128 v[100:103], v9 offset:8192
    s_add_u32 m0, s82, 57344
    s_nop 0
    buffer_load_dwordx4 v1, s[12:15], m0 offen offset:0 sc1 lds
    v_mfma_f32_32x32x16_bf16 v[48:63], a[56:59], v[112:115], v[48:63]
    s_add_u32 m0, s82, 58368
    ds_read_b128 v[104:107], v9 offset:49664
    buffer_load_dwordx4 v1, s[12:15], m0 offen offset:0 sc1 lds
    v_mfma_f32_32x32x16_bf16 v[64:79], a[56:59], v[116:119], v[64:79]
    s_waitcnt lgkmcnt(3)
    ds_read_b128 v[108:111], v9 offset:8704
    v_mfma_f32_32x32x16_bf16 v[48:63], a[60:63], v[120:123], v[48:63]
    ds_read_b128 v[112:115], v9 offset:50176
    buffer_load_dwordx4 a[104:107], v165, s[4:7], s99 offen offset:2048
    v_mfma_f32_32x32x16_bf16 v[64:79], a[60:63], v[124:127], v[64:79]
    s_waitcnt lgkmcnt(3)
    ds_read_b128 v[116:119], v9 offset:9216
    buffer_load_dwordx4 a[108:111], v165, s[4:7], s99 offen offset:3072
    v_mfma_f32_32x32x16_bf16 v[48:63], a[64:67], v[96:99], v[48:63]
    s_add_u32 s99, s99, 4096
    ds_read_b128 v[120:123], v9 offset:50688
    buffer_load_dwordx4 a[112:115], v165, s[4:7], s99 offen offset:0
    v_mfma_f32_32x32x16_bf16 v[64:79], a[64:67], v[100:103], v[64:79]
    s_waitcnt lgkmcnt(3)
    ds_read_b128 v[124:127], v9 offset:9728
    buffer_load_dwordx4 a[116:119], v165, s[4:7], s99 offen offset:1024
    v_mfma_f32_32x32x16_bf16 v[48:63], a[68:71], v[104:107], v[48:63]
    ds_read_b128 v[96:99], v9 offset:51200
    buffer_load_dwordx4 a[120:123], v165, s[4:7], s99 offen offset:2048
    v_mfma_f32_32x32x16_bf16 v[64:79], a[68:71], v[108:111], v[64:79]
    s_waitcnt lgkmcnt(3)
    ds_read_b128 v[100:103], v9 offset:10240
    s_waitcnt vmcnt(22)
    v_mfma_f32_32x32x16_bf16 v[48:63], a[72:75], v[112:115], v[48:63]
    ds_read_b128 v[104:107], v9 offset:51712
    buffer_load_dwordx4 a[124:127], v165, s[4:7], s99 offen offset:3072
    v_mfma_f32_32x32x16_bf16 v[64:79], a[72:75], v[116:119], v[64:79]
    s_waitcnt lgkmcnt(3)
    ds_read_b128 v[108:111], v9 offset:10752
    s_add_u32 s99, s99, 4096
    buffer_load_dwordx4 a[128:131], v165, s[4:7], s99 offen offset:0
    v_mfma_f32_32x32x16_bf16 v[48:63], a[76:79], v[120:123], v[48:63]
    ds_read_b128 v[112:115], v9 offset:52224
    buffer_load_dwordx4 a[132:135], v165, s[4:7], s99 offen offset:1024
    v_mfma_f32_32x32x16_bf16 v[64:79], a[76:79], v[124:127], v[64:79]
    s_waitcnt lgkmcnt(3)
    ds_read_b128 v[116:119], v9 offset:11264
    s_add_u32 m0, s82, 20480
    s_nop 0
    buffer_load_dwordx4 v1, s[12:15], m0 offen offset:0 sc1 lds
    s_waitcnt vmcnt(24)
    v_mfma_f32_32x32x16_bf16 v[48:63], a[80:83], v[96:99], v[48:63]
    s_add_u32 m0, s82, 21504
    ds_read_b128 v[120:123], v9 offset:52736
    buffer_load_dwordx4 v1, s[12:15], m0 offen offset:0 sc1 lds
    s_waitcnt vmcnt(18)
    v_add_f32 v176, v176, v180
    v_add_f32 v177, v177, v181
    v_mfma_f32_32x32x16_bf16 v[64:79], a[80:83], v[100:103], v[64:79]
    s_waitcnt lgkmcnt(3)
    ds_read_b128 v[124:127], v9 offset:11776
    v_add_f32 v178, v178, v182
    v_add_f32 v179, v179, v183
    v_add_f32 v184, v184, v188
    v_add_f32 v185, v185, v189
    v_add_f32 v186, v186, v190
    v_mfma_f32_32x32x16_bf16 v[48:63], a[84:87], v[104:107], v[48:63]
    s_add_u32 m0, s82, 61440
    s_waitcnt vmcnt(10)
    s_barrier
    ds_read_b128 v[96:99], v9 offset:53248
    buffer_load_dwordx4 v1, s[12:15], m0 offen offset:0 sc1 lds
    v_add_f32 v187, v187, v191
    v_mfma_f32_32x32x16_bf16 v[64:79], a[84:87], v[108:111], v[64:79]
    s_waitcnt lgkmcnt(3)
    ds_read_b128 v[100:103], v9 offset:12288
    s_add_u32 m0, s82, 62464
    s_nop 0
    buffer_load_dwordx4 v1, s[12:15], m0 offen offset:0 sc1 lds
    v_add_f32 v176, v176, v192
    v_mfma_f32_32x32x16_bf16 v[48:63], a[88:91], v[112:115], v[48:63]
    ds_read_b128 v[104:107], v9 offset:53760
    buffer_load_dwordx4 a[136:139], v165, s[4:7], s99 offen offset:2048
    v_add_f32 v177, v177, v193
    v_add_f32 v178, v178, v194
    v_add_f32 v179, v179, v195
    v_mfma_f32_32x32x16_bf16 v[64:79], a[88:91], v[116:119], v[64:79]
    s_waitcnt lgkmcnt(3)
    ds_read_b128 v[108:111], v9 offset:12800
    buffer_load_dwordx4 a[140:143], v165, s[4:7], s99 offen offset:3072
    v_add_f32 v176, v176, v184
    v_add_f32 v177, v177, v185
    v_add_f32 v178, v178, v186
    v_mfma_f32_32x32x16_bf16 v[48:63], a[92:95], v[120:123], v[48:63]
    s_add_u32 s99, s99, 4096
    ds_read_b128 v[112:115], v9 offset:54272
    buffer_load_dwordx4 a[144:147], v165, s[4:7], s99 offen offset:0
    v_add_f32 v179, v179, v187
    v_min_u32 v196, 2032, v196
    v_mfma_f32_32x32x16_bf16 v[64:79], a[92:95], v[124:127], v[64:79]
    s_waitcnt lgkmcnt(3)
    ds_read_b128 v[116:119], v9 offset:13312
    ds_write_b128 v196, v[176:179]
    v_mfma_f32_32x32x16_bf16 v[48:63], a[96:99], v[96:99], v[48:63]
    ds_read_b128 v[120:123], v9 offset:54784
    buffer_load_dwordx4 a[148:151], v165, s[4:7], s99 offen offset:1024
    v_add_f32 v144, v144, v146
    v_add_f32 v145, v145, v147
    s_nop 1
    v_permlane16_swap_b32 v144, v145
    v_mfma_f32_32x32x16_bf16 v[64:79], a[96:99], v[100:103], v[64:79]
    s_waitcnt lgkmcnt(4)
    ds_read_b128 v[124:127], v9 offset:13824
    buffer_load_dwordx4 a[152:155], v165, s[4:7], s99 offen offset:2048
    v_add_f32 v144, v144, v145
    v_mov_b32 v145, v144
    s_nop 1
    v_permlane32_swap_b32 v144, v145
    v_mfma_f32_32x32x16_bf16 v[48:63], a[100:103], v[104:107], v[48:63]
    ds_read_b128 v[96:99], v9 offset:55296
    buffer_load_dwordx4 a[156:159], v165, s[4:7], s99 offen offset:3072
    v_add_f32 v144, v144, v145
    v_mov_b32 v145, v144
    s_nop 1
    v_permlane16_swap_b32 v144, v145
    v_mfma_f32_32x32x16_bf16 v[64:79], a[100:103], v[108:111], v[64:79]
    s_waitcnt lgkmcnt(4)
    ds_read_b128 v[100:103], v9 offset:14336
    v_mul_f32 v146, s64, v144
    v_mul_f32 v145, s64, v145
    v_fma_f32 v145, -v146, v146, v145
    v_max_f32 v145, 0, v145
    v_add_f32 v145, s65, v145
    s_waitcnt vmcnt(16)
    v_mfma_f32_32x32x16_bf16 v[48:63], a[104:107], v[112:115], v[48:63]
    v_lshrrev_b32 v32, 2, v5
    ds_read_b128 v[104:107], v9 offset:55808
    v_and_b32 v31, 31, v32
    v_min_u32 v31, 9, v31
    v_lshlrev_b32 v31, 7, v31
    v_lshrrev_b32 v32, 5, v32
    s_mov_b32 s88, 3145728
    v_mad_u32_u24 v31, v32, s88, v31
    s_mul_i32 s88, s26, 0
    s_add_u32 s88, s88, s93
    buffer_load_dword v0, v31, s[4:7], s88 offen offset:0
    v_mfma_f32_32x32x16_bf16 v[64:79], a[104:107], v[116:119], v[64:79]
    s_waitcnt lgkmcnt(3)
    ds_read_b128 v[108:111], v9 offset:14848
    buffer_load_dword v0, v5, s[4:7], s31 offen sc1
    v_rsq_f32 v147, v145
    v_add_u32 v144, s0, v17
    v_mfma_f32_32x32x16_bf16 v[48:63], a[108:111], v[120:123], v[48:63]
    ds_read_b128 v[112:115], v9 offset:56320
    buffer_load_dwordx4 v[36:39], v1, s[4:7], s95 offen
    ds_write_b64 v144, v[146:147] offset:0
    v_mfma_f32_32x32x16_bf16 v[64:79], a[108:111], v[124:127], v[64:79]
    s_waitcnt lgkmcnt(4)
    ds_read_b128 v[116:119], v9 offset:15360
    buffer_load_dwordx4 v[40:43], v1, s[4:7], s95 offen offset:1024
    v_add_f32 v148, v148, v150
    v_add_f32 v149, v149, v151
    s_nop 1
    v_permlane16_swap_b32 v148, v149
    s_waitcnt vmcnt(18)
    v_mfma_f32_32x32x16_bf16 v[48:63], a[112:115], v[96:99], v[48:63]
    ds_read_b128 v[120:123], v9 offset:56832
    buffer_load_dwordx2 v[44:45], v25, s[4:7], s96 offen
    v_add_f32 v148, v148, v149
    v_mov_b32 v149, v148
    s_nop 1
    v_permlane32_swap_b32 v148, v149
    v_mfma_f32_32x32x16_bf16 v[64:79], a[112:115], v[100:103], v[64:79]
    s_waitcnt lgkmcnt(4)
    ds_read_b128 v[124:127], v9 offset:15872
    v_add_f32 v148, v148, v149
    v_mov_b32 v149, v148
    s_nop 1
    v_permlane16_swap_b32 v148, v149
    v_mfma_f32_32x32x16_bf16 v[48:63], a[116:119], v[104:107], v[48:63]
    v_mul_f32 v150, s64, v148
    v_mul_f32 v149, s64, v149
    v_fma_f32 v149, -v150, v150, v149
    v_max_f32 v149, 0, v149
    v_add_f32 v149, s65, v149
    v_rsq_f32 v151, v149
    v_add_u32 v148, s0, v17
    ds_write_b64 v148, v[150:151] offset:512
    s_waitcnt vmcnt(11)
    s_waitcnt lgkmcnt(0)
    s_barrier
    ds_read_b128 v[96:99], v9 offset:57344
    v_mfma_f32_32x32x16_bf16 v[64:79], a[116:119], v[108:111], v[64:79]
    s_add_u32 m0, s82, 45056
    ds_read_b128 v[100:103], v9 offset:16384
    s_add_u32 s88, s82, 4096
    buffer_load_dwordx4 v1, s[16:19], s88 offen offset:0 sc1 lds
    v_mfma_f32_32x32x16_bf16 v[48:63], a[120:123], v[112:115], v[48:63]
    s_add_u32 m0, s82, 46080
    ds_read_b128 v[104:107], v9 offset:57856
    s_add_u32 s88, s82, 5120
    buffer_load_dwordx4 v1, s[16:19], s88 offen offset:0 sc1 lds
    v_mfma_f32_32x32x16_bf16 v[64:79], a[120:123], v[116:119], v[64:79]
    s_add_u32 m0, s82, 49152
    ds_read_b128 v[108:111], v9 offset:16896
    s_add_u32 s88, s82, 8192
    buffer_load_dwordx4 v1, s[16:19], s88 offen offset:0 sc1 lds
    v_mfma_f32_32x32x16_bf16 v[48:63], a[124:127], v[120:123], v[48:63]
    s_add_u32 m0, s82, 50176
    ds_read_b128 v[112:115], v9 offset:58368
    s_add_u32 s88, s82, 9216
    buffer_load_dwordx4 v1, s[16:19], s88 offen offset:0 sc1 lds
    v_mfma_f32_32x32x16_bf16 v[64:79], a[124:127], v[124:127], v[64:79]
    s_waitcnt lgkmcnt(3)
    ds_read_b128 v[116:119], v9 offset:17408
    s_add_u32 m0, s82, 53248
    s_add_u32 s88, s82, 12288
    buffer_load_dwordx4 v1, s[16:19], s88 offen offset:0 sc1 lds
    v_mfma_f32_32x32x16_bf16 v[48:63], a[128:131], v[96:99], v[48:63]
    s_add_u32 m0, s82, 54272
    ds_read_b128 v[120:123], v9 offset:58880
    v_lshrrev_b32 v140, 3, v5
    v_and_b32 v140, 16, v140
    v_add_u32 v140, s0, v140
    ds_read_b128 v[128:131], v140 offset:0
    ds_read_b128 v[132:135], v140 offset:32
    v_mfma_f32_32x32x16_bf16 v[64:79], a[128:131], v[100:103], v[64:79]
    s_waitcnt lgkmcnt(5)
    ds_read_b128 v[124:127], v9 offset:17920
    s_add_u32 s88, s82, 13312
    buffer_load_dwordx4 v1, s[16:19], s88 offen offset:0 sc1 lds
    ds_read_b128 v[136:139], v140 offset:64
    ds_read_b128 v[140:143], v140 offset:96
    v_mfma_f32_32x32x16_bf16 v[48:63], a[132:135], v[104:107], v[48:63]
    s_add_u32 m0, s82, 4096
    ds_read_b128 v[96:99], v9 offset:59392
    s_add_u32 s88, s82, 45056
    buffer_load_dwordx4 v1, s[16:19], s88 offen offset:0 sc1 lds
    v_and_b32 v154, 124, v5
    v_lshlrev_b32 v154, 1, v154
    v_mfma_f32_32x32x16_bf16 v[64:79], a[132:135], v[108:111], v[64:79]
    s_waitcnt lgkmcnt(7)
    ds_read_b128 v[100:103], v9 offset:18432
    s_add_u32 m0, s82, 5120
    s_add_u32 s88, s82, 46080
    buffer_load_dwordx4 v1, s[16:19], s88 offen offset:0 sc1 lds
    v_add_u32 v154, 2048, v154
    s_waitcnt vmcnt(17)
    v_mfma_f32_32x32x16_bf16 v[48:63], a[136:139], v[112:115], v[48:63]
    s_add_u32 m0, s82, 8192
    ds_read_b128 v[104:107], v9 offset:59904
    s_add_u32 s88, s82, 49152
    buffer_load_dwordx4 v1, s[16:19], s88 offen offset:0 sc1 lds
    ds_read_b64 v[152:153], v154 offset:256
    buffer_load_dword v29, v5, s[4:7], s101 offen sc1
    v_mfma_f32_32x32x16_bf16 v[64:79], a[136:139], v[116:119], v[64:79]
    s_waitcnt lgkmcnt(6)
    ds_read_b128 v[108:111], v9 offset:18944
    s_add_u32 m0, s82, 9216
    s_add_u32 s88, s82, 50176
    buffer_load_dwordx4 v1, s[16:19], s88 offen offset:0 sc1 lds
    v_mfma_f32_32x32x16_bf16 v[48:63], a[140:143], v[120:123], v[48:63]
    s_add_u32 m0, s82, 12288
    ds_read_b128 v[112:115], v9 offset:60416
    v_mfma_f32_32x32x16_bf16 v[64:79], a[140:143], v[124:127], v[64:79]
    s_waitcnt lgkmcnt(4)
    ds_read_b128 v[116:119], v9 offset:19456
    s_add_u32 s88, s82, 53248
    buffer_load_dwordx4 v1, s[16:19], s88 offen offset:0 sc1 lds
    s_waitcnt vmcnt(19)
    v_mfma_f32_32x32x16_bf16 v[48:63], a[144:147], v[96:99], v[48:63]
    s_add_u32 m0, s82, 13312
    ds_read_b128 v[120:123], v9 offset:60928
    s_add_u32 s88, s82, 54272
    buffer_load_dwordx4 v1, s[16:19], s88 offen offset:0 sc1 lds
    v_mfma_f32_32x32x16_bf16 v[64:79], a[144:147], v[100:103], v[64:79]
    s_waitcnt lgkmcnt(3)
    ds_read_b128 v[124:127], v9 offset:19968
    v_mfma_f32_32x32x16_bf16 v[48:63], a[148:151], v[104:107], v[48:63]
    s_waitcnt vmcnt(7)
    s_barrier
    ds_read_b128 v[96:99], v9 offset:40960
    v_mfma_f32_32x32x16_bf16 v[64:79], a[148:151], v[108:111], v[64:79]
    s_waitcnt lgkmcnt(3)
    ds_read_b128 v[100:103], v9 offset:41472
    v_mfma_f32_32x32x16_bf16 v[48:63], a[152:155], v[112:115], v[48:63]
    ds_read_b128 v[104:107], v9 offset:41984
    v_mfma_f32_32x32x16_bf16 v[64:79], a[152:155], v[116:119], v[64:79]
    s_waitcnt lgkmcnt(3)
    ds_read_b128 v[108:111], v9 offset:42496
    v_mfma_f32_32x32x16_bf16 v[48:63], a[156:159], v[120:123], v[48:63]
    ds_read_b128 v[112:115], v9 offset:43008
    v_mfma_f32_32x32x16_bf16 v[64:79], a[156:159], v[124:127], v[64:79]
    s_waitcnt lgkmcnt(3)
    ds_read_b128 v[116:119], v9 offset:43520
    s_barrier
    s_add_u32 m0, s82, 57344
    s_add_u32 s88, s82, 16384
    buffer_load_dwordx4 v1, s[16:19], s88 offen offset:0 sc1 lds
    s_nop 3
    v_pk_fma_f32 v[48:49], v[128:129], v[152:153], v[48:49] op_sel_hi:[1,0,1] neg_lo:[0,1,0] neg_hi:[0,1,0]
    v_pk_fma_f32 v[50:51], v[130:131], v[152:153], v[50:51] op_sel_hi:[1,0,1] neg_lo:[0,1,0] neg_hi:[0,1,0]
    s_add_u32 m0, s82, 58368
    s_add_u32 s88, s82, 17408
    buffer_load_dwordx4 v1, s[16:19], s88 offen offset:0 sc1 lds
    v_pk_mul_f32 v[48:49], v[48:49], v[152:153] op_sel:[0,1] op_sel_hi:[1,1]
    v_pk_mul_f32 v[50:51], v[50:51], v[152:153] op_sel:[0,1] op_sel_hi:[1,1]
    v_cvt_pk_bf16_f32 v48, v48, v49
    v_cvt_pk_bf16_f32 v49, v50, v51
    ds_write_b64 v8, v[48:49] offset:29568
    s_add_u32 m0, s82, 61440
    s_add_u32 s88, s82, 20480
    buffer_load_dwordx4 v1, s[16:19], s88 offen offset:0 sc1 lds
    v_pk_fma_f32 v[52:53], v[132:133], v[152:153], v[52:53] op_sel_hi:[1,0,1] neg_lo:[0,1,0] neg_hi:[0,1,0]
    v_pk_fma_f32 v[54:55], v[134:135], v[152:153], v[54:55] op_sel_hi:[1,0,1] neg_lo:[0,1,0] neg_hi:[0,1,0]
    v_pk_mul_f32 v[52:53], v[52:53], v[152:153] op_sel:[0,1] op_sel_hi:[1,1]
    v_pk_mul_f32 v[54:55], v[54:55], v[152:153] op_sel:[0,1] op_sel_hi:[1,1]
    v_cvt_pk_bf16_f32 v52, v52, v53
    v_cvt_pk_bf16_f32 v53, v54, v55
    s_add_u32 m0, s82, 62464
    s_add_u32 s88, s82, 21504
    buffer_load_dwordx4 v1, s[16:19], s88 offen offset:0 sc1 lds
    ds_write_b64 v8, v[52:53] offset:29584
    v_pk_fma_f32 v[56:57], v[136:137], v[152:153], v[56:57] op_sel_hi:[1,0,1] neg_lo:[0,1,0] neg_hi:[0,1,0]
    v_pk_fma_f32 v[58:59], v[138:139], v[152:153], v[58:59] op_sel_hi:[1,0,1] neg_lo:[0,1,0] neg_hi:[0,1,0]
    v_pk_mul_f32 v[56:57], v[56:57], v[152:153] op_sel:[0,1] op_sel_hi:[1,1]
    v_pk_mul_f32 v[58:59], v[58:59], v[152:153] op_sel:[0,1] op_sel_hi:[1,1]
    v_cvt_pk_bf16_f32 v56, v56, v57
    v_cvt_pk_bf16_f32 v57, v58, v59
    ds_write_b64 v8, v[56:57] offset:29600
    s_add_u32 m0, s82, 16384
    s_add_u32 s88, s82, 57344
    buffer_load_dwordx4 v1, s[16:19], s88 offen offset:0 sc1 lds
    v_pk_fma_f32 v[60:61], v[140:141], v[152:153], v[60:61] op_sel_hi:[1,0,1] neg_lo:[0,1,0] neg_hi:[0,1,0]
    v_pk_fma_f32 v[62:63], v[142:143], v[152:153], v[62:63] op_sel_hi:[1,0,1] neg_lo:[0,1,0] neg_hi:[0,1,0]
    v_pk_mul_f32 v[60:61], v[60:61], v[152:153] op_sel:[0,1] op_sel_hi:[1,1]
    v_pk_mul_f32 v[62:63], v[62:63], v[152:153] op_sel:[0,1] op_sel_hi:[1,1]
    v_cvt_pk_bf16_f32 v60, v60, v61
    v_cvt_pk_bf16_f32 v61, v62, v63
    ds_write_b64 v8, v[60:61] offset:29616
    v_mfma_f32_32x32x16_bf16 v[80:95], a[0:3], v[96:99], 0
    s_add_u32 m0, s82, 17408
    ds_read_b128 v[120:123], v9 offset:44032
    s_add_u32 s88, s82, 58368
    buffer_load_dwordx4 v1, s[16:19], s88 offen offset:0 sc1 lds
    v_mfma_f32_32x32x16_bf16 v[80:95], a[4:7], v[100:103], v[80:95]
    s_waitcnt lgkmcnt(7)
    ds_read_b128 v[124:127], v9 offset:44544
    v_mfma_f32_32x32x16_bf16 v[80:95], a[8:11], v[104:107], v[80:95]
    s_add_u32 m0, s82, 20480
    ds_read_b128 v[96:99], v9 offset:45056
    s_add_u32 s88, s82, 61440
    buffer_load_dwordx4 v1, s[16:19], s88 offen offset:0 sc1 lds
    v_mfma_f32_32x32x16_bf16 v[80:95], a[12:15], v[108:111], v[80:95]
    s_waitcnt lgkmcnt(7)
    ds_read_b128 v[100:103], v9 offset:45568
    s_waitcnt lgkmcnt(4)
    s_barrier
    v_add_u32 v156, 33792, v4
    ds_read2_b64 v[156:159], v156 offset1:1
    s_add_u32 s91, s85, 0
    v_mfma_f32_32x32x16_bf16 v[80:95], a[16:19], v[112:115], v[80:95]
    s_add_u32 m0, s82, 21504
    ds_read_b128 v[104:107], v9 offset:46080
    s_add_u32 s88, s82, 62464
    buffer_load_dwordx4 v1, s[16:19], s88 offen offset:0 sc1 lds
    v_mfma_f32_32x32x16_bf16 v[80:95], a[20:23], v[116:119], v[80:95]
    s_waitcnt lgkmcnt(4)
    ds_read_b128 v[108:111], v9 offset:46592
    v_mfma_f32_32x32x16_bf16 v[80:95], a[24:27], v[120:123], v[80:95]
    s_add_u32 s33, s60, 0
    ds_read_b128 v[112:115], v9 offset:47104
    buffer_load_dwordx4 a[160:163], v1, s[4:7], s33 offen offset:0
    v_mfma_f32_32x32x16_bf16 v[80:95], a[28:31], v[124:127], v[80:95]
    s_waitcnt lgkmcnt(4)
    ds_read_b128 v[116:119], v9 offset:47616
    v_mfma_f32_32x32x16_bf16 v[80:95], a[32:35], v[96:99], v[80:95]
    s_waitcnt lgkmcnt(4)
    ds_read_b128 v[120:123], v9 offset:48128
    buffer_load_dwordx4 a[164:167], v1, s[4:7], s33 offen offset:1024
    buffer_store_dwordx4 v[156:159], v1, s[4:7], s91 offen sc1
    v_mfma_f32_32x32x16_bf16 v[80:95], a[36:39], v[100:103], v[80:95]
    s_waitcnt lgkmcnt(3)
    ds_read_b128 v[124:127], v9 offset:48640
    s_waitcnt vmcnt(14)
poll_2:
    v_cmp_le_u32 vcc, 1, v29
    s_nop 0
    s_andn2_b64 s[56:57], s[42:43], vcc
    s_cbranch_scc1 pollr_1
    v_cmp_ne_u32 vcc, s100, v29
    s_nop 0
    s_and_b64 s[56:57], s[42:43], vcc
    s_cselect_b32 s28, 1, 0
    v_mfma_f32_32x32x16_bf16 v[80:95], a[40:43], v[104:107], v[80:95]
    ds_read_b128 v[96:99], v9 offset:49152
    buffer_load_dwordx4 a[168:171], v1, s[4:7], s33 offen offset:2048
    v_mfma_f32_32x32x16_bf16 v[80:95], a[44:47], v[108:111], v[80:95]
    s_waitcnt lgkmcnt(3)
    ds_read_b128 v[100:103], v9 offset:49664
    v_mfma_f32_32x32x16_bf16 v[80:95], a[48:51], v[112:115], v[80:95]
    v_lshrrev_b32 v32, 2, v5
    ds_read_b128 v[104:107], v9 offset:50176
    v_and_b32 v31, 31, v32
    v_min_u32 v31, 2, v31
    v_lshlrev_b32 v31, 7, v31
    v_lshrrev_b32 v32, 5, v32
    s_mov_b32 s88, 3145728
    v_mad_u32_u24 v31, v32, s88, v31
    s_mul_i32 s88, s26, 1792
    s_add_u32 s88, s88, s93
    buffer_load_dword v0, v31, s[4:7], s88 offen offset:0
    v_mfma_f32_32x32x16_bf16 v[80:95], a[52:55], v[116:119], v[80:95]
    s_waitcnt lgkmcnt(3)
    ds_read_b128 v[108:111], v9 offset:50688
    v_mfma_f32_32x32x16_bf16 v[80:95], a[56:59], v[120:123], v[80:95]
    ds_read_b128 v[112:115], v9 offset:51200
    buffer_load_dwordx4 a[172:175], v1, s[4:7], s33 offen offset:3072
    v_mfma_f32_32x32x16_bf16 v[80:95], a[60:63], v[124:127], v[80:95]
    s_waitcnt lgkmcnt(3)
    ds_read_b128 v[116:119], v9 offset:51712
    v_mfma_f32_32x32x16_bf16 v[80:95], a[64:67], v[96:99], v[80:95]
    v_lshrrev_b32 v32, 2, v5
    ds_read_b128 v[120:123], v9 offset:52224
    v_and_b32 v31, 31, v32
    v_min_u32 v31, 2, v31
    v_lshlrev_b32 v31, 7, v31
    v_lshrrev_b32 v32, 5, v32
    s_mov_b32 s88, 3145728
    v_mad_u32_u24 v31, v32, s88, v31
    s_mul_i32 s88, s26, 1792
    s_add_u32 s88, s88, s93
    buffer_load_dword v0, v31, s[4:7], s88 offen offset:384
    v_mfma_f32_32x32x16_bf16 v[80:95], a[68:71], v[100:103], v[80:95]
    s_waitcnt lgkmcnt(3)
    ds_read_b128 v[124:127], v9 offset:52736
    v_mfma_f32_32x32x16_bf16 v[80:95], a[72:75], v[104:107], v[80:95]
    s_waitcnt vmcnt(11)
    s_barrier
    ds_read_b128 v[96:99], v9 offset:53248
    buffer_load_dwordx4 a[176:179], v2, s[4:7], s33 offen offset:0
    v_mfma_f32_32x32x16_bf16 v[80:95], a[76:79], v[108:111], v[80:95]
    s_waitcnt lgkmcnt(3)
    ds_read_b128 v[100:103], v9 offset:53760
    v_mfma_f32_32x32x16_bf16 v[80:95], a[80:83], v[112:115], v[80:95]
    v_lshrrev_b32 v32, 2, v5
    ds_read_b128 v[104:107], v9 offset:54272
    v_and_b32 v31, 31, v32
    v_min_u32 v31, 2, v31
    v_lshlrev_b32 v31, 7, v31
    v_lshrrev_b32 v32, 5, v32
    s_mov_b32 s88, 3145728
    v_mad_u32_u24 v31, v32, s88, v31
    s_mul_i32 s88, s26, 1792
    s_add_u32 s88, s88, s93
    buffer_load_dword v0, v31, s[4:7], s88 offen offset:768
    v_mfma_f32_32x32x16_bf16 v[80:95], a[84:87], v[116:119], v[80:95]
    s_waitcnt lgkmcnt(3)
    ds_read_b128 v[108:111], v9 offset:54784
    ds_read_b64 v[152:153], v154 offset:0
    v_mfma_f32_32x32x16_bf16 v[80:95], a[88:91], v[120:123], v[80:95]
    ds_read_b128 v[112:115], v9 offset:55296
    buffer_load_dwordx4 a[180:183], v2, s[4:7], s33 offen offset:1024
    v_mfma_f32_32x32x16_bf16 v[80:95], a[92:95], v[124:127], v[80:95]
    s_waitcnt lgkmcnt(4)
    ds_read_b128 v[116:119], v9 offset:55808
    v_mfma_f32_32x32x16_bf16 v[80:95], a[96:99], v[96:99], v[80:95]
    v_lshrrev_b32 v32, 2, v5
    ds_read_b128 v[120:123], v9 offset:56320
    v_and_b32 v31, 31, v32
    v_min_u32 v31, 2, v31
    v_lshlrev_b32 v31, 7, v31
    v_lshrrev_b32 v32, 5, v32
    s_mov_b32 s88, 3145728
    v_mad_u32_u24 v31, v32, s88, v31
    s_mul_i32 s88, s26, 1792
    s_add_u32 s88, s88, s93
    buffer_load_dword v0, v31, s[4:7], s88 offen offset:1152
    v_mfma_f32_32x32x16_bf16 v[80:95], a[100:103], v[100:103], v[80:95]
    s_waitcnt lgkmcnt(4)
    ds_read_b128 v[124:127], v9 offset:56832
    v_mfma_f32_32x32x16_bf16 v[80:95], a[104:107], v[104:107], v[80:95]
    s_waitcnt lgkmcnt(4)
    ds_read_b128 v[96:99], v9 offset:57344
    buffer_load_dwordx4 a[184:187], v2, s[4:7], s33 offen offset:2048
    v_fma_f32 v64, -v128, v152, v64
    v_fma_f32 v65, -v129, v152, v65
    v_fma_f32 v66, -v130, v152, v66
    v_mfma_f32_32x32x16_bf16 v[80:95], a[108:111], v[108:111], v[80:95]
    s_waitcnt lgkmcnt(3)
    ds_read_b128 v[100:103], v9 offset:57856
    v_fma_f32 v67, -v131, v152, v67
    v_mul_f32 v64, v64, v153
    v_mul_f32 v65, v65, v153
    v_mul_f32 v66, v66, v153
    v_mul_f32 v67, v67, v153
    v_mfma_f32_32x32x16_bf16 v[80:95], a[112:115], v[112:115], v[80:95]
    v_lshrrev_b32 v32, 2, v5
    ds_read_b128 v[104:107], v9 offset:58368
    v_and_b32 v31, 31, v32
    v_min_u32 v31, 2, v31
    v_lshlrev_b32 v31, 7, v31
    v_lshrrev_b32 v32, 5, v32
    s_mov_b32 s88, 3145728
    v_mad_u32_u24 v31, v32, s88, v31
    s_mul_i32 s88, s26, 1792
    s_add_u32 s88, s88, s93
    buffer_load_dword v0, v31, s[4:7], s88 offen offset:1536
    v_mfma_f32_32x32x16_bf16 v[80:95], a[116:119], v[116:119], v[80:95]
    s_waitcnt lgkmcnt(3)
    ds_read_b128 v[108:111], v9 offset:58880
    v_cvt_pk_bf16_f32 v64, v64, v65
    v_cvt_pk_bf16_f32 v65, v66, v67
    ds_write_b64 v8, v[64:65] offset:21120
    v_mfma_f32_32x32x16_bf16 v[80:95], a[120:123], v[120:123], v[80:95]
    s_lshl_b32 s88, s27, 2
    ds_read_b128 v[112:115], v9 offset:59392
    s_add_u32 s88, s88, s24
    s_lshl_b32 s88, s88, 11
    v_lshlrev_b32 v31, 5, v5
    v_and_b32 v31, 0x780, v31
    buffer_load_dword v0, v31, s[20:23], s88 offen
    v_mfma_f32_32x32x16_bf16 v[80:95], a[124:127], v[124:127], v[80:95]
    s_waitcnt lgkmcnt(4)
    ds_read_b128 v[116:119], v9 offset:59904
    v_fma_f32 v68, -v132, v152, v68
    v_fma_f32 v69, -v133, v152, v69
    v_fma_f32 v70, -v134, v152, v70
    v_fma_f32 v71, -v135, v152, v71
    v_mul_f32 v68, v68, v153
    v_mfma_f32_32x32x16_bf16 v[80:95], a[128:131], v[96:99], v[80:95]
    v_lshrrev_b32 v32, 2, v5
    ds_read_b128 v[120:123], v9 offset:60416
    v_and_b32 v31, 31, v32
    v_min_u32 v31, 2, v31
    v_lshlrev_b32 v31, 7, v31
    v_lshrrev_b32 v32, 5, v32
    s_mov_b32 s88, 3145728
    v_mad_u32_u24 v31, v32, s88, v31
    s_mul_i32 s88, s26, 1792
    s_add_u32 s88, s88, s93
    buffer_load_dword v0, v31, s[4:7], s88 offen offset:1920
    v_mfma_f32_32x32x16_bf16 v[80:95], a[132:135], v[100:103], v[80:95]
    s_waitcnt lgkmcnt(4)
    ds_read_b128 v[124:127], v9 offset:60928
    v_mul_f32 v69, v69, v153
    v_mul_f32 v70, v70, v153
    v_mul_f32 v71, v71, v153
    v_cvt_pk_bf16_f32 v68, v68, v69
    v_cvt_pk_bf16_f32 v69, v70, v71
    v_mfma_f32_32x32x16_bf16 v[80:95], a[136:139], v[104:107], v[80:95]
    s_waitcnt vmcnt(15)
    s_barrier
    ds_read_b128 v[96:99], v9 offset:0
    buffer_load_dwordx4 a[188:191], v2, s[4:7], s33 offen offset:3072
    ds_write_b64 v8, v[68:69] offset:21136
    v_mfma_f32_32x32x16_bf16 v[80:95], a[140:143], v[108:111], v[80:95]
    s_waitcnt lgkmcnt(4)
    ds_read_b128 v[100:103], v9 offset:512
    v_fma_f32 v72, -v136, v152, v72
    v_fma_f32 v73, -v137, v152, v73
    v_fma_f32 v74, -v138, v152, v74
    v_fma_f32 v75, -v139, v152, v75
    v_mul_f32 v72, v72, v153
    v_mfma_f32_32x32x16_bf16 v[80:95], a[144:147], v[112:115], v[80:95]
    v_lshrrev_b32 v32, 2, v5
    ds_read_b128 v[104:107], v9 offset:1024
    v_and_b32 v31, 31, v32
    v_min_u32 v31, 2, v31
    v_lshlrev_b32 v31, 7, v31
    v_lshrrev_b32 v32, 5, v32
    s_mov_b32 s88, 3145728
    v_mad_u32_u24 v31, v32, s88, v31
    s_mul_i32 s88, s26, 1792
    s_add_u32 s88, s88, s93
    buffer_load_dword v0, v31, s[4:7], s88 offen offset:2304
    v_mfma_f32_32x32x16_bf16 v[80:95], a[148:151], v[116:119], v[80:95]
    s_waitcnt lgkmcnt(4)
    ds_read_b128 v[108:111], v9 offset:1536
    v_mul_f32 v73, v73, v153
    v_mul_f32 v74, v74, v153
    v_mul_f32 v75, v75, v153
    v_cvt_pk_bf16_f32 v72, v72, v73
    v_cvt_pk_bf16_f32 v73, v74, v75
    v_mfma_f32_32x32x16_bf16 v[80:95], a[152:155], v[120:123], v[80:95]
    ds_read_b128 v[112:115], v9 offset:2048
    buffer_load_dwordx4 a[192:195], v3, s[4:7], s33 offen offset:0
    ds_write_b64 v8, v[72:73] offset:21152
    v_mfma_f32_32x32x16_bf16 v[80:95], a[156:159], v[124:127], v[80:95]
    s_waitcnt lgkmcnt(4)
    ds_read_b128 v[116:119], v9 offset:2560
    v_fma_f32 v76, -v140, v152, v76
    v_fma_f32 v77, -v141, v152, v77
    v_fma_f32 v78, -v142, v152, v78
    v_fma_f32 v79, -v143, v152, v79
    v_mul_f32 v76, v76, v153
    v_mfma_f32_32x32x16_bf16 v[48:63], a[0:3], v[96:99], 0
    v_lshrrev_b32 v32, 2, v5
    ds_read_b128 v[120:123], v9 offset:3072
    v_and_b32 v31, 31, v32
    v_min_u32 v31, 2, v31
    v_lshlrev_b32 v31, 7, v31
    v_lshrrev_b32 v32, 5, v32
    s_mov_b32 s88, 3145728
    v_mad_u32_u24 v31, v32, s88, v31
    s_mul_i32 s88, s26, 1792
    s_add_u32 s88, s88, s93
    buffer_load_dword v0, v31, s[4:7], s88 offen offset:2688
    v_mfma_f32_32x32x16_bf16 v[48:63], a[4:7], v[100:103], v[48:63]
    s_waitcnt lgkmcnt(4)
    ds_read_b128 v[124:127], v9 offset:3584
    v_mul_f32 v77, v77, v153
    v_mul_f32 v78, v78, v153
    v_mul_f32 v79, v79, v153
    v_cvt_pk_bf16_f32 v76, v76, v77
    v_cvt_pk_bf16_f32 v77, v78, v79
    ds_write_b64 v8, v[76:77] offset:21168
    v_mfma_f32_32x32x16_bf16 v[48:63], a[8:11], v[104:107], v[48:63]
    ds_read_b128 v[96:99], v9 offset:4096
    buffer_load_dwordx4 a[196:199], v3, s[4:7], s33 offen offset:1024
    ds_read_b64 v[152:153], v154 offset:512
    v_mfma_f32_32x32x16_bf16 v[48:63], a[12:15], v[108:111], v[48:63]
    s_waitcnt lgkmcnt(5)
    ds_read_b128 v[100:103], v9 offset:4608
    v_mfma_f32_32x32x16_bf16 v[48:63], a[16:19], v[112:115], v[48:63]
    v_mov_b32 v30, 1
    s_mov_b64 exec, 1
    s_waitcnt vmcnt(17)
    buffer_store_dword v30, off, s[4:7], s3 sc1
    s_mov_b64 exec, -1
    ds_read_b128 v[104:107], v9 offset:5120
    v_mfma_f32_32x32x16_bf16 v[48:63], a[20:23], v[116:119], v[48:63]
    s_waitcnt lgkmcnt(5)
    ds_read_b128 v[108:111], v9 offset:5632
    buffer_load_dwordx4 a[200:203], v3, s[4:7], s33 offen offset:2048
    v_mfma_f32_32x32x16_bf16 v[48:63], a[24:27], v[120:123], v[48:63]
    ds_read_b128 v[112:115], v9 offset:6144
    v_mfma_f32_32x32x16_bf16 v[48:63], a[28:31], v[124:127], v[48:63]
    s_waitcnt lgkmcnt(3)
    ds_read_b128 v[116:119], v9 offset:6656
    buffer_load_dwordx4 a[204:207], v3, s[4:7], s33 offen offset:3072
    v_fma_f32 v80, -v128, v152, v80
    v_fma_f32 v81, -v129, v152, v81
    v_fma_f32 v82, -v130, v152, v82
    v_fma_f32 v83, -v131, v152, v83
    v_mul_f32 v80, v80, v153
    v_mfma_f32_32x32x16_bf16 v[48:63], a[32:35], v[96:99], v[48:63]
    s_add_u32 s33, s60, 12288
    ds_read_b128 v[120:123], v9 offset:7168
    v_mul_f32 v81, v81, v153
    v_mul_f32 v82, v82, v153
    v_mul_f32 v83, v83, v153
    v_cvt_pk_bf16_f32 v80, v80, v81
    v_cvt_pk_bf16_f32 v81, v82, v83
    ds_write_b64 v8, v[80:81] offset:12672
    v_mfma_f32_32x32x16_bf16 v[48:63], a[36:39], v[100:103], v[48:63]
    s_waitcnt lgkmcnt(4)
    ds_read_b128 v[124:127], v9 offset:7680
    buffer_load_dwordx4 a[208:211], v1, s[4:7], s33 offen offset:0
    v_fma_f32 v84, -v132, v152, v84
    v_fma_f32 v85, -v133, v152, v85
    v_fma_f32 v86, -v134, v152, v86
    v_fma_f32 v87, -v135, v152, v87
    v_mul_f32 v84, v84, v153
    v_mfma_f32_32x32x16_bf16 v[48:63], a[40:43], v[104:107], v[48:63]
    ds_read_b128 v[96:99], v9 offset:8192
    v_mul_f32 v85, v85, v153
    v_mul_f32 v86, v86, v153
    v_mul_f32 v87, v87, v153
    v_cvt_pk_bf16_f32 v84, v84, v85
    v_cvt_pk_bf16_f32 v85, v86, v87
    ds_write_b64 v8, v[84:85] offset:12688
    v_mfma_f32_32x32x16_bf16 v[48:63], a[44:47], v[108:111], v[48:63]
    s_waitcnt lgkmcnt(5)
    ds_read_b128 v[100:103], v9 offset:8704
    buffer_load_dwordx4 a[212:215], v1, s[4:7], s33 offen offset:1024
    v_fma_f32 v88, -v136, v152, v88
    v_fma_f32 v89, -v137, v152, v89
    v_fma_f32 v90, -v138, v152, v90
    v_fma_f32 v91, -v139, v152, v91
    v_mul_f32 v88, v88, v153
    v_mfma_f32_32x32x16_bf16 v[48:63], a[48:51], v[112:115], v[48:63]
    ds_read_b128 v[104:107], v9 offset:9216
    v_mul_f32 v89, v89, v153
    v_mul_f32 v90, v90, v153
    v_mul_f32 v91, v91, v153
    v_cvt_pk_bf16_f32 v88, v88, v89
    v_cvt_pk_bf16_f32 v89, v90, v91
    ds_write_b64 v8, v[88:89] offset:12704
    v_mfma_f32_32x32x16_bf16 v[48:63], a[52:55], v[116:119], v[48:63]
    s_waitcnt lgkmcnt(5)
    ds_read_b128 v[108:111], v9 offset:9728
    buffer_load_dwordx4 a[216:219], v1, s[4:7], s33 offen offset:2048
    v_fma_f32 v92, -v140, v152, v92
    v_fma_f32 v93, -v141, v152, v93
    v_fma_f32 v94, -v142, v152, v94
    v_fma_f32 v95, -v143, v152, v95
    v_mul_f32 v92, v92, v153
    v_mfma_f32_32x32x16_bf16 v[48:63], a[56:59], v[120:123], v[48:63]
    ds_read_b128 v[112:115], v9 offset:10240
    v_mul_f32 v93, v93, v153
    v_mul_f32 v94, v94, v153
    v_mul_f32 v95, v95, v153
    v_cvt_pk_bf16_f32 v92, v92, v93
    v_cvt_pk_bf16_f32 v93, v94, v95
    ds_write_b64 v8, v[92:93] offset:12720
    v_mfma_f32_32x32x16_bf16 v[48:63], a[60:63], v[124:127], v[48:63]
    s_waitcnt lgkmcnt(5)
    ds_read_b128 v[116:119], v9 offset:10752
    buffer_load_dwordx4 a[220:223], v1, s[4:7], s33 offen offset:3072
    buffer_load_dword v29, v5, s[4:7], s87 offen sc1
    v_mfma_f32_32x32x16_bf16 v[48:63], a[64:67], v[96:99], v[48:63]
    ds_read_b128 v[120:123], v9 offset:11264
    v_mfma_f32_32x32x16_bf16 v[48:63], a[68:71], v[100:103], v[48:63]
    s_waitcnt lgkmcnt(4)
    ds_read_b128 v[124:127], v9 offset:11776
    buffer_load_dwordx4 a[224:227], v2, s[4:7], s33 offen offset:0
    s_waitcnt lgkmcnt(3)
    s_barrier
    ds_read2_b64 v[160:163], v11 offset0:10 offset1:14
    ds_read2_b64 v[164:167], v10 offset0:0 offset1:4
    ds_read2_b64 v[168:171], v11 offset0:0 offset1:4
    v_mfma_f32_32x32x16_bf16 v[48:63], a[72:75], v[104:107], v[48:63]
    ds_read_b128 v[96:99], v9 offset:12288
    ds_read2_b64 v[172:175], v11 offset0:15 offset1:19
    ds_read2_b64 v[80:83], v10 offset0:5 offset1:9
    ds_read2_b64 v[84:87], v11 offset0:5 offset1:9
    s_add_u32 s89, s93, 0
    v_mfma_f32_32x32x16_bf16 v[48:63], a[76:79], v[108:111], v[48:63]
    s_waitcnt lgkmcnt(9)
    ds_read_b128 v[100:103], v9 offset:12800
    buffer_load_dwordx4 a[228:231], v2, s[4:7], s33 offen offset:1024
    v_mfma_f32_32x32x16_bf16 v[48:63], a[80:83], v[112:115], v[48:63]
    ds_read_b128 v[104:107], v9 offset:13312
    v_mfma_f32_32x32x16_bf16 v[48:63], a[84:87], v[116:119], v[48:63]
    s_waitcnt lgkmcnt(9)
    ds_read_b128 v[108:111], v9 offset:13824
    buffer_load_dwordx4 a[232:235], v2, s[4:7], s33 offen offset:2048
    v_mfma_f32_32x32x16_bf16 v[48:63], a[88:91], v[120:123], v[48:63]
    ds_read_b128 v[112:115], v9 offset:14336
    v_mfma_f32_32x32x16_bf16 v[48:63], a[92:95], v[124:127], v[48:63]
    s_waitcnt lgkmcnt(3)
    ds_read_b128 v[116:119], v9 offset:14848
    buffer_load_dwordx4 a[236:239], v2, s[4:7], s33 offen offset:3072
    v_cndmask_b32 v162, 0, v162, s[50:51]
    v_cndmask_b32 v163, 0, v163, s[50:51]
    v_cndmask_b32 v174, 0, v174, s[50:51]
    v_cndmask_b32 v175, 0, v175, s[50:51]
    v_mfma_f32_32x32x16_bf16 v[48:63], a[96:99], v[96:99], v[48:63]
    v_mfma_f32_16x16x32_bf16 v[88:91], v[164:167], v[160:163], 0
    v_mfma_f32_16x16x32_bf16 v[92:95], v[168:171], v[160:163], 0
    v_mfma_f32_16x16x32_bf16 v[160:163], v[80:83], v[172:175], 0
    v_mfma_f32_16x16x32_bf16 v[164:167], v[84:87], v[172:175], 0
    ds_read_b128 v[120:123], v9 offset:15360
    ds_read_b64_tr_b16 v[80:81], v12 offset:0
    ds_read_b64_tr_b16 v[82:83], v12 offset:4224
    ds_read_b64_tr_b16 v[84:85], v12 offset:32
    ds_read_b64_tr_b16 v[86:87], v12 offset:4256
    v_cndmask_b32 v88, v88, v89, s[44:45]
    v_cndmask_b32 v90, v90, v91, s[44:45]
    v_cndmask_b32 v92, v92, v93, s[44:45]
    v_mfma_f32_32x32x16_bf16 v[48:63], a[100:103], v[100:103], v[48:63]
    s_waitcnt lgkmcnt(7)
    ds_read_b128 v[124:127], v9 offset:15872
    buffer_load_dwordx4 a[240:243], v3, s[4:7], s33 offen offset:0
    v_cndmask_b32 v94, v94, v95, s[44:45]
    v_cndmask_b32 v168, v92, v88, s[46:47]
    v_cndmask_b32 v169, v94, v90, s[48:49]
    v_max_f32 v172, v168, v169
    v_cndmask_b32 v160, v160, v161, s[44:45]
    v_mfma_f32_32x32x16_bf16 v[48:63], a[104:107], v[104:107], v[48:63]
    ds_read_b128 v[96:99], v9 offset:16384
    v_cndmask_b32 v162, v162, v163, s[44:45]
    v_cndmask_b32 v164, v164, v165, s[44:45]
    v_cndmask_b32 v166, v166, v167, s[44:45]
    v_cndmask_b32 v170, v164, v160, s[46:47]
    v_cndmask_b32 v171, v166, v162, s[48:49]
    v_max_f32 v173, v170, v171
    s_nop 1
    v_permlane16_swap_b32 v172, v173
    v_mfma_f32_32x32x16_bf16 v[48:63], a[108:111], v[108:111], v[48:63]
    s_waitcnt lgkmcnt(7)
    ds_read_b128 v[100:103], v9 offset:16896
    buffer_load_dwordx4 a[244:247], v3, s[4:7], s33 offen offset:1024
    v_max_f32 v172, v172, v173
    v_mov_b32 v173, v172
    ds_read_b64_tr_b16 v[88:89], v12 offset:40
    ds_read_b64_tr_b16 v[90:91], v12 offset:4264
    v_permlane32_swap_b32 v172, v173
    v_mfma_f32_32x32x16_bf16 v[48:63], a[112:115], v[112:115], v[48:63]
    ds_read_b128 v[104:107], v9 offset:17408
    v_max_f32 v172, v172, v173
    v_mov_b32 v173, v172
    ds_read_b64_tr_b16 v[92:93], v12 offset:72
    ds_read_b64_tr_b16 v[94:95], v12 offset:4296
    v_permlane16_swap_b32 v172, v173
    v_mul_f32 v172, s63, v172
    v_mul_f32 v173, s63, v173
    v_mfma_f32_32x32x16_bf16 v[48:63], a[116:119], v[116:119], v[48:63]
    s_waitcnt lgkmcnt(7)
    ds_read_b128 v[108:111], v9 offset:17920
    buffer_load_dwordx4 a[248:251], v3, s[4:7], s33 offen offset:2048
    v_fma_f32 v168, v168, s63, -v172
    v_fma_f32 v169, v169, s63, -v172
    v_fma_f32 v170, v170, s63, -v173
    v_fma_f32 v171, v171, s63, -v173
    s_waitcnt vmcnt(7)
poll_6:
    v_cmp_le_u32 vcc, 1, v29
    s_nop 0
    s_andn2_b64 s[56:57], s[40:41], vcc
    s_cbranch_scc1 pollr_5
    s_add_u32 s91, s86, 0
    buffer_load_dwordx4 v[156:159], v1, s[4:7], s91 offen sc1
    v_mfma_f32_32x32x16_bf16 v[48:63], a[120:123], v[120:123], v[48:63]
    ds_read_b128 v[112:115], v9 offset:18432
    v_exp_f32 v168, v168
    v_exp_f32 v169, v169
    v_exp_f32 v170, v170
    v_mfma_f32_32x32x16_bf16 v[48:63], a[124:127], v[124:127], v[48:63]
    s_waitcnt lgkmcnt(7)
    ds_read_b128 v[116:119], v9 offset:18944
    buffer_load_dwordx4 a[252:255], v3, s[4:7], s33 offen offset:3072
    v_exp_f32 v171, v171
    v_add_f32 v172, v168, v169
    v_add_f32 v173, v170, v171
    s_nop 1
    v_permlane16_swap_b32 v172, v173
    v_mfma_f32_32x32x16_bf16 v[48:63], a[128:131], v[96:99], v[48:63]
    s_add_u32 s33, s60, 24576
    ds_read_b128 v[120:123], v9 offset:19456
    v_add_f32 v172, v172, v173
    v_mov_b32 v173, v172
    v_add_u32 v10, s1, v10
    v_add_u32 v11, s1, v11
    v_permlane32_swap_b32 v172, v173
    v_add_f32 v172, v172, v173
    v_mov_b32 v173, v172
    v_mfma_f32_32x32x16_bf16 v[48:63], a[132:135], v[100:103], v[48:63]
    s_waitcnt lgkmcnt(3)
    ds_read_b128 v[124:127], v9 offset:19968
    buffer_load_dwordx4 v[252:255], v1, s[4:7], s33 offen offset:0
    v_add_u32 v12, s1, v12
    v_permlane16_swap_b32 v172, v173
    v_rcp_f32 v172, v172
    v_mfma_f32_32x32x16_bf16 v[48:63], a[136:139], v[104:107], v[48:63]
    s_add_u32 s33, s61, 0
    v_rcp_f32 v173, v173
    v_mul_f32 v168, v168, v172
    v_mul_f32 v169, v169, v172
    v_mul_f32 v170, v170, v173
    v_mul_f32 v171, v171, v173
    v_cvt_pk_bf16_f32 v168, v168, v168
    v_cvt_pk_bf16_f32 v169, v169, v169
    v_mfma_f32_32x32x16_bf16 v[48:63], a[140:143], v[108:111], v[48:63]
    s_waitcnt lgkmcnt(2)
    buffer_load_dwordx4 v[248:251], v1, s[4:7], s33 offen offset:0
    v_and_b32 v160, v13, v168
    v_and_b32 v161, v14, v169
    v_and_b32 v162, v15, v168
    v_and_b32 v163, v16, v169
    v_cvt_pk_bf16_f32 v170, v170, v170
    v_mfma_f32_32x32x16_bf16 v[48:63], a[144:147], v[112:115], v[48:63]
    v_cvt_pk_bf16_f32 v171, v171, v171
    v_and_b32 v164, v13, v170
    v_and_b32 v165, v14, v171
    v_and_b32 v166, v15, v170
    v_and_b32 v167, v16, v171
    v_mfma_f32_32x32x16_bf16 v[48:63], a[148:151], v[116:119], v[48:63]
    s_waitcnt lgkmcnt(0)
    buffer_load_dwordx4 v[244:247], v1, s[4:7], s33 offen offset:1024
    v_mfma_f32_16x16x32_bf16 v[168:171], v[80:83], v[160:163], 0
    v_mfma_f32_16x16x32_bf16 v[172:175], v[84:87], v[160:163], 0
    v_mfma_f32_16x16x32_bf16 v[80:83], v[88:91], v[164:167], 0
    v_mfma_f32_16x16x32_bf16 v[84:87], v[92:95], v[164:167], 0
    v_mfma_f32_32x32x16_bf16 v[48:63], a[152:155], v[120:123], v[48:63]
    v_mfma_f32_32x32x16_bf16 v[48:63], a[156:159], v[124:127], v[48:63]
    buffer_load_dwordx4 v[240:243], v1, s[4:7], s33 offen offset:2048
    s_nop 1
    v_cvt_pk_bf16_f32 v88, v168, v169
    v_cvt_pk_bf16_f32 v89, v170, v171
    v_cvt_pk_bf16_f32 v90, v80, v81
    v_cvt_pk_bf16_f32 v91, v82, v83
    buffer_store_dwordx4 v[88:91], v1, s[4:7], s89 offen
    v_cvt_pk_bf16_f32 v92, v172, v173
    v_cvt_pk_bf16_f32 v93, v174, v175
    v_cvt_pk_bf16_f32 v94, v84, v85
    v_cvt_pk_bf16_f32 v95, v86, v87
    buffer_load_dwordx4 v[236:239], v1, s[4:7], s33 offen offset:3072
    s_mov_b64 exec, s[42:43]
    buffer_store_dwordx4 v[92:95], v1, s[4:7], s89 offen offset:1024
    s_mov_b64 exec, -1
    ds_read_b64 v[152:153], v154 offset:768
    s_waitcnt lgkmcnt(0)
    v_pk_fma_f32 v[48:49], v[128:129], v[152:153], v[48:49] op_sel_hi:[1,0,1] neg_lo:[0,1,0] neg_hi:[0,1,0]
    v_pk_fma_f32 v[50:51], v[130:131], v[152:153], v[50:51] op_sel_hi:[1,0,1] neg_lo:[0,1,0] neg_hi:[0,1,0]
    v_pk_mul_f32 v[48:49], v[48:49], v[152:153] op_sel:[0,1] op_sel_hi:[1,1]
    v_pk_mul_f32 v[50:51], v[50:51], v[152:153] op_sel:[0,1] op_sel_hi:[1,1]
    v_cvt_pk_bf16_f32 v48, v48, v49
    v_cvt_pk_bf16_f32 v49, v50, v51
    ds_write_b64 v8, v[48:49] offset:4224
    v_pk_fma_f32 v[52:53], v[132:133], v[152:153], v[52:53] op_sel_hi:[1,0,1] neg_lo:[0,1,0] neg_hi:[0,1,0]
    buffer_load_dwordx4 v[232:235], v2, s[4:7], s33 offen offset:0
    v_pk_fma_f32 v[54:55], v[134:135], v[152:153], v[54:55] op_sel_hi:[1,0,1] neg_lo:[0,1,0] neg_hi:[0,1,0]
    v_pk_mul_f32 v[52:53], v[52:53], v[152:153] op_sel:[0,1] op_sel_hi:[1,1]
    v_pk_mul_f32 v[54:55], v[54:55], v[152:153] op_sel:[0,1] op_sel_hi:[1,1]
    v_cvt_pk_bf16_f32 v52, v52, v53
    v_cvt_pk_bf16_f32 v53, v54, v55
    ds_write_b64 v8, v[52:53] offset:4240
    v_pk_fma_f32 v[56:57], v[136:137], v[152:153], v[56:57] op_sel_hi:[1,0,1] neg_lo:[0,1,0] neg_hi:[0,1,0]
    v_pk_fma_f32 v[58:59], v[138:139], v[152:153], v[58:59] op_sel_hi:[1,0,1] neg_lo:[0,1,0] neg_hi:[0,1,0]
    v_pk_mul_f32 v[56:57], v[56:57], v[152:153] op_sel:[0,1] op_sel_hi:[1,1]
    v_pk_mul_f32 v[58:59], v[58:59], v[152:153] op_sel:[0,1] op_sel_hi:[1,1]
    buffer_load_dwordx4 v[228:231], v2, s[4:7], s33 offen offset:1024
    v_cvt_pk_bf16_f32 v56, v56, v57
    v_cvt_pk_bf16_f32 v57, v58, v59
    ds_write_b64 v8, v[56:57] offset:4256
    v_pk_fma_f32 v[60:61], v[140:141], v[152:153], v[60:61] op_sel_hi:[1,0,1] neg_lo:[0,1,0] neg_hi:[0,1,0]
    v_pk_fma_f32 v[62:63], v[142:143], v[152:153], v[62:63] op_sel_hi:[1,0,1] neg_lo:[0,1,0] neg_hi:[0,1,0]
    v_pk_mul_f32 v[60:61], v[60:61], v[152:153] op_sel:[0,1] op_sel_hi:[1,1]
    v_pk_mul_f32 v[62:63], v[62:63], v[152:153] op_sel:[0,1] op_sel_hi:[1,1]
    v_cvt_pk_bf16_f32 v60, v60, v61
    v_cvt_pk_bf16_f32 v61, v62, v63
    ds_write_b64 v8, v[60:61] offset:4272
    buffer_load_dwordx4 v[224:227], v2, s[4:7], s33 offen offset:2048
    s_waitcnt vmcnt(11)
    ds_write2_b64 v4, v[156:157], v[158:159] offset1:1
    v_mov_b32 v30, 1
    s_mov_b64 exec, 1
    s_cmp_lg_u32 s28, 0
    s_waitcnt vmcnt(3)
    s_cbranch_scc1 pubs_9
    buffer_store_dword v30, off, s[4:7], s32
pubd_10:
    s_mov_b64 exec, -1
    s_waitcnt lgkmcnt(0)
    s_barrier
    ds_read2_b64 v[160:163], v11 offset0:10 offset1:14
    ds_read2_b64 v[164:167], v10 offset0:0 offset1:4
    ds_read2_b64 v[168:171], v11 offset0:0 offset1:4
    ds_read2_b64 v[172:175], v11 offset0:15 offset1:19
    ds_read2_b64 v[80:83], v10 offset0:5 offset1:9
    ds_read2_b64 v[84:87], v11 offset0:5 offset1:9
    s_add_u32 s89, s93, 3145728
    s_waitcnt lgkmcnt(5)
    v_cndmask_b32 v162, 0, v162, s[50:51]
    v_cndmask_b32 v163, 0, v163, s[50:51]
    s_waitcnt lgkmcnt(2)
    v_cndmask_b32 v174, 0, v174, s[50:51]
    buffer_load_dwordx4 v[220:223], v2, s[4:7], s33 offen offset:3072
    v_cndmask_b32 v175, 0, v175, s[50:51]
    s_waitcnt lgkmcnt(0)
    v_mfma_f32_16x16x32_bf16 v[88:91], v[164:167], v[160:163], 0
    v_mfma_f32_16x16x32_bf16 v[92:95], v[168:171], v[160:163], 0
    v_mfma_f32_16x16x32_bf16 v[160:163], v[80:83], v[172:175], 0
    v_mfma_f32_16x16x32_bf16 v[164:167], v[84:87], v[172:175], 0
    ds_read_b64_tr_b16 v[80:81], v12 offset:0
    buffer_load_dword v29, v5, s[4:7], s31 offen sc1
    ds_read_b64_tr_b16 v[82:83], v12 offset:4224
    ds_read_b64_tr_b16 v[84:85], v12 offset:32
    ds_read_b64_tr_b16 v[86:87], v12 offset:4256
    v_mov_b32 v174, s66
    v_cndmask_b32 v88, v88, v89, s[44:45]
    v_cndmask_b32 v90, v90, v91, s[44:45]
    v_cndmask_b32 v92, v92, v93, s[44:45]
    buffer_load_dwordx4 v[216:219], v3, s[4:7], s33 offen offset:0
    v_cndmask_b32 v94, v94, v95, s[44:45]
    v_cndmask_b32 v168, v92, v88, s[46:47]
    v_cndmask_b32 v169, v94, v90, s[48:49]
    v_cndmask_b32 v168, v168, v174, s[52:53]
    v_cndmask_b32 v169, v169, v174, s[54:55]
    v_max_f32 v172, v168, v169
    v_cndmask_b32 v160, v160, v161, s[44:45]
    v_cndmask_b32 v162, v162, v163, s[44:45]
    v_cndmask_b32 v164, v164, v165, s[44:45]
    v_cndmask_b32 v166, v166, v167, s[44:45]
    v_cndmask_b32 v170, v164, v160, s[46:47]
    v_cndmask_b32 v171, v166, v162, s[48:49]
    v_cndmask_b32 v170, v170, v174, s[52:53]
    buffer_load_dwordx4 v[212:215], v3, s[4:7], s33 offen offset:1024
    v_cndmask_b32 v171, v171, v174, s[54:55]
    v_max_f32 v173, v170, v171
    s_nop 1
    v_permlane16_swap_b32 v172, v173
    v_max_f32 v172, v172, v173
    v_mov_b32 v173, v172
    ds_read_b64_tr_b16 v[88:89], v12 offset:40
    ds_read_b64_tr_b16 v[90:91], v12 offset:4264
    v_permlane32_swap_b32 v172, v173
    v_max_f32 v172, v172, v173
    v_mov_b32 v173, v172
    ds_read_b64_tr_b16 v[92:93], v12 offset:72
    ds_read_b64_tr_b16 v[94:95], v12 offset:4296
    v_permlane16_swap_b32 v172, v173
    v_mul_f32 v172, s63, v172
    buffer_load_dwordx4 v[208:211], v3, s[4:7], s33 offen offset:2048
    v_mul_f32 v173, s63, v173
    v_fma_f32 v168, v168, s63, -v172
    v_fma_f32 v169, v169, s63, -v172
    v_fma_f32 v170, v170, s63, -v173
    v_fma_f32 v171, v171, s63, -v173
    v_exp_f32 v168, v168
    v_exp_f32 v169, v169
    v_exp_f32 v170, v170
    v_exp_f32 v171, v171
    v_add_f32 v172, v168, v169
    v_add_f32 v173, v170, v171
    s_nop 1
    v_permlane16_swap_b32 v172, v173
    buffer_load_dwordx4 v[204:207], v3, s[4:7], s33 offen offset:3072
    v_add_f32 v172, v172, v173
    v_mov_b32 v173, v172
    v_subrev_u32 v10, s1, v10
    v_subrev_u32 v11, s1, v11
    v_permlane32_swap_b32 v172, v173
    s_waitcnt vmcnt(4)
poll_12:
    v_cmp_le_u32 vcc, 1, v29
    s_nop 0
    s_andn2_b64 s[56:57], s[34:35], vcc
    s_cbranch_scc1 pollr_11
    s_cmp_lg_u32 s28, 0
    s_cbranch_scc1 acq_13
polld_14:
    v_add_f32 v172, v172, v173
    s_add_u32 m0, s83, 4096
    s_nop 0
    buffer_load_dwordx4 v1, s[4:7], s75 offen offset:0 sc1 lds
    v_mov_b32 v173, v172
    v_subrev_u32 v12, s1, v12
    s_nop 0
    v_permlane16_swap_b32 v172, v173
    v_rcp_f32 v172, v172
    v_rcp_f32 v173, v173
    v_mul_f32 v168, v168, v172
    s_add_u32 m0, s83, 5120
    s_nop 0
    buffer_load_dwordx4 v1, s[4:7], s76 offen offset:0 sc1 lds
    v_mul_f32 v169, v169, v172
    v_mul_f32 v170, v170, v173
    v_mul_f32 v171, v171, v173
    v_cvt_pk_bf16_f32 v168, v168, v168
    v_cvt_pk_bf16_f32 v169, v169, v169
    v_and_b32 v160, v13, v168
    v_and_b32 v161, v14, v169
    s_add_u32 m0, s83, 6144
    s_nop 0
    buffer_load_dwordx4 v1, s[4:7], s77 offen offset:0 sc1 lds
    v_and_b32 v162, v15, v168
    v_and_b32 v163, v16, v169
    v_cvt_pk_bf16_f32 v170, v170, v170
    v_cvt_pk_bf16_f32 v171, v171, v171
    v_and_b32 v164, v13, v170
    v_and_b32 v165, v14, v171
    s_add_u32 m0, s83, 6144
    s_nop 0
    buffer_load_dwordx4 v1, s[4:7], s75 offen offset:1024 sc1 lds
    v_and_b32 v166, v15, v170
    v_and_b32 v167, v16, v171
    s_waitcnt lgkmcnt(0)
    v_mfma_f32_16x16x32_bf16 v[168:171], v[80:83], v[160:163], 0
    v_mfma_f32_16x16x32_bf16 v[172:175], v[84:87], v[160:163], 0
    v_mfma_f32_16x16x32_bf16 v[80:83], v[88:91], v[164:167], 0
    v_mfma_f32_16x16x32_bf16 v[84:87], v[92:95], v[164:167], 0
    s_add_u32 m0, s83, 7168
    s_nop 0
    buffer_load_dwordx4 v1, s[4:7], s76 offen offset:1024 sc1 lds
    s_nop 1
    v_cvt_pk_bf16_f32 v88, v168, v169
    v_cvt_pk_bf16_f32 v89, v170, v171
    v_cvt_pk_bf16_f32 v90, v80, v81
    v_cvt_pk_bf16_f32 v91, v82, v83
    buffer_store_dwordx4 v[88:91], v1, s[4:7], s89 offen
    v_cvt_pk_bf16_f32 v92, v172, v173
    s_add_u32 m0, s83, 8192
    s_nop 0
    buffer_load_dwordx4 v1, s[4:7], s77 offen offset:1024 sc1 lds
    v_cvt_pk_bf16_f32 v93, v174, v175
    v_cvt_pk_bf16_f32 v94, v84, v85
    v_cvt_pk_bf16_f32 v95, v86, v87
    s_mov_b64 exec, s[42:43]
    buffer_store_dwordx4 v[92:95], v1, s[4:7], s89 offen offset:1024
    s_mov_b64 exec, -1
    s_add_u32 m0, s83, 10240
    s_nop 0
    buffer_load_dwordx4 v1, s[4:7], s74 offen offset:0 sc1 lds
    s_add_u32 m0, s83, 10240
    s_nop 0
    buffer_load_dwordx4 v1, s[4:7], s74 offen offset:1024 sc1 lds
    s_add_u32 m0, s83, 10240
    s_nop 0
    buffer_load_dwordx4 v1, s[4:7], s75 offen offset:2048 sc1 lds
    s_add_u32 m0, s83, 10240
    s_nop 0
    buffer_load_dwordx4 v1, s[4:7], s75 offen offset:3072 sc1 lds
    s_add_u32 m0, s83, 14336
    s_nop 0
    buffer_load_dwordx4 v2, s[4:7], s75 offen offset:0 sc1 lds
    s_add_u32 m0, s83, 13312
    s_nop 0
    buffer_load_dwordx4 v1, s[4:7], s76 offen offset:2048 sc1 lds
    v_mov_b32 v30, 2
    s_mov_b64 exec, 1
    s_cmp_lg_u32 s28, 0
    s_waitcnt vmcnt(6)
    s_cbranch_scc1 pubs_15
    buffer_store_dword v30, off, s[4:7], s32
pubd_16:
    s_mov_b64 exec, -1
    s_barrier
    ds_read_b128 v[128:131], v33 offset:0
    ds_read_b128 v[132:135], v33 offset:1024
    ds_read_b128 v[136:139], v33 offset:2048
    s_waitcnt lgkmcnt(2)
    v_mfma_f32_16x16x32_bf16 v[68:71], a[160:163], v[128:131], 0
    s_add_u32 m0, s83, 13312
    ds_read_b128 v[140:143], v33 offset:3072
    v_lshlrev_b32 v48, 16, v36
    v_mfma_f32_16x16x32_bf16 v[72:75], a[164:167], v[128:131], 0
    s_add_u32 s33, s61, 12288
    v_and_b32 v49, 0xffff0000, v36
    v_lshlrev_b32 v50, 16, v37
    v_mfma_f32_16x16x32_bf16 v[76:79], a[168:171], v[128:131], 0
    buffer_load_dwordx4 v1, s[4:7], s76 offen offset:3072 sc1 lds
    v_mfma_f32_16x16x32_bf16 v[80:83], a[172:175], v[128:131], 0
    s_add_u32 m0, s83, 17408
    v_and_b32 v51, 0xffff0000, v37
    v_lshlrev_b32 v52, 16, v38
    v_mfma_f32_16x16x32_bf16 v[84:87], a[176:179], v[128:131], 0
    s_waitcnt lgkmcnt(2)
    v_and_b32 v53, 0xffff0000, v38
    v_lshlrev_b32 v54, 16, v39
    v_mfma_f32_16x16x32_bf16 v[88:91], a[160:163], v[132:135], 0
    ds_read_b128 v[128:131], v33 offset:4096
    v_and_b32 v55, 0xffff0000, v39
    v_mfma_f32_16x16x32_bf16 v[92:95], a[164:167], v[132:135], 0
    buffer_load_dwordx4 v2, s[4:7], s76 offen offset:0 sc1 lds
    v_mfma_f32_16x16x32_bf16 v[96:99], a[168:171], v[132:135], 0
    s_add_u32 m0, s83, 16384
    v_lshlrev_b32 v56, 16, v40
    v_and_b32 v57, 0xffff0000, v40
    v_mfma_f32_16x16x32_bf16 v[100:103], a[172:175], v[132:135], 0
    v_lshlrev_b32 v58, 16, v41
    v_and_b32 v59, 0xffff0000, v41
    v_mfma_f32_16x16x32_bf16 v[104:107], a[176:179], v[132:135], 0
    s_waitcnt lgkmcnt(2)
    buffer_load_dwordx4 v1, s[4:7], s77 offen offset:2048 sc1 lds
    v_mfma_f32_16x16x32_bf16 v[108:111], a[160:163], v[136:139], 0
    s_add_u32 m0, s83, 16384
    ds_read_b128 v[132:135], v33 offset:5120
    v_lshlrev_b32 v60, 16, v42
    v_mfma_f32_16x16x32_bf16 v[112:115], a[164:167], v[136:139], 0
    v_and_b32 v61, 0xffff0000, v42
    v_lshlrev_b32 v62, 16, v43
    v_mfma_f32_16x16x32_bf16 v[116:119], a[168:171], v[136:139], 0
    v_and_b32 v63, 0xffff0000, v43
    v_lshlrev_b32 v64, 16, v44
    v_mfma_f32_16x16x32_bf16 v[120:123], a[172:175], v[136:139], 0
    buffer_load_dwordx4 v1, s[4:7], s77 offen offset:3072 sc1 lds
    v_mfma_f32_16x16x32_bf16 v[124:127], a[176:179], v[136:139], 0
    s_waitcnt lgkmcnt(2)
    v_and_b32 v65, 0xffff0000, v44
    v_lshlrev_b32 v66, 16, v45
    v_mfma_f32_16x16x32_bf16 v[68:71], a[180:183], v[140:143], v[68:71]
    s_add_u32 m0, s83, 20480
    s_waitcnt vmcnt(10)
    ds_read_b128 v[136:139], v33 offset:6144
    v_mfma_f32_16x16x32_bf16 v[72:75], a[184:187], v[140:143], v[72:75]
    buffer_load_dwordx4 v2, s[4:7], s77 offen offset:0 sc1 lds
    v_mfma_f32_16x16x32_bf16 v[76:79], a[188:191], v[140:143], v[76:79]
    s_add_u32 m0, s83, 19456
    v_and_b32 v67, 0xffff0000, v45
    v_mfma_f32_16x16x32_bf16 v[80:83], a[192:195], v[140:143], v[80:83]
    v_mfma_f32_16x16x32_bf16 v[84:87], a[196:199], v[140:143], v[84:87]
    s_waitcnt lgkmcnt(2)
    v_mfma_f32_16x16x32_bf16 v[88:91], a[180:183], v[128:131], v[88:91]
    s_waitcnt vmcnt(10)
    ds_read_b128 v[140:143], v33 offset:7168
    v_mfma_f32_16x16x32_bf16 v[92:95], a[184:187], v[128:131], v[92:95]
    buffer_load_dwordx4 v1, s[4:7], s74 offen offset:2048 sc1 lds
    v_mfma_f32_16x16x32_bf16 v[96:99], a[188:191], v[128:131], v[96:99]
    s_add_u32 m0, s83, 19456
    v_mfma_f32_16x16x32_bf16 v[100:103], a[192:195], v[128:131], v[100:103]
    v_mfma_f32_16x16x32_bf16 v[104:107], a[196:199], v[128:131], v[104:107]
    s_waitcnt lgkmcnt(2)
    buffer_load_dwordx4 v1, s[4:7], s74 offen offset:3072 sc1 lds
    v_mfma_f32_16x16x32_bf16 v[108:111], a[180:183], v[132:135], v[108:111]
    s_add_u32 m0, s83, 23552
    s_waitcnt vmcnt(11)
    ds_read_b128 v[128:131], v33 offset:8192
    v_mfma_f32_16x16x32_bf16 v[112:115], a[184:187], v[132:135], v[112:115]
    v_mfma_f32_16x16x32_bf16 v[116:119], a[188:191], v[132:135], v[116:119]
    buffer_load_dwordx4 v2, s[4:7], s74 offen offset:0 sc1 lds
    v_mfma_f32_16x16x32_bf16 v[120:123], a[192:195], v[132:135], v[120:123]
    v_mfma_f32_16x16x32_bf16 v[124:127], a[196:199], v[132:135], v[124:127]
    s_waitcnt lgkmcnt(2)
    v_mfma_f32_16x16x32_bf16 v[48:51], a[160:163], v[136:139], v[48:51]
    s_waitcnt vmcnt(11)
    ds_read_b128 v[132:135], v33 offset:9216
    v_mfma_f32_16x16x32_bf16 v[52:55], a[164:167], v[136:139], v[52:55]
    buffer_load_dwordx4 v[164:167], v1, s[4:7], s33 offen offset:0
    v_mfma_f32_16x16x32_bf16 v[56:59], a[168:171], v[136:139], v[56:59]
    v_mfma_f32_16x16x32_bf16 v[60:63], a[172:175], v[136:139], v[60:63]
    v_mfma_f32_16x16x32_bf16 v[64:67], a[176:179], v[136:139], v[64:67]
    s_waitcnt lgkmcnt(2)
    buffer_load_dwordx4 v[168:171], v1, s[4:7], s33 offen offset:1024
    v_mfma_f32_16x16x32_bf16 v[48:51], a[180:183], v[140:143], v[48:51]
    s_waitcnt vmcnt(12)
    ds_read_b128 v[136:139], v33 offset:10240
    v_mfma_f32_16x16x32_bf16 v[52:55], a[184:187], v[140:143], v[52:55]
    v_mfma_f32_16x16x32_bf16 v[56:59], a[188:191], v[140:143], v[56:59]
    v_mfma_f32_16x16x32_bf16 v[60:63], a[192:195], v[140:143], v[60:63]
    buffer_load_dwordx4 v[172:175], v1, s[4:7], s33 offen offset:2048
    v_mfma_f32_16x16x32_bf16 v[64:67], a[196:199], v[140:143], v[64:67]
    s_waitcnt lgkmcnt(2)
    v_mfma_f32_16x16x32_bf16 v[68:71], a[200:203], v[128:131], v[68:71]
    s_waitcnt vmcnt(12)
    ds_read_b128 v[140:143], v33 offset:11264
    v_mfma_f32_16x16x32_bf16 v[72:75], a[204:207], v[128:131], v[72:75]
    buffer_load_dwordx4 v[200:203], v1, s[4:7], s33 offen offset:3072
    v_mfma_f32_16x16x32_bf16 v[76:79], a[208:211], v[128:131], v[76:79]
    v_mfma_f32_16x16x32_bf16 v[80:83], a[212:215], v[128:131], v[80:83]
    v_mfma_f32_16x16x32_bf16 v[84:87], a[216:219], v[128:131], v[84:87]
    s_waitcnt lgkmcnt(2)
    v_mfma_f32_16x16x32_bf16 v[68:71], a[220:223], v[132:135], v[68:71]
    s_waitcnt vmcnt(11)
    ds_read_b128 v[128:131], v33 offset:12288
    v_mfma_f32_16x16x32_bf16 v[72:75], a[224:227], v[132:135], v[72:75]
    buffer_load_dwordx4 v[196:199], v2, s[4:7], s33 offen offset:0
    v_mfma_f32_16x16x32_bf16 v[76:79], a[228:231], v[132:135], v[76:79]
    v_mfma_f32_16x16x32_bf16 v[80:83], a[232:235], v[132:135], v[80:83]
    v_mfma_f32_16x16x32_bf16 v[84:87], a[236:239], v[132:135], v[84:87]
    s_waitcnt lgkmcnt(2)
    buffer_load_dwordx4 v[192:195], v2, s[4:7], s33 offen offset:1024
    v_mfma_f32_16x16x32_bf16 v[68:71], a[240:243], v[136:139], v[68:71]
    s_waitcnt vmcnt(12)
    ds_read_b128 v[132:135], v33 offset:13312
    v_mfma_f32_16x16x32_bf16 v[72:75], a[244:247], v[136:139], v[72:75]
    v_mfma_f32_16x16x32_bf16 v[76:79], a[248:251], v[136:139], v[76:79]
    buffer_load_dwordx4 v[188:191], v2, s[4:7], s33 offen offset:2048
    v_mfma_f32_16x16x32_bf16 v[80:83], a[252:255], v[136:139], v[80:83]
    v_mfma_f32_16x16x32_bf16 v[84:87], v[252:255], v[136:139], v[84:87]
    s_waitcnt lgkmcnt(2)
    v_mfma_f32_16x16x32_bf16 v[88:91], a[200:203], v[140:143], v[88:91]
    s_waitcnt vmcnt(12)
    ds_read_b128 v[136:139], v33 offset:14336
    v_mfma_f32_16x16x32_bf16 v[92:95], a[204:207], v[140:143], v[92:95]
    buffer_load_dwordx4 v[184:187], v2, s[4:7], s33 offen offset:3072
    v_mfma_f32_16x16x32_bf16 v[96:99], a[208:211], v[140:143], v[96:99]
    ds_write_b128 v20, v[68:71] offset:0
    v_mfma_f32_16x16x32_bf16 v[100:103], a[212:215], v[140:143], v[100:103]
    v_mfma_f32_16x16x32_bf16 v[104:107], a[216:219], v[140:143], v[104:107]
    s_waitcnt lgkmcnt(3)
    buffer_load_dwordx4 v[180:183], v3, s[4:7], s33 offen offset:0
    v_mfma_f32_16x16x32_bf16 v[88:91], a[220:223], v[128:131], v[88:91]
    s_waitcnt vmcnt(13)
    ds_read_b128 v[140:143], v33 offset:15360
    v_mfma_f32_16x16x32_bf16 v[92:95], a[224:227], v[128:131], v[92:95]
    ds_write_b128 v20, v[72:75] offset:1024
    v_mfma_f32_16x16x32_bf16 v[96:99], a[228:231], v[128:131], v[96:99]
    v_mfma_f32_16x16x32_bf16 v[100:103], a[232:235], v[128:131], v[100:103]
    buffer_load_dwordx4 v[176:179], v3, s[4:7], s33 offen offset:1024
    v_mfma_f32_16x16x32_bf16 v[104:107], a[236:239], v[128:131], v[104:107]
    s_waitcnt lgkmcnt(4)
    ds_write_b128 v20, v[76:79] offset:2048
    v_mfma_f32_16x16x32_bf16 v[88:91], a[240:243], v[132:135], v[88:91]
    s_waitcnt vmcnt(13)
    ds_read_b128 v[128:131], v33 offset:16384
    v_mfma_f32_16x16x32_bf16 v[92:95], a[244:247], v[132:135], v[92:95]
    buffer_load_dwordx4 a[160:163], v3, s[4:7], s33 offen offset:2048
    v_mfma_f32_16x16x32_bf16 v[96:99], a[248:251], v[132:135], v[96:99]
    ds_write_b128 v20, v[80:83] offset:3072
    v_mfma_f32_16x16x32_bf16 v[100:103], a[252:255], v[132:135], v[100:103]
    v_mfma_f32_16x16x32_bf16 v[104:107], v[252:255], v[132:135], v[104:107]
    s_waitcnt lgkmcnt(6)
    v_mfma_f32_16x16x32_bf16 v[108:111], a[200:203], v[136:139], v[108:111]
    s_waitcnt vmcnt(13)
    ds_read_b128 v[132:135], v33 offset:17408
    v_mfma_f32_16x16x32_bf16 v[112:115], a[204:207], v[136:139], v[112:115]
    buffer_load_dwordx4 a[164:167], v3, s[4:7], s33 offen offset:3072
    v_mfma_f32_16x16x32_bf16 v[116:119], a[208:211], v[136:139], v[116:119]
    s_add_u32 s33, s61, 24576
    ds_write_b128 v20, v[84:87] offset:4096
    v_mfma_f32_16x16x32_bf16 v[120:123], a[212:215], v[136:139], v[120:123]
    v_mfma_f32_16x16x32_bf16 v[124:127], a[216:219], v[136:139], v[124:127]
    s_waitcnt lgkmcnt(6)
    buffer_load_dwordx4 a[168:171], v1, s[4:7], s33 offen offset:0
    v_mfma_f32_16x16x32_bf16 v[108:111], a[220:223], v[140:143], v[108:111]
    s_waitcnt vmcnt(14)
    ds_read_b128 v[136:139], v33 offset:18432
    v_mfma_f32_16x16x32_bf16 v[112:115], a[224:227], v[140:143], v[112:115]
    v_mfma_f32_16x16x32_bf16 v[116:119], a[228:231], v[140:143], v[116:119]
    buffer_load_dwordx4 a[172:175], v1, s[4:7], s33 offen offset:1024
    v_mfma_f32_16x16x32_bf16 v[120:123], a[232:235], v[140:143], v[120:123]
    ds_write_b128 v21, v[88:91] offset:0
    v_mfma_f32_16x16x32_bf16 v[124:127], a[236:239], v[140:143], v[124:127]
    s_waitcnt lgkmcnt(5)
    v_mfma_f32_16x16x32_bf16 v[108:111], a[240:243], v[128:131], v[108:111]
    s_waitcnt vmcnt(14)
    ds_read_b128 v[140:143], v33 offset:19456
    v_mfma_f32_16x16x32_bf16 v[112:115], a[244:247], v[128:131], v[112:115]
    buffer_load_dwordx4 a[176:179], v1, s[4:7], s33 offen offset:2048
    v_mfma_f32_16x16x32_bf16 v[116:119], a[248:251], v[128:131], v[116:119]
    ds_write_b128 v21, v[92:95] offset:1024
    v_mfma_f32_16x16x32_bf16 v[120:123], a[252:255], v[128:131], v[120:123]
    v_mfma_f32_16x16x32_bf16 v[124:127], v[252:255], v[128:131], v[124:127]
    s_waitcnt lgkmcnt(5)
    buffer_load_dwordx4 a[180:183], v1, s[4:7], s33 offen offset:3072
    ds_write_b128 v21, v[96:99] offset:2048
    ds_write_b128 v21, v[100:103] offset:3072
    ds_write_b128 v21, v[104:107] offset:4096
    buffer_load_dwordx4 a[184:187], v2, s[4:7], s33 offen offset:0
    s_waitcnt lgkmcnt(0)
    s_barrier
    v_mfma_f32_16x16x32_bf16 v[48:51], a[200:203], v[132:135], v[48:51]
    ds_read_b128 v[68:71], v23 offset:0
    ds_read_b128 v[88:91], v23 offset:5120
    v_mfma_f32_16x16x32_bf16 v[52:55], a[204:207], v[132:135], v[52:55]
    ds_write_b128 v22, v[108:111] offset:0
    v_mfma_f32_16x16x32_bf16 v[56:59], a[208:211], v[132:135], v[56:59]
    buffer_load_dwordx4 a[188:191], v2, s[4:7], s33 offen offset:1024
    v_mfma_f32_16x16x32_bf16 v[60:63], a[212:215], v[132:135], v[60:63]
    s_add_u32 s33, s62, 0
    ds_read_b128 v[72:75], v23 offset:1024
    ds_read_b128 v[92:95], v23 offset:6144
    v_mfma_f32_16x16x32_bf16 v[64:67], a[216:219], v[132:135], v[64:67]
    ds_write_b128 v22, v[112:115] offset:1024
    v_mfma_f32_16x16x32_bf16 v[48:51], a[220:223], v[136:139], v[48:51]
    ds_read_b128 v[76:79], v23 offset:2048
    ds_read_b128 v[96:99], v23 offset:7168
    v_mfma_f32_16x16x32_bf16 v[52:55], a[224:227], v[136:139], v[52:55]
    buffer_load_dwordx4 a[192:195], v1, s[4:7], s33 offen offset:0
    v_mfma_f32_16x16x32_bf16 v[56:59], a[228:231], v[136:139], v[56:59]
    ds_write_b128 v22, v[116:119] offset:2048
    v_mfma_f32_16x16x32_bf16 v[60:63], a[232:235], v[136:139], v[60:63]
    ds_read_b128 v[80:83], v23 offset:3072
    ds_read_b128 v[100:103], v23 offset:8192
    v_mfma_f32_16x16x32_bf16 v[64:67], a[236:239], v[136:139], v[64:67]
    ds_write_b128 v22, v[120:123] offset:3072
    v_mfma_f32_16x16x32_bf16 v[48:51], a[240:243], v[140:143], v[48:51]
    buffer_load_dwordx4 a[196:199], v1, s[4:7], s33 offen offset:1024
    v_mfma_f32_16x16x32_bf16 v[52:55], a[244:247], v[140:143], v[52:55]
    ds_read_b128 v[84:87], v23 offset:4096
    ds_read_b128 v[104:107], v23 offset:9216
    v_mfma_f32_16x16x32_bf16 v[56:59], a[248:251], v[140:143], v[56:59]
    ds_write_b128 v22, v[124:127] offset:4096
    v_mfma_f32_16x16x32_bf16 v[60:63], a[252:255], v[140:143], v[60:63]
    s_waitcnt lgkmcnt(13)
    v_add_f32 v68, v68, v88
    v_add_f32 v69, v69, v89
    v_mfma_f32_16x16x32_bf16 v[64:67], v[252:255], v[140:143], v[64:67]
    buffer_load_dwordx4 a[200:203], v1, s[4:7], s33 offen offset:2048
    s_waitcnt lgkmcnt(0)
    s_barrier
    ds_read_b128 v[108:111], v23 offset:10240
    ds_read_b128 v[112:115], v23 offset:11264
    ds_read_b128 v[116:119], v23 offset:12288
    ds_read_b128 v[120:123], v23 offset:13312
    ds_read_b128 v[124:127], v23 offset:14336
    v_add_f32 v70, v70, v90
    v_add_f32 v71, v71, v91
    v_add_f32 v72, v72, v92
    v_add_f32 v73, v73, v93
    v_add_f32 v74, v74, v94
    v_add_f32 v75, v75, v95
    v_add_f32 v76, v76, v96
    v_add_f32 v77, v77, v97
    v_add_f32 v78, v78, v98
    v_add_f32 v79, v79, v99
    v_add_f32 v80, v80, v100
    v_add_f32 v81, v81, v101
    v_add_f32 v82, v82, v102
    v_add_f32 v83, v83, v103
    v_add_f32 v84, v84, v104
    v_add_f32 v85, v85, v105
    v_add_f32 v86, v86, v106
    v_add_f32 v87, v87, v107
    v_pk_add_f32 v[48:49], v[48:49], v[68:69]
    v_pk_add_f32 v[50:51], v[50:51], v[70:71]
    v_pk_add_f32 v[52:53], v[52:53], v[72:73]
    v_pk_add_f32 v[54:55], v[54:55], v[74:75]
    v_pk_add_f32 v[56:57], v[56:57], v[76:77]
    v_pk_add_f32 v[58:59], v[58:59], v[78:79]
    v_pk_add_f32 v[60:61], v[60:61], v[80:81]
    v_pk_add_f32 v[62:63], v[62:63], v[82:83]
    v_pk_add_f32 v[64:65], v[64:65], v[84:85]
    v_pk_add_f32 v[66:67], v[66:67], v[86:87]
    s_waitcnt lgkmcnt(4)
    v_pk_add_f32 v[48:49], v[48:49], v[108:109]
    v_pk_add_f32 v[50:51], v[50:51], v[110:111]
    v_cvt_pk_bf16_f32 v36, v48, v49
    v_cvt_pk_bf16_f32 v37, v50, v51
    s_waitcnt lgkmcnt(3)
    v_pk_add_f32 v[52:53], v[52:53], v[112:113]
    v_pk_add_f32 v[54:55], v[54:55], v[114:115]
    v_cvt_pk_bf16_f32 v38, v52, v53
    v_cvt_pk_bf16_f32 v39, v54, v55
    buffer_store_dwordx4 v[36:39], v1, s[4:7], s95 offen
    s_waitcnt lgkmcnt(2)
    v_pk_add_f32 v[56:57], v[56:57], v[116:117]
    v_pk_add_f32 v[58:59], v[58:59], v[118:119]
    v_cvt_pk_bf16_f32 v40, v56, v57
    v_cvt_pk_bf16_f32 v41, v58, v59
    s_waitcnt lgkmcnt(1)
    v_pk_add_f32 v[60:61], v[60:61], v[120:121]
    v_pk_add_f32 v[62:63], v[62:63], v[122:123]
    v_cvt_pk_bf16_f32 v42, v60, v61
    v_cvt_pk_bf16_f32 v43, v62, v63
    buffer_store_dwordx4 v[40:43], v1, s[4:7], s95 offen offset:1024
    s_waitcnt lgkmcnt(0)
    v_pk_add_f32 v[64:65], v[64:65], v[124:125]
    v_pk_add_f32 v[66:67], v[66:67], v[126:127]
    v_cvt_pk_bf16_f32 v44, v64, v65
    v_cvt_pk_bf16_f32 v45, v66, v67
    buffer_store_dwordx2 v[44:45], v25, s[4:7], s96 offen
    v_dot2_f32_bf16 v31, v36, s30, 0
    v_dot2_f32_bf16 v32, v36, v36, 0
    v_dot2_f32_bf16 v31, v37, s30, v31
    v_dot2_f32_bf16 v32, v37, v37, v32
    v_dot2_f32_bf16 v31, v38, s30, v31
    v_dot2_f32_bf16 v32, v38, v38, v32
    v_dot2_f32_bf16 v31, v39, s30, v31
    v_dot2_f32_bf16 v32, v39, v39, v32
    v_dot2_f32_bf16 v31, v40, s30, v31
    v_dot2_f32_bf16 v32, v40, v40, v32
    v_dot2_f32_bf16 v31, v41, s30, v31
    v_dot2_f32_bf16 v32, v41, v41, v32
    v_dot2_f32_bf16 v31, v42, s30, v31
    v_dot2_f32_bf16 v32, v42, v42, v32
    v_dot2_f32_bf16 v31, v43, s30, v31
    v_dot2_f32_bf16 v32, v43, v43, v32
    v_dot2_f32_bf16 v31, v44, s30, v31
    v_dot2_f32_bf16 v32, v44, v44, v32
    v_dot2_f32_bf16 v31, v45, s30, v31
    v_dot2_f32_bf16 v32, v45, v45, v32
    s_nop 2
    v_permlane16_swap_b32 v31, v32
    v_add_f32 v31, v31, v32
    v_mov_b32 v32, v31
    s_nop 1
    v_permlane32_swap_b32 v31, v32
    v_add_f32 v34, v31, v32
    s_mov_b64 exec, s[36:37]
    buffer_store_dword v34, v28, s[4:7], s97 offen
    s_mov_b64 exec, -1
    v_mov_b32 v30, 3
    s_mov_b64 exec, 1
    s_cmp_lg_u32 s28, 0
    s_waitcnt vmcnt(0)
    s_cbranch_scc1 pubs_17
    buffer_store_dword v30, off, s[4:7], s32
pubd_18:
    s_mov_b64 exec, -1
    buffer_load_dwordx4 a[204:207], v1, s[4:7], s33 offen offset:3072
    buffer_load_dwordx4 a[208:211], v2, s[4:7], s33 offen offset:0
    buffer_load_dwordx4 a[212:215], v2, s[4:7], s33 offen offset:1024
    buffer_load_dwordx4 a[216:219], v2, s[4:7], s33 offen offset:2048
    buffer_load_dwordx4 a[220:223], v2, s[4:7], s33 offen offset:3072
    buffer_load_dwordx4 a[224:227], v3, s[4:7], s33 offen offset:0
    buffer_load_dword v29, v5, s[4:7], s31 offen sc1
    s_waitcnt vmcnt(0)
poll_20:
    v_cmp_le_u32 vcc, 3, v29
    s_nop 0
    s_andn2_b64 s[56:57], s[36:37], vcc
    s_cbranch_scc1 pollr_19
    s_cmp_lg_u32 s28, 0
    s_cbranch_scc1 acq_21
polld_22:
    s_add_u32 m0, s72, 4096
    s_nop 0
    buffer_load_dwordx4 v1, s[12:15], m0 offen offset:0 sc1 lds
    s_add_u32 m0, s72, 8192
    s_nop 0
    buffer_load_dwordx4 v1, s[12:15], m0 offen offset:0 sc1 lds
    s_add_u32 m0, s72, 12288
    s_nop 0
    buffer_load_dwordx4 v1, s[12:15], m0 offen offset:0 sc1 lds
    s_add_u32 m0, s72, 16384
    s_nop 0
    buffer_load_dwordx4 v1, s[12:15], m0 offen offset:0 sc1 lds
    s_add_u32 m0, s72, 20480
    s_nop 0
    buffer_load_dwordx4 v1, s[12:15], m0 offen offset:0 sc1 lds
    s_add_u32 s88, s98, 0
    buffer_load_dwordx4 v[144:147], v1, s[4:7], s88 offen sc1
    s_add_u32 m0, s73, 4096
    s_nop 0
    buffer_load_dwordx4 v1, s[12:15], m0 offen offset:0 sc1 lds
    s_add_u32 m0, s73, 8192
    s_nop 0
    buffer_load_dwordx4 v1, s[12:15], m0 offen offset:0 sc1 lds
    s_add_u32 m0, s73, 12288
    s_nop 0
    buffer_load_dwordx4 v1, s[12:15], m0 offen offset:0 sc1 lds
    s_add_u32 m0, s73, 16384
    s_nop 0
    buffer_load_dwordx4 v1, s[12:15], m0 offen offset:0 sc1 lds
    s_waitcnt vmcnt(5)
    s_barrier
    ds_read_b128 v[96:99], v7 offset:0
    ds_read_b128 v[100:103], v7 offset:2048
    ds_read_b128 v[104:107], v7 offset:4096
    ds_read_b128 v[108:111], v7 offset:6144
    ds_read_b128 v[112:115], v7 offset:8192
    s_waitcnt lgkmcnt(3)
    v_mfma_f32_16x16x32_bf16 v[72:75], v[248:251], v[96:99], 0
    s_add_u32 m0, s73, 20480
    ds_read_b128 v[116:119], v7 offset:10240
    v_mfma_f32_16x16x32_bf16 v[76:79], v[244:247], v[96:99], 0
    buffer_load_dwordx4 v1, s[12:15], m0 offen offset:0 sc1 lds
    v_mfma_f32_16x16x32_bf16 v[80:83], v[240:243], v[96:99], 0
    s_add_u32 m0, s70, 4096
    s_nop 0
    buffer_load_dwordx4 v1, s[12:15], m0 offen offset:0 sc1 lds
    v_mfma_f32_16x16x32_bf16 v[72:75], v[236:239], v[100:103], v[72:75]
    s_add_u32 m0, s70, 8192
    ds_read_b128 v[120:123], v7 offset:12288
    s_lshr_b32 s92, s24, 1
    v_mfma_f32_16x16x32_bf16 v[76:79], v[232:235], v[100:103], v[76:79]
    s_mul_i32 s92, s92, 192
    buffer_load_dwordx4 v1, s[12:15], m0 offen offset:0 sc1 lds
    v_mfma_f32_16x16x32_bf16 v[80:83], v[228:231], v[100:103], v[80:83]
    s_waitcnt lgkmcnt(3)
    v_add_u32 v156, s92, v24
    ds_read_b128 v[128:131], v156 offset:480
    v_mfma_f32_16x16x32_bf16 v[72:75], v[224:227], v[104:107], v[72:75]
    s_add_u32 m0, s70, 12288
    ds_read_b128 v[124:127], v7 offset:14336
    ds_read_b128 v[132:135], v156 offset:864
    v_mfma_f32_16x16x32_bf16 v[76:79], v[220:223], v[104:107], v[76:79]
    buffer_load_dwordx4 v1, s[12:15], m0 offen offset:0 sc1 lds
    v_mfma_f32_16x16x32_bf16 v[80:83], v[216:219], v[104:107], v[80:83]
    s_add_u32 m0, s70, 16384
    s_nop 0
    buffer_load_dwordx4 v1, s[12:15], m0 offen offset:0 sc1 lds
    v_mfma_f32_16x16x32_bf16 v[72:75], v[212:215], v[108:111], v[72:75]
    s_add_u32 m0, s70, 20480
    ds_read_b128 v[96:99], v7 offset:16384
    ds_read_b128 v[136:139], v156 offset:544
    v_mfma_f32_16x16x32_bf16 v[76:79], v[208:211], v[108:111], v[76:79]
    buffer_load_dwordx4 v1, s[12:15], m0 offen offset:0 sc1 lds
    v_mfma_f32_16x16x32_bf16 v[80:83], v[204:207], v[108:111], v[80:83]
    s_waitcnt lgkmcnt(6)
    ds_read_b128 v[140:143], v156 offset:928
    ds_read_b128 v[148:151], v156 offset:608
    v_mfma_f32_16x16x32_bf16 v[72:75], v[164:167], v[112:115], v[72:75]
    s_add_u32 m0, s71, 4096
    ds_read_b128 v[100:103], v7 offset:18432
    ds_read_b128 v[152:155], v156 offset:992
    v_mfma_f32_16x16x32_bf16 v[76:79], v[168:171], v[112:115], v[76:79]
    buffer_load_dwordx4 v1, s[12:15], m0 offen offset:0 sc1 lds
    v_mfma_f32_16x16x32_bf16 v[80:83], v[172:175], v[112:115], v[80:83]
    s_add_u32 m0, s71, 8192
    s_nop 0
    buffer_load_dwordx4 v1, s[12:15], m0 offen offset:0 sc1 lds
    v_mfma_f32_16x16x32_bf16 v[72:75], v[200:203], v[116:119], v[72:75]
    s_add_u32 m0, s71, 12288
    s_waitcnt vmcnt(7)
    s_barrier
    ds_read_b128 v[104:107], v7 offset:20480
    v_mfma_f32_16x16x32_bf16 v[76:79], v[196:199], v[116:119], v[76:79]
    buffer_load_dwordx4 v1, s[12:15], m0 offen offset:0 sc1 lds
    v_mfma_f32_16x16x32_bf16 v[80:83], v[192:195], v[116:119], v[80:83]
    s_waitcnt lgkmcnt(8)
    v_mfma_f32_16x16x32_bf16 v[72:75], v[188:191], v[120:123], v[72:75]
    s_add_u32 m0, s71, 16384
    ds_read_b128 v[108:111], v7 offset:22528
    v_mfma_f32_16x16x32_bf16 v[76:79], v[184:187], v[120:123], v[76:79]
    buffer_load_dwordx4 v1, s[12:15], m0 offen offset:0 sc1 lds
    v_mfma_f32_16x16x32_bf16 v[80:83], v[180:183], v[120:123], v[80:83]
    s_add_u32 m0, s71, 20480
    s_nop 0
    buffer_load_dwordx4 v1, s[12:15], m0 offen offset:0 sc1 lds
    v_mfma_f32_16x16x32_bf16 v[72:75], v[176:179], v[124:127], v[72:75]
    ds_read_b128 v[112:115], v7 offset:24576
    v_mfma_f32_16x16x32_bf16 v[76:79], a[160:163], v[124:127], v[76:79]
    v_mfma_f32_16x16x32_bf16 v[80:83], a[164:167], v[124:127], v[80:83]
    s_waitcnt lgkmcnt(4)
    buffer_load_dwordx4 a[228:231], v3, s[4:7], s33 offen offset:1024
    v_mfma_f32_16x16x32_bf16 v[72:75], a[168:171], v[96:99], v[72:75]
    buffer_load_dword v29, v5, s[4:7], s31 offen sc1
    ds_read_b128 v[116:119], v7 offset:26624
    v_mfma_f32_16x16x32_bf16 v[76:79], a[172:175], v[96:99], v[76:79]
    v_add_f32 v144, v144, v146
    v_add_f32 v145, v145, v147
    v_mfma_f32_16x16x32_bf16 v[80:83], a[176:179], v[96:99], v[80:83]
    s_nop 0
    v_permlane16_swap_b32 v144, v145
    v_add_f32 v144, v144, v145
    v_mfma_f32_16x16x32_bf16 v[72:75], a[180:183], v[100:103], v[72:75]
    ds_read_b128 v[120:123], v7 offset:28672
    v_mov_b32 v145, v144
    v_mfma_f32_16x16x32_bf16 v[76:79], a[184:187], v[100:103], v[76:79]
    buffer_load_dwordx4 a[232:235], v3, s[4:7], s33 offen offset:2048
    v_mfma_f32_16x16x32_bf16 v[80:83], a[188:191], v[100:103], v[80:83]
    s_waitcnt lgkmcnt(3)
    v_permlane32_swap_b32 v144, v145
    v_add_f32 v144, v144, v145
    v_mfma_f32_16x16x32_bf16 v[84:87], v[248:251], v[104:107], 0
    ds_read_b128 v[124:127], v7 offset:30720
    v_mov_b32 v145, v144
    v_mfma_f32_16x16x32_bf16 v[88:91], v[244:247], v[104:107], 0
    buffer_load_dwordx4 a[236:239], v3, s[4:7], s33 offen offset:3072
    v_mfma_f32_16x16x32_bf16 v[92:95], v[240:243], v[104:107], 0
    s_add_u32 s33, s62, 12288
    v_permlane16_swap_b32 v144, v145
    v_mul_f32 v146, s64, v144
    v_mfma_f32_16x16x32_bf16 v[84:87], v[236:239], v[108:111], v[84:87]
    ds_read_b128 v[96:99], v7 offset:32768
    v_mul_f32 v145, s64, v145
    v_mfma_f32_16x16x32_bf16 v[88:91], v[232:235], v[108:111], v[88:91]
    buffer_load_dwordx4 a[240:243], v1, s[4:7], s33 offen offset:0
    v_mfma_f32_16x16x32_bf16 v[92:95], v[228:231], v[108:111], v[92:95]
    s_waitcnt lgkmcnt(3)
    v_fma_f32 v145, -v146, v146, v145
    v_max_f32 v145, 0, v145
    v_mfma_f32_16x16x32_bf16 v[84:87], v[224:227], v[112:115], v[84:87]
    ds_read_b128 v[100:103], v7 offset:34816
    v_add_f32 v145, s65, v145
    v_mfma_f32_16x16x32_bf16 v[88:91], v[220:223], v[112:115], v[88:91]
    v_rsq_f32 v147, v145
    v_mfma_f32_16x16x32_bf16 v[92:95], v[216:219], v[112:115], v[92:95]
    buffer_load_dwordx4 a[244:247], v1, s[4:7], s33 offen offset:1024
    v_mfma_f32_16x16x32_bf16 v[84:87], v[212:215], v[116:119], v[84:87]
    ds_read_b128 v[104:107], v7 offset:36864
    v_add_u32 v144, s0, v17
    v_mfma_f32_16x16x32_bf16 v[88:91], v[208:211], v[116:119], v[88:91]
    ds_write_b64 v144, v[146:147] offset:0
    v_mfma_f32_16x16x32_bf16 v[92:95], v[204:207], v[116:119], v[92:95]
    s_waitcnt lgkmcnt(4)
    buffer_load_dwordx4 a[248:251], v1, s[4:7], s33 offen offset:2048
    v_mfma_f32_16x16x32_bf16 v[84:87], v[164:167], v[120:123], v[84:87]
    ds_read_b128 v[108:111], v7 offset:38912
    v_mfma_f32_16x16x32_bf16 v[88:91], v[168:171], v[120:123], v[88:91]
    v_mfma_f32_16x16x32_bf16 v[92:95], v[172:175], v[120:123], v[92:95]
    v_mfma_f32_16x16x32_bf16 v[84:87], v[200:203], v[124:127], v[84:87]
    s_waitcnt vmcnt(12)
    s_barrier
    ds_read_b128 v[112:115], v6 offset:0
    v_mfma_f32_16x16x32_bf16 v[88:91], v[196:199], v[124:127], v[88:91]
    buffer_load_dwordx4 a[252:255], v1, s[4:7], s33 offen offset:3072
    v_mfma_f32_16x16x32_bf16 v[92:95], v[192:195], v[124:127], v[92:95]
    s_waitcnt lgkmcnt(4)
    v_mfma_f32_16x16x32_bf16 v[84:87], v[188:191], v[96:99], v[84:87]
    ds_read_b128 v[116:119], v6 offset:2048
    v_mfma_f32_16x16x32_bf16 v[88:91], v[184:187], v[96:99], v[88:91]
    buffer_load_dwordx4 v[252:255], v2, s[4:7], s33 offen offset:0
    v_mfma_f32_16x16x32_bf16 v[92:95], v[180:183], v[96:99], v[92:95]
    v_mfma_f32_16x16x32_bf16 v[84:87], v[176:179], v[100:103], v[84:87]
    ds_read_b128 v[120:123], v6 offset:4096
    v_mfma_f32_16x16x32_bf16 v[88:91], a[160:163], v[100:103], v[88:91]
    s_add_u32 m0, s84, 84992
    s_nop 0
    buffer_load_dwordx4 v2, s[4:7], s33 offen offset:1024 lds
    v_mfma_f32_16x16x32_bf16 v[92:95], a[164:167], v[100:103], v[92:95]
    s_waitcnt lgkmcnt(3)
    v_mfma_f32_16x16x32_bf16 v[84:87], a[168:171], v[104:107], v[84:87]
    ds_read_b128 v[124:127], v6 offset:6144
    v_mfma_f32_16x16x32_bf16 v[88:91], a[172:175], v[104:107], v[88:91]
    ds_write_b128 v18, v[72:75] offset:0
    v_mfma_f32_16x16x32_bf16 v[92:95], a[176:179], v[104:107], v[92:95]
    s_add_u32 m0, s84, 88064
    s_nop 0
    buffer_load_dwordx4 v2, s[4:7], s33 offen offset:2048 lds
    v_mfma_f32_16x16x32_bf16 v[84:87], a[180:183], v[108:111], v[84:87]
    ds_read_b128 v[96:99], v6 offset:8192
    v_mfma_f32_16x16x32_bf16 v[88:91], a[184:187], v[108:111], v[88:91]
    ds_write_b128 v18, v[76:79] offset:1024
    v_mfma_f32_16x16x32_bf16 v[92:95], a[188:191], v[108:111], v[92:95]
    s_waitcnt lgkmcnt(5)
    s_add_u32 m0, s84, 91136
    s_nop 0
    buffer_load_dwordx4 v2, s[4:7], s33 offen offset:3072 lds
    ds_write_b128 v18, v[80:83] offset:2048
    v_mfma_f32_16x16x32_bf16 v[48:51], v[248:251], v[112:115], 0
    s_waitcnt vmcnt(10)
poll_24:
    v_cmp_le_u32 vcc, 3, v29
    s_nop 0
    s_andn2_b64 s[56:57], s[38:39], vcc
    s_cbranch_scc1 pollr_23
    s_cmp_lg_u32 s28, 0
    s_cbranch_scc1 acq_25
polld_26:
    ds_read_b128 v[100:103], v6 offset:10240
    v_mfma_f32_16x16x32_bf16 v[52:55], v[244:247], v[112:115], 0
    s_add_u32 m0, s72, 4096
    v_mfma_f32_16x16x32_bf16 v[56:59], v[240:243], v[112:115], 0
    v_mfma_f32_16x16x32_bf16 v[48:51], v[236:239], v[116:119], v[48:51]
    ds_read_b128 v[104:107], v6 offset:12288
    v_mfma_f32_16x16x32_bf16 v[52:55], v[232:235], v[116:119], v[52:55]
    buffer_load_dwordx4 v1, s[16:19], m0 offen offset:0 sc1 lds
    v_mfma_f32_16x16x32_bf16 v[56:59], v[228:231], v[116:119], v[56:59]
    s_waitcnt lgkmcnt(6)
    ds_write_b128 v18, v[84:87] offset:3072
    v_mfma_f32_16x16x32_bf16 v[48:51], v[224:227], v[120:123], v[48:51]
    s_add_u32 m0, s72, 8192
    ds_read_b128 v[108:111], v6 offset:14336
    v_mfma_f32_16x16x32_bf16 v[52:55], v[220:223], v[120:123], v[52:55]
    buffer_load_dwordx4 v1, s[16:19], m0 offen offset:0 sc1 lds
    v_mfma_f32_16x16x32_bf16 v[56:59], v[216:219], v[120:123], v[56:59]
    s_add_u32 m0, s72, 12288
    ds_write_b128 v18, v[88:91] offset:4096
    v_mfma_f32_16x16x32_bf16 v[48:51], v[212:215], v[124:127], v[48:51]
    ds_read_b128 v[112:115], v6 offset:16384
    v_mfma_f32_16x16x32_bf16 v[52:55], v[208:211], v[124:127], v[52:55]
    buffer_load_dwordx4 v1, s[16:19], m0 offen offset:0 sc1 lds
    v_mfma_f32_16x16x32_bf16 v[56:59], v[204:207], v[124:127], v[56:59]
    s_waitcnt lgkmcnt(5)
    ds_write_b128 v18, v[92:95] offset:5120
    v_mfma_f32_16x16x32_bf16 v[48:51], v[164:167], v[96:99], v[48:51]
    s_add_u32 m0, s72, 16384
    ds_read_b128 v[116:119], v6 offset:18432
    v_mfma_f32_16x16x32_bf16 v[52:55], v[168:171], v[96:99], v[52:55]
    v_mfma_f32_16x16x32_bf16 v[56:59], v[172:175], v[96:99], v[56:59]
    buffer_load_dwordx4 v1, s[16:19], m0 offen offset:0 sc1 lds
    v_mfma_f32_16x16x32_bf16 v[48:51], v[200:203], v[100:103], v[48:51]
    s_add_u32 m0, s72, 20480
    s_waitcnt lgkmcnt(1)
    s_barrier
    ds_read_b128 v[120:123], v6 offset:20480
    v_mfma_f32_16x16x32_bf16 v[52:55], v[196:199], v[100:103], v[52:55]
    v_add_u32 v46, s69, v17
    ds_read_b64 v[46:47], v46 offset:0
    ds_read_b128 v[72:75], v19 offset:0
    v_mfma_f32_16x16x32_bf16 v[56:59], v[192:195], v[100:103], v[56:59]
    buffer_load_dwordx4 v1, s[16:19], m0 offen offset:0 sc1 lds
    ds_read_b128 v[76:79], v19 offset:1024
    v_mfma_f32_16x16x32_bf16 v[48:51], v[188:191], v[104:107], v[48:51]
    s_add_u32 s88, s98, 65536
    ds_read_b128 v[124:127], v6 offset:22528
    ds_read_b128 v[80:83], v19 offset:2048
    v_add_u32 v162, s69, v17
    v_mfma_f32_16x16x32_bf16 v[52:55], v[184:187], v[104:107], v[52:55]
    ds_read_b64 v[162:163], v162 offset:128
    ds_read_b128 v[84:87], v19 offset:3072
    ds_read_b128 v[88:91], v19 offset:4096
    v_mfma_f32_16x16x32_bf16 v[56:59], v[180:183], v[104:107], v[56:59]
    ds_read_b128 v[92:95], v19 offset:5120
    v_mfma_f32_16x16x32_bf16 v[48:51], v[176:179], v[108:111], v[48:51]
    ds_read_b128 v[96:99], v6 offset:24576
    buffer_load_dwordx4 v[144:147], v1, s[4:7], s88 offen sc1
    v_mfma_f32_16x16x32_bf16 v[52:55], a[160:163], v[108:111], v[52:55]
    s_add_u32 m0, s73, 4096
    v_mfma_f32_16x16x32_bf16 v[56:59], a[164:167], v[108:111], v[56:59]
    s_waitcnt lgkmcnt(11)
    v_mfma_f32_16x16x32_bf16 v[48:51], a[168:171], v[112:115], v[48:51]
    ds_read_b128 v[100:103], v6 offset:26624
    buffer_load_dwordx4 v1, s[16:19], m0 offen offset:0 sc1 lds
    v_mfma_f32_16x16x32_bf16 v[52:55], a[172:175], v[112:115], v[52:55]
    s_add_u32 m0, s73, 8192
    s_waitcnt lgkmcnt(6)
    v_fma_f32 v72, -v128, v46, v72
    v_fma_f32 v73, -v129, v46, v73
    v_mfma_f32_16x16x32_bf16 v[56:59], a[176:179], v[112:115], v[56:59]
    v_fma_f32 v74, -v130, v46, v74
    v_fma_f32 v75, -v131, v46, v75
    v_fma_f32 v72, v72, v47, v132
    v_mfma_f32_16x16x32_bf16 v[48:51], a[180:183], v[116:119], v[48:51]
    ds_read_b128 v[104:107], v6 offset:28672
    v_fma_f32 v73, v73, v47, v133
    v_mfma_f32_16x16x32_bf16 v[52:55], a[184:187], v[116:119], v[52:55]
    buffer_load_dwordx4 v1, s[16:19], m0 offen offset:0 sc1 lds
    v_mfma_f32_16x16x32_bf16 v[56:59], a[188:191], v[116:119], v[56:59]
    s_add_u32 m0, s73, 12288
    v_fma_f32 v74, v74, v47, v134
    v_fma_f32 v75, v75, v47, v135
    v_mfma_f32_16x16x32_bf16 v[60:63], v[248:251], v[120:123], 0
    ds_read_b128 v[108:111], v6 offset:30720
    v_fma_f32 v76, -v136, v46, v76
    v_mfma_f32_16x16x32_bf16 v[64:67], v[244:247], v[120:123], 0
    v_fma_f32 v77, -v137, v46, v77
    v_fma_f32 v78, -v138, v46, v78
    v_mfma_f32_16x16x32_bf16 v[68:71], v[240:243], v[120:123], 0
    buffer_load_dwordx4 v1, s[16:19], m0 offen offset:0 sc1 lds
    v_mfma_f32_16x16x32_bf16 v[60:63], v[236:239], v[124:127], v[60:63]
    s_add_u32 m0, s73, 16384
    ds_read_b128 v[112:115], v6 offset:32768
    v_fma_f32 v79, -v139, v46, v79
    v_fma_f32 v76, v76, v47, v140
    v_mfma_f32_16x16x32_bf16 v[64:67], v[232:235], v[124:127], v[64:67]
    v_fma_f32 v77, v77, v47, v141
    v_fma_f32 v78, v78, v47, v142
    v_fma_f32 v79, v79, v47, v143
    v_mfma_f32_16x16x32_bf16 v[68:71], v[228:231], v[124:127], v[68:71]
    s_waitcnt lgkmcnt(3)
    buffer_load_dwordx4 v1, s[16:19], m0 offen offset:0 sc1 lds
    v_fma_f32 v80, -v148, v46, v80
    v_mfma_f32_16x16x32_bf16 v[60:63], v[224:227], v[96:99], v[60:63]
    s_add_u32 m0, s73, 20480
    ds_read_b128 v[116:119], v6 offset:34816
    v_fma_f32 v81, -v149, v46, v81
    v_fma_f32 v82, -v150, v46, v82
    v_mfma_f32_16x16x32_bf16 v[64:67], v[220:223], v[96:99], v[64:67]
    v_fma_f32 v83, -v151, v46, v83
    v_fma_f32 v80, v80, v47, v152
    v_fma_f32 v81, v81, v47, v153
    v_mfma_f32_16x16x32_bf16 v[68:71], v[216:219], v[96:99], v[68:71]
    v_fma_f32 v82, v82, v47, v154
    v_fma_f32 v83, v83, v47, v155
    v_fma_f32 v84, -v128, v162, v84
    v_mfma_f32_16x16x32_bf16 v[60:63], v[212:215], v[100:103], v[60:63]
    ds_read_b128 v[120:123], v6 offset:36864
    buffer_load_dwordx4 v1, s[16:19], m0 offen offset:0 sc1 lds
    v_mfma_f32_16x16x32_bf16 v[64:67], v[208:211], v[100:103], v[64:67]
    v_fma_f32 v85, -v129, v162, v85
    v_fma_f32 v86, -v130, v162, v86
    v_fma_f32 v87, -v131, v162, v87
    v_mfma_f32_16x16x32_bf16 v[68:71], v[204:207], v[100:103], v[68:71]
    s_waitcnt lgkmcnt(3)
    v_fma_f32 v84, v84, v163, v132
    v_fma_f32 v85, v85, v163, v133
    v_fma_f32 v86, v86, v163, v134
    v_mfma_f32_16x16x32_bf16 v[60:63], v[164:167], v[104:107], v[60:63]
    ds_read_b128 v[124:127], v6 offset:38912
    s_add_u32 m0, s84, 98304
    s_nop 0
    buffer_load_dwordx4 v3, s[4:7], s33 offen offset:0 lds
    v_mfma_f32_16x16x32_bf16 v[64:67], v[168:171], v[104:107], v[64:67]
    v_fma_f32 v87, v87, v163, v135
    v_fma_f32 v88, -v136, v162, v88
    v_fma_f32 v89, -v137, v162, v89
    v_mfma_f32_16x16x32_bf16 v[68:71], v[172:175], v[104:107], v[68:71]
    v_fma_f32 v90, -v138, v162, v90
    v_fma_f32 v91, -v139, v162, v91
    v_fma_f32 v88, v88, v163, v140
    v_mfma_f32_16x16x32_bf16 v[60:63], v[200:203], v[108:111], v[60:63]
    s_waitcnt vmcnt(7)
    s_barrier
    ds_read_b128 v[96:99], v7 offset:0
    v_fma_f32 v89, v89, v163, v141
    v_mfma_f32_16x16x32_bf16 v[64:67], v[196:199], v[108:111], v[64:67]
    s_add_u32 m0, s70, 4096
    s_nop 0
    buffer_load_dwordx4 v1, s[16:19], m0 offen offset:0 sc1 lds
    v_mfma_f32_16x16x32_bf16 v[68:71], v[192:195], v[108:111], v[68:71]
    s_waitcnt lgkmcnt(3)
    v_fma_f32 v90, v90, v163, v142
    v_fma_f32 v91, v91, v163, v143
    v_fma_f32 v92, -v148, v162, v92
    v_mfma_f32_16x16x32_bf16 v[60:63], v[188:191], v[112:115], v[60:63]
    s_add_u32 m0, s70, 8192
    ds_read_b128 v[100:103], v7 offset:2048
    v_fma_f32 v93, -v149, v162, v93
    v_fma_f32 v94, -v150, v162, v94
    v_mfma_f32_16x16x32_bf16 v[64:67], v[184:187], v[112:115], v[64:67]
    buffer_load_dwordx4 v1, s[16:19], m0 offen offset:0 sc1 lds
    v_fma_f32 v95, -v151, v162, v95
    v_mfma_f32_16x16x32_bf16 v[68:71], v[180:183], v[112:115], v[68:71]
    s_add_u32 m0, s70, 12288
    v_fma_f32 v92, v92, v163, v152
    v_fma_f32 v93, v93, v163, v153
    v_mfma_f32_16x16x32_bf16 v[60:63], v[176:179], v[116:119], v[60:63]
    ds_read_b128 v[104:107], v7 offset:4096
    v_fma_f32 v94, v94, v163, v154
    v_mfma_f32_16x16x32_bf16 v[64:67], a[160:163], v[116:119], v[64:67]
    v_fma_f32 v95, v95, v163, v155
    s_add_u32 s90, s94, 0
    v_mfma_f32_16x16x32_bf16 v[68:71], a[164:167], v[116:119], v[68:71]
    s_waitcnt lgkmcnt(3)
    buffer_load_dwordx4 v1, s[16:19], m0 offen offset:0 sc1 lds
    v_mfma_f32_16x16x32_bf16 v[60:63], a[168:171], v[120:123], v[60:63]
    s_add_u32 m0, s70, 16384
    ds_read_b128 v[108:111], v7 offset:6144
    v_fma_f32 v48, v48, v47, v72
    v_mfma_f32_16x16x32_bf16 v[64:67], a[172:175], v[120:123], v[64:67]
    v_fma_f32 v49, v49, v47, v73
    v_fma_f32 v50, v50, v47, v74
    v_mfma_f32_16x16x32_bf16 v[68:71], a[176:179], v[120:123], v[68:71]
    buffer_load_dwordx4 v1, s[16:19], m0 offen offset:0 sc1 lds
    v_mfma_f32_16x16x32_bf16 v[60:63], a[180:183], v[124:127], v[60:63]
    s_add_u32 m0, s70, 20480
    ds_read_b128 v[112:115], v7 offset:8192
    v_fma_f32 v51, v51, v47, v75
    v_mfma_f32_16x16x32_bf16 v[64:67], a[184:187], v[124:127], v[64:67]
    v_fma_f32 v52, v52, v47, v76
    v_fma_f32 v53, v53, v47, v77
    v_mfma_f32_16x16x32_bf16 v[68:71], a[188:191], v[124:127], v[68:71]
    s_waitcnt lgkmcnt(3)
    v_fma_f32 v54, v54, v47, v78
    v_fma_f32 v55, v55, v47, v79
    v_fma_f32 v56, v56, v47, v80
    v_fma_f32 v57, v57, v47, v81
    v_fma_f32 v58, v58, v47, v82
    v_fma_f32 v59, v59, v47, v83
    v_mfma_f32_16x16x32_bf16 v[72:75], v[248:251], v[96:99], 0
    ds_read_b128 v[116:119], v7 offset:10240
    v_mul_f32 v48, v48, abs(v48)
    v_mfma_f32_16x16x32_bf16 v[76:79], v[244:247], v[96:99], 0
    buffer_load_dwordx4 v1, s[16:19], m0 offen offset:0 sc1 lds
    v_mfma_f32_16x16x32_bf16 v[80:83], v[240:243], v[96:99], 0
    v_mul_f32 v49, v49, abs(v49)
    v_mul_f32 v50, v50, abs(v50)
    v_mfma_f32_16x16x32_bf16 v[72:75], v[236:239], v[100:103], v[72:75]
    ds_read_b128 v[120:123], v7 offset:12288
    v_mul_f32 v51, v51, abs(v51)
    v_cvt_pk_bf16_f32 v156, v48, v49
    v_mfma_f32_16x16x32_bf16 v[76:79], v[232:235], v[100:103], v[76:79]
    s_add_u32 m0, s84, 101376
    s_nop 0
    buffer_load_dwordx4 v3, s[4:7], s33 offen offset:1024 lds
    v_mfma_f32_16x16x32_bf16 v[80:83], v[228:231], v[100:103], v[80:83]
    s_waitcnt lgkmcnt(3)
    v_cvt_pk_bf16_f32 v157, v50, v51
    v_pk_max_i16 v156, v156, 0
    v_pk_max_i16 v157, v157, 0
    v_mfma_f32_16x16x32_bf16 v[72:75], v[224:227], v[104:107], v[72:75]
    ds_read_b128 v[124:127], v7 offset:14336
    v_mul_f32 v52, v52, abs(v52)
    v_mul_f32 v53, v53, abs(v53)
    v_mfma_f32_16x16x32_bf16 v[76:79], v[220:223], v[104:107], v[76:79]
    s_add_u32 m0, s84, 129024
    s_nop 0
    buffer_load_dwordx4 v3, s[4:7], s33 offen offset:2048 lds
    v_mfma_f32_16x16x32_bf16 v[80:83], v[216:219], v[104:107], v[80:83]
    v_mul_f32 v54, v54, abs(v54)
    v_mul_f32 v55, v55, abs(v55)
    v_cvt_pk_bf16_f32 v158, v52, v53
    v_mfma_f32_16x16x32_bf16 v[72:75], v[212:215], v[108:111], v[72:75]
    ds_read_b128 v[96:99], v7 offset:16384
    v_cvt_pk_bf16_f32 v159, v54, v55
    v_pk_max_i16 v158, v158, 0
    v_mfma_f32_16x16x32_bf16 v[76:79], v[208:211], v[108:111], v[76:79]
    v_pk_max_i16 v159, v159, 0
    buffer_store_dwordx4 v[156:159], v27, s[4:7], s90 offen
    v_mfma_f32_16x16x32_bf16 v[80:83], v[204:207], v[108:111], v[80:83]
    s_waitcnt lgkmcnt(3)
    s_add_u32 m0, s84, 132096
    s_nop 0
    buffer_load_dwordx4 v3, s[4:7], s33 offen offset:3072 lds
    v_mfma_f32_16x16x32_bf16 v[72:75], v[164:167], v[112:115], v[72:75]
    s_add_u32 s33, s62, 24576
    ds_read_b128 v[100:103], v7 offset:18432
    v_mul_f32 v56, v56, abs(v56)
    v_mul_f32 v57, v57, abs(v57)
    v_mfma_f32_16x16x32_bf16 v[76:79], v[168:171], v[112:115], v[76:79]
    v_mul_f32 v58, v58, abs(v58)
    v_mul_f32 v59, v59, abs(v59)
    v_cvt_pk_bf16_f32 v160, v56, v57
    v_mfma_f32_16x16x32_bf16 v[80:83], v[172:175], v[112:115], v[80:83]
    s_add_u32 m0, s84, 139264
    s_nop 0
    buffer_load_dwordx4 v1, s[4:7], s33 offen offset:0 lds
    v_mfma_f32_16x16x32_bf16 v[72:75], v[200:203], v[116:119], v[72:75]
    s_waitcnt vmcnt(11)
    s_barrier
    ds_read_b128 v[104:107], v7 offset:20480
    v_cvt_pk_bf16_f32 v161, v58, v59
    v_mfma_f32_16x16x32_bf16 v[76:79], v[196:199], v[116:119], v[76:79]
    s_add_u32 m0, s71, 4096
    s_nop 0
    buffer_load_dwordx4 v1, s[16:19], m0 offen offset:0 sc1 lds
    v_mfma_f32_16x16x32_bf16 v[80:83], v[192:195], v[116:119], v[80:83]
    s_waitcnt lgkmcnt(3)
    v_pk_max_i16 v160, v160, 0
    v_pk_max_i16 v161, v161, 0
    v_mfma_f32_16x16x32_bf16 v[72:75], v[188:191], v[120:123], v[72:75]
    s_add_u32 m0, s71, 8192
    ds_read_b128 v[108:111], v7 offset:22528
    buffer_store_dwordx2 v[160:161], v26, s[4:7], s90 offen offset:1024
    v_mfma_f32_16x16x32_bf16 v[76:79], v[184:187], v[120:123], v[76:79]
    s_add_u32 s90, s94, 49152
    buffer_load_dwordx4 v1, s[16:19], m0 offen offset:0 sc1 lds
    v_mfma_f32_16x16x32_bf16 v[80:83], v[180:183], v[120:123], v[80:83]
    s_add_u32 m0, s71, 12288
    s_nop 0
    buffer_load_dwordx4 v1, s[16:19], m0 offen offset:0 sc1 lds
    v_mfma_f32_16x16x32_bf16 v[72:75], v[176:179], v[124:127], v[72:75]
    s_add_u32 m0, s71, 16384
    ds_read_b128 v[112:115], v7 offset:24576
    v_fma_f32 v60, v60, v163, v84
    v_mfma_f32_16x16x32_bf16 v[76:79], a[160:163], v[124:127], v[76:79]
    buffer_load_dwordx4 v1, s[16:19], m0 offen offset:0 sc1 lds
    v_mfma_f32_16x16x32_bf16 v[80:83], a[164:167], v[124:127], v[80:83]
    s_waitcnt lgkmcnt(3)
    v_fma_f32 v61, v61, v163, v85
    v_fma_f32 v62, v62, v163, v86
    v_mfma_f32_16x16x32_bf16 v[72:75], a[168:171], v[96:99], v[72:75]
    s_add_u32 m0, s71, 20480
    ds_read_b128 v[116:119], v7 offset:26624
    v_fma_f32 v63, v63, v163, v87
    v_mfma_f32_16x16x32_bf16 v[76:79], a[172:175], v[96:99], v[76:79]
    buffer_load_dwordx4 v1, s[16:19], m0 offen offset:0 sc1 lds
    v_mfma_f32_16x16x32_bf16 v[80:83], a[176:179], v[96:99], v[80:83]
    s_lshl_b32 s88, s27, 2
    v_fma_f32 v64, v64, v163, v88
    v_fma_f32 v65, v65, v163, v89
    v_mfma_f32_16x16x32_bf16 v[72:75], a[180:183], v[100:103], v[72:75]
    s_add_u32 s88, s88, s24
    ds_read_b128 v[120:123], v7 offset:28672
    v_fma_f32 v66, v66, v163, v90
    v_mfma_f32_16x16x32_bf16 v[76:79], a[184:187], v[100:103], v[76:79]
    s_lshl_b32 s88, s88, 11
    v_fma_f32 v67, v67, v163, v91
    v_fma_f32 v68, v68, v163, v92
    v_mfma_f32_16x16x32_bf16 v[80:83], a[188:191], v[100:103], v[80:83]
    s_waitcnt lgkmcnt(3)
    v_lshlrev_b32 v31, 5, v5
    v_and_b32 v31, 0x780, v31
    buffer_load_dword v0, v31, s[20:23], s88 offen
    v_fma_f32 v69, v69, v163, v93
    v_fma_f32 v70, v70, v163, v94
    v_fma_f32 v71, v71, v163, v95
    v_mfma_f32_16x16x32_bf16 v[84:87], v[248:251], v[104:107], 0
    ds_read_b128 v[124:127], v7 offset:30720
    v_mul_f32 v60, v60, abs(v60)
    v_mfma_f32_16x16x32_bf16 v[88:91], v[244:247], v[104:107], 0
    v_mul_f32 v61, v61, abs(v61)
    v_mul_f32 v62, v62, abs(v62)
    v_mfma_f32_16x16x32_bf16 v[92:95], v[240:243], v[104:107], 0
    s_add_u32 m0, s84, 142336
    s_nop 0
    buffer_load_dwordx4 v1, s[4:7], s33 offen offset:1024 lds
    v_mfma_f32_16x16x32_bf16 v[84:87], v[236:239], v[108:111], v[84:87]
    ds_read_b128 v[96:99], v7 offset:32768
    v_mul_f32 v63, v63, abs(v63)
    v_mfma_f32_16x16x32_bf16 v[88:91], v[232:235], v[108:111], v[88:91]
    v_cvt_pk_bf16_f32 v156, v60, v61
    v_cvt_pk_bf16_f32 v157, v62, v63
    v_mfma_f32_16x16x32_bf16 v[92:95], v[228:231], v[108:111], v[92:95]
    s_waitcnt lgkmcnt(3)
    s_add_u32 m0, s84, 145408
    s_nop 0
    buffer_load_dwordx4 v1, s[4:7], s33 offen offset:2048 lds
    v_mfma_f32_16x16x32_bf16 v[84:87], v[224:227], v[112:115], v[84:87]
    ds_read_b128 v[100:103], v7 offset:34816
    v_pk_max_i16 v156, v156, 0
    v_mfma_f32_16x16x32_bf16 v[88:91], v[220:223], v[112:115], v[88:91]
    v_pk_max_i16 v157, v157, 0
    v_mul_f32 v64, v64, abs(v64)
    v_mfma_f32_16x16x32_bf16 v[92:95], v[216:219], v[112:115], v[92:95]
    v_mul_f32 v65, v65, abs(v65)
    v_mul_f32 v66, v66, abs(v66)
    v_mfma_f32_16x16x32_bf16 v[84:87], v[212:215], v[116:119], v[84:87]
    ds_read_b128 v[104:107], v7 offset:36864
    v_mul_f32 v67, v67, abs(v67)
    v_mfma_f32_16x16x32_bf16 v[88:91], v[208:211], v[116:119], v[88:91]
    s_add_u32 m0, s84, 148480
    s_nop 0
    buffer_load_dwordx4 v1, s[4:7], s33 offen offset:3072 lds
    v_mfma_f32_16x16x32_bf16 v[92:95], v[204:207], v[116:119], v[92:95]
    s_waitcnt lgkmcnt(3)
    v_cvt_pk_bf16_f32 v158, v64, v65
    v_cvt_pk_bf16_f32 v159, v66, v67
    v_mfma_f32_16x16x32_bf16 v[84:87], v[164:167], v[120:123], v[84:87]
    ds_read_b128 v[108:111], v7 offset:38912
    v_pk_max_i16 v158, v158, 0
    v_mfma_f32_16x16x32_bf16 v[88:91], v[168:171], v[120:123], v[88:91]
    s_add_u32 m0, s84, 155648
    s_nop 0
    buffer_load_dwordx4 v2, s[4:7], s33 offen offset:0 lds
    v_mfma_f32_16x16x32_bf16 v[92:95], v[172:175], v[120:123], v[92:95]
    v_pk_max_i16 v159, v159, 0
    buffer_store_dwordx4 v[156:159], v27, s[4:7], s90 offen
    v_mfma_f32_16x16x32_bf16 v[84:87], v[200:203], v[124:127], v[84:87]
    s_waitcnt vmcnt(17)
    s_barrier
    ds_read_b128 v[112:115], v6 offset:0
    v_mfma_f32_16x16x32_bf16 v[88:91], v[196:199], v[124:127], v[88:91]
    s_add_u32 m0, s84, 158720
    s_nop 0
    buffer_load_dwordx4 v2, s[4:7], s33 offen offset:1024 lds
    v_mfma_f32_16x16x32_bf16 v[92:95], v[192:195], v[124:127], v[92:95]
    s_waitcnt lgkmcnt(3)
    v_mul_f32 v68, v68, abs(v68)
    v_mul_f32 v69, v69, abs(v69)
    v_mfma_f32_16x16x32_bf16 v[84:87], v[188:191], v[96:99], v[84:87]
    ds_read_b128 v[116:119], v6 offset:2048
    v_mul_f32 v70, v70, abs(v70)
    v_mfma_f32_16x16x32_bf16 v[88:91], v[184:187], v[96:99], v[88:91]
    v_mul_f32 v71, v71, abs(v71)
    v_cvt_pk_bf16_f32 v160, v68, v69
    v_mfma_f32_16x16x32_bf16 v[92:95], v[180:183], v[96:99], v[92:95]
    v_cvt_pk_bf16_f32 v161, v70, v71
    v_pk_max_i16 v160, v160, 0
    v_mfma_f32_16x16x32_bf16 v[84:87], v[176:179], v[100:103], v[84:87]
    ds_read_b128 v[120:123], v6 offset:4096
    v_pk_max_i16 v161, v161, 0
    v_mfma_f32_16x16x32_bf16 v[88:91], a[160:163], v[100:103], v[88:91]
    buffer_store_dwordx2 v[160:161], v26, s[4:7], s90 offen offset:1024
    v_mfma_f32_16x16x32_bf16 v[92:95], a[164:167], v[100:103], v[92:95]
    s_waitcnt lgkmcnt(3)
    v_add_f32 v144, v144, v146
    v_add_f32 v145, v145, v147
    v_mfma_f32_16x16x32_bf16 v[84:87], a[168:171], v[104:107], v[84:87]
    ds_read_b128 v[124:127], v6 offset:6144
    v_mfma_f32_16x16x32_bf16 v[88:91], a[172:175], v[104:107], v[88:91]
    ds_write_b128 v18, v[72:75] offset:0
    v_mfma_f32_16x16x32_bf16 v[92:95], a[176:179], v[104:107], v[92:95]
    v_mfma_f32_16x16x32_bf16 v[84:87], a[180:183], v[108:111], v[84:87]
    ds_read_b128 v[96:99], v6 offset:8192
    v_mfma_f32_16x16x32_bf16 v[88:91], a[184:187], v[108:111], v[88:91]
    ds_write_b128 v18, v[76:79] offset:1024
    v_mfma_f32_16x16x32_bf16 v[92:95], a[188:191], v[108:111], v[92:95]
    s_waitcnt lgkmcnt(5)
    ds_write_b128 v18, v[80:83] offset:2048
    v_mfma_f32_16x16x32_bf16 v[48:51], v[248:251], v[112:115], 0
    ds_read_b128 v[100:103], v6 offset:10240
    v_mfma_f32_16x16x32_bf16 v[52:55], v[244:247], v[112:115], 0
    v_mfma_f32_16x16x32_bf16 v[56:59], v[240:243], v[112:115], 0
    v_mfma_f32_16x16x32_bf16 v[48:51], v[236:239], v[116:119], v[48:51]
    ds_read_b128 v[104:107], v6 offset:12288
    v_mfma_f32_16x16x32_bf16 v[52:55], v[232:235], v[116:119], v[52:55]
    ds_write_b128 v18, v[84:87] offset:3072
    v_mfma_f32_16x16x32_bf16 v[56:59], v[228:231], v[116:119], v[56:59]
    s_waitcnt lgkmcnt(7)
    v_mfma_f32_16x16x32_bf16 v[48:51], v[224:227], v[120:123], v[48:51]
    v_mov_b32 v30, 4
    s_mov_b64 exec, 1
    s_cmp_lg_u32 s28, 0
    s_waitcnt vmcnt(0)
    s_cbranch_scc1 pubs_27
    buffer_store_dword v30, off, s[4:7], s32
pubd_28:
    s_mov_b64 exec, -1
    ds_read_b128 v[108:111], v6 offset:14336
    v_mfma_f32_16x16x32_bf16 v[52:55], v[220:223], v[120:123], v[52:55]
    ds_write_b128 v18, v[88:91] offset:4096
    v_mfma_f32_16x16x32_bf16 v[56:59], v[216:219], v[120:123], v[56:59]
    v_mfma_f32_16x16x32_bf16 v[48:51], v[212:215], v[124:127], v[48:51]
    ds_read_b128 v[112:115], v6 offset:16384
    v_mfma_f32_16x16x32_bf16 v[52:55], v[208:211], v[124:127], v[52:55]
    ds_write_b128 v18, v[92:95] offset:5120
    v_mfma_f32_16x16x32_bf16 v[56:59], v[204:207], v[124:127], v[56:59]
    s_waitcnt lgkmcnt(6)
    v_mfma_f32_16x16x32_bf16 v[48:51], v[164:167], v[96:99], v[48:51]
    ds_read_b128 v[116:119], v6 offset:18432
    v_permlane16_swap_b32 v144, v145
    v_mfma_f32_16x16x32_bf16 v[52:55], v[168:171], v[96:99], v[52:55]
    v_add_f32 v144, v144, v145
    v_mov_b32 v145, v144
    v_mfma_f32_16x16x32_bf16 v[56:59], v[172:175], v[96:99], v[56:59]
    s_nop 0
    v_permlane32_swap_b32 v144, v145
    v_add_f32 v144, v144, v145
    v_mfma_f32_16x16x32_bf16 v[48:51], v[200:203], v[100:103], v[48:51]
    v_mov_b32 v145, v144
    s_nop 1
    v_permlane16_swap_b32 v144, v145
    v_mul_f32 v146, s64, v144
    v_mul_f32 v145, s64, v145
    v_fma_f32 v145, -v146, v146, v145
    v_max_f32 v145, 0, v145
    v_add_f32 v145, s65, v145
    v_rsq_f32 v147, v145
    v_add_u32 v144, s0, v17
    ds_write_b64 v144, v[146:147] offset:512
    s_waitcnt lgkmcnt(0)
    s_barrier
    ds_read_b128 v[120:123], v6 offset:20480
    v_mfma_f32_16x16x32_bf16 v[52:55], v[196:199], v[100:103], v[52:55]
    v_add_u32 v46, s69, v17
    ds_read_b64 v[46:47], v46 offset:512
    ds_read_b128 v[72:75], v19 offset:0
    v_mfma_f32_16x16x32_bf16 v[56:59], v[192:195], v[100:103], v[56:59]
    ds_read_b128 v[76:79], v19 offset:1024
    ds_read_b128 v[80:83], v19 offset:2048
    v_add_u32 v162, s69, v17
    v_mfma_f32_16x16x32_bf16 v[48:51], v[188:191], v[104:107], v[48:51]
    ds_read_b128 v[124:127], v6 offset:22528
    ds_read_b64 v[162:163], v162 offset:640
    ds_read_b128 v[84:87], v19 offset:3072
    v_mfma_f32_16x16x32_bf16 v[52:55], v[184:187], v[104:107], v[52:55]
    ds_read_b128 v[88:91], v19 offset:4096
    ds_read_b128 v[92:95], v19 offset:5120
    v_mfma_f32_16x16x32_bf16 v[56:59], v[180:183], v[104:107], v[56:59]
    v_mfma_f32_16x16x32_bf16 v[48:51], v[176:179], v[108:111], v[48:51]
    ds_read_b128 v[96:99], v6 offset:24576
    v_mfma_f32_16x16x32_bf16 v[52:55], a[160:163], v[108:111], v[52:55]
    v_mfma_f32_16x16x32_bf16 v[56:59], a[164:167], v[108:111], v[56:59]
    v_mfma_f32_16x16x32_bf16 v[48:51], a[168:171], v[112:115], v[48:51]
    s_waitcnt lgkmcnt(6)
    ds_read_b128 v[100:103], v6 offset:26624
    v_fma_f32 v72, -v128, v46, v72
    v_fma_f32 v73, -v129, v46, v73
    v_mfma_f32_16x16x32_bf16 v[52:55], a[172:175], v[112:115], v[52:55]
    v_fma_f32 v74, -v130, v46, v74
    v_fma_f32 v75, -v131, v46, v75
    v_fma_f32 v72, v72, v47, v132
    v_mfma_f32_16x16x32_bf16 v[56:59], a[176:179], v[112:115], v[56:59]
    v_fma_f32 v73, v73, v47, v133
    v_fma_f32 v74, v74, v47, v134
    v_mfma_f32_16x16x32_bf16 v[48:51], a[180:183], v[116:119], v[48:51]
    ds_read_b128 v[104:107], v6 offset:28672
    v_fma_f32 v75, v75, v47, v135
    v_mfma_f32_16x16x32_bf16 v[52:55], a[184:187], v[116:119], v[52:55]
    v_fma_f32 v76, -v136, v46, v76
    v_fma_f32 v77, -v137, v46, v77
    v_mfma_f32_16x16x32_bf16 v[56:59], a[188:191], v[116:119], v[56:59]
    s_waitcnt lgkmcnt(7)
    v_fma_f32 v78, -v138, v46, v78
    v_fma_f32 v79, -v139, v46, v79
    v_mfma_f32_16x16x32_bf16 v[60:63], v[248:251], v[120:123], 0
    ds_read_b128 v[108:111], v6 offset:30720
    v_fma_f32 v76, v76, v47, v140
    v_mfma_f32_16x16x32_bf16 v[64:67], v[244:247], v[120:123], 0
    v_fma_f32 v77, v77, v47, v141
    v_fma_f32 v78, v78, v47, v142
    v_mfma_f32_16x16x32_bf16 v[68:71], v[240:243], v[120:123], 0
    buffer_load_dwordx4 v[248:251], v2, s[4:7], s33 offen offset:2048
    v_mfma_f32_16x16x32_bf16 v[60:63], v[236:239], v[124:127], v[60:63]
    ds_read_b128 v[112:115], v6 offset:32768
    v_fma_f32 v79, v79, v47, v143
    v_fma_f32 v80, -v148, v46, v80
    v_mfma_f32_16x16x32_bf16 v[64:67], v[232:235], v[124:127], v[64:67]
    v_fma_f32 v81, -v149, v46, v81
    v_fma_f32 v82, -v150, v46, v82
    v_fma_f32 v83, -v151, v46, v83
    v_mfma_f32_16x16x32_bf16 v[68:71], v[228:231], v[124:127], v[68:71]
    s_waitcnt lgkmcnt(3)
    buffer_load_dwordx4 v[244:247], v2, s[4:7], s33 offen offset:3072
    v_fma_f32 v80, v80, v47, v152
    v_mfma_f32_16x16x32_bf16 v[60:63], v[224:227], v[96:99], v[60:63]
    ds_read_b128 v[116:119], v6 offset:34816
    v_fma_f32 v81, v81, v47, v153
    v_fma_f32 v82, v82, v47, v154
    v_mfma_f32_16x16x32_bf16 v[64:67], v[220:223], v[96:99], v[64:67]
    v_fma_f32 v83, v83, v47, v155
    v_fma_f32 v84, -v128, v162, v84
    v_fma_f32 v85, -v129, v162, v85
    v_mfma_f32_16x16x32_bf16 v[68:71], v[216:219], v[96:99], v[68:71]
    buffer_load_dwordx4 v[240:243], v3, s[4:7], s33 offen offset:0
    v_fma_f32 v86, -v130, v162, v86
    v_mfma_f32_16x16x32_bf16 v[60:63], v[212:215], v[100:103], v[60:63]
    ds_read_b128 v[120:123], v6 offset:36864
    v_fma_f32 v87, -v131, v162, v87
    v_fma_f32 v84, v84, v163, v132
    v_mfma_f32_16x16x32_bf16 v[64:67], v[208:211], v[100:103], v[64:67]
    v_fma_f32 v85, v85, v163, v133
    v_fma_f32 v86, v86, v163, v134
    v_fma_f32 v87, v87, v163, v135
    v_mfma_f32_16x16x32_bf16 v[68:71], v[204:207], v[100:103], v[68:71]
    s_waitcnt lgkmcnt(3)
    v_fma_f32 v88, -v136, v162, v88
    v_fma_f32 v89, -v137, v162, v89
    v_fma_f32 v90, -v138, v162, v90
    v_mfma_f32_16x16x32_bf16 v[60:63], v[164:167], v[104:107], v[60:63]
    ds_read_b128 v[124:127], v6 offset:38912
    buffer_load_dwordx4 v[236:239], v3, s[4:7], s33 offen offset:1024
    v_mfma_f32_16x16x32_bf16 v[64:67], v[168:171], v[104:107], v[64:67]
    v_fma_f32 v91, -v139, v162, v91
    v_fma_f32 v88, v88, v163, v140
    v_fma_f32 v89, v89, v163, v141
    v_mfma_f32_16x16x32_bf16 v[68:71], v[172:175], v[104:107], v[68:71]
    v_fma_f32 v90, v90, v163, v142
    v_fma_f32 v91, v91, v163, v143
    v_fma_f32 v92, -v148, v162, v92
    v_mfma_f32_16x16x32_bf16 v[60:63], v[200:203], v[108:111], v[60:63]
    buffer_load_dwordx4 v[232:235], v3, s[4:7], s33 offen offset:2048
    v_fma_f32 v93, -v149, v162, v93
    v_mfma_f32_16x16x32_bf16 v[64:67], v[196:199], v[108:111], v[64:67]
    v_fma_f32 v94, -v150, v162, v94
    v_fma_f32 v95, -v151, v162, v95
    v_fma_f32 v92, v92, v163, v152
    v_mfma_f32_16x16x32_bf16 v[68:71], v[192:195], v[108:111], v[68:71]
    s_waitcnt lgkmcnt(2)
    v_fma_f32 v93, v93, v163, v153
    v_fma_f32 v94, v94, v163, v154
    v_mfma_f32_16x16x32_bf16 v[60:63], v[188:191], v[112:115], v[60:63]
    v_fma_f32 v95, v95, v163, v155
    s_add_u32 s90, s94, 3145728
    v_mfma_f32_16x16x32_bf16 v[64:67], v[184:187], v[112:115], v[64:67]
    buffer_load_dwordx4 v[228:231], v3, s[4:7], s33 offen offset:3072
    v_mfma_f32_16x16x32_bf16 v[68:71], v[180:183], v[112:115], v[68:71]
    s_add_u32 s33, s62, 36864
    v_fma_f32 v48, v48, v47, v72
    v_fma_f32 v49, v49, v47, v73
    v_mfma_f32_16x16x32_bf16 v[60:63], v[176:179], v[116:119], v[60:63]
    v_fma_f32 v50, v50, v47, v74
    v_fma_f32 v51, v51, v47, v75
    v_mfma_f32_16x16x32_bf16 v[64:67], a[160:163], v[116:119], v[64:67]
    buffer_load_dwordx4 v[224:227], v1, s[4:7], s33 offen offset:0
    v_mfma_f32_16x16x32_bf16 v[68:71], a[164:167], v[116:119], v[68:71]
    s_waitcnt lgkmcnt(0)
    v_fma_f32 v52, v52, v47, v76
    v_fma_f32 v53, v53, v47, v77
    v_mfma_f32_16x16x32_bf16 v[60:63], a[168:171], v[120:123], v[60:63]
    v_fma_f32 v54, v54, v47, v78
    v_fma_f32 v55, v55, v47, v79
    v_mfma_f32_16x16x32_bf16 v[64:67], a[172:175], v[120:123], v[64:67]
    v_fma_f32 v56, v56, v47, v80
    v_fma_f32 v57, v57, v47, v81
    v_mfma_f32_16x16x32_bf16 v[68:71], a[176:179], v[120:123], v[68:71]
    buffer_load_dwordx4 v[220:223], v1, s[4:7], s33 offen offset:1024
    v_mfma_f32_16x16x32_bf16 v[60:63], a[180:183], v[124:127], v[60:63]
    v_fma_f32 v58, v58, v47, v82
    v_fma_f32 v59, v59, v47, v83
    v_mfma_f32_16x16x32_bf16 v[64:67], a[184:187], v[124:127], v[64:67]
    v_mul_f32 v48, v48, abs(v48)
    v_mul_f32 v49, v49, abs(v49)
    v_mfma_f32_16x16x32_bf16 v[68:71], a[188:191], v[124:127], v[68:71]
    v_mul_f32 v50, v50, abs(v50)
    v_mul_f32 v51, v51, abs(v51)
    buffer_load_dword v29, v5, s[4:7], s31 offen sc1
    v_cvt_pk_bf16_f32 v156, v48, v49
    buffer_load_dwordx4 v[216:219], v1, s[4:7], s33 offen offset:2048
    v_cvt_pk_bf16_f32 v157, v50, v51
    v_pk_max_i16 v156, v156, 0
    v_pk_max_i16 v157, v157, 0
    v_mul_f32 v52, v52, abs(v52)
    v_mul_f32 v53, v53, abs(v53)
    v_mul_f32 v54, v54, abs(v54)
    v_mul_f32 v55, v55, abs(v55)
    v_cvt_pk_bf16_f32 v158, v52, v53
    v_cvt_pk_bf16_f32 v159, v54, v55
    v_pk_max_i16 v158, v158, 0
    v_pk_max_i16 v159, v159, 0
    buffer_store_dwordx4 v[156:159], v27, s[4:7], s90 offen
    v_mul_f32 v56, v56, abs(v56)
    buffer_load_dwordx4 v[212:215], v1, s[4:7], s33 offen offset:3072
    v_mul_f32 v57, v57, abs(v57)
    v_mul_f32 v58, v58, abs(v58)
    v_mul_f32 v59, v59, abs(v59)
    v_cvt_pk_bf16_f32 v160, v56, v57
    v_cvt_pk_bf16_f32 v161, v58, v59
    v_pk_max_i16 v160, v160, 0
    v_pk_max_i16 v161, v161, 0
    buffer_store_dwordx2 v[160:161], v26, s[4:7], s90 offen offset:1024
    s_add_u32 s90, s94, 3194880
    v_pk_fma_f32 v[60:61], v[60:61], v[162:163], v[84:85] op_sel:[0,1,0] op_sel_hi:[1,1,1]
    v_pk_fma_f32 v[62:63], v[62:63], v[162:163], v[86:87] op_sel:[0,1,0] op_sel_hi:[1,1,1]
    v_pk_fma_f32 v[64:65], v[64:65], v[162:163], v[88:89] op_sel:[0,1,0] op_sel_hi:[1,1,1]
    buffer_load_dwordx4 v[208:211], v2, s[4:7], s33 offen offset:0
    v_pk_fma_f32 v[66:67], v[66:67], v[162:163], v[90:91] op_sel:[0,1,0] op_sel_hi:[1,1,1]
    v_pk_fma_f32 v[68:69], v[68:69], v[162:163], v[92:93] op_sel:[0,1,0] op_sel_hi:[1,1,1]
    v_pk_fma_f32 v[70:71], v[70:71], v[162:163], v[94:95] op_sel:[0,1,0] op_sel_hi:[1,1,1]
    v_mul_f32 v60, v60, abs(v60)
    v_mul_f32 v61, v61, abs(v61)
    v_mul_f32 v62, v62, abs(v62)
    v_mul_f32 v63, v63, abs(v63)
    v_cvt_pk_bf16_f32 v156, v60, v61
    v_cvt_pk_bf16_f32 v157, v62, v63
    v_pk_max_i16 v156, v156, 0
    v_pk_max_i16 v157, v157, 0
    v_mul_f32 v64, v64, abs(v64)
    buffer_load_dwordx4 v[204:207], v2, s[4:7], s33 offen offset:1024
    v_mul_f32 v65, v65, abs(v65)
    v_mul_f32 v66, v66, abs(v66)
    v_mul_f32 v67, v67, abs(v67)
    v_cvt_pk_bf16_f32 v158, v64, v65
    v_cvt_pk_bf16_f32 v159, v66, v67
    v_pk_max_i16 v158, v158, 0
    v_pk_max_i16 v159, v159, 0
    buffer_store_dwordx4 v[156:159], v27, s[4:7], s90 offen
    v_mul_f32 v68, v68, abs(v68)
    v_mul_f32 v69, v69, abs(v69)
    v_mul_f32 v70, v70, abs(v70)
    v_mul_f32 v71, v71, abs(v71)
    v_cvt_pk_bf16_f32 v160, v68, v69
    buffer_load_dwordx4 v[164:167], v2, s[4:7], s33 offen offset:2048
    v_cvt_pk_bf16_f32 v161, v70, v71
    v_pk_max_i16 v160, v160, 0
    v_pk_max_i16 v161, v161, 0
    buffer_store_dwordx2 v[160:161], v26, s[4:7], s90 offen offset:1024
    s_barrier
    s_waitcnt vmcnt(9)
poll_30:
    v_cmp_le_u32 vcc, 4, v29
    s_nop 0
    s_andn2_b64 s[56:57], s[34:35], vcc
    s_cbranch_scc1 pollr_29
    s_cmp_lg_u32 s28, 0
    s_cbranch_scc1 acq_31
polld_32:
    s_add_u32 m0, s83, 4096
    s_nop 0
    buffer_load_dwordx4 v1, s[4:7], s79 offen offset:0 sc1 lds
    s_add_u32 m0, s83, 5120
    s_nop 0
    buffer_load_dwordx4 v1, s[4:7], s80 offen offset:0 sc1 lds
    s_add_u32 m0, s83, 6144
    s_nop 0
    buffer_load_dwordx4 v1, s[4:7], s81 offen offset:0 sc1 lds
    s_add_u32 m0, s83, 6144
    s_nop 0
    buffer_load_dwordx4 v1, s[4:7], s79 offen offset:1024 sc1 lds
    s_add_u32 m0, s83, 7168
    s_nop 0
    buffer_load_dwordx4 v1, s[4:7], s80 offen offset:1024 sc1 lds
    s_add_u32 m0, s83, 8192
    s_nop 0
    buffer_load_dwordx4 v1, s[4:7], s81 offen offset:1024 sc1 lds
    v_mov_b32 v30, 5
    s_mov_b64 exec, 1
    s_cmp_lg_u32 s28, 0
    s_waitcnt vmcnt(6)
    s_cbranch_scc1 pubs_33
    buffer_store_dword v30, off, s[4:7], s32
pubd_34:
    s_mov_b64 exec, -1
    s_barrier
    s_waitcnt vmcnt(6)
    ds_read_b128 v[128:131], v33 offset:0
    s_waitcnt vmcnt(5)
    ds_read_b128 v[132:135], v33 offset:1024
    s_waitcnt vmcnt(4)
    ds_read_b128 v[136:139], v33 offset:2048
    s_waitcnt lgkmcnt(2)
    v_mfma_f32_16x16x32_bf16 v[68:71], a[192:195], v[128:131], 0
    s_add_u32 m0, s83, 10240
    s_waitcnt vmcnt(3)
    ds_read_b128 v[140:143], v33 offset:3072
    v_mfma_f32_16x16x32_bf16 v[72:75], a[196:199], v[128:131], 0
    s_add_u32 s89, s84, 86016
    buffer_load_dwordx4 v1, s[4:7], s78 offen offset:0 sc1 lds
    v_mfma_f32_16x16x32_bf16 v[76:79], a[200:203], v[128:131], 0
    s_add_u32 m0, s83, 10240
    s_nop 0
    buffer_load_dwordx4 v1, s[4:7], s78 offen offset:1024 sc1 lds
    v_mfma_f32_16x16x32_bf16 v[80:83], a[204:207], v[128:131], 0
    s_add_u32 m0, s83, 10240
    v_add_u32 v35, s89, v1
    v_add_u32 v34, 45056, v35
    v_mfma_f32_16x16x32_bf16 v[84:87], a[208:211], v[128:131], 0
    s_waitcnt lgkmcnt(2)
    buffer_load_dwordx4 v1, s[4:7], s79 offen offset:2048 sc1 lds
    v_mfma_f32_16x16x32_bf16 v[88:91], a[192:195], v[132:135], 0
    s_add_u32 m0, s83, 11264
    s_waitcnt vmcnt(5)
    ds_read_b128 v[128:131], v33 offset:4096
    v_mfma_f32_16x16x32_bf16 v[92:95], a[196:199], v[132:135], 0
    buffer_load_dwordx4 v1, s[4:7], s80 offen offset:2048 sc1 lds
    v_mfma_f32_16x16x32_bf16 v[96:99], a[200:203], v[132:135], 0
    s_add_u32 m0, s83, 12288
    s_nop 0
    buffer_load_dwordx4 v1, s[4:7], s81 offen offset:2048 sc1 lds
    v_mfma_f32_16x16x32_bf16 v[100:103], a[204:207], v[132:135], 0
    s_add_u32 m0, s83, 13312
    ds_read_b128 v[144:147], v24 offset:1536
    ds_read_b128 v[148:151], v24 offset:1600
    v_mfma_f32_16x16x32_bf16 v[104:107], a[208:211], v[132:135], 0
    s_waitcnt lgkmcnt(4)
    buffer_load_dwordx4 v1, s[4:7], s78 offen offset:2048 sc1 lds
    v_mfma_f32_16x16x32_bf16 v[108:111], a[192:195], v[136:139], 0
    s_add_u32 m0, s83, 13312
    s_waitcnt vmcnt(7)
    ds_read_b128 v[132:135], v33 offset:5120
    v_mfma_f32_16x16x32_bf16 v[112:115], a[196:199], v[136:139], 0
    buffer_load_dwordx4 v1, s[4:7], s79 offen offset:3072 sc1 lds
    v_mfma_f32_16x16x32_bf16 v[116:119], a[200:203], v[136:139], 0
    s_add_u32 m0, s83, 14336
    s_nop 0
    buffer_load_dwordx4 v1, s[4:7], s80 offen offset:3072 sc1 lds
    v_mfma_f32_16x16x32_bf16 v[120:123], a[204:207], v[136:139], 0
    s_add_u32 m0, s83, 15360
    ds_read_b128 v[152:155], v24 offset:1664
    ds_read_b128 v[156:159], v24 offset:1728
    v_mfma_f32_16x16x32_bf16 v[124:127], a[208:211], v[136:139], 0
    s_waitcnt lgkmcnt(6)
    ds_read_b128 v[160:163], v24 offset:1792
    v_lshlrev_b32 v48, 16, v36
    v_mfma_f32_16x16x32_bf16 v[68:71], a[212:215], v[140:143], v[68:71]
    s_waitcnt vmcnt(7)
    ds_read_b128 v[136:139], v33 offset:6144
    v_and_b32 v49, 0xffff0000, v36
    v_mfma_f32_16x16x32_bf16 v[72:75], a[216:219], v[140:143], v[72:75]
    buffer_load_dwordx4 v1, s[4:7], s81 offen offset:3072 sc1 lds
    v_mfma_f32_16x16x32_bf16 v[76:79], a[220:223], v[140:143], v[76:79]
    s_add_u32 m0, s83, 16384
    v_lshlrev_b32 v50, 16, v37
    v_and_b32 v51, 0xffff0000, v37
    v_mfma_f32_16x16x32_bf16 v[80:83], a[224:227], v[140:143], v[80:83]
    v_lshlrev_b32 v52, 16, v38
    v_and_b32 v53, 0xffff0000, v38
    v_mfma_f32_16x16x32_bf16 v[84:87], a[228:231], v[140:143], v[84:87]
    s_waitcnt lgkmcnt(7)
    buffer_load_dwordx4 v1, s[4:7], s78 offen offset:3072 sc1 lds
    v_mfma_f32_16x16x32_bf16 v[88:91], a[212:215], v[128:131], v[88:91]
    s_add_u32 m0, s83, 20480
    s_waitcnt vmcnt(8)
    ds_read_b128 v[140:143], v33 offset:7168
    v_mfma_f32_16x16x32_bf16 v[92:95], a[216:219], v[128:131], v[92:95]
    v_lshlrev_b32 v54, 16, v39
    v_and_b32 v55, 0xffff0000, v39
    v_mfma_f32_16x16x32_bf16 v[96:99], a[220:223], v[128:131], v[96:99]
    buffer_load_dwordx4 v2, s[4:7], s79 offen offset:0 sc1 lds
    v_mfma_f32_16x16x32_bf16 v[100:103], a[224:227], v[128:131], v[100:103]
    s_add_u32 m0, s83, 21504
    v_lshlrev_b32 v56, 16, v40
    v_and_b32 v57, 0xffff0000, v40
    v_mfma_f32_16x16x32_bf16 v[104:107], a[228:231], v[128:131], v[104:107]
    s_waitcnt lgkmcnt(5)
    v_lshlrev_b32 v58, 16, v41
    v_and_b32 v59, 0xffff0000, v41
    v_mfma_f32_16x16x32_bf16 v[108:111], a[212:215], v[132:135], v[108:111]
    s_waitcnt vmcnt(8)
    ds_read_b128 v[128:131], v33 offset:8192
    v_lshlrev_b32 v60, 16, v42
    v_mfma_f32_16x16x32_bf16 v[112:115], a[216:219], v[132:135], v[112:115]
    buffer_load_dwordx4 v2, s[4:7], s80 offen offset:0 sc1 lds
    v_mfma_f32_16x16x32_bf16 v[116:119], a[220:223], v[132:135], v[116:119]
    s_add_u32 m0, s83, 22528
    v_and_b32 v61, 0xffff0000, v42
    v_lshlrev_b32 v62, 16, v43
    v_mfma_f32_16x16x32_bf16 v[120:123], a[224:227], v[132:135], v[120:123]
    v_and_b32 v63, 0xffff0000, v43
    v_lshlrev_b32 v64, 16, v44
    v_mfma_f32_16x16x32_bf16 v[124:127], a[228:231], v[132:135], v[124:127]
    s_waitcnt lgkmcnt(2)
    buffer_load_dwordx4 v2, s[4:7], s81 offen offset:0 sc1 lds
    v_and_b32 v65, 0xffff0000, v44
    v_lshlrev_b32 v66, 16, v45
    v_and_b32 v67, 0xffff0000, v45
    v_add_f32 v48, v48, v144
    v_add_f32 v49, v49, v145
    v_add_f32 v50, v50, v146
    v_add_f32 v51, v51, v147
    v_add_f32 v52, v52, v148
    v_add_f32 v53, v53, v149
    v_add_f32 v54, v54, v150
    v_add_f32 v55, v55, v151
    v_add_f32 v56, v56, v152
    v_add_f32 v57, v57, v153
    v_add_f32 v58, v58, v154
    v_add_f32 v59, v59, v155
    v_add_f32 v60, v60, v156
    v_add_f32 v61, v61, v157
    v_add_f32 v62, v62, v158
    v_add_f32 v63, v63, v159
    v_add_f32 v64, v64, v160
    v_add_f32 v65, v65, v161
    v_add_f32 v66, v66, v162
    v_add_f32 v67, v67, v163
    v_mfma_f32_16x16x32_bf16 v[48:51], a[192:195], v[136:139], v[48:51]
    s_add_u32 m0, s83, 23552
    s_waitcnt vmcnt(9)
    ds_read_b128 v[132:135], v33 offset:9216
    v_mfma_f32_16x16x32_bf16 v[52:55], a[196:199], v[136:139], v[52:55]
    v_mfma_f32_16x16x32_bf16 v[56:59], a[200:203], v[136:139], v[56:59]
    v_mfma_f32_16x16x32_bf16 v[60:63], a[204:207], v[136:139], v[60:63]
    buffer_load_dwordx4 v2, s[4:7], s78 offen offset:0 sc1 lds
    v_mfma_f32_16x16x32_bf16 v[64:67], a[208:211], v[136:139], v[64:67]
    s_waitcnt lgkmcnt(2)
    ds_read_b128 a[192:195], v35 offset:0
    ds_read_b128 a[196:199], v35 offset:4096
    v_mfma_f32_16x16x32_bf16 v[48:51], a[212:215], v[140:143], v[48:51]
    s_add_u32 m0, s83, 3072
    s_waitcnt vmcnt(9)
    ds_read_b128 v[136:139], v33 offset:10240
    v_mfma_f32_16x16x32_bf16 v[52:55], a[216:219], v[140:143], v[52:55]
    buffer_load_dwordx4 v2, s[4:7], s79 offen offset:1024 sc1 lds
    v_mfma_f32_16x16x32_bf16 v[56:59], a[220:223], v[140:143], v[56:59]
    s_add_u32 m0, s83, 4096
    ds_read_b128 a[200:203], v35 offset:8192
    ds_read_b128 a[204:207], v35 offset:12288
    v_mfma_f32_16x16x32_bf16 v[60:63], a[224:227], v[140:143], v[60:63]
    ds_read_b128 a[208:211], v35 offset:16384
    v_mfma_f32_16x16x32_bf16 v[64:67], a[228:231], v[140:143], v[64:67]
    s_waitcnt lgkmcnt(7)
    ds_read_b128 a[212:215], v34 offset:0
    ds_read_b128 a[216:219], v34 offset:4096
    v_mfma_f32_16x16x32_bf16 v[68:71], a[232:235], v[128:131], v[68:71]
    s_waitcnt vmcnt(9)
    ds_read_b128 v[140:143], v33 offset:11264
    ds_read_b128 a[220:223], v34 offset:8192
    v_mfma_f32_16x16x32_bf16 v[72:75], a[236:239], v[128:131], v[72:75]
    buffer_load_dwordx4 v2, s[4:7], s80 offen offset:1024 sc1 lds
    v_mfma_f32_16x16x32_bf16 v[76:79], a[240:243], v[128:131], v[76:79]
    s_add_u32 m0, s83, 5120
    ds_read_b128 a[224:227], v34 offset:12288
    ds_read_b128 a[228:231], v34 offset:16384
    v_mfma_f32_16x16x32_bf16 v[80:83], a[244:247], v[128:131], v[80:83]
    v_mfma_f32_16x16x32_bf16 v[84:87], a[248:251], v[128:131], v[84:87]
    s_waitcnt lgkmcnt(12)
    buffer_load_dwordx4 v2, s[4:7], s81 offen offset:1024 sc1 lds
    v_mfma_f32_16x16x32_bf16 v[88:91], a[232:235], v[132:135], v[88:91]
    s_add_u32 m0, s83, 6144
    s_waitcnt vmcnt(10)
    ds_read_b128 v[128:131], v33 offset:12288
    v_mfma_f32_16x16x32_bf16 v[92:95], a[236:239], v[132:135], v[92:95]
    v_mfma_f32_16x16x32_bf16 v[96:99], a[240:243], v[132:135], v[96:99]
    buffer_load_dwordx4 v2, s[4:7], s78 offen offset:1024 sc1 lds
    v_mfma_f32_16x16x32_bf16 v[100:103], a[244:247], v[132:135], v[100:103]
    s_add_u32 m0, s83, 6144
    v_mfma_f32_16x16x32_bf16 v[104:107], a[248:251], v[132:135], v[104:107]
    s_waitcnt lgkmcnt(10)
    v_mfma_f32_16x16x32_bf16 v[108:111], a[232:235], v[136:139], v[108:111]
    s_waitcnt vmcnt(10)
    ds_read_b128 v[132:135], v33 offset:13312
    v_mfma_f32_16x16x32_bf16 v[112:115], a[236:239], v[136:139], v[112:115]
    buffer_load_dwordx4 v2, s[4:7], s79 offen offset:2048 sc1 lds
    v_mfma_f32_16x16x32_bf16 v[116:119], a[240:243], v[136:139], v[116:119]
    s_add_u32 m0, s83, 7168
    v_mfma_f32_16x16x32_bf16 v[120:123], a[244:247], v[136:139], v[120:123]
    v_mfma_f32_16x16x32_bf16 v[124:127], a[248:251], v[136:139], v[124:127]
    s_waitcnt lgkmcnt(5)
    buffer_load_dwordx4 v2, s[4:7], s80 offen offset:2048 sc1 lds
    v_mfma_f32_16x16x32_bf16 v[48:51], a[232:235], v[140:143], v[48:51]
    s_add_u32 m0, s83, 8192
    s_waitcnt vmcnt(11)
    ds_read_b128 v[136:139], v33 offset:14336
    v_mfma_f32_16x16x32_bf16 v[52:55], a[236:239], v[140:143], v[52:55]
    v_mfma_f32_16x16x32_bf16 v[56:59], a[240:243], v[140:143], v[56:59]
    v_mfma_f32_16x16x32_bf16 v[60:63], a[244:247], v[140:143], v[60:63]
    buffer_load_dwordx4 v2, s[4:7], s81 offen offset:2048 sc1 lds
    v_mfma_f32_16x16x32_bf16 v[64:67], a[248:251], v[140:143], v[64:67]
    s_waitcnt lgkmcnt(2)
    ds_read_b128 a[232:235], v34 offset:20480
    ds_read_b128 a[236:239], v34 offset:24576
    v_mfma_f32_16x16x32_bf16 v[68:71], a[252:255], v[128:131], v[68:71]
    s_add_u32 m0, s83, 9216
    s_waitcnt vmcnt(11)
    ds_read_b128 v[140:143], v33 offset:15360
    v_mfma_f32_16x16x32_bf16 v[72:75], v[252:255], v[128:131], v[72:75]
    buffer_load_dwordx4 v2, s[4:7], s78 offen offset:2048 sc1 lds
    v_mfma_f32_16x16x32_bf16 v[76:79], a[192:195], v[128:131], v[76:79]
    s_add_u32 m0, s83, 9216
    ds_read_b128 a[240:243], v34 offset:28672
    v_mfma_f32_16x16x32_bf16 v[80:83], a[196:199], v[128:131], v[80:83]
    v_mfma_f32_16x16x32_bf16 v[84:87], a[200:203], v[128:131], v[84:87]
    s_waitcnt lgkmcnt(5)
    v_mfma_f32_16x16x32_bf16 v[88:91], a[252:255], v[132:135], v[88:91]
    s_waitcnt vmcnt(11)
    ds_read_b128 v[128:131], v33 offset:16384
    v_mfma_f32_16x16x32_bf16 v[92:95], v[252:255], v[132:135], v[92:95]
    buffer_load_dwordx4 v2, s[4:7], s79 offen offset:3072 sc1 lds
    v_mfma_f32_16x16x32_bf16 v[96:99], a[192:195], v[132:135], v[96:99]
    s_add_u32 m0, s83, 10240
    v_mfma_f32_16x16x32_bf16 v[100:103], a[196:199], v[132:135], v[100:103]
    v_mfma_f32_16x16x32_bf16 v[104:107], a[200:203], v[132:135], v[104:107]
    s_waitcnt lgkmcnt(5)
    buffer_load_dwordx4 v[200:203], v2, s[4:7], s33 offen offset:3072
    v_mfma_f32_16x16x32_bf16 v[108:111], a[252:255], v[136:139], v[108:111]
    s_waitcnt vmcnt(12)
    ds_read_b128 v[132:135], v33 offset:17408
    v_mfma_f32_16x16x32_bf16 v[112:115], v[252:255], v[136:139], v[112:115]
    v_mfma_f32_16x16x32_bf16 v[116:119], a[192:195], v[136:139], v[116:119]
    buffer_load_dwordx4 v[196:199], v3, s[4:7], s33 offen offset:0
    v_mfma_f32_16x16x32_bf16 v[120:123], a[196:199], v[136:139], v[120:123]
    v_mfma_f32_16x16x32_bf16 v[124:127], a[200:203], v[136:139], v[124:127]
    s_waitcnt lgkmcnt(3)
    v_mfma_f32_16x16x32_bf16 v[48:51], a[252:255], v[140:143], v[48:51]
    s_waitcnt vmcnt(12)
    ds_read_b128 v[136:139], v33 offset:18432
    v_mfma_f32_16x16x32_bf16 v[52:55], v[252:255], v[140:143], v[52:55]
    buffer_load_dwordx4 v2, s[4:7], s80 offen offset:3072 sc1 lds
    v_mfma_f32_16x16x32_bf16 v[56:59], a[192:195], v[140:143], v[56:59]
    s_add_u32 m0, s83, 11264
    v_mfma_f32_16x16x32_bf16 v[60:63], a[196:199], v[140:143], v[60:63]
    v_mfma_f32_16x16x32_bf16 v[64:67], a[200:203], v[140:143], v[64:67]
    s_waitcnt lgkmcnt(2)
    buffer_load_dwordx4 v[192:195], v3, s[4:7], s33 offen offset:1024
    v_mfma_f32_16x16x32_bf16 v[68:71], a[204:207], v[128:131], v[68:71]
    s_waitcnt vmcnt(13)
    ds_read_b128 v[140:143], v33 offset:19456
    v_mfma_f32_16x16x32_bf16 v[72:75], a[208:211], v[128:131], v[72:75]
    v_mfma_f32_16x16x32_bf16 v[76:79], a[212:215], v[128:131], v[76:79]
    v_mfma_f32_16x16x32_bf16 v[80:83], a[216:219], v[128:131], v[80:83]
    buffer_load_dwordx4 v[188:191], v3, s[4:7], s33 offen offset:2048
    v_mfma_f32_16x16x32_bf16 v[84:87], a[220:223], v[128:131], v[84:87]
    s_waitcnt lgkmcnt(2)
    v_mfma_f32_16x16x32_bf16 v[88:91], a[204:207], v[132:135], v[88:91]
    s_waitcnt vmcnt(13)
    ds_read_b128 v[128:131], v33 offset:0
    v_mfma_f32_16x16x32_bf16 v[92:95], a[208:211], v[132:135], v[92:95]
    buffer_load_dwordx4 v[184:187], v3, s[4:7], s33 offen offset:3072
    v_mfma_f32_16x16x32_bf16 v[96:99], a[212:215], v[132:135], v[96:99]
    s_add_u32 s33, s62, 49152
    v_mfma_f32_16x16x32_bf16 v[100:103], a[216:219], v[132:135], v[100:103]
    v_mfma_f32_16x16x32_bf16 v[104:107], a[220:223], v[132:135], v[104:107]
    s_waitcnt lgkmcnt(2)
    v_mfma_f32_16x16x32_bf16 v[108:111], a[204:207], v[136:139], v[108:111]
    s_waitcnt vmcnt(13)
    ds_read_b128 v[132:135], v33 offset:1024
    v_mfma_f32_16x16x32_bf16 v[112:115], a[208:211], v[136:139], v[112:115]
    buffer_load_dwordx4 v[180:183], v1, s[4:7], s33 offen offset:0
    v_mfma_f32_16x16x32_bf16 v[116:119], a[212:215], v[136:139], v[116:119]
    buffer_load_dwordx4 v[176:179], v1, s[4:7], s33 offen offset:1024
    v_mfma_f32_16x16x32_bf16 v[120:123], a[216:219], v[136:139], v[120:123]
    v_mfma_f32_16x16x32_bf16 v[124:127], a[220:223], v[136:139], v[124:127]
    s_waitcnt lgkmcnt(2)
    v_mfma_f32_16x16x32_bf16 v[48:51], a[204:207], v[140:143], v[48:51]
    s_waitcnt vmcnt(14)
    ds_read_b128 v[136:139], v33 offset:2048
    v_mfma_f32_16x16x32_bf16 v[52:55], a[208:211], v[140:143], v[52:55]
    buffer_load_dwordx4 v2, s[4:7], s81 offen offset:3072 sc1 lds
    v_mfma_f32_16x16x32_bf16 v[56:59], a[212:215], v[140:143], v[56:59]
    s_add_u32 m0, s83, 12288
    buffer_load_dwordx4 a[160:163], v1, s[4:7], s33 offen offset:2048
    v_mfma_f32_16x16x32_bf16 v[60:63], a[216:219], v[140:143], v[60:63]
    buffer_load_dwordx4 a[164:167], v1, s[4:7], s33 offen offset:3072
    v_mfma_f32_16x16x32_bf16 v[64:67], a[220:223], v[140:143], v[64:67]
    s_waitcnt lgkmcnt(2)
    buffer_load_dwordx4 a[168:171], v2, s[4:7], s33 offen offset:0
    v_mfma_f32_16x16x32_bf16 v[68:71], a[224:227], v[128:131], v[68:71]
    s_waitcnt vmcnt(17)
    ds_read_b128 v[140:143], v33 offset:3072
    v_mfma_f32_16x16x32_bf16 v[72:75], a[228:231], v[128:131], v[72:75]
    buffer_load_dwordx4 a[172:175], v2, s[4:7], s33 offen offset:1024
    v_mfma_f32_16x16x32_bf16 v[76:79], a[232:235], v[128:131], v[76:79]
    buffer_load_dwordx4 a[176:179], v2, s[4:7], s33 offen offset:2048
    v_mfma_f32_16x16x32_bf16 v[80:83], a[236:239], v[128:131], v[80:83]
    buffer_load_dwordx4 v2, s[4:7], s78 offen offset:3072 sc1 lds
    v_mfma_f32_16x16x32_bf16 v[84:87], a[240:243], v[128:131], v[84:87]
    s_waitcnt lgkmcnt(2)
    buffer_load_dwordx4 a[180:183], v2, s[4:7], s33 offen offset:3072
    v_mfma_f32_16x16x32_bf16 v[88:91], a[224:227], v[132:135], v[88:91]
    s_add_u32 m0, s83, 16384
    s_waitcnt vmcnt(20)
    ds_read_b128 v[128:131], v33 offset:4096
    v_mfma_f32_16x16x32_bf16 v[92:95], a[228:231], v[132:135], v[92:95]
    buffer_load_dwordx4 a[184:187], v3, s[4:7], s33 offen offset:0
    v_mfma_f32_16x16x32_bf16 v[96:99], a[232:235], v[132:135], v[96:99]
    buffer_load_dwordx4 a[188:191], v3, s[4:7], s33 offen offset:1024
    v_mfma_f32_16x16x32_bf16 v[100:103], a[236:239], v[132:135], v[100:103]
    buffer_load_dwordx4 a[244:247], v3, s[4:7], s33 offen offset:2048
    v_mfma_f32_16x16x32_bf16 v[104:107], a[240:243], v[132:135], v[104:107]
    s_waitcnt lgkmcnt(2)
    buffer_load_dwordx4 a[248:251], v3, s[4:7], s33 offen offset:3072
    v_mfma_f32_16x16x32_bf16 v[108:111], a[224:227], v[136:139], v[108:111]
    s_add_u32 s33, s60, 0
    s_waitcnt vmcnt(23)
    ds_read_b128 v[132:135], v33 offset:5120
    v_mfma_f32_16x16x32_bf16 v[112:115], a[228:231], v[136:139], v[112:115]
    buffer_load_dwordx4 v3, s[4:7], s79 offen offset:0 sc1 lds
    v_mfma_f32_16x16x32_bf16 v[116:119], a[232:235], v[136:139], v[116:119]
    s_add_u32 m0, s83, 16384
    s_nop 0
    buffer_load_dwordx4 v3, s[4:7], s79 offen offset:1024 sc1 lds
    v_mfma_f32_16x16x32_bf16 v[120:123], a[236:239], v[136:139], v[120:123]
    s_add_u32 m0, s83, 16384
    v_mfma_f32_16x16x32_bf16 v[124:127], a[240:243], v[136:139], v[124:127]
    s_waitcnt lgkmcnt(2)
    v_mfma_f32_16x16x32_bf16 v[48:51], a[224:227], v[140:143], v[48:51]
    s_waitcnt vmcnt(24)
    ds_read_b128 v[136:139], v33 offset:6144
    v_mfma_f32_16x16x32_bf16 v[52:55], a[228:231], v[140:143], v[52:55]
    buffer_load_dwordx4 v3, s[4:7], s79 offen offset:2048 sc1 lds
    v_mfma_f32_16x16x32_bf16 v[56:59], a[232:235], v[140:143], v[56:59]
    s_add_u32 m0, s83, 16384
    v_mfma_f32_16x16x32_bf16 v[60:63], a[236:239], v[140:143], v[60:63]
    v_mfma_f32_16x16x32_bf16 v[64:67], a[240:243], v[140:143], v[64:67]
    s_waitcnt lgkmcnt(2)
    buffer_load_dwordx4 v3, s[4:7], s79 offen offset:3072 sc1 lds
    v_mfma_f32_16x16x32_bf16 v[68:71], v[248:251], v[128:131], v[68:71]
    s_add_u32 m0, s83, 20480
    s_waitcnt vmcnt(25)
    ds_read_b128 v[140:143], v33 offset:7168
    v_mfma_f32_16x16x32_bf16 v[72:75], v[244:247], v[128:131], v[72:75]
    v_mfma_f32_16x16x32_bf16 v[76:79], v[240:243], v[128:131], v[76:79]
    buffer_load_dwordx4 v3, s[4:7], s80 offen offset:0 sc1 lds
    v_mfma_f32_16x16x32_bf16 v[80:83], v[236:239], v[128:131], v[80:83]
    s_add_u32 m0, s83, 20480
    v_mfma_f32_16x16x32_bf16 v[84:87], v[232:235], v[128:131], v[84:87]
    s_waitcnt lgkmcnt(2)
    v_mfma_f32_16x16x32_bf16 v[88:91], v[248:251], v[132:135], v[88:91]
    s_waitcnt vmcnt(25)
    ds_read_b128 v[128:131], v33 offset:8192
    v_mfma_f32_16x16x32_bf16 v[92:95], v[244:247], v[132:135], v[92:95]
    buffer_load_dwordx4 v3, s[4:7], s80 offen offset:1024 sc1 lds
    v_mfma_f32_16x16x32_bf16 v[96:99], v[240:243], v[132:135], v[96:99]
    s_add_u32 m0, s83, 20480
    v_mfma_f32_16x16x32_bf16 v[100:103], v[236:239], v[132:135], v[100:103]
    v_mfma_f32_16x16x32_bf16 v[104:107], v[232:235], v[132:135], v[104:107]
    s_waitcnt lgkmcnt(2)
    buffer_load_dwordx4 v3, s[4:7], s80 offen offset:2048 sc1 lds
    v_mfma_f32_16x16x32_bf16 v[108:111], v[248:251], v[136:139], v[108:111]
    s_add_u32 m0, s83, 20480
    s_waitcnt vmcnt(24)
    ds_read_b128 v[132:135], v33 offset:9216
    v_mfma_f32_16x16x32_bf16 v[112:115], v[244:247], v[136:139], v[112:115]
    v_mfma_f32_16x16x32_bf16 v[116:119], v[240:243], v[136:139], v[116:119]
    v_mfma_f32_16x16x32_bf16 v[120:123], v[236:239], v[136:139], v[120:123]
    buffer_load_dwordx4 v3, s[4:7], s80 offen offset:3072 sc1 lds
    v_mfma_f32_16x16x32_bf16 v[124:127], v[232:235], v[136:139], v[124:127]
    s_waitcnt lgkmcnt(2)
    v_mfma_f32_16x16x32_bf16 v[48:51], v[248:251], v[140:143], v[48:51]
    s_add_u32 m0, s83, 4096
    s_waitcnt vmcnt(19)
    ds_read_b128 v[136:139], v33 offset:10240
    v_mfma_f32_16x16x32_bf16 v[52:55], v[244:247], v[140:143], v[52:55]
    buffer_load_dwordx4 v3, s[4:7], s81 offen offset:0 sc1 lds
    v_mfma_f32_16x16x32_bf16 v[56:59], v[240:243], v[140:143], v[56:59]
    s_add_u32 m0, s83, 4096
    v_mfma_f32_16x16x32_bf16 v[60:63], v[236:239], v[140:143], v[60:63]
    v_mfma_f32_16x16x32_bf16 v[64:67], v[232:235], v[140:143], v[64:67]
    s_waitcnt lgkmcnt(2)
    v_mfma_f32_16x16x32_bf16 v[68:71], v[228:231], v[128:131], v[68:71]
    s_waitcnt vmcnt(14)
    ds_read_b128 v[140:143], v33 offset:11264
    v_mfma_f32_16x16x32_bf16 v[72:75], v[224:227], v[128:131], v[72:75]
    buffer_load_dwordx4 v3, s[4:7], s81 offen offset:1024 sc1 lds
    v_mfma_f32_16x16x32_bf16 v[76:79], v[220:223], v[128:131], v[76:79]
    s_add_u32 m0, s83, 4096
    v_mfma_f32_16x16x32_bf16 v[80:83], v[216:219], v[128:131], v[80:83]
    v_mfma_f32_16x16x32_bf16 v[84:87], v[212:215], v[128:131], v[84:87]
    s_waitcnt lgkmcnt(2)
    buffer_load_dwordx4 v3, s[4:7], s81 offen offset:2048 sc1 lds
    v_mfma_f32_16x16x32_bf16 v[88:91], v[228:231], v[132:135], v[88:91]
    s_add_u32 m0, s83, 4096
    s_waitcnt vmcnt(10)
    ds_read_b128 v[128:131], v33 offset:12288
    v_mfma_f32_16x16x32_bf16 v[92:95], v[224:227], v[132:135], v[92:95]
    v_mfma_f32_16x16x32_bf16 v[96:99], v[220:223], v[132:135], v[96:99]
    buffer_load_dwordx4 v3, s[4:7], s81 offen offset:3072 sc1 lds
    v_mfma_f32_16x16x32_bf16 v[100:103], v[216:219], v[132:135], v[100:103]
    s_add_u32 m0, s83, 8192
    v_mfma_f32_16x16x32_bf16 v[104:107], v[212:215], v[132:135], v[104:107]
    s_waitcnt lgkmcnt(2)
    v_mfma_f32_16x16x32_bf16 v[108:111], v[228:231], v[136:139], v[108:111]
    s_waitcnt vmcnt(10)
    ds_read_b128 v[132:135], v33 offset:13312
    v_mfma_f32_16x16x32_bf16 v[112:115], v[224:227], v[136:139], v[112:115]
    buffer_load_dwordx4 v3, s[4:7], s78 offen offset:0 sc1 lds
    v_mfma_f32_16x16x32_bf16 v[116:119], v[220:223], v[136:139], v[116:119]
    s_add_u32 m0, s83, 8192
    v_mfma_f32_16x16x32_bf16 v[120:123], v[216:219], v[136:139], v[120:123]
    v_mfma_f32_16x16x32_bf16 v[124:127], v[212:215], v[136:139], v[124:127]
    s_waitcnt lgkmcnt(2)
    buffer_load_dwordx4 v3, s[4:7], s78 offen offset:1024 sc1 lds
    v_mfma_f32_16x16x32_bf16 v[48:51], v[228:231], v[140:143], v[48:51]
    s_add_u32 m0, s83, 8192
    s_waitcnt vmcnt(11)
    ds_read_b128 v[136:139], v33 offset:14336
    v_mfma_f32_16x16x32_bf16 v[52:55], v[224:227], v[140:143], v[52:55]
    v_mfma_f32_16x16x32_bf16 v[56:59], v[220:223], v[140:143], v[56:59]
    v_mfma_f32_16x16x32_bf16 v[60:63], v[216:219], v[140:143], v[60:63]
    buffer_load_dwordx4 v3, s[4:7], s78 offen offset:2048 sc1 lds
    v_mfma_f32_16x16x32_bf16 v[64:67], v[212:215], v[140:143], v[64:67]
    s_waitcnt lgkmcnt(2)
    v_mfma_f32_16x16x32_bf16 v[68:71], v[208:211], v[128:131], v[68:71]
    s_add_u32 m0, s83, 8192
    s_waitcnt vmcnt(11)
    ds_read_b128 v[140:143], v33 offset:15360
    v_mfma_f32_16x16x32_bf16 v[72:75], v[204:207], v[128:131], v[72:75]
    buffer_load_dwordx4 v3, s[4:7], s78 offen offset:3072 sc1 lds
    v_mfma_f32_16x16x32_bf16 v[76:79], v[164:167], v[128:131], v[76:79]
    v_mfma_f32_16x16x32_bf16 v[80:83], v[200:203], v[128:131], v[80:83]
    v_mfma_f32_16x16x32_bf16 v[84:87], v[196:199], v[128:131], v[84:87]
    s_waitcnt lgkmcnt(2)
    v_mfma_f32_16x16x32_bf16 v[68:71], v[192:195], v[132:135], v[68:71]
    s_waitcnt vmcnt(11)
    ds_read_b128 v[128:131], v33 offset:16384
    v_mfma_f32_16x16x32_bf16 v[72:75], v[188:191], v[132:135], v[72:75]
    buffer_load_dwordx4 a[252:255], v1, s[4:7], s33 offen offset:0
    v_mfma_f32_16x16x32_bf16 v[76:79], v[184:187], v[132:135], v[76:79]
    v_mfma_f32_16x16x32_bf16 v[80:83], v[180:183], v[132:135], v[80:83]
    v_mfma_f32_16x16x32_bf16 v[84:87], v[176:179], v[132:135], v[84:87]
    s_waitcnt lgkmcnt(2)
    buffer_load_dwordx4 v[252:255], v1, s[4:7], s33 offen offset:1024
    v_mfma_f32_16x16x32_bf16 v[68:71], a[160:163], v[136:139], v[68:71]
    s_waitcnt vmcnt(12)
    ds_read_b128 v[132:135], v33 offset:17408
    v_mfma_f32_16x16x32_bf16 v[72:75], a[164:167], v[136:139], v[72:75]
    v_mfma_f32_16x16x32_bf16 v[76:79], a[168:171], v[136:139], v[76:79]
    buffer_load_dwordx4 a[192:195], v1, s[4:7], s33 offen offset:2048
    v_mfma_f32_16x16x32_bf16 v[80:83], a[172:175], v[136:139], v[80:83]
    v_mfma_f32_16x16x32_bf16 v[84:87], a[176:179], v[136:139], v[84:87]
    s_waitcnt lgkmcnt(2)
    v_mfma_f32_16x16x32_bf16 v[68:71], a[180:183], v[140:143], v[68:71]
    s_waitcnt vmcnt(12)
    ds_read_b128 v[136:139], v33 offset:18432
    v_mfma_f32_16x16x32_bf16 v[72:75], a[184:187], v[140:143], v[72:75]
    buffer_load_dwordx4 a[196:199], v1, s[4:7], s33 offen offset:3072
    v_mfma_f32_16x16x32_bf16 v[76:79], a[188:191], v[140:143], v[76:79]
    v_mfma_f32_16x16x32_bf16 v[80:83], a[244:247], v[140:143], v[80:83]
    v_mfma_f32_16x16x32_bf16 v[84:87], a[248:251], v[140:143], v[84:87]
    s_waitcnt lgkmcnt(2)
    buffer_load_dwordx4 a[200:203], v2, s[4:7], s33 offen offset:0
    s_barrier
    v_mfma_f32_16x16x32_bf16 v[88:91], v[208:211], v[128:131], v[88:91]
    s_waitcnt vmcnt(13)
    ds_read_b128 v[140:143], v33 offset:19456
    v_mfma_f32_16x16x32_bf16 v[92:95], v[204:207], v[128:131], v[92:95]
    v_mfma_f32_16x16x32_bf16 v[96:99], v[164:167], v[128:131], v[96:99]
    ds_write_b128 v20, v[68:71] offset:0
    v_mfma_f32_16x16x32_bf16 v[100:103], v[200:203], v[128:131], v[100:103]
    buffer_load_dwordx4 a[204:207], v2, s[4:7], s33 offen offset:1024
    v_mfma_f32_16x16x32_bf16 v[104:107], v[196:199], v[128:131], v[104:107]
    s_waitcnt lgkmcnt(3)
    v_mfma_f32_16x16x32_bf16 v[88:91], v[192:195], v[132:135], v[88:91]
    s_waitcnt vmcnt(13)
    ds_read_b128 v[128:131], v33 offset:0
    v_mfma_f32_16x16x32_bf16 v[92:95], v[188:191], v[132:135], v[92:95]
    buffer_load_dwordx4 a[208:211], v2, s[4:7], s33 offen offset:2048
    v_mfma_f32_16x16x32_bf16 v[96:99], v[184:187], v[132:135], v[96:99]
    ds_write_b128 v20, v[72:75] offset:1024
    v_mfma_f32_16x16x32_bf16 v[100:103], v[180:183], v[132:135], v[100:103]
    v_mfma_f32_16x16x32_bf16 v[104:107], v[176:179], v[132:135], v[104:107]
    s_waitcnt lgkmcnt(4)
    v_mfma_f32_16x16x32_bf16 v[88:91], a[160:163], v[136:139], v[88:91]
    s_waitcnt vmcnt(13)
    ds_read_b128 v[132:135], v33 offset:1024
    v_mfma_f32_16x16x32_bf16 v[92:95], a[164:167], v[136:139], v[92:95]
    buffer_load_dwordx4 a[212:215], v2, s[4:7], s33 offen offset:3072
    v_mfma_f32_16x16x32_bf16 v[96:99], a[168:171], v[136:139], v[96:99]
    ds_write_b128 v20, v[76:79] offset:2048
    v_mfma_f32_16x16x32_bf16 v[100:103], a[172:175], v[136:139], v[100:103]
    v_mfma_f32_16x16x32_bf16 v[104:107], a[176:179], v[136:139], v[104:107]
    s_waitcnt lgkmcnt(5)
    buffer_load_dwordx4 a[216:219], v3, s[4:7], s33 offen offset:0
    v_mfma_f32_16x16x32_bf16 v[88:91], a[180:183], v[140:143], v[88:91]
    s_waitcnt vmcnt(14)
    ds_read_b128 v[136:139], v33 offset:2048
    v_mfma_f32_16x16x32_bf16 v[92:95], a[184:187], v[140:143], v[92:95]
    ds_write_b128 v20, v[80:83] offset:3072
    v_mfma_f32_16x16x32_bf16 v[96:99], a[188:191], v[140:143], v[96:99]
    buffer_load_dwordx4 a[220:223], v3, s[4:7], s33 offen offset:1024
    v_mfma_f32_16x16x32_bf16 v[100:103], a[244:247], v[140:143], v[100:103]
    v_mfma_f32_16x16x32_bf16 v[104:107], a[248:251], v[140:143], v[104:107]
    s_waitcnt lgkmcnt(5)
    ds_write_b128 v20, v[84:87] offset:4096
    v_mfma_f32_16x16x32_bf16 v[108:111], v[208:211], v[128:131], v[108:111]
    s_waitcnt vmcnt(14)
    ds_read_b128 v[140:143], v33 offset:3072
    v_mfma_f32_16x16x32_bf16 v[112:115], v[204:207], v[128:131], v[112:115]
    buffer_load_dwordx4 a[224:227], v3, s[4:7], s33 offen offset:2048
    v_mfma_f32_16x16x32_bf16 v[116:119], v[164:167], v[128:131], v[116:119]
    v_mfma_f32_16x16x32_bf16 v[120:123], v[200:203], v[128:131], v[120:123]
    v_mfma_f32_16x16x32_bf16 v[124:127], v[196:199], v[128:131], v[124:127]
    s_waitcnt lgkmcnt(5)
    buffer_load_dwordx4 a[228:231], v3, s[4:7], s33 offen offset:3072
    v_mfma_f32_16x16x32_bf16 v[108:111], v[192:195], v[132:135], v[108:111]
    s_add_u32 s33, s60, 12288
    s_waitcnt vmcnt(15)
    ds_read_b128 v[128:131], v33 offset:4096
    v_mfma_f32_16x16x32_bf16 v[112:115], v[188:191], v[132:135], v[112:115]
    ds_write_b128 v21, v[88:91] offset:0
    v_mfma_f32_16x16x32_bf16 v[116:119], v[184:187], v[132:135], v[116:119]
    v_mfma_f32_16x16x32_bf16 v[120:123], v[180:183], v[132:135], v[120:123]
    buffer_load_dwordx4 a[232:235], v1, s[4:7], s33 offen offset:0
    v_mfma_f32_16x16x32_bf16 v[124:127], v[176:179], v[132:135], v[124:127]
    s_waitcnt lgkmcnt(5)
    ds_write_b128 v21, v[92:95] offset:1024
    v_mfma_f32_16x16x32_bf16 v[108:111], a[160:163], v[136:139], v[108:111]
    s_waitcnt vmcnt(15)
    ds_read_b128 v[132:135], v33 offset:5120
    v_mfma_f32_16x16x32_bf16 v[112:115], a[164:167], v[136:139], v[112:115]
    buffer_load_dwordx4 a[236:239], v1, s[4:7], s33 offen offset:1024
    v_mfma_f32_16x16x32_bf16 v[116:119], a[168:171], v[136:139], v[116:119]
    ds_write_b128 v21, v[96:99] offset:2048
    v_mfma_f32_16x16x32_bf16 v[120:123], a[172:175], v[136:139], v[120:123]
    v_mfma_f32_16x16x32_bf16 v[124:127], a[176:179], v[136:139], v[124:127]
    s_waitcnt lgkmcnt(5)
    v_mfma_f32_16x16x32_bf16 v[108:111], a[180:183], v[140:143], v[108:111]
    s_waitcnt vmcnt(15)
    ds_read_b128 v[136:139], v33 offset:6144
    v_mfma_f32_16x16x32_bf16 v[112:115], a[184:187], v[140:143], v[112:115]
    buffer_load_dwordx4 a[240:243], v1, s[4:7], s33 offen offset:2048
    v_mfma_f32_16x16x32_bf16 v[116:119], a[188:191], v[140:143], v[116:119]
    ds_write_b128 v21, v[100:103] offset:3072
    v_mfma_f32_16x16x32_bf16 v[120:123], a[244:247], v[140:143], v[120:123]
    v_mfma_f32_16x16x32_bf16 v[124:127], a[248:251], v[140:143], v[124:127]
    s_waitcnt lgkmcnt(6)
    buffer_load_dwordx4 v[248:251], v1, s[4:7], s33 offen offset:3072
    ds_write_b128 v21, v[104:107] offset:4096
    s_waitcnt lgkmcnt(0)
    s_barrier
    v_mfma_f32_16x16x32_bf16 v[48:51], v[208:211], v[128:131], v[48:51]
    s_waitcnt vmcnt(16)
    ds_read_b128 v[140:143], v33 offset:7168
    ds_read_b128 v[68:71], v23 offset:0
    v_mfma_f32_16x16x32_bf16 v[52:55], v[204:207], v[128:131], v[52:55]
    buffer_load_dwordx4 v[244:247], v2, s[4:7], s33 offen offset:0
    v_mfma_f32_16x16x32_bf16 v[56:59], v[164:167], v[128:131], v[56:59]
    ds_read_b128 v[88:91], v23 offset:5120
    v_mfma_f32_16x16x32_bf16 v[60:63], v[200:203], v[128:131], v[60:63]
    ds_write_b128 v22, v[108:111] offset:0
    v_mfma_f32_16x16x32_bf16 v[64:67], v[196:199], v[128:131], v[64:67]
    buffer_load_dwordx4 v[240:243], v2, s[4:7], s33 offen offset:1024
    v_mfma_f32_16x16x32_bf16 v[48:51], v[192:195], v[132:135], v[48:51]
    ds_read_b128 v[72:75], v23 offset:1024
    ds_read_b128 v[92:95], v23 offset:6144
    v_mfma_f32_16x16x32_bf16 v[52:55], v[188:191], v[132:135], v[52:55]
    ds_write_b128 v22, v[112:115] offset:1024
    v_mfma_f32_16x16x32_bf16 v[56:59], v[184:187], v[132:135], v[56:59]
    ds_read_b128 v[76:79], v23 offset:2048
    ds_read_b128 v[96:99], v23 offset:7168
    v_mfma_f32_16x16x32_bf16 v[60:63], v[180:183], v[132:135], v[60:63]
    buffer_load_dwordx4 v[236:239], v2, s[4:7], s33 offen offset:2048
    v_mfma_f32_16x16x32_bf16 v[64:67], v[176:179], v[132:135], v[64:67]
    ds_write_b128 v22, v[116:119] offset:2048
    v_mfma_f32_16x16x32_bf16 v[48:51], a[160:163], v[136:139], v[48:51]
    ds_read_b128 v[80:83], v23 offset:3072
    ds_read_b128 v[100:103], v23 offset:8192
    v_mfma_f32_16x16x32_bf16 v[52:55], a[164:167], v[136:139], v[52:55]
    ds_write_b128 v22, v[120:123] offset:3072
    v_mfma_f32_16x16x32_bf16 v[56:59], a[168:171], v[136:139], v[56:59]
    buffer_load_dwordx4 v[232:235], v2, s[4:7], s33 offen offset:3072
    v_mfma_f32_16x16x32_bf16 v[60:63], a[172:175], v[136:139], v[60:63]
    ds_read_b128 v[84:87], v23 offset:4096
    ds_read_b128 v[104:107], v23 offset:9216
    v_mfma_f32_16x16x32_bf16 v[64:67], a[176:179], v[136:139], v[64:67]
    s_waitcnt lgkmcnt(14)
    ds_write_b128 v22, v[124:127] offset:4096
    v_mfma_f32_16x16x32_bf16 v[48:51], a[180:183], v[140:143], v[48:51]
    s_waitcnt lgkmcnt(13)
    buffer_load_dwordx4 v[228:231], v3, s[4:7], s33 offen offset:0
    v_mfma_f32_16x16x32_bf16 v[52:55], a[184:187], v[140:143], v[52:55]
    v_add_f32 v68, v68, v88
    v_add_f32 v69, v69, v89
    v_mfma_f32_16x16x32_bf16 v[56:59], a[188:191], v[140:143], v[56:59]
    v_add_f32 v70, v70, v90
    v_add_f32 v71, v71, v91
    v_mfma_f32_16x16x32_bf16 v[60:63], a[244:247], v[140:143], v[60:63]
    s_waitcnt lgkmcnt(10)
    v_add_f32 v72, v72, v92
    v_add_f32 v73, v73, v93
    v_mfma_f32_16x16x32_bf16 v[64:67], a[248:251], v[140:143], v[64:67]
    buffer_load_dwordx4 v[224:227], v3, s[4:7], s33 offen offset:1024
    s_waitcnt lgkmcnt(0)
    s_barrier
    ds_read_b128 v[108:111], v23 offset:10240
    ds_read_b128 v[112:115], v23 offset:11264
    ds_read_b128 v[116:119], v23 offset:12288
    ds_read_b128 v[120:123], v23 offset:13312
    ds_read_b128 v[124:127], v23 offset:14336
    v_add_f32 v74, v74, v94
    v_add_f32 v75, v75, v95
    v_add_f32 v76, v76, v96
    v_add_f32 v77, v77, v97
    v_add_f32 v78, v78, v98
    v_add_f32 v79, v79, v99
    v_add_f32 v80, v80, v100
    v_add_f32 v81, v81, v101
    v_add_f32 v82, v82, v102
    v_add_f32 v83, v83, v103
    v_add_f32 v84, v84, v104
    v_add_f32 v85, v85, v105
    v_add_f32 v86, v86, v106
    v_add_f32 v87, v87, v107
    v_pk_add_f32 v[48:49], v[48:49], v[68:69]
    v_pk_add_f32 v[50:51], v[50:51], v[70:71]
    v_pk_add_f32 v[52:53], v[52:53], v[72:73]
    v_pk_add_f32 v[54:55], v[54:55], v[74:75]
    v_pk_add_f32 v[56:57], v[56:57], v[76:77]
    v_pk_add_f32 v[58:59], v[58:59], v[78:79]
    v_pk_add_f32 v[60:61], v[60:61], v[80:81]
    v_pk_add_f32 v[62:63], v[62:63], v[82:83]
    v_pk_add_f32 v[64:65], v[64:65], v[84:85]
    v_pk_add_f32 v[66:67], v[66:67], v[86:87]
    s_waitcnt lgkmcnt(4)
    v_pk_add_f32 v[48:49], v[48:49], v[108:109]
    v_pk_add_f32 v[50:51], v[50:51], v[110:111]
    v_cvt_pk_bf16_f32 v36, v48, v49
    v_cvt_pk_bf16_f32 v37, v50, v51
    s_waitcnt lgkmcnt(3)
    v_pk_add_f32 v[52:53], v[52:53], v[112:113]
    v_pk_add_f32 v[54:55], v[54:55], v[114:115]
    v_cvt_pk_bf16_f32 v38, v52, v53
    v_cvt_pk_bf16_f32 v39, v54, v55
    buffer_store_dwordx4 v[36:39], v1, s[4:7], s95 offen
    s_waitcnt lgkmcnt(2)
    v_pk_add_f32 v[56:57], v[56:57], v[116:117]
    v_pk_add_f32 v[58:59], v[58:59], v[118:119]
    v_cvt_pk_bf16_f32 v40, v56, v57
    v_cvt_pk_bf16_f32 v41, v58, v59
    s_waitcnt lgkmcnt(1)
    v_pk_add_f32 v[60:61], v[60:61], v[120:121]
    v_pk_add_f32 v[62:63], v[62:63], v[122:123]
    v_cvt_pk_bf16_f32 v42, v60, v61
    v_cvt_pk_bf16_f32 v43, v62, v63
    buffer_store_dwordx4 v[40:43], v1, s[4:7], s95 offen offset:1024
    s_waitcnt lgkmcnt(0)
    v_pk_add_f32 v[64:65], v[64:65], v[124:125]
    v_pk_add_f32 v[66:67], v[66:67], v[126:127]
    v_cvt_pk_bf16_f32 v44, v64, v65
    v_cvt_pk_bf16_f32 v45, v66, v67
    buffer_store_dwordx2 v[44:45], v25, s[4:7], s96 offen
    v_dot2_f32_bf16 v31, v36, s30, 0
    v_dot2_f32_bf16 v32, v36, v36, 0
    v_dot2_f32_bf16 v31, v37, s30, v31
    v_dot2_f32_bf16 v32, v37, v37, v32
    v_dot2_f32_bf16 v31, v38, s30, v31
    v_dot2_f32_bf16 v32, v38, v38, v32
    v_dot2_f32_bf16 v31, v39, s30, v31
    v_dot2_f32_bf16 v32, v39, v39, v32
    v_dot2_f32_bf16 v31, v40, s30, v31
    v_dot2_f32_bf16 v32, v40, v40, v32
    v_dot2_f32_bf16 v31, v41, s30, v31
    v_dot2_f32_bf16 v32, v41, v41, v32
    v_dot2_f32_bf16 v31, v42, s30, v31
    v_dot2_f32_bf16 v32, v42, v42, v32
    v_dot2_f32_bf16 v31, v43, s30, v31
    v_dot2_f32_bf16 v32, v43, v43, v32
    v_dot2_f32_bf16 v31, v44, s30, v31
    v_dot2_f32_bf16 v32, v44, v44, v32
    v_dot2_f32_bf16 v31, v45, s30, v31
    v_dot2_f32_bf16 v32, v45, v45, v32
    s_nop 2
    v_permlane16_swap_b32 v31, v32
    v_add_f32 v31, v31, v32
    v_mov_b32 v32, v31
    s_nop 1
    v_permlane32_swap_b32 v31, v32
    v_add_f32 v34, v31, v32
    s_mov_b64 exec, s[36:37]
    buffer_store_dword v34, v28, s[4:7], s97 offen
    s_mov_b64 exec, -1
    v_mov_b32 v30, 6
    s_mov_b64 exec, 1
    s_cmp_lg_u32 s28, 0
    s_waitcnt vmcnt(0)
    s_cbranch_scc1 pubs_35
    buffer_store_dword v30, off, s[4:7], s32
pubd_36:
    s_mov_b64 exec, -1
    buffer_load_dword v29, v5, s[4:7], s31 offen sc1
    s_waitcnt vmcnt(0)
poll_38:
    v_cmp_le_u32 vcc, 6, v29
    s_nop 0
    s_andn2_b64 s[56:57], s[36:37], vcc
    s_cbranch_scc1 pollr_37
    s_cmp_lg_u32 s28, 0
    s_cbranch_scc1 acq_39
polld_40:
    s_add_u32 m0, s82, 45056
    s_nop 0
    buffer_load_dwordx4 v1, s[12:15], m0 offen offset:0 sc1 lds
    s_add_u32 m0, s82, 46080
    s_nop 0
    buffer_load_dwordx4 v1, s[12:15], m0 offen offset:0 sc1 lds
    s_add_u32 m0, s82, 49152
    s_nop 0
    buffer_load_dwordx4 v1, s[12:15], m0 offen offset:0 sc1 lds
    s_add_u32 m0, s82, 50176
    s_nop 0
    buffer_load_dwordx4 v1, s[12:15], m0 offen offset:0 sc1 lds
    s_add_u32 s88, s98, 0
    buffer_load_dwordx4 v[144:147], v1, s[4:7], s88 offen sc1
    s_add_u32 m0, s82, 53248
    s_nop 0
    buffer_load_dwordx4 v1, s[12:15], m0 offen offset:0 sc1 lds
    s_add_u32 m0, s82, 54272
    s_nop 0
    buffer_load_dwordx4 v1, s[12:15], m0 offen offset:0 sc1 lds
    s_add_u32 m0, s82, 57344
    s_nop 0
    buffer_load_dwordx4 v1, s[12:15], m0 offen offset:0 sc1 lds
    s_add_u32 m0, s82, 58368
    s_nop 0
    buffer_load_dwordx4 v1, s[12:15], m0 offen offset:0 sc1 lds
    s_add_u32 m0, s82, 61440
    s_nop 0
    buffer_load_dwordx4 v1, s[12:15], m0 offen offset:0 sc1 lds
    s_waitcnt vmcnt(6)
    s_barrier
    ds_read_b128 v[96:99], v9 offset:40960
    ds_read_b128 v[100:103], v9 offset:41472
    ds_read_b128 v[104:107], v9 offset:41984
    ds_read_b128 v[108:111], v9 offset:42496
    ds_read_b128 v[112:115], v9 offset:43008
    ds_read_b128 v[116:119], v9 offset:43520
    s_waitcnt lgkmcnt(4)
    v_mfma_f32_32x32x16_bf16 v[48:63], a[0:3], v[96:99], 0
    s_add_u32 m0, s82, 62464
    ds_read_b128 v[120:123], v9 offset:44032
    buffer_load_dwordx4 v1, s[12:15], m0 offen offset:0 sc1 lds
    v_mfma_f32_32x32x16_bf16 v[48:63], a[4:7], v[100:103], v[48:63]
    s_waitcnt lgkmcnt(3)
    ds_read_b128 v[124:127], v9 offset:44544
    s_add_u32 m0, s82, 4096
    s_nop 0
    buffer_load_dwordx4 v1, s[12:15], m0 offen offset:0 sc1 lds
    v_mfma_f32_32x32x16_bf16 v[48:63], a[8:11], v[104:107], v[48:63]
    s_add_u32 m0, s82, 5120
    ds_read_b128 v[96:99], v9 offset:45056
    buffer_load_dwordx4 v1, s[12:15], m0 offen offset:0 sc1 lds
    v_lshrrev_b32 v140, 3, v5
    v_and_b32 v140, 16, v140
    v_add_u32 v140, s0, v140
    v_mfma_f32_32x32x16_bf16 v[48:63], a[12:15], v[108:111], v[48:63]
    s_waitcnt lgkmcnt(3)
    ds_read_b128 v[100:103], v9 offset:45568
    s_add_u32 m0, s82, 8192
    s_nop 0
    buffer_load_dwordx4 v1, s[12:15], m0 offen offset:0 sc1 lds
    ds_read_b128 v[128:131], v140 offset:0
    v_mfma_f32_32x32x16_bf16 v[48:63], a[16:19], v[112:115], v[48:63]
    s_add_u32 m0, s82, 9216
    ds_read_b128 v[104:107], v9 offset:46080
    buffer_load_dwordx4 v1, s[12:15], m0 offen offset:0 sc1 lds
    ds_read_b128 v[132:135], v140 offset:32
    ds_read_b128 v[136:139], v140 offset:64
    ds_read_b128 v[140:143], v140 offset:96
    v_mfma_f32_32x32x16_bf16 v[48:63], a[20:23], v[116:119], v[48:63]
    s_waitcnt lgkmcnt(7)
    ds_read_b128 v[108:111], v9 offset:46592
    s_add_u32 m0, s82, 12288
    s_nop 0
    buffer_load_dwordx4 v1, s[12:15], m0 offen offset:0 sc1 lds
    v_and_b32 v154, 124, v5
    v_mfma_f32_32x32x16_bf16 v[48:63], a[24:27], v[120:123], v[48:63]
    s_add_u32 m0, s82, 13312
    ds_read_b128 v[112:115], v9 offset:47104
    buffer_load_dwordx4 v1, s[12:15], m0 offen offset:0 sc1 lds
    v_lshlrev_b32 v154, 1, v154
    v_add_u32 v154, 2048, v154
    v_mfma_f32_32x32x16_bf16 v[48:63], a[28:31], v[124:127], v[48:63]
    s_waitcnt lgkmcnt(7)
    ds_read_b128 v[116:119], v9 offset:47616
    s_add_u32 m0, s82, 16384
    s_nop 0
    buffer_load_dwordx4 v1, s[12:15], m0 offen offset:0 sc1 lds
    v_mfma_f32_32x32x16_bf16 v[48:63], a[32:35], v[96:99], v[48:63]
    s_add_u32 m0, s82, 17408
    ds_read_b128 v[120:123], v9 offset:48128
    buffer_load_dwordx4 v1, s[12:15], m0 offen offset:0 sc1 lds
    v_mfma_f32_32x32x16_bf16 v[48:63], a[36:39], v[100:103], v[48:63]
    s_waitcnt lgkmcnt(3)
    ds_read_b128 v[124:127], v9 offset:48640
    s_add_u32 m0, s82, 20480
    s_nop 0
    buffer_load_dwordx4 v1, s[12:15], m0 offen offset:0 sc1 lds
    v_mfma_f32_32x32x16_bf16 v[48:63], a[40:43], v[104:107], v[48:63]
    s_add_u32 m0, s82, 21504
    s_waitcnt vmcnt(9)
    s_barrier
    ds_read_b128 v[96:99], v9 offset:49152
    buffer_load_dwordx4 v1, s[12:15], m0 offen offset:0 sc1 lds
    v_mfma_f32_32x32x16_bf16 v[48:63], a[44:47], v[108:111], v[48:63]
    s_waitcnt lgkmcnt(3)
    ds_read_b128 v[100:103], v9 offset:49664
    v_mfma_f32_32x32x16_bf16 v[48:63], a[48:51], v[112:115], v[48:63]
    ds_read_b128 v[104:107], v9 offset:50176
    buffer_load_dwordx4 v[220:223], v3, s[4:7], s33 offen offset:2048
    v_mfma_f32_32x32x16_bf16 v[48:63], a[52:55], v[116:119], v[48:63]
    s_waitcnt lgkmcnt(3)
    ds_read_b128 v[108:111], v9 offset:50688
    v_mfma_f32_32x32x16_bf16 v[48:63], a[56:59], v[120:123], v[48:63]
    ds_read_b128 v[112:115], v9 offset:51200
    v_add_f32 v144, v144, v146
    v_add_f32 v145, v145, v147
    s_nop 1
    v_permlane16_swap_b32 v144, v145
    v_mfma_f32_32x32x16_bf16 v[48:63], a[60:63], v[124:127], v[48:63]
    s_waitcnt lgkmcnt(3)
    ds_read_b128 v[116:119], v9 offset:51712
    v_add_f32 v144, v144, v145
    v_mov_b32 v145, v144
    s_nop 1
    v_permlane32_swap_b32 v144, v145
    v_mfma_f32_32x32x16_bf16 v[48:63], a[64:67], v[96:99], v[48:63]
    buffer_load_dword v29, v5, s[4:7], s31 offen sc1
    ds_read_b128 v[120:123], v9 offset:52224
    v_add_f32 v144, v144, v145
    v_mov_b32 v145, v144
    s_nop 1
    v_permlane16_swap_b32 v144, v145
    v_mfma_f32_32x32x16_bf16 v[48:63], a[68:71], v[100:103], v[48:63]
    s_waitcnt lgkmcnt(3)
    ds_read_b128 v[124:127], v9 offset:52736
    buffer_load_dwordx4 v[216:219], v3, s[4:7], s33 offen offset:3072
    v_mul_f32 v146, s64, v144
    v_mul_f32 v145, s64, v145
    v_fma_f32 v145, -v146, v146, v145
    v_mfma_f32_32x32x16_bf16 v[48:63], a[72:75], v[104:107], v[48:63]
    s_add_u32 s33, s60, 24576
    ds_read_b128 v[96:99], v9 offset:53248
    v_max_f32 v145, 0, v145
    v_add_f32 v145, s65, v145
    v_rsq_f32 v147, v145
    v_add_u32 v144, s0, v17
    v_mfma_f32_32x32x16_bf16 v[48:63], a[76:79], v[108:111], v[48:63]
    s_waitcnt lgkmcnt(3)
    ds_read_b128 v[100:103], v9 offset:53760
    ds_write_b64 v144, v[146:147] offset:0
    v_mfma_f32_32x32x16_bf16 v[48:63], a[80:83], v[112:115], v[48:63]
    ds_read_b128 v[104:107], v9 offset:54272
    v_mfma_f32_32x32x16_bf16 v[48:63], a[84:87], v[116:119], v[48:63]
    s_waitcnt lgkmcnt(4)
    ds_read_b128 v[108:111], v9 offset:54784
    v_mfma_f32_32x32x16_bf16 v[48:63], a[88:91], v[120:123], v[48:63]
    ds_read_b128 v[112:115], v9 offset:55296
    v_mfma_f32_32x32x16_bf16 v[48:63], a[92:95], v[124:127], v[48:63]
    s_waitcnt lgkmcnt(4)
    ds_read_b128 v[116:119], v9 offset:55808
    buffer_load_dwordx4 v[212:215], v1, s[4:7], s33 offen offset:0
    v_mfma_f32_32x32x16_bf16 v[48:63], a[96:99], v[96:99], v[48:63]
    s_add_u32 s33, s61, 0
    ds_read_b128 v[120:123], v9 offset:56320
    v_mfma_f32_32x32x16_bf16 v[48:63], a[100:103], v[100:103], v[48:63]
    s_waitcnt lgkmcnt(3)
    ds_read_b128 v[124:127], v9 offset:56832
    v_mfma_f32_32x32x16_bf16 v[48:63], a[104:107], v[104:107], v[48:63]
    ds_read_b128 v[96:99], v9 offset:57344
    v_mfma_f32_32x32x16_bf16 v[48:63], a[108:111], v[108:111], v[48:63]
    s_waitcnt lgkmcnt(3)
    ds_read_b128 v[100:103], v9 offset:57856
    v_mfma_f32_32x32x16_bf16 v[48:63], a[112:115], v[112:115], v[48:63]
    ds_read_b128 v[104:107], v9 offset:58368
    v_mfma_f32_32x32x16_bf16 v[48:63], a[116:119], v[116:119], v[48:63]
    s_waitcnt lgkmcnt(3)
    ds_read_b128 v[108:111], v9 offset:58880
    buffer_load_dwordx4 v[208:211], v1, s[4:7], s33 offen offset:0
    v_mfma_f32_32x32x16_bf16 v[48:63], a[120:123], v[120:123], v[48:63]
    ds_read_b128 v[112:115], v9 offset:59392
    v_mfma_f32_32x32x16_bf16 v[48:63], a[124:127], v[124:127], v[48:63]
    s_waitcnt lgkmcnt(3)
    ds_read_b128 v[116:119], v9 offset:59904
    v_mfma_f32_32x32x16_bf16 v[48:63], a[128:131], v[96:99], v[48:63]
    ds_read_b128 v[120:123], v9 offset:60416
    v_mfma_f32_32x32x16_bf16 v[48:63], a[132:135], v[100:103], v[48:63]
    s_waitcnt lgkmcnt(3)
    ds_read_b128 v[124:127], v9 offset:60928
    v_mfma_f32_32x32x16_bf16 v[48:63], a[136:139], v[104:107], v[48:63]
    s_waitcnt vmcnt(5)
    s_barrier
    s_waitcnt vmcnt(3)
poll_42:
    v_cmp_le_u32 vcc, 6, v29
    s_nop 0
    s_andn2_b64 s[56:57], s[38:39], vcc
    s_cbranch_scc1 pollr_41
    s_cmp_lg_u32 s28, 0
    s_cbranch_scc1 acq_43
polld_44:
    ds_read_b128 v[96:99], v9 offset:0
    v_mfma_f32_32x32x16_bf16 v[48:63], a[140:143], v[108:111], v[48:63]
    s_waitcnt lgkmcnt(3)
    ds_read_b128 v[100:103], v9 offset:512
    s_add_u32 s88, s98, 65536
    buffer_load_dwordx4 v[144:147], v1, s[4:7], s88 offen sc1
    v_mfma_f32_32x32x16_bf16 v[48:63], a[144:147], v[112:115], v[48:63]
    s_add_u32 m0, s82, 45056
    ds_read_b128 v[104:107], v9 offset:1024
    s_add_u32 s88, s82, 4096
    buffer_load_dwordx4 v1, s[16:19], s88 offen offset:0 sc1 lds
    v_mfma_f32_32x32x16_bf16 v[48:63], a[148:151], v[116:119], v[48:63]
    s_waitcnt lgkmcnt(3)
    ds_read_b128 v[108:111], v9 offset:1536
    s_add_u32 m0, s82, 46080
    s_add_u32 s88, s82, 5120
    buffer_load_dwordx4 v1, s[16:19], s88 offen offset:0 sc1 lds
    v_mfma_f32_32x32x16_bf16 v[48:63], a[152:155], v[120:123], v[48:63]
    s_add_u32 m0, s82, 49152
    ds_read_b128 v[112:115], v9 offset:2048
    s_add_u32 s88, s82, 8192
    buffer_load_dwordx4 v1, s[16:19], s88 offen offset:0 sc1 lds
    v_mfma_f32_32x32x16_bf16 v[48:63], a[156:159], v[124:127], v[48:63]
    s_waitcnt lgkmcnt(3)
    ds_read_b128 v[116:119], v9 offset:2560
    s_add_u32 m0, s82, 50176
    s_add_u32 s88, s82, 9216
    buffer_load_dwordx4 v1, s[16:19], s88 offen offset:0 sc1 lds
    v_mfma_f32_32x32x16_bf16 v[64:79], a[0:3], v[96:99], 0
    s_add_u32 m0, s82, 53248
    ds_read_b128 v[120:123], v9 offset:3072
    s_add_u32 s88, s82, 12288
    buffer_load_dwordx4 v1, s[16:19], s88 offen offset:0 sc1 lds
    v_mfma_f32_32x32x16_bf16 v[64:79], a[4:7], v[100:103], v[64:79]
    s_waitcnt lgkmcnt(3)
    ds_read_b128 v[124:127], v9 offset:3584
    s_add_u32 m0, s82, 54272
    s_add_u32 s88, s82, 13312
    buffer_load_dwordx4 v1, s[16:19], s88 offen offset:0 sc1 lds
    v_mfma_f32_32x32x16_bf16 v[64:79], a[8:11], v[104:107], v[64:79]
    s_add_u32 m0, s82, 57344
    ds_read_b128 v[96:99], v9 offset:4096
    s_add_u32 s88, s82, 16384
    buffer_load_dwordx4 v1, s[16:19], s88 offen offset:0 sc1 lds
    v_mfma_f32_32x32x16_bf16 v[64:79], a[12:15], v[108:111], v[64:79]
    s_waitcnt lgkmcnt(3)
    ds_read_b128 v[100:103], v9 offset:4608
    s_add_u32 m0, s82, 58368
    s_add_u32 s88, s82, 17408
    buffer_load_dwordx4 v1, s[16:19], s88 offen offset:0 sc1 lds
    v_mfma_f32_32x32x16_bf16 v[64:79], a[16:19], v[112:115], v[64:79]
    ds_read_b128 v[104:107], v9 offset:5120
    v_mfma_f32_32x32x16_bf16 v[64:79], a[20:23], v[116:119], v[64:79]
    s_waitcnt lgkmcnt(3)
    ds_read_b128 v[108:111], v9 offset:5632
    buffer_load_dwordx4 v[204:207], v1, s[4:7], s33 offen offset:1024
    s_barrier
    v_mfma_f32_32x32x16_bf16 v[64:79], a[24:27], v[120:123], v[64:79]
    s_add_u32 m0, s82, 61440
    ds_read_b128 v[112:115], v9 offset:6144
    v_mfma_f32_32x32x16_bf16 v[64:79], a[28:31], v[124:127], v[64:79]
    s_waitcnt lgkmcnt(3)
    ds_read_b128 v[116:119], v9 offset:6656
    s_add_u32 s88, s82, 20480
    buffer_load_dwordx4 v1, s[16:19], s88 offen offset:0 sc1 lds
    v_mfma_f32_32x32x16_bf16 v[64:79], a[32:35], v[96:99], v[64:79]
    s_add_u32 m0, s82, 62464
    ds_read_b128 v[120:123], v9 offset:7168
    ds_read_b64 v[152:153], v154 offset:256
    v_mfma_f32_32x32x16_bf16 v[64:79], a[36:39], v[100:103], v[64:79]
    s_waitcnt lgkmcnt(4)
    ds_read_b128 v[124:127], v9 offset:7680
    s_add_u32 s88, s82, 21504
    buffer_load_dwordx4 v1, s[16:19], s88 offen offset:0 sc1 lds
    v_mfma_f32_32x32x16_bf16 v[64:79], a[40:43], v[104:107], v[64:79]
    ds_read_b128 v[96:99], v9 offset:8192
    v_mfma_f32_32x32x16_bf16 v[64:79], a[44:47], v[108:111], v[64:79]
    s_waitcnt lgkmcnt(4)
    ds_read_b128 v[100:103], v9 offset:8704
    buffer_load_dwordx4 v[200:203], v1, s[4:7], s33 offen offset:2048
    v_mfma_f32_32x32x16_bf16 v[64:79], a[48:51], v[112:115], v[64:79]
    ds_read_b128 v[104:107], v9 offset:9216
    v_mfma_f32_32x32x16_bf16 v[64:79], a[52:55], v[116:119], v[64:79]
    s_waitcnt lgkmcnt(3)
    ds_read_b128 v[108:111], v9 offset:9728
    v_fma_f32 v48, -v128, v152, v48
    v_fma_f32 v49, -v129, v152, v49
    v_fma_f32 v50, -v130, v152, v50
    v_fma_f32 v51, -v131, v152, v51
    v_mul_f32 v48, v48, v153
    v_mfma_f32_32x32x16_bf16 v[64:79], a[56:59], v[120:123], v[64:79]
    ds_read_b128 v[112:115], v9 offset:10240
    v_mul_f32 v49, v49, v153
    v_mul_f32 v50, v50, v153
    v_mul_f32 v51, v51, v153
    v_cvt_pk_bf16_f32 v48, v48, v49
    v_cvt_pk_bf16_f32 v49, v50, v51
    v_mfma_f32_32x32x16_bf16 v[64:79], a[60:63], v[124:127], v[64:79]
    s_waitcnt lgkmcnt(3)
    ds_read_b128 v[116:119], v9 offset:10752
    ds_write_b64 v8, v[48:49] offset:29568
    v_fma_f32 v52, -v132, v152, v52
    v_mfma_f32_32x32x16_bf16 v[64:79], a[64:67], v[96:99], v[64:79]
    ds_read_b128 v[120:123], v9 offset:11264
    buffer_load_dwordx4 v[196:199], v1, s[4:7], s33 offen offset:3072
    v_fma_f32 v53, -v133, v152, v53
    v_fma_f32 v54, -v134, v152, v54
    v_fma_f32 v55, -v135, v152, v55
    v_mfma_f32_32x32x16_bf16 v[64:79], a[68:71], v[100:103], v[64:79]
    s_waitcnt lgkmcnt(4)
    ds_read_b128 v[124:127], v9 offset:11776
    v_mul_f32 v52, v52, v153
    v_mul_f32 v53, v53, v153
    v_mul_f32 v54, v54, v153
    v_mul_f32 v55, v55, v153
    v_cvt_pk_bf16_f32 v52, v52, v53
    v_mfma_f32_32x32x16_bf16 v[64:79], a[72:75], v[104:107], v[64:79]
    ds_read_b128 v[96:99], v9 offset:12288
    v_cvt_pk_bf16_f32 v53, v54, v55
    ds_write_b64 v8, v[52:53] offset:29584
    v_mfma_f32_32x32x16_bf16 v[64:79], a[76:79], v[108:111], v[64:79]
    s_waitcnt lgkmcnt(5)
    ds_read_b128 v[100:103], v9 offset:12800
    v_fma_f32 v56, -v136, v152, v56
    v_fma_f32 v57, -v137, v152, v57
    v_fma_f32 v58, -v138, v152, v58
    v_fma_f32 v59, -v139, v152, v59
    v_mul_f32 v56, v56, v153
    v_mfma_f32_32x32x16_bf16 v[64:79], a[80:83], v[112:115], v[64:79]
    ds_read_b128 v[104:107], v9 offset:13312
    v_mul_f32 v57, v57, v153
    v_mul_f32 v58, v58, v153
    v_mul_f32 v59, v59, v153
    v_cvt_pk_bf16_f32 v56, v56, v57
    v_cvt_pk_bf16_f32 v57, v58, v59
    v_mfma_f32_32x32x16_bf16 v[64:79], a[84:87], v[116:119], v[64:79]
    s_waitcnt lgkmcnt(4)
    ds_read_b128 v[108:111], v9 offset:13824
    ds_write_b64 v8, v[56:57] offset:29600
    v_fma_f32 v60, -v140, v152, v60
    v_mfma_f32_32x32x16_bf16 v[64:79], a[88:91], v[120:123], v[64:79]
    ds_read_b128 v[112:115], v9 offset:14336
    buffer_load_dwordx4 v[192:195], v2, s[4:7], s33 offen offset:0
    v_fma_f32 v61, -v141, v152, v61
    v_fma_f32 v62, -v142, v152, v62
    v_fma_f32 v63, -v143, v152, v63
    v_mfma_f32_32x32x16_bf16 v[64:79], a[92:95], v[124:127], v[64:79]
    s_waitcnt lgkmcnt(4)
    ds_read_b128 v[116:119], v9 offset:14848
    v_mul_f32 v60, v60, v153
    v_mul_f32 v61, v61, v153
    v_mul_f32 v62, v62, v153
    v_mul_f32 v63, v63, v153
    v_cvt_pk_bf16_f32 v60, v60, v61
    v_mfma_f32_32x32x16_bf16 v[64:79], a[96:99], v[96:99], v[64:79]
    ds_read_b128 v[120:123], v9 offset:15360
    v_cvt_pk_bf16_f32 v61, v62, v63
    ds_write_b64 v8, v[60:61] offset:29616
    v_mfma_f32_32x32x16_bf16 v[64:79], a[100:103], v[100:103], v[64:79]
    s_waitcnt lgkmcnt(5)
    ds_read_b128 v[124:127], v9 offset:15872
    v_mfma_f32_32x32x16_bf16 v[64:79], a[104:107], v[104:107], v[64:79]
    ds_read_b128 v[96:99], v9 offset:16384
    v_mfma_f32_32x32x16_bf16 v[64:79], a[108:111], v[108:111], v[64:79]
    s_waitcnt lgkmcnt(4)
    ds_read_b128 v[100:103], v9 offset:16896
    s_waitcnt lgkmcnt(3)
    s_barrier
    v_add_u32 v156, 33792, v4
    ds_read2_b64 v[156:159], v156 offset1:1
    s_add_u32 s91, s85, 1048576
    v_mfma_f32_32x32x16_bf16 v[64:79], a[112:115], v[112:115], v[64:79]
    ds_read_b128 v[104:107], v9 offset:17408
    buffer_load_dwordx4 v[188:191], v2, s[4:7], s33 offen offset:1024
    v_mfma_f32_32x32x16_bf16 v[64:79], a[116:119], v[116:119], v[64:79]
    s_waitcnt lgkmcnt(4)
    ds_read_b128 v[108:111], v9 offset:17920
    v_mfma_f32_32x32x16_bf16 v[64:79], a[120:123], v[120:123], v[64:79]
    ds_read_b128 v[112:115], v9 offset:18432
    v_mfma_f32_32x32x16_bf16 v[64:79], a[124:127], v[124:127], v[64:79]
    s_waitcnt lgkmcnt(4)
    ds_read_b128 v[116:119], v9 offset:18944
    v_mfma_f32_32x32x16_bf16 v[64:79], a[128:131], v[96:99], v[64:79]
    s_waitcnt lgkmcnt(4)
    ds_read_b128 v[120:123], v9 offset:19456
    buffer_store_dwordx4 v[156:159], v1, s[4:7], s91 offen sc1
    s_waitcnt vmcnt(16)
    v_add_f32 v144, v144, v146
    v_add_f32 v145, v145, v147
    v_mfma_f32_32x32x16_bf16 v[64:79], a[132:135], v[100:103], v[64:79]
    s_waitcnt lgkmcnt(3)
    ds_read_b128 v[124:127], v9 offset:19968
    v_permlane16_swap_b32 v144, v145
    v_add_f32 v144, v144, v145
    v_mov_b32 v145, v144
    s_nop 1
    v_permlane32_swap_b32 v144, v145
    v_mfma_f32_32x32x16_bf16 v[64:79], a[136:139], v[104:107], v[64:79]
    v_add_f32 v144, v144, v145
    v_mov_b32 v145, v144
    s_nop 1
    v_permlane16_swap_b32 v144, v145
    v_mul_f32 v146, s64, v144
    v_mul_f32 v145, s64, v145
    v_fma_f32 v145, -v146, v146, v145
    v_max_f32 v145, 0, v145
    v_add_f32 v145, s65, v145
    v_rsq_f32 v147, v145
    v_add_u32 v144, s0, v17
    ds_write_b64 v144, v[146:147] offset:512
    s_waitcnt vmcnt(5)
    s_waitcnt lgkmcnt(0)
    s_barrier
    ds_read_b128 v[96:99], v9 offset:40960
    v_mfma_f32_32x32x16_bf16 v[64:79], a[140:143], v[108:111], v[64:79]
    s_add_u32 m0, s82, 4096
    ds_read_b128 v[100:103], v9 offset:41472
    s_add_u32 s88, s82, 45056
    buffer_load_dwordx4 v1, s[16:19], s88 offen offset:0 sc1 lds
    v_mfma_f32_32x32x16_bf16 v[64:79], a[144:147], v[112:115], v[64:79]
    s_add_u32 m0, s82, 5120
    ds_read_b128 v[104:107], v9 offset:41984
    s_add_u32 s88, s82, 46080
    buffer_load_dwordx4 v1, s[16:19], s88 offen offset:0 sc1 lds
    v_mfma_f32_32x32x16_bf16 v[64:79], a[148:151], v[116:119], v[64:79]
    s_add_u32 m0, s82, 8192
    ds_read_b128 v[108:111], v9 offset:42496
    s_add_u32 s88, s82, 49152
    buffer_load_dwordx4 v1, s[16:19], s88 offen offset:0 sc1 lds
    v_mfma_f32_32x32x16_bf16 v[64:79], a[152:155], v[120:123], v[64:79]
    s_add_u32 m0, s82, 9216
    ds_read_b128 v[112:115], v9 offset:43008
    s_add_u32 s88, s82, 50176
    buffer_load_dwordx4 v1, s[16:19], s88 offen offset:0 sc1 lds
    v_mfma_f32_32x32x16_bf16 v[64:79], a[156:159], v[124:127], v[64:79]
    s_waitcnt lgkmcnt(3)
    ds_read_b128 v[116:119], v9 offset:43520
    s_add_u32 m0, s82, 12288
    s_add_u32 s88, s82, 53248
    buffer_load_dwordx4 v1, s[16:19], s88 offen offset:0 sc1 lds
    v_mfma_f32_32x32x16_bf16 v[80:95], a[0:3], v[96:99], 0
    s_add_u32 m0, s82, 13312
    ds_read_b128 v[120:123], v9 offset:44032
    s_add_u32 s88, s82, 54272
    buffer_load_dwordx4 v1, s[16:19], s88 offen offset:0 sc1 lds
    v_mfma_f32_32x32x16_bf16 v[80:95], a[4:7], v[100:103], v[80:95]
    s_waitcnt lgkmcnt(3)
    ds_read_b128 v[124:127], v9 offset:44544
    s_add_u32 m0, s82, 16384
    s_add_u32 s88, s82, 57344
    buffer_load_dwordx4 v1, s[16:19], s88 offen offset:0 sc1 lds
    v_mfma_f32_32x32x16_bf16 v[80:95], a[8:11], v[104:107], v[80:95]
    s_add_u32 m0, s82, 17408
    ds_read_b128 v[96:99], v9 offset:45056
    s_add_u32 s88, s82, 58368
    buffer_load_dwordx4 v1, s[16:19], s88 offen offset:0 sc1 lds
    v_mfma_f32_32x32x16_bf16 v[80:95], a[12:15], v[108:111], v[80:95]
    s_waitcnt lgkmcnt(3)
    ds_read_b128 v[100:103], v9 offset:45568
    v_mfma_f32_32x32x16_bf16 v[80:95], a[16:19], v[112:115], v[80:95]
    ds_read_b128 v[104:107], v9 offset:46080
    buffer_load_dwordx4 v[184:187], v2, s[4:7], s33 offen offset:2048
    v_mfma_f32_32x32x16_bf16 v[80:95], a[20:23], v[116:119], v[80:95]
    s_waitcnt lgkmcnt(3)
    ds_read_b128 v[108:111], v9 offset:46592
    s_barrier
    v_mfma_f32_32x32x16_bf16 v[80:95], a[24:27], v[120:123], v[80:95]
    s_add_u32 m0, s82, 20480
    ds_read_b128 v[112:115], v9 offset:47104
    s_add_u32 s88, s82, 61440
    buffer_load_dwordx4 v1, s[16:19], s88 offen offset:0 sc1 lds
    v_mfma_f32_32x32x16_bf16 v[80:95], a[28:31], v[124:127], v[80:95]
    s_waitcnt lgkmcnt(3)
    ds_read_b128 v[116:119], v9 offset:47616
    v_mfma_f32_32x32x16_bf16 v[80:95], a[32:35], v[96:99], v[80:95]
    s_add_u32 m0, s82, 21504
    ds_read_b128 v[120:123], v9 offset:48128
    s_add_u32 s88, s82, 62464
    buffer_load_dwordx4 v1, s[16:19], s88 offen offset:0 sc1 lds
    v_mfma_f32_32x32x16_bf16 v[80:95], a[36:39], v[100:103], v[80:95]
    s_waitcnt lgkmcnt(3)
    ds_read_b128 v[124:127], v9 offset:48640
    v_mfma_f32_32x32x16_bf16 v[80:95], a[40:43], v[104:107], v[80:95]
    ds_read_b128 v[96:99], v9 offset:49152
    buffer_load_dwordx4 v[180:183], v2, s[4:7], s33 offen offset:3072
    v_mfma_f32_32x32x16_bf16 v[80:95], a[44:47], v[108:111], v[80:95]
    s_waitcnt lgkmcnt(3)
    ds_read_b128 v[100:103], v9 offset:49664
    v_mfma_f32_32x32x16_bf16 v[80:95], a[48:51], v[112:115], v[80:95]
    ds_read_b128 v[104:107], v9 offset:50176
    v_mfma_f32_32x32x16_bf16 v[80:95], a[52:55], v[116:119], v[80:95]
    s_waitcnt lgkmcnt(3)
    ds_read_b128 v[108:111], v9 offset:50688
    v_mfma_f32_32x32x16_bf16 v[80:95], a[56:59], v[120:123], v[80:95]
    ds_read_b128 v[112:115], v9 offset:51200
    v_mfma_f32_32x32x16_bf16 v[80:95], a[60:63], v[124:127], v[80:95]
    s_waitcnt lgkmcnt(3)
    ds_read_b128 v[116:119], v9 offset:51712
    buffer_load_dwordx4 v[176:179], v3, s[4:7], s33 offen offset:0
    v_mfma_f32_32x32x16_bf16 v[80:95], a[64:67], v[96:99], v[80:95]
    ds_read_b128 v[120:123], v9 offset:52224
    v_mfma_f32_32x32x16_bf16 v[80:95], a[68:71], v[100:103], v[80:95]
    s_waitcnt lgkmcnt(3)
    ds_read_b128 v[124:127], v9 offset:52736
    v_mfma_f32_32x32x16_bf16 v[80:95], a[72:75], v[104:107], v[80:95]
    ds_read_b128 v[96:99], v9 offset:53248
    ds_read_b64 v[152:153], v154 offset:0
    v_mfma_f32_32x32x16_bf16 v[80:95], a[76:79], v[108:111], v[80:95]
    s_waitcnt lgkmcnt(4)
    ds_read_b128 v[100:103], v9 offset:53760
    v_mfma_f32_32x32x16_bf16 v[80:95], a[80:83], v[112:115], v[80:95]
    ds_read_b128 v[104:107], v9 offset:54272
    buffer_load_dwordx4 a[160:163], v3, s[4:7], s33 offen offset:1024
    v_mfma_f32_32x32x16_bf16 v[80:95], a[84:87], v[116:119], v[80:95]
    s_waitcnt lgkmcnt(4)
    ds_read_b128 v[108:111], v9 offset:54784
    v_mfma_f32_32x32x16_bf16 v[80:95], a[88:91], v[120:123], v[80:95]
    ds_read_b128 v[112:115], v9 offset:55296
    buffer_load_dwordx4 a[164:167], v3, s[4:7], s33 offen offset:2048
    v_mfma_f32_32x32x16_bf16 v[80:95], a[92:95], v[124:127], v[80:95]
    s_waitcnt lgkmcnt(3)
    ds_read_b128 v[116:119], v9 offset:55808
    v_fma_f32 v64, -v128, v152, v64
    v_fma_f32 v65, -v129, v152, v65
    v_fma_f32 v66, -v130, v152, v66
    v_fma_f32 v67, -v131, v152, v67
    v_mul_f32 v64, v64, v153
    v_mfma_f32_32x32x16_bf16 v[80:95], a[96:99], v[96:99], v[80:95]
    ds_read_b128 v[120:123], v9 offset:56320
    v_mul_f32 v65, v65, v153
    v_mul_f32 v66, v66, v153
    v_mul_f32 v67, v67, v153
    v_cvt_pk_bf16_f32 v64, v64, v65
    v_cvt_pk_bf16_f32 v65, v66, v67
    v_mfma_f32_32x32x16_bf16 v[80:95], a[100:103], v[100:103], v[80:95]
    s_waitcnt lgkmcnt(3)
    ds_read_b128 v[124:127], v9 offset:56832
    buffer_load_dwordx4 a[168:171], v3, s[4:7], s33 offen offset:3072
    ds_write_b64 v8, v[64:65] offset:21120
    v_mfma_f32_32x32x16_bf16 v[80:95], a[104:107], v[104:107], v[80:95]
    s_add_u32 s33, s61, 12288
    ds_read_b128 v[96:99], v9 offset:57344
    v_fma_f32 v68, -v132, v152, v68
    v_fma_f32 v69, -v133, v152, v69
    v_fma_f32 v70, -v134, v152, v70
    v_fma_f32 v71, -v135, v152, v71
    v_mul_f32 v68, v68, v153
    v_mfma_f32_32x32x16_bf16 v[80:95], a[108:111], v[108:111], v[80:95]
    s_waitcnt lgkmcnt(4)
    ds_read_b128 v[100:103], v9 offset:57856
    v_mul_f32 v69, v69, v153
    v_mul_f32 v70, v70, v153
    v_mul_f32 v71, v71, v153
    v_cvt_pk_bf16_f32 v68, v68, v69
    v_cvt_pk_bf16_f32 v69, v70, v71
    v_mfma_f32_32x32x16_bf16 v[80:95], a[112:115], v[112:115], v[80:95]
    v_mov_b32 v30, 2
    s_mov_b64 exec, 1
    s_waitcnt vmcnt(16)
    buffer_store_dword v30, off, s[4:7], s3 sc1
    s_mov_b64 exec, -1
    ds_read_b128 v[104:107], v9 offset:58368
    v_mfma_f32_32x32x16_bf16 v[80:95], a[116:119], v[116:119], v[80:95]
    s_waitcnt lgkmcnt(4)
    ds_read_b128 v[108:111], v9 offset:58880
    v_lshrrev_b32 v32, 2, v5
    v_and_b32 v31, 31, v32
    v_min_u32 v31, 23, v31
    v_lshlrev_b32 v31, 7, v31
    v_lshrrev_b32 v32, 5, v32
    s_mov_b32 s88, 3145728
    v_mad_u32_u24 v31, v32, s88, v31
    s_mul_i32 s88, s26, 1792
    s_add_u32 s88, s88, s93
    buffer_load_dword v0, v31, s[4:7], s88 offen offset:0
    v_mfma_f32_32x32x16_bf16 v[80:95], a[120:123], v[120:123], v[80:95]
    s_lshl_b32 s88, s27, 2
    ds_read_b128 v[112:115], v9 offset:59392
    ds_write_b64 v8, v[68:69] offset:21136
    v_fma_f32 v72, -v136, v152, v72
    v_mfma_f32_32x32x16_bf16 v[80:95], a[124:127], v[124:127], v[80:95]
    s_waitcnt lgkmcnt(4)
    ds_read_b128 v[116:119], v9 offset:59904
    s_add_u32 s88, s88, s24
    s_lshl_b32 s88, s88, 11
    v_lshlrev_b32 v31, 5, v5
    v_and_b32 v31, 0x780, v31
    buffer_load_dword v0, v31, s[20:23], s88 offen
    v_mfma_f32_32x32x16_bf16 v[80:95], a[128:131], v[96:99], v[80:95]
    ds_read_b128 v[120:123], v9 offset:60416
    v_fma_f32 v73, -v137, v152, v73
    v_fma_f32 v74, -v138, v152, v74
    v_fma_f32 v75, -v139, v152, v75
    v_mul_f32 v72, v72, v153
    v_mul_f32 v73, v73, v153
    v_mfma_f32_32x32x16_bf16 v[80:95], a[132:135], v[100:103], v[80:95]
    s_waitcnt lgkmcnt(4)
    ds_read_b128 v[124:127], v9 offset:60928
    buffer_load_dwordx4 a[172:175], v1, s[4:7], s33 offen offset:0
    v_mul_f32 v74, v74, v153
    v_mul_f32 v75, v75, v153
    v_cvt_pk_bf16_f32 v72, v72, v73
    v_mfma_f32_32x32x16_bf16 v[80:95], a[136:139], v[104:107], v[80:95]
    s_waitcnt vmcnt(9)
    s_barrier
    ds_read_b128 v[96:99], v9 offset:0
    v_cvt_pk_bf16_f32 v73, v74, v75
    ds_write_b64 v8, v[72:73] offset:21152
    v_mfma_f32_32x32x16_bf16 v[80:95], a[140:143], v[108:111], v[80:95]
    s_waitcnt lgkmcnt(4)
    ds_read_b128 v[100:103], v9 offset:512
    buffer_load_dwordx4 a[176:179], v1, s[4:7], s33 offen offset:1024
    v_fma_f32 v76, -v140, v152, v76
    v_fma_f32 v77, -v141, v152, v77
    v_fma_f32 v78, -v142, v152, v78
    v_mfma_f32_32x32x16_bf16 v[80:95], a[144:147], v[112:115], v[80:95]
    ds_read_b128 v[104:107], v9 offset:1024
    v_fma_f32 v79, -v143, v152, v79
    v_mul_f32 v76, v76, v153
    v_mul_f32 v77, v77, v153
    v_mul_f32 v78, v78, v153
    v_mul_f32 v79, v79, v153
    v_mfma_f32_32x32x16_bf16 v[80:95], a[148:151], v[116:119], v[80:95]
    s_waitcnt lgkmcnt(4)
    ds_read_b128 v[108:111], v9 offset:1536
    buffer_load_dwordx4 a[180:183], v1, s[4:7], s33 offen offset:2048
    v_cvt_pk_bf16_f32 v76, v76, v77
    v_cvt_pk_bf16_f32 v77, v78, v79
    v_mfma_f32_32x32x16_bf16 v[80:95], a[152:155], v[120:123], v[80:95]
    ds_read_b128 v[112:115], v9 offset:2048
    ds_write_b64 v8, v[76:77] offset:21168
    v_mfma_f32_32x32x16_bf16 v[80:95], a[156:159], v[124:127], v[80:95]
    s_waitcnt lgkmcnt(4)
    ds_read_b128 v[116:119], v9 offset:2560
    buffer_load_dwordx4 a[184:187], v1, s[4:7], s33 offen offset:3072
    v_mfma_f32_32x32x16_bf16 v[48:63], a[0:3], v[96:99], 0
    ds_read_b128 v[120:123], v9 offset:3072
    ds_read_b64 v[152:153], v154 offset:512
    v_mfma_f32_32x32x16_bf16 v[48:63], a[4:7], v[100:103], v[48:63]
    s_waitcnt lgkmcnt(5)
    ds_read_b128 v[124:127], v9 offset:3584
    buffer_load_dwordx4 a[188:191], v2, s[4:7], s33 offen offset:0
    buffer_load_dword v29, v5, s[4:7], s87 offen sc1
    v_mfma_f32_32x32x16_bf16 v[48:63], a[8:11], v[104:107], v[48:63]
    ds_read_b128 v[96:99], v9 offset:4096
    v_mfma_f32_32x32x16_bf16 v[48:63], a[12:15], v[108:111], v[48:63]
    s_waitcnt lgkmcnt(4)
    ds_read_b128 v[100:103], v9 offset:4608
    v_mfma_f32_32x32x16_bf16 v[48:63], a[16:19], v[112:115], v[48:63]
    ds_read_b128 v[104:107], v9 offset:5120
    buffer_load_dwordx4 a[244:247], v2, s[4:7], s33 offen offset:1024
    v_mfma_f32_32x32x16_bf16 v[48:63], a[20:23], v[116:119], v[48:63]
    s_waitcnt lgkmcnt(3)
    ds_read_b128 v[108:111], v9 offset:5632
    v_fma_f32 v80, -v128, v152, v80
    v_fma_f32 v81, -v129, v152, v81
    v_fma_f32 v82, -v130, v152, v82
    v_fma_f32 v83, -v131, v152, v83
    v_mul_f32 v80, v80, v153
    v_mul_f32 v81, v81, v153
    v_mul_f32 v82, v82, v153
    v_mfma_f32_32x32x16_bf16 v[48:63], a[24:27], v[120:123], v[48:63]
    ds_read_b128 v[112:115], v9 offset:6144
    v_mul_f32 v83, v83, v153
    v_cvt_pk_bf16_f32 v80, v80, v81
    v_cvt_pk_bf16_f32 v81, v82, v83
    ds_write_b64 v8, v[80:81] offset:12672
    v_mfma_f32_32x32x16_bf16 v[48:63], a[28:31], v[124:127], v[48:63]
    s_waitcnt lgkmcnt(4)
    ds_read_b128 v[116:119], v9 offset:6656
    v_fma_f32 v84, -v132, v152, v84
    v_fma_f32 v85, -v133, v152, v85
    v_fma_f32 v86, -v134, v152, v86
    v_fma_f32 v87, -v135, v152, v87
    v_mul_f32 v84, v84, v153
    v_mul_f32 v85, v85, v153
    v_mul_f32 v86, v86, v153
    v_mfma_f32_32x32x16_bf16 v[48:63], a[32:35], v[96:99], v[48:63]
    ds_read_b128 v[120:123], v9 offset:7168
    buffer_load_dwordx4 a[248:251], v2, s[4:7], s33 offen offset:2048
    v_mul_f32 v87, v87, v153
    v_cvt_pk_bf16_f32 v84, v84, v85
    v_cvt_pk_bf16_f32 v85, v86, v87
    ds_write_b64 v8, v[84:85] offset:12688
    v_mfma_f32_32x32x16_bf16 v[48:63], a[36:39], v[100:103], v[48:63]
    s_waitcnt lgkmcnt(5)
    ds_read_b128 v[124:127], v9 offset:7680
    v_fma_f32 v88, -v136, v152, v88
    v_fma_f32 v89, -v137, v152, v89
    v_fma_f32 v90, -v138, v152, v90
    v_fma_f32 v91, -v139, v152, v91
    v_mul_f32 v88, v88, v153
    v_mul_f32 v89, v89, v153
    v_mul_f32 v90, v90, v153
    v_mfma_f32_32x32x16_bf16 v[48:63], a[40:43], v[104:107], v[48:63]
    ds_read_b128 v[96:99], v9 offset:8192
    v_mul_f32 v91, v91, v153
    v_cvt_pk_bf16_f32 v88, v88, v89
    v_cvt_pk_bf16_f32 v89, v90, v91
    ds_write_b64 v8, v[88:89] offset:12704
    v_mfma_f32_32x32x16_bf16 v[48:63], a[44:47], v[108:111], v[48:63]
    s_waitcnt lgkmcnt(5)
    ds_read_b128 v[100:103], v9 offset:8704
    buffer_load_dwordx4 a[0:3], v2, s[4:7], s33 offen offset:3072
    v_fma_f32 v92, -v140, v152, v92
    v_fma_f32 v93, -v141, v152, v93
    v_fma_f32 v94, -v142, v152, v94
    v_fma_f32 v95, -v143, v152, v95
    v_mul_f32 v92, v92, v153
    v_mfma_f32_32x32x16_bf16 v[48:63], a[48:51], v[112:115], v[48:63]
    ds_read_b128 v[104:107], v9 offset:9216
    v_mul_f32 v93, v93, v153
    v_mul_f32 v94, v94, v153
    v_mul_f32 v95, v95, v153
    v_cvt_pk_bf16_f32 v92, v92, v93
    v_cvt_pk_bf16_f32 v93, v94, v95
    ds_write_b64 v8, v[92:93] offset:12720
    v_mfma_f32_32x32x16_bf16 v[48:63], a[52:55], v[116:119], v[48:63]
    s_waitcnt lgkmcnt(5)
    ds_read_b128 v[108:111], v9 offset:9728
    v_mfma_f32_32x32x16_bf16 v[48:63], a[56:59], v[120:123], v[48:63]
    ds_read_b128 v[112:115], v9 offset:10240
    buffer_load_dwordx4 a[4:7], v3, s[4:7], s33 offen offset:0
    v_mfma_f32_32x32x16_bf16 v[48:63], a[60:63], v[124:127], v[48:63]
    s_waitcnt lgkmcnt(4)
    ds_read_b128 v[116:119], v9 offset:10752
    s_waitcnt lgkmcnt(3)
    s_barrier
    ds_read2_b64 v[160:163], v11 offset0:10 offset1:14
    ds_read2_b64 v[164:167], v10 offset0:0 offset1:4
    ds_read2_b64 v[168:171], v11 offset0:0 offset1:4
    ds_read2_b64 v[172:175], v11 offset0:15 offset1:19
    ds_read2_b64 v[80:83], v10 offset0:5 offset1:9
    v_mfma_f32_32x32x16_bf16 v[48:63], a[64:67], v[96:99], v[48:63]
    ds_read_b128 v[120:123], v9 offset:11264
    ds_read2_b64 v[84:87], v11 offset0:5 offset1:9
    s_add_u32 s89, s93, 0
    v_mfma_f32_32x32x16_bf16 v[48:63], a[68:71], v[100:103], v[48:63]
    s_waitcnt lgkmcnt(9)
    ds_read_b128 v[124:127], v9 offset:11776
    buffer_load_dwordx4 a[8:11], v3, s[4:7], s33 offen offset:1024
    v_mfma_f32_32x32x16_bf16 v[48:63], a[72:75], v[104:107], v[48:63]
    ds_read_b128 v[96:99], v9 offset:12288
    v_mfma_f32_32x32x16_bf16 v[48:63], a[76:79], v[108:111], v[48:63]
    s_waitcnt lgkmcnt(9)
    ds_read_b128 v[100:103], v9 offset:12800
    s_waitcnt vmcnt(5)
poll_46:
    v_cmp_le_u32 vcc, 2, v29
    s_nop 0
    s_andn2_b64 s[56:57], s[40:41], vcc
    s_cbranch_scc1 pollr_45
    s_add_u32 s91, s86, 1048576
    buffer_load_dwordx4 v[156:159], v1, s[4:7], s91 offen sc1
    v_mfma_f32_32x32x16_bf16 v[48:63], a[80:83], v[112:115], v[48:63]
    ds_read_b128 v[104:107], v9 offset:13312
    buffer_load_dwordx4 a[12:15], v3, s[4:7], s33 offen offset:2048
    v_mfma_f32_32x32x16_bf16 v[48:63], a[84:87], v[116:119], v[48:63]
    s_waitcnt lgkmcnt(3)
    ds_read_b128 v[108:111], v9 offset:13824
    v_cndmask_b32 v162, 0, v162, s[50:51]
    v_cndmask_b32 v163, 0, v163, s[50:51]
    v_cndmask_b32 v174, 0, v174, s[50:51]
    v_cndmask_b32 v175, 0, v175, s[50:51]
    v_mfma_f32_16x16x32_bf16 v[88:91], v[164:167], v[160:163], 0
    v_mfma_f32_16x16x32_bf16 v[92:95], v[168:171], v[160:163], 0
    v_mfma_f32_16x16x32_bf16 v[160:163], v[80:83], v[172:175], 0
    v_mfma_f32_16x16x32_bf16 v[164:167], v[84:87], v[172:175], 0
    ds_read_b64_tr_b16 v[80:81], v12 offset:0
    ds_read_b64_tr_b16 v[82:83], v12 offset:4224
    ds_read_b64_tr_b16 v[84:85], v12 offset:32
    ds_read_b64_tr_b16 v[86:87], v12 offset:4256
    s_nop 0
    v_cndmask_b32 v88, v88, v89, s[44:45]
    v_cndmask_b32 v90, v90, v91, s[44:45]
    v_cndmask_b32 v92, v92, v93, s[44:45]
    v_mfma_f32_32x32x16_bf16 v[48:63], a[88:91], v[120:123], v[48:63]
    ds_read_b128 v[112:115], v9 offset:14336
    v_cndmask_b32 v94, v94, v95, s[44:45]
    v_cndmask_b32 v168, v92, v88, s[46:47]
    v_cndmask_b32 v169, v94, v90, s[48:49]
    v_max_f32 v172, v168, v169
    v_cndmask_b32 v160, v160, v161, s[44:45]
    v_cndmask_b32 v162, v162, v163, s[44:45]
    v_cndmask_b32 v164, v164, v165, s[44:45]
    v_mfma_f32_32x32x16_bf16 v[48:63], a[92:95], v[124:127], v[48:63]
    s_waitcnt lgkmcnt(7)
    ds_read_b128 v[116:119], v9 offset:14848
    v_cndmask_b32 v166, v166, v167, s[44:45]
    v_cndmask_b32 v170, v164, v160, s[46:47]
    v_cndmask_b32 v171, v166, v162, s[48:49]
    v_max_f32 v173, v170, v171
    s_nop 1
    v_permlane16_swap_b32 v172, v173
    v_mfma_f32_32x32x16_bf16 v[48:63], a[96:99], v[96:99], v[48:63]
    ds_read_b128 v[120:123], v9 offset:15360
    buffer_load_dwordx4 a[16:19], v3, s[4:7], s33 offen offset:3072
    v_max_f32 v172, v172, v173
    v_mov_b32 v173, v172
    ds_read_b64_tr_b16 v[88:89], v12 offset:40
    ds_read_b64_tr_b16 v[90:91], v12 offset:4264
    v_permlane32_swap_b32 v172, v173
    v_mfma_f32_32x32x16_bf16 v[48:63], a[100:103], v[100:103], v[48:63]
    s_waitcnt lgkmcnt(9)
    ds_read_b128 v[124:127], v9 offset:15872
    v_max_f32 v172, v172, v173
    v_mov_b32 v173, v172
    ds_read_b64_tr_b16 v[92:93], v12 offset:72
    ds_read_b64_tr_b16 v[94:95], v12 offset:4296
    v_permlane16_swap_b32 v172, v173
    v_mul_f32 v172, s63, v172
    v_mul_f32 v173, s63, v173
    v_mfma_f32_32x32x16_bf16 v[48:63], a[104:107], v[104:107], v[48:63]
    s_add_u32 s33, s61, 24576
    ds_read_b128 v[96:99], v9 offset:16384
    v_fma_f32 v168, v168, s63, -v172
    v_fma_f32 v169, v169, s63, -v172
    v_fma_f32 v170, v170, s63, -v173
    v_fma_f32 v171, v171, s63, -v173
    v_exp_f32 v168, v168
    v_mfma_f32_32x32x16_bf16 v[48:63], a[108:111], v[108:111], v[48:63]
    s_waitcnt lgkmcnt(7)
    ds_read_b128 v[100:103], v9 offset:16896
    buffer_load_dwordx4 a[20:23], v1, s[4:7], s33 offen offset:0
    v_exp_f32 v169, v169
    v_exp_f32 v170, v170
    v_mfma_f32_32x32x16_bf16 v[48:63], a[112:115], v[112:115], v[48:63]
    ds_read_b128 v[104:107], v9 offset:17408
    v_exp_f32 v171, v171
    v_add_f32 v172, v168, v169
    v_add_f32 v173, v170, v171
    s_nop 1
    v_permlane16_swap_b32 v172, v173
    v_mfma_f32_32x32x16_bf16 v[48:63], a[116:119], v[116:119], v[48:63]
    s_waitcnt lgkmcnt(5)
    ds_read_b128 v[108:111], v9 offset:17920
    v_add_f32 v172, v172, v173
    v_mov_b32 v173, v172
    v_add_u32 v10, s1, v10
    v_add_u32 v11, s1, v11
    v_permlane32_swap_b32 v172, v173
    v_add_f32 v172, v172, v173
    v_mov_b32 v173, v172
    v_mfma_f32_32x32x16_bf16 v[48:63], a[120:123], v[120:123], v[48:63]
    ds_read_b128 v[112:115], v9 offset:18432
    buffer_load_dwordx4 a[24:27], v1, s[4:7], s33 offen offset:1024
    v_add_u32 v12, s1, v12
    v_permlane16_swap_b32 v172, v173
    v_rcp_f32 v172, v172
    v_mfma_f32_32x32x16_bf16 v[48:63], a[124:127], v[124:127], v[48:63]
    s_waitcnt lgkmcnt(3)
    ds_read_b128 v[116:119], v9 offset:18944
    v_rcp_f32 v173, v173
    v_mul_f32 v168, v168, v172
    v_mul_f32 v169, v169, v172
    v_mul_f32 v170, v170, v173
    v_mul_f32 v171, v171, v173
    v_cvt_pk_bf16_f32 v168, v168, v168
    v_mfma_f32_32x32x16_bf16 v[48:63], a[128:131], v[96:99], v[48:63]
    ds_read_b128 v[120:123], v9 offset:19456
    v_cvt_pk_bf16_f32 v169, v169, v169
    v_and_b32 v160, v13, v168
    v_and_b32 v161, v14, v169
    v_and_b32 v162, v15, v168
    v_and_b32 v163, v16, v169
    v_cvt_pk_bf16_f32 v170, v170, v170
    v_mfma_f32_32x32x16_bf16 v[48:63], a[132:135], v[100:103], v[48:63]
    s_waitcnt lgkmcnt(3)
    ds_read_b128 v[124:127], v9 offset:19968
    buffer_load_dwordx4 a[28:31], v1, s[4:7], s33 offen offset:2048
    v_cvt_pk_bf16_f32 v171, v171, v171
    v_and_b32 v164, v13, v170
    v_and_b32 v165, v14, v171
    v_and_b32 v166, v15, v170
    v_mfma_f32_32x32x16_bf16 v[48:63], a[136:139], v[104:107], v[48:63]
    v_and_b32 v167, v16, v171
    v_mfma_f32_16x16x32_bf16 v[168:171], v[80:83], v[160:163], 0
    v_mfma_f32_16x16x32_bf16 v[172:175], v[84:87], v[160:163], 0
    v_mfma_f32_16x16x32_bf16 v[80:83], v[88:91], v[164:167], 0
    v_mfma_f32_16x16x32_bf16 v[84:87], v[92:95], v[164:167], 0
    v_mfma_f32_32x32x16_bf16 v[48:63], a[140:143], v[108:111], v[48:63]
    s_waitcnt lgkmcnt(2)
    v_mfma_f32_32x32x16_bf16 v[48:63], a[144:147], v[112:115], v[48:63]
    v_mfma_f32_32x32x16_bf16 v[48:63], a[148:151], v[116:119], v[48:63]
    s_waitcnt lgkmcnt(0)
    buffer_load_dwordx4 a[32:35], v1, s[4:7], s33 offen offset:3072
    v_cvt_pk_bf16_f32 v88, v168, v169
    v_cvt_pk_bf16_f32 v89, v170, v171
    v_cvt_pk_bf16_f32 v90, v80, v81
    v_cvt_pk_bf16_f32 v91, v82, v83
    v_mfma_f32_32x32x16_bf16 v[48:63], a[152:155], v[120:123], v[48:63]
    buffer_store_dwordx4 v[88:91], v1, s[4:7], s89 offen
    v_cvt_pk_bf16_f32 v92, v172, v173
    v_cvt_pk_bf16_f32 v93, v174, v175
    v_cvt_pk_bf16_f32 v94, v84, v85
    v_cvt_pk_bf16_f32 v95, v86, v87
    v_mfma_f32_32x32x16_bf16 v[48:63], a[156:159], v[124:127], v[48:63]
    s_mov_b64 exec, s[42:43]
    buffer_store_dwordx4 v[92:95], v1, s[4:7], s89 offen offset:1024
    s_mov_b64 exec, -1
    ds_read_b64 v[152:153], v154 offset:768
    s_waitcnt lgkmcnt(0)
    s_nop 6
    v_pk_fma_f32 v[48:49], v[128:129], v[152:153], v[48:49] op_sel_hi:[1,0,1] neg_lo:[0,1,0] neg_hi:[0,1,0]
    v_pk_fma_f32 v[50:51], v[130:131], v[152:153], v[50:51] op_sel_hi:[1,0,1] neg_lo:[0,1,0] neg_hi:[0,1,0]
    buffer_load_dwordx4 a[36:39], v2, s[4:7], s33 offen offset:0
    v_pk_mul_f32 v[48:49], v[48:49], v[152:153] op_sel:[0,1] op_sel_hi:[1,1]
    v_pk_mul_f32 v[50:51], v[50:51], v[152:153] op_sel:[0,1] op_sel_hi:[1,1]
    v_cvt_pk_bf16_f32 v48, v48, v49
    v_cvt_pk_bf16_f32 v49, v50, v51
    ds_write_b64 v8, v[48:49] offset:4224
    v_pk_fma_f32 v[52:53], v[132:133], v[152:153], v[52:53] op_sel_hi:[1,0,1] neg_lo:[0,1,0] neg_hi:[0,1,0]
    v_pk_fma_f32 v[54:55], v[134:135], v[152:153], v[54:55] op_sel_hi:[1,0,1] neg_lo:[0,1,0] neg_hi:[0,1,0]
    v_pk_mul_f32 v[52:53], v[52:53], v[152:153] op_sel:[0,1] op_sel_hi:[1,1]
    v_pk_mul_f32 v[54:55], v[54:55], v[152:153] op_sel:[0,1] op_sel_hi:[1,1]
    v_cvt_pk_bf16_f32 v52, v52, v53
    v_cvt_pk_bf16_f32 v53, v54, v55
    ds_write_b64 v8, v[52:53] offset:4240
    v_pk_fma_f32 v[56:57], v[136:137], v[152:153], v[56:57] op_sel_hi:[1,0,1] neg_lo:[0,1,0] neg_hi:[0,1,0]
    v_pk_fma_f32 v[58:59], v[138:139], v[152:153], v[58:59] op_sel_hi:[1,0,1] neg_lo:[0,1,0] neg_hi:[0,1,0]
    v_pk_mul_f32 v[56:57], v[56:57], v[152:153] op_sel:[0,1] op_sel_hi:[1,1]
    v_pk_mul_f32 v[58:59], v[58:59], v[152:153] op_sel:[0,1] op_sel_hi:[1,1]
    v_cvt_pk_bf16_f32 v56, v56, v57
    v_cvt_pk_bf16_f32 v57, v58, v59
    buffer_load_dwordx4 a[40:43], v2, s[4:7], s33 offen offset:1024
    ds_write_b64 v8, v[56:57] offset:4256
    v_pk_fma_f32 v[60:61], v[140:141], v[152:153], v[60:61] op_sel_hi:[1,0,1] neg_lo:[0,1,0] neg_hi:[0,1,0]
    v_pk_fma_f32 v[62:63], v[142:143], v[152:153], v[62:63] op_sel_hi:[1,0,1] neg_lo:[0,1,0] neg_hi:[0,1,0]
    v_pk_mul_f32 v[60:61], v[60:61], v[152:153] op_sel:[0,1] op_sel_hi:[1,1]
    v_pk_mul_f32 v[62:63], v[62:63], v[152:153] op_sel:[0,1] op_sel_hi:[1,1]
    v_cvt_pk_bf16_f32 v60, v60, v61
    v_cvt_pk_bf16_f32 v61, v62, v63
    ds_write_b64 v8, v[60:61] offset:4272
    s_waitcnt vmcnt(10)
    ds_write2_b64 v4, v[156:157], v[158:159] offset1:1
    v_mov_b32 v30, 7
    s_mov_b64 exec, 1
    s_cmp_lg_u32 s28, 0
    s_waitcnt vmcnt(2)
    s_cbranch_scc1 pubs_49
    buffer_store_dword v30, off, s[4:7], s32
pubd_50:
    s_mov_b64 exec, -1
    s_waitcnt lgkmcnt(0)
    s_barrier
    ds_read2_b64 v[160:163], v11 offset0:10 offset1:14
    s_add_u32 s33, s62, 0
    buffer_load_dwordx4 a[44:47], v1, s[4:7], s33 offen offset:0
    ds_read2_b64 v[164:167], v10 offset0:0 offset1:4
    ds_read2_b64 v[168:171], v11 offset0:0 offset1:4
    ds_read2_b64 v[172:175], v11 offset0:15 offset1:19
    ds_read2_b64 v[80:83], v10 offset0:5 offset1:9
    ds_read2_b64 v[84:87], v11 offset0:5 offset1:9
    s_add_u32 s89, s93, 3145728
    s_waitcnt lgkmcnt(5)
    v_cndmask_b32 v162, 0, v162, s[50:51]
    v_cndmask_b32 v163, 0, v163, s[50:51]
    s_waitcnt lgkmcnt(2)
    v_cndmask_b32 v174, 0, v174, s[50:51]
    v_cndmask_b32 v175, 0, v175, s[50:51]
    s_waitcnt lgkmcnt(0)
    v_mfma_f32_16x16x32_bf16 v[88:91], v[164:167], v[160:163], 0
    v_mfma_f32_16x16x32_bf16 v[92:95], v[168:171], v[160:163], 0
    v_mfma_f32_16x16x32_bf16 v[160:163], v[80:83], v[172:175], 0
    v_mfma_f32_16x16x32_bf16 v[164:167], v[84:87], v[172:175], 0
    buffer_load_dwordx4 a[48:51], v1, s[4:7], s33 offen offset:1024
    ds_read_b64_tr_b16 v[80:81], v12 offset:0
    buffer_load_dword v29, v5, s[4:7], s31 offen sc1
    ds_read_b64_tr_b16 v[82:83], v12 offset:4224
    ds_read_b64_tr_b16 v[84:85], v12 offset:32
    ds_read_b64_tr_b16 v[86:87], v12 offset:4256
    v_mov_b32 v174, s66
    v_cndmask_b32 v88, v88, v89, s[44:45]
    v_cndmask_b32 v90, v90, v91, s[44:45]
    v_cndmask_b32 v92, v92, v93, s[44:45]
    v_cndmask_b32 v94, v94, v95, s[44:45]
    v_cndmask_b32 v168, v92, v88, s[46:47]
    v_cndmask_b32 v169, v94, v90, s[48:49]
    v_cndmask_b32 v168, v168, v174, s[52:53]
    v_cndmask_b32 v169, v169, v174, s[54:55]
    v_max_f32 v172, v168, v169
    v_cndmask_b32 v160, v160, v161, s[44:45]
    v_cndmask_b32 v162, v162, v163, s[44:45]
    v_cndmask_b32 v164, v164, v165, s[44:45]
    v_cndmask_b32 v166, v166, v167, s[44:45]
    v_cndmask_b32 v170, v164, v160, s[46:47]
    v_cndmask_b32 v171, v166, v162, s[48:49]
    v_cndmask_b32 v170, v170, v174, s[52:53]
    v_cndmask_b32 v171, v171, v174, s[54:55]
    v_max_f32 v173, v170, v171
    s_nop 1
    v_permlane16_swap_b32 v172, v173
    v_max_f32 v172, v172, v173
    v_mov_b32 v173, v172
    ds_read_b64_tr_b16 v[88:89], v12 offset:40
    ds_read_b64_tr_b16 v[90:91], v12 offset:4264
    v_permlane32_swap_b32 v172, v173
    v_max_f32 v172, v172, v173
    v_mov_b32 v173, v172
    ds_read_b64_tr_b16 v[92:93], v12 offset:72
    ds_read_b64_tr_b16 v[94:95], v12 offset:4296
    v_permlane16_swap_b32 v172, v173
    v_mul_f32 v172, s63, v172
    v_mul_f32 v173, s63, v173
    v_fma_f32 v168, v168, s63, -v172
    v_fma_f32 v169, v169, s63, -v172
    v_fma_f32 v170, v170, s63, -v173
    v_fma_f32 v171, v171, s63, -v173
    v_exp_f32 v168, v168
    v_exp_f32 v169, v169
    v_exp_f32 v170, v170
    v_exp_f32 v171, v171
    v_add_f32 v172, v168, v169
    v_add_f32 v173, v170, v171
    s_nop 1
    v_permlane16_swap_b32 v172, v173
    v_add_f32 v172, v172, v173
    v_mov_b32 v173, v172
    v_subrev_u32 v10, s1, v10
    v_subrev_u32 v11, s1, v11
    s_waitcnt vmcnt(0)
poll_52:
    v_cmp_le_u32 vcc, 7, v29
    s_nop 0
    s_andn2_b64 s[56:57], s[34:35], vcc
    s_cbranch_scc1 pollr_51
    s_cmp_lg_u32 s28, 0
    s_cbranch_scc1 acq_53
polld_54:
    s_add_u32 m0, s83, 4096
    s_nop 0
    buffer_load_dwordx4 v1, s[4:7], s75 offen offset:0 sc1 lds
    v_permlane32_swap_b32 v172, v173
    v_add_f32 v172, v172, v173
    s_add_u32 m0, s83, 4096
    s_nop 0
    buffer_load_dwordx4 v1, s[4:7], s75 offen offset:1024 sc1 lds
    v_mov_b32 v173, v172
    v_subrev_u32 v12, s1, v12
    s_nop 0
    v_permlane16_swap_b32 v172, v173
    v_rcp_f32 v172, v172
    v_rcp_f32 v173, v173
    v_mul_f32 v168, v168, v172
    s_add_u32 m0, s83, 4096
    s_nop 0
    buffer_load_dwordx4 v1, s[4:7], s75 offen offset:2048 sc1 lds
    v_mul_f32 v169, v169, v172
    v_mul_f32 v170, v170, v173
    v_mul_f32 v171, v171, v173
    v_cvt_pk_bf16_f32 v168, v168, v168
    v_cvt_pk_bf16_f32 v169, v169, v169
    v_and_b32 v160, v13, v168
    v_and_b32 v161, v14, v169
    s_add_u32 m0, s83, 4096
    s_nop 0
    buffer_load_dwordx4 v1, s[4:7], s75 offen offset:3072 sc1 lds
    v_and_b32 v162, v15, v168
    v_and_b32 v163, v16, v169
    v_cvt_pk_bf16_f32 v170, v170, v170
    v_cvt_pk_bf16_f32 v171, v171, v171
    v_and_b32 v164, v13, v170
    v_and_b32 v165, v14, v171
    s_add_u32 m0, s83, 8192
    s_nop 0
    buffer_load_dwordx4 v2, s[4:7], s75 offen offset:0 sc1 lds
    v_and_b32 v166, v15, v170
    v_and_b32 v167, v16, v171
    s_waitcnt lgkmcnt(0)
    v_mfma_f32_16x16x32_bf16 v[168:171], v[80:83], v[160:163], 0
    v_mfma_f32_16x16x32_bf16 v[172:175], v[84:87], v[160:163], 0
    v_mfma_f32_16x16x32_bf16 v[80:83], v[88:91], v[164:167], 0
    v_mfma_f32_16x16x32_bf16 v[84:87], v[92:95], v[164:167], 0
    s_nop 4
    v_cvt_pk_bf16_f32 v88, v168, v169
    s_add_u32 m0, s83, 9216
    s_nop 0
    buffer_load_dwordx4 v1, s[4:7], s76 offen offset:0 sc1 lds
    v_cvt_pk_bf16_f32 v89, v170, v171
    v_cvt_pk_bf16_f32 v90, v80, v81
    v_cvt_pk_bf16_f32 v91, v82, v83
    buffer_store_dwordx4 v[88:91], v1, s[4:7], s89 offen
    v_cvt_pk_bf16_f32 v92, v172, v173
    v_cvt_pk_bf16_f32 v93, v174, v175
    s_add_u32 m0, s83, 9216
    s_nop 0
    buffer_load_dwordx4 v1, s[4:7], s76 offen offset:1024 sc1 lds
    v_cvt_pk_bf16_f32 v94, v84, v85
    v_cvt_pk_bf16_f32 v95, v86, v87
    s_mov_b64 exec, s[42:43]
    buffer_store_dwordx4 v[92:95], v1, s[4:7], s89 offen offset:1024
    s_mov_b64 exec, -1
    s_add_u32 m0, s83, 9216
    s_nop 0
    buffer_load_dwordx4 v1, s[4:7], s76 offen offset:2048 sc1 lds
    s_add_u32 m0, s83, 9216
    s_nop 0
    buffer_load_dwordx4 v1, s[4:7], s76 offen offset:3072 sc1 lds
    s_add_u32 m0, s83, 13312
    s_nop 0
    buffer_load_dwordx4 v2, s[4:7], s76 offen offset:0 sc1 lds
    s_add_u32 m0, s83, 14336
    s_nop 0
    buffer_load_dwordx4 v1, s[4:7], s77 offen offset:0 sc1 lds
    s_add_u32 m0, s83, 14336
    s_nop 0
    buffer_load_dwordx4 v1, s[4:7], s77 offen offset:1024 sc1 lds
    s_add_u32 m0, s83, 14336
    s_nop 0
    buffer_load_dwordx4 v1, s[4:7], s77 offen offset:2048 sc1 lds
    v_mov_b32 v30, 8
    s_mov_b64 exec, 1
    s_cmp_lg_u32 s28, 0
    s_waitcnt vmcnt(6)
    s_cbranch_scc1 pubs_55
    buffer_store_dword v30, off, s[4:7], s32
pubd_56:
    s_mov_b64 exec, -1
    s_barrier
    ds_read_b128 v[128:131], v33 offset:0
    ds_read_b128 v[132:135], v33 offset:1024
    ds_read_b128 v[136:139], v33 offset:2048
    s_waitcnt lgkmcnt(2)
    v_mfma_f32_16x16x32_bf16 v[68:71], a[252:255], v[128:131], 0
    s_add_u32 m0, s83, 14336
    ds_read_b128 v[140:143], v33 offset:3072
    v_lshlrev_b32 v48, 16, v36
    v_mfma_f32_16x16x32_bf16 v[72:75], v[252:255], v[128:131], 0
    v_and_b32 v49, 0xffff0000, v36
    v_lshlrev_b32 v50, 16, v37
    v_mfma_f32_16x16x32_bf16 v[76:79], a[192:195], v[128:131], 0
    buffer_load_dwordx4 v1, s[4:7], s77 offen offset:3072 sc1 lds
    v_mfma_f32_16x16x32_bf16 v[80:83], a[196:199], v[128:131], 0
    s_add_u32 m0, s83, 18432
    v_and_b32 v51, 0xffff0000, v37
    v_lshlrev_b32 v52, 16, v38
    v_mfma_f32_16x16x32_bf16 v[84:87], a[200:203], v[128:131], 0
    s_waitcnt lgkmcnt(2)
    v_and_b32 v53, 0xffff0000, v38
    v_lshlrev_b32 v54, 16, v39
    v_mfma_f32_16x16x32_bf16 v[68:71], a[204:207], v[132:135], v[68:71]
    ds_read_b128 v[128:131], v33 offset:4096
    v_and_b32 v55, 0xffff0000, v39
    v_mfma_f32_16x16x32_bf16 v[72:75], a[208:211], v[132:135], v[72:75]
    buffer_load_dwordx4 v2, s[4:7], s77 offen offset:0 sc1 lds
    v_mfma_f32_16x16x32_bf16 v[76:79], a[212:215], v[132:135], v[76:79]
    s_add_u32 m0, s83, 19456
    v_lshlrev_b32 v56, 16, v40
    v_and_b32 v57, 0xffff0000, v40
    v_mfma_f32_16x16x32_bf16 v[80:83], a[216:219], v[132:135], v[80:83]
    v_lshlrev_b32 v58, 16, v41
    v_and_b32 v59, 0xffff0000, v41
    v_mfma_f32_16x16x32_bf16 v[84:87], a[220:223], v[132:135], v[84:87]
    s_waitcnt lgkmcnt(2)
    buffer_load_dwordx4 v1, s[4:7], s74 offen offset:0 sc1 lds
    v_mfma_f32_16x16x32_bf16 v[68:71], a[224:227], v[136:139], v[68:71]
    s_add_u32 m0, s83, 19456
    ds_read_b128 v[132:135], v33 offset:5120
    v_lshlrev_b32 v60, 16, v42
    v_mfma_f32_16x16x32_bf16 v[72:75], a[228:231], v[136:139], v[72:75]
    v_and_b32 v61, 0xffff0000, v42
    v_lshlrev_b32 v62, 16, v43
    v_mfma_f32_16x16x32_bf16 v[76:79], a[232:235], v[136:139], v[76:79]
    v_and_b32 v63, 0xffff0000, v43
    v_lshlrev_b32 v64, 16, v44
    v_mfma_f32_16x16x32_bf16 v[80:83], a[236:239], v[136:139], v[80:83]
    buffer_load_dwordx4 v1, s[4:7], s74 offen offset:1024 sc1 lds
    v_mfma_f32_16x16x32_bf16 v[84:87], a[240:243], v[136:139], v[84:87]
    s_waitcnt lgkmcnt(2)
    v_and_b32 v65, 0xffff0000, v44
    v_lshlrev_b32 v66, 16, v45
    v_mfma_f32_16x16x32_bf16 v[68:71], v[248:251], v[140:143], v[68:71]
    s_add_u32 m0, s83, 19456
    ds_read_b128 v[136:139], v33 offset:6144
    v_and_b32 v67, 0xffff0000, v45
    v_mfma_f32_16x16x32_bf16 v[72:75], v[244:247], v[140:143], v[72:75]
    buffer_load_dwordx4 v1, s[4:7], s74 offen offset:2048 sc1 lds
    v_mfma_f32_16x16x32_bf16 v[76:79], v[240:243], v[140:143], v[76:79]
    s_add_u32 m0, s83, 19456
    v_mfma_f32_16x16x32_bf16 v[80:83], v[236:239], v[140:143], v[80:83]
    v_mfma_f32_16x16x32_bf16 v[84:87], v[232:235], v[140:143], v[84:87]
    s_waitcnt lgkmcnt(2)
    v_mfma_f32_16x16x32_bf16 v[68:71], v[228:231], v[128:131], v[68:71]
    s_waitcnt vmcnt(11)
    ds_read_b128 v[140:143], v33 offset:7168
    v_mfma_f32_16x16x32_bf16 v[72:75], v[224:227], v[128:131], v[72:75]
    buffer_load_dwordx4 v1, s[4:7], s74 offen offset:3072 sc1 lds
    v_mfma_f32_16x16x32_bf16 v[76:79], v[220:223], v[128:131], v[76:79]
    s_add_u32 m0, s83, 23552
    v_mfma_f32_16x16x32_bf16 v[80:83], v[216:219], v[128:131], v[80:83]
    v_mfma_f32_16x16x32_bf16 v[84:87], v[212:215], v[128:131], v[84:87]
    s_waitcnt lgkmcnt(2)
    buffer_load_dwordx4 v2, s[4:7], s74 offen offset:0 sc1 lds
    v_mfma_f32_16x16x32_bf16 v[88:91], a[252:255], v[132:135], 0
    s_waitcnt vmcnt(12)
    ds_read_b128 v[128:131], v33 offset:8192
    v_mfma_f32_16x16x32_bf16 v[92:95], v[252:255], v[132:135], 0
    v_mfma_f32_16x16x32_bf16 v[96:99], a[192:195], v[132:135], 0
    buffer_load_dwordx4 v[164:167], v1, s[4:7], s33 offen offset:2048
    v_mfma_f32_16x16x32_bf16 v[100:103], a[196:199], v[132:135], 0
    ds_write_b128 v20, v[68:71] offset:0
    v_mfma_f32_16x16x32_bf16 v[104:107], a[200:203], v[132:135], 0
    s_waitcnt lgkmcnt(3)
    v_mfma_f32_16x16x32_bf16 v[88:91], a[204:207], v[136:139], v[88:91]
    s_waitcnt vmcnt(12)
    ds_read_b128 v[132:135], v33 offset:9216
    v_mfma_f32_16x16x32_bf16 v[92:95], a[208:211], v[136:139], v[92:95]
    buffer_load_dwordx4 v[168:171], v1, s[4:7], s33 offen offset:3072
    v_mfma_f32_16x16x32_bf16 v[96:99], a[212:215], v[136:139], v[96:99]
    ds_write_b128 v20, v[72:75] offset:1024
    v_mfma_f32_16x16x32_bf16 v[100:103], a[216:219], v[136:139], v[100:103]
    v_mfma_f32_16x16x32_bf16 v[104:107], a[220:223], v[136:139], v[104:107]
    s_waitcnt lgkmcnt(4)
    buffer_load_dwordx4 v[172:175], v2, s[4:7], s33 offen offset:0
    v_mfma_f32_16x16x32_bf16 v[88:91], a[224:227], v[140:143], v[88:91]
    s_waitcnt vmcnt(13)
    ds_read_b128 v[136:139], v33 offset:10240
    v_mfma_f32_16x16x32_bf16 v[92:95], a[228:231], v[140:143], v[92:95]
    ds_write_b128 v20, v[76:79] offset:2048
    v_mfma_f32_16x16x32_bf16 v[96:99], a[232:235], v[140:143], v[96:99]
    v_mfma_f32_16x16x32_bf16 v[100:103], a[236:239], v[140:143], v[100:103]
    buffer_load_dwordx4 a[52:55], v2, s[4:7], s33 offen offset:1024
    v_mfma_f32_16x16x32_bf16 v[104:107], a[240:243], v[140:143], v[104:107]
    s_waitcnt lgkmcnt(5)
    ds_write_b128 v20, v[80:83] offset:3072
    v_mfma_f32_16x16x32_bf16 v[88:91], v[248:251], v[128:131], v[88:91]
    s_waitcnt vmcnt(13)
    ds_read_b128 v[140:143], v33 offset:11264
    v_mfma_f32_16x16x32_bf16 v[92:95], v[244:247], v[128:131], v[92:95]
    buffer_load_dwordx4 a[56:59], v2, s[4:7], s33 offen offset:2048
    v_mfma_f32_16x16x32_bf16 v[96:99], v[240:243], v[128:131], v[96:99]
    ds_write_b128 v20, v[84:87] offset:4096
    v_mfma_f32_16x16x32_bf16 v[100:103], v[236:239], v[128:131], v[100:103]
    v_mfma_f32_16x16x32_bf16 v[104:107], v[232:235], v[128:131], v[104:107]
    s_waitcnt lgkmcnt(6)
    v_mfma_f32_16x16x32_bf16 v[88:91], v[228:231], v[132:135], v[88:91]
    s_waitcnt vmcnt(13)
    ds_read_b128 v[128:131], v33 offset:12288
    v_mfma_f32_16x16x32_bf16 v[92:95], v[224:227], v[132:135], v[92:95]
    buffer_load_dwordx4 a[60:63], v2, s[4:7], s33 offen offset:3072
    v_mfma_f32_16x16x32_bf16 v[96:99], v[220:223], v[132:135], v[96:99]
    v_mfma_f32_16x16x32_bf16 v[100:103], v[216:219], v[132:135], v[100:103]
    v_mfma_f32_16x16x32_bf16 v[104:107], v[212:215], v[132:135], v[104:107]
    s_waitcnt lgkmcnt(5)
    buffer_load_dwordx4 a[64:67], v3, s[4:7], s33 offen offset:0
    v_mfma_f32_16x16x32_bf16 v[108:111], a[252:255], v[136:139], 0
    s_waitcnt vmcnt(13)
    ds_read_b128 v[132:135], v33 offset:13312
    v_mfma_f32_16x16x32_bf16 v[112:115], v[252:255], v[136:139], 0
    v_mfma_f32_16x16x32_bf16 v[116:119], a[192:195], v[136:139], 0
    buffer_load_dwordx4 a[68:71], v3, s[4:7], s33 offen offset:1024
    v_mfma_f32_16x16x32_bf16 v[120:123], a[196:199], v[136:139], 0
    ds_write_b128 v21, v[88:91] offset:0
    v_mfma_f32_16x16x32_bf16 v[124:127], a[200:203], v[136:139], 0
    s_waitcnt lgkmcnt(4)
    v_mfma_f32_16x16x32_bf16 v[108:111], a[204:207], v[140:143], v[108:111]
    s_waitcnt vmcnt(13)
    ds_read_b128 v[136:139], v33 offset:14336
    v_mfma_f32_16x16x32_bf16 v[112:115], a[208:211], v[140:143], v[112:115]
    buffer_load_dwordx4 a[72:75], v3, s[4:7], s33 offen offset:2048
    v_mfma_f32_16x16x32_bf16 v[116:119], a[212:215], v[140:143], v[116:119]
    ds_write_b128 v21, v[92:95] offset:1024
    v_mfma_f32_16x16x32_bf16 v[120:123], a[216:219], v[140:143], v[120:123]
    v_mfma_f32_16x16x32_bf16 v[124:127], a[220:223], v[140:143], v[124:127]
    s_waitcnt lgkmcnt(4)
    buffer_load_dwordx4 a[76:79], v3, s[4:7], s33 offen offset:3072
    v_mfma_f32_16x16x32_bf16 v[108:111], a[224:227], v[128:131], v[108:111]
    s_add_u32 s33, s62, 12288
    s_waitcnt vmcnt(14)
    ds_read_b128 v[140:143], v33 offset:15360
    v_mfma_f32_16x16x32_bf16 v[112:115], a[228:231], v[128:131], v[112:115]
    ds_write_b128 v21, v[96:99] offset:2048
    v_mfma_f32_16x16x32_bf16 v[116:119], a[232:235], v[128:131], v[116:119]
    v_mfma_f32_16x16x32_bf16 v[120:123], a[236:239], v[128:131], v[120:123]
    buffer_load_dwordx4 a[80:83], v1, s[4:7], s33 offen offset:0
    v_mfma_f32_16x16x32_bf16 v[124:127], a[240:243], v[128:131], v[124:127]
    s_waitcnt lgkmcnt(5)
    ds_write_b128 v21, v[100:103] offset:3072
    v_mfma_f32_16x16x32_bf16 v[108:111], v[248:251], v[132:135], v[108:111]
    s_waitcnt vmcnt(14)
    ds_read_b128 v[128:131], v33 offset:16384
    v_mfma_f32_16x16x32_bf16 v[112:115], v[244:247], v[132:135], v[112:115]
    buffer_load_dwordx4 a[84:87], v1, s[4:7], s33 offen offset:1024
    v_mfma_f32_16x16x32_bf16 v[116:119], v[240:243], v[132:135], v[116:119]
    ds_write_b128 v21, v[104:107] offset:4096
    v_mfma_f32_16x16x32_bf16 v[120:123], v[236:239], v[132:135], v[120:123]
    v_mfma_f32_16x16x32_bf16 v[124:127], v[232:235], v[132:135], v[124:127]
    s_waitcnt lgkmcnt(6)
    v_mfma_f32_16x16x32_bf16 v[108:111], v[228:231], v[136:139], v[108:111]
    s_waitcnt vmcnt(14)
    ds_read_b128 v[132:135], v33 offset:17408
    v_mfma_f32_16x16x32_bf16 v[112:115], v[224:227], v[136:139], v[112:115]
    buffer_load_dwordx4 a[88:91], v1, s[4:7], s33 offen offset:2048
    v_mfma_f32_16x16x32_bf16 v[116:119], v[220:223], v[136:139], v[116:119]
    v_mfma_f32_16x16x32_bf16 v[120:123], v[216:219], v[136:139], v[120:123]
    v_mfma_f32_16x16x32_bf16 v[124:127], v[212:215], v[136:139], v[124:127]
    s_waitcnt lgkmcnt(5)
    buffer_load_dwordx4 a[92:95], v1, s[4:7], s33 offen offset:3072
    s_waitcnt lgkmcnt(1)
    s_barrier
    v_mfma_f32_16x16x32_bf16 v[48:51], a[252:255], v[140:143], v[48:51]
    s_waitcnt vmcnt(15)
    ds_read_b128 v[136:139], v33 offset:18432
    ds_read_b128 v[68:71], v23 offset:0
    v_mfma_f32_16x16x32_bf16 v[52:55], v[252:255], v[140:143], v[52:55]
    ds_read_b128 v[88:91], v23 offset:5120
    v_mfma_f32_16x16x32_bf16 v[56:59], a[192:195], v[140:143], v[56:59]
    buffer_load_dwordx4 a[96:99], v2, s[4:7], s33 offen offset:0
    v_mfma_f32_16x16x32_bf16 v[60:63], a[196:199], v[140:143], v[60:63]
    ds_write_b128 v22, v[108:111] offset:0
    v_mfma_f32_16x16x32_bf16 v[64:67], a[200:203], v[140:143], v[64:67]
    ds_read_b128 v[72:75], v23 offset:1024
    ds_read_b128 v[92:95], v23 offset:6144
    v_mfma_f32_16x16x32_bf16 v[48:51], a[204:207], v[128:131], v[48:51]
    s_waitcnt vmcnt(15)
    ds_read_b128 v[140:143], v33 offset:19456
    v_mfma_f32_16x16x32_bf16 v[52:55], a[208:211], v[128:131], v[52:55]
    buffer_load_dwordx4 a[100:103], v2, s[4:7], s33 offen offset:1024
    v_mfma_f32_16x16x32_bf16 v[56:59], a[212:215], v[128:131], v[56:59]
    ds_write_b128 v22, v[112:115] offset:1024
    v_mfma_f32_16x16x32_bf16 v[60:63], a[216:219], v[128:131], v[60:63]
    ds_read_b128 v[76:79], v23 offset:2048
    ds_read_b128 v[96:99], v23 offset:7168
    v_mfma_f32_16x16x32_bf16 v[64:67], a[220:223], v[128:131], v[64:67]
    s_waitcnt lgkmcnt(10)
    buffer_load_dwordx4 a[104:107], v2, s[4:7], s33 offen offset:2048
    v_mfma_f32_16x16x32_bf16 v[48:51], a[224:227], v[132:135], v[48:51]
    ds_write_b128 v22, v[116:119] offset:2048
    v_mfma_f32_16x16x32_bf16 v[52:55], a[228:231], v[132:135], v[52:55]
    ds_read_b128 v[80:83], v23 offset:3072
    ds_read_b128 v[100:103], v23 offset:8192
    v_mfma_f32_16x16x32_bf16 v[56:59], a[232:235], v[132:135], v[56:59]
    ds_write_b128 v22, v[120:123] offset:3072
    v_mfma_f32_16x16x32_bf16 v[60:63], a[236:239], v[132:135], v[60:63]
    buffer_load_dwordx4 a[108:111], v2, s[4:7], s33 offen offset:3072
    v_mfma_f32_16x16x32_bf16 v[64:67], a[240:243], v[132:135], v[64:67]
    s_waitcnt lgkmcnt(13)
    ds_read_b128 v[84:87], v23 offset:4096
    ds_read_b128 v[104:107], v23 offset:9216
    v_mfma_f32_16x16x32_bf16 v[48:51], v[248:251], v[136:139], v[48:51]
    ds_write_b128 v22, v[124:127] offset:4096
    v_mfma_f32_16x16x32_bf16 v[52:55], v[244:247], v[136:139], v[52:55]
    s_waitcnt lgkmcnt(14)
    buffer_load_dwordx4 a[112:115], v3, s[4:7], s33 offen offset:0
    v_mfma_f32_16x16x32_bf16 v[56:59], v[240:243], v[136:139], v[56:59]
    v_add_f32 v68, v68, v88
    v_add_f32 v69, v69, v89
    v_mfma_f32_16x16x32_bf16 v[60:63], v[236:239], v[136:139], v[60:63]
    v_add_f32 v70, v70, v90
    v_add_f32 v71, v71, v91
    v_mfma_f32_16x16x32_bf16 v[64:67], v[232:235], v[136:139], v[64:67]
    s_waitcnt lgkmcnt(10)
    v_add_f32 v72, v72, v92
    v_add_f32 v73, v73, v93
    v_mfma_f32_16x16x32_bf16 v[48:51], v[228:231], v[140:143], v[48:51]
    buffer_load_dwordx4 a[116:119], v3, s[4:7], s33 offen offset:1024
    v_mfma_f32_16x16x32_bf16 v[52:55], v[224:227], v[140:143], v[52:55]
    v_add_f32 v74, v74, v94
    v_add_f32 v75, v75, v95
    v_mfma_f32_16x16x32_bf16 v[56:59], v[220:223], v[140:143], v[56:59]
    s_waitcnt lgkmcnt(7)
    v_add_f32 v76, v76, v96
    v_add_f32 v77, v77, v97
    v_mfma_f32_16x16x32_bf16 v[60:63], v[216:219], v[140:143], v[60:63]
    v_add_f32 v78, v78, v98
    v_add_f32 v79, v79, v99
    v_mfma_f32_16x16x32_bf16 v[64:67], v[212:215], v[140:143], v[64:67]
    s_waitcnt lgkmcnt(4)
    buffer_load_dwordx4 a[120:123], v3, s[4:7], s33 offen offset:2048
    s_waitcnt lgkmcnt(0)
    s_barrier
    ds_read_b128 v[108:111], v23 offset:10240
    ds_read_b128 v[112:115], v23 offset:11264
    ds_read_b128 v[116:119], v23 offset:12288
    ds_read_b128 v[120:123], v23 offset:13312
    ds_read_b128 v[124:127], v23 offset:14336
    v_add_f32 v80, v80, v100
    v_add_f32 v81, v81, v101
    v_add_f32 v82, v82, v102
    v_add_f32 v83, v83, v103
    v_add_f32 v84, v84, v104
    v_add_f32 v85, v85, v105
    v_add_f32 v86, v86, v106
    v_add_f32 v87, v87, v107
    v_pk_add_f32 v[48:49], v[48:49], v[68:69]
    v_pk_add_f32 v[50:51], v[50:51], v[70:71]
    v_pk_add_f32 v[52:53], v[52:53], v[72:73]
    v_pk_add_f32 v[54:55], v[54:55], v[74:75]
    v_pk_add_f32 v[56:57], v[56:57], v[76:77]
    v_pk_add_f32 v[58:59], v[58:59], v[78:79]
    v_pk_add_f32 v[60:61], v[60:61], v[80:81]
    v_pk_add_f32 v[62:63], v[62:63], v[82:83]
    v_pk_add_f32 v[64:65], v[64:65], v[84:85]
    v_pk_add_f32 v[66:67], v[66:67], v[86:87]
    s_waitcnt lgkmcnt(4)
    v_pk_add_f32 v[48:49], v[48:49], v[108:109]
    v_pk_add_f32 v[50:51], v[50:51], v[110:111]
    v_cvt_pk_bf16_f32 v36, v48, v49
    v_cvt_pk_bf16_f32 v37, v50, v51
    s_waitcnt lgkmcnt(3)
    v_pk_add_f32 v[52:53], v[52:53], v[112:113]
    v_pk_add_f32 v[54:55], v[54:55], v[114:115]
    v_cvt_pk_bf16_f32 v38, v52, v53
    v_cvt_pk_bf16_f32 v39, v54, v55
    buffer_store_dwordx4 v[36:39], v1, s[4:7], s95 offen
    s_waitcnt lgkmcnt(2)
    v_pk_add_f32 v[56:57], v[56:57], v[116:117]
    v_pk_add_f32 v[58:59], v[58:59], v[118:119]
    v_cvt_pk_bf16_f32 v40, v56, v57
    v_cvt_pk_bf16_f32 v41, v58, v59
    s_waitcnt lgkmcnt(1)
    v_pk_add_f32 v[60:61], v[60:61], v[120:121]
    v_pk_add_f32 v[62:63], v[62:63], v[122:123]
    v_cvt_pk_bf16_f32 v42, v60, v61
    v_cvt_pk_bf16_f32 v43, v62, v63
    buffer_store_dwordx4 v[40:43], v1, s[4:7], s95 offen offset:1024
    s_waitcnt lgkmcnt(0)
    v_pk_add_f32 v[64:65], v[64:65], v[124:125]
    v_pk_add_f32 v[66:67], v[66:67], v[126:127]
    v_cvt_pk_bf16_f32 v44, v64, v65
    v_cvt_pk_bf16_f32 v45, v66, v67
    buffer_store_dwordx2 v[44:45], v25, s[4:7], s96 offen
    v_dot2_f32_bf16 v31, v36, s30, 0
    v_dot2_f32_bf16 v32, v36, v36, 0
    v_dot2_f32_bf16 v31, v37, s30, v31
    v_dot2_f32_bf16 v32, v37, v37, v32
    v_dot2_f32_bf16 v31, v38, s30, v31
    v_dot2_f32_bf16 v32, v38, v38, v32
    v_dot2_f32_bf16 v31, v39, s30, v31
    v_dot2_f32_bf16 v32, v39, v39, v32
    v_dot2_f32_bf16 v31, v40, s30, v31
    v_dot2_f32_bf16 v32, v40, v40, v32
    v_dot2_f32_bf16 v31, v41, s30, v31
    v_dot2_f32_bf16 v32, v41, v41, v32
    v_dot2_f32_bf16 v31, v42, s30, v31
    v_dot2_f32_bf16 v32, v42, v42, v32
    v_dot2_f32_bf16 v31, v43, s30, v31
    v_dot2_f32_bf16 v32, v43, v43, v32
    v_dot2_f32_bf16 v31, v44, s30, v31
    v_dot2_f32_bf16 v32, v44, v44, v32
    v_dot2_f32_bf16 v31, v45, s30, v31
    v_dot2_f32_bf16 v32, v45, v45, v32
    s_nop 2
    v_permlane16_swap_b32 v31, v32
    v_add_f32 v31, v31, v32
    v_mov_b32 v32, v31
    s_nop 1
    v_permlane32_swap_b32 v31, v32
    v_add_f32 v34, v31, v32
    s_mov_b64 exec, s[36:37]
    buffer_store_dword v34, v28, s[4:7], s97 offen
    s_mov_b64 exec, -1
    v_mov_b32 v30, 9
    s_mov_b64 exec, 1
    s_cmp_lg_u32 s28, 0
    s_waitcnt vmcnt(0)
    s_cbranch_scc1 pubs_57
    buffer_store_dword v30, off, s[4:7], s32
pubd_58:
    s_mov_b64 exec, -1
    buffer_load_dword v29, v5, s[4:7], s31 offen sc1
    s_waitcnt vmcnt(0)
poll_60:
    v_cmp_le_u32 vcc, 9, v29
    s_nop 0
    s_andn2_b64 s[56:57], s[36:37], vcc
    s_cbranch_scc1 pollr_59
    s_cmp_lg_u32 s28, 0
    s_cbranch_scc1 acq_61
polld_62:
    s_add_u32 m0, s72, 4096
    s_nop 0
    buffer_load_dwordx4 v1, s[12:15], m0 offen offset:0 sc1 lds
    s_add_u32 m0, s72, 8192
    s_nop 0
    buffer_load_dwordx4 v1, s[12:15], m0 offen offset:0 sc1 lds
    s_add_u32 m0, s72, 12288
    s_nop 0
    buffer_load_dwordx4 v1, s[12:15], m0 offen offset:0 sc1 lds
    s_add_u32 m0, s72, 16384
    s_nop 0
    buffer_load_dwordx4 v1, s[12:15], m0 offen offset:0 sc1 lds
    s_add_u32 m0, s72, 20480
    s_nop 0
    buffer_load_dwordx4 v1, s[12:15], m0 offen offset:0 sc1 lds
    s_add_u32 s88, s98, 0
    buffer_load_dwordx4 v[144:147], v1, s[4:7], s88 offen sc1
    s_add_u32 m0, s73, 4096
    s_nop 0
    buffer_load_dwordx4 v1, s[12:15], m0 offen offset:0 sc1 lds
    s_add_u32 m0, s73, 8192
    s_nop 0
    buffer_load_dwordx4 v1, s[12:15], m0 offen offset:0 sc1 lds
    s_add_u32 m0, s73, 12288
    s_nop 0
    buffer_load_dwordx4 v1, s[12:15], m0 offen offset:0 sc1 lds
    s_add_u32 m0, s73, 16384
    s_nop 0
    buffer_load_dwordx4 v1, s[12:15], m0 offen offset:0 sc1 lds
    s_waitcnt vmcnt(5)
    s_barrier
    ds_read_b128 v[96:99], v7 offset:0
    ds_read_b128 v[100:103], v7 offset:2048
    ds_read_b128 v[104:107], v7 offset:4096
    ds_read_b128 v[108:111], v7 offset:6144
    ds_read_b128 v[112:115], v7 offset:8192
    s_waitcnt lgkmcnt(3)
    v_mfma_f32_16x16x32_bf16 v[72:75], v[208:211], v[96:99], 0
    s_add_u32 m0, s73, 20480
    ds_read_b128 v[116:119], v7 offset:10240
    v_mfma_f32_16x16x32_bf16 v[76:79], v[204:207], v[96:99], 0
    buffer_load_dwordx4 v1, s[12:15], m0 offen offset:0 sc1 lds
    v_mfma_f32_16x16x32_bf16 v[80:83], v[200:203], v[96:99], 0
    s_add_u32 m0, s70, 4096
    s_nop 0
    buffer_load_dwordx4 v1, s[12:15], m0 offen offset:0 sc1 lds
    v_mfma_f32_16x16x32_bf16 v[72:75], v[196:199], v[100:103], v[72:75]
    s_add_u32 m0, s70, 8192
    ds_read_b128 v[120:123], v7 offset:12288
    s_lshr_b32 s92, s24, 1
    v_mfma_f32_16x16x32_bf16 v[76:79], v[192:195], v[100:103], v[76:79]
    s_mul_i32 s92, s92, 192
    buffer_load_dwordx4 v1, s[12:15], m0 offen offset:0 sc1 lds
    v_mfma_f32_16x16x32_bf16 v[80:83], v[188:191], v[100:103], v[80:83]
    s_waitcnt lgkmcnt(3)
    v_add_u32 v156, s92, v24
    ds_read_b128 v[128:131], v156 offset:480
    v_mfma_f32_16x16x32_bf16 v[72:75], v[184:187], v[104:107], v[72:75]
    s_add_u32 m0, s70, 12288
    ds_read_b128 v[124:127], v7 offset:14336
    ds_read_b128 v[132:135], v156 offset:864
    v_mfma_f32_16x16x32_bf16 v[76:79], v[180:183], v[104:107], v[76:79]
    buffer_load_dwordx4 v1, s[12:15], m0 offen offset:0 sc1 lds
    v_mfma_f32_16x16x32_bf16 v[80:83], v[176:179], v[104:107], v[80:83]
    s_add_u32 m0, s70, 16384
    s_nop 0
    buffer_load_dwordx4 v1, s[12:15], m0 offen offset:0 sc1 lds
    v_mfma_f32_16x16x32_bf16 v[72:75], a[160:163], v[108:111], v[72:75]
    s_add_u32 m0, s70, 20480
    ds_read_b128 v[96:99], v7 offset:16384
    ds_read_b128 v[136:139], v156 offset:544
    v_mfma_f32_16x16x32_bf16 v[76:79], a[164:167], v[108:111], v[76:79]
    buffer_load_dwordx4 v1, s[12:15], m0 offen offset:0 sc1 lds
    v_mfma_f32_16x16x32_bf16 v[80:83], a[168:171], v[108:111], v[80:83]
    s_waitcnt lgkmcnt(6)
    ds_read_b128 v[140:143], v156 offset:928
    ds_read_b128 v[148:151], v156 offset:608
    v_mfma_f32_16x16x32_bf16 v[72:75], a[172:175], v[112:115], v[72:75]
    s_add_u32 m0, s71, 4096
    ds_read_b128 v[100:103], v7 offset:18432
    ds_read_b128 v[152:155], v156 offset:992
    v_mfma_f32_16x16x32_bf16 v[76:79], a[176:179], v[112:115], v[76:79]
    buffer_load_dwordx4 v1, s[12:15], m0 offen offset:0 sc1 lds
    v_mfma_f32_16x16x32_bf16 v[80:83], a[180:183], v[112:115], v[80:83]
    s_add_u32 m0, s71, 8192
    s_nop 0
    buffer_load_dwordx4 v1, s[12:15], m0 offen offset:0 sc1 lds
    v_mfma_f32_16x16x32_bf16 v[72:75], a[184:187], v[116:119], v[72:75]
    s_add_u32 m0, s71, 12288
    s_waitcnt vmcnt(7)
    s_barrier
    ds_read_b128 v[104:107], v7 offset:20480
    v_mfma_f32_16x16x32_bf16 v[76:79], a[188:191], v[116:119], v[76:79]
    buffer_load_dwordx4 v1, s[12:15], m0 offen offset:0 sc1 lds
    v_mfma_f32_16x16x32_bf16 v[80:83], a[244:247], v[116:119], v[80:83]
    s_waitcnt lgkmcnt(8)
    v_mfma_f32_16x16x32_bf16 v[72:75], a[248:251], v[120:123], v[72:75]
    s_add_u32 m0, s71, 16384
    ds_read_b128 v[108:111], v7 offset:22528
    v_mfma_f32_16x16x32_bf16 v[76:79], a[0:3], v[120:123], v[76:79]
    buffer_load_dwordx4 v1, s[12:15], m0 offen offset:0 sc1 lds
    v_mfma_f32_16x16x32_bf16 v[80:83], a[4:7], v[120:123], v[80:83]
    s_add_u32 m0, s71, 20480
    s_nop 0
    buffer_load_dwordx4 v1, s[12:15], m0 offen offset:0 sc1 lds
    v_mfma_f32_16x16x32_bf16 v[72:75], a[8:11], v[124:127], v[72:75]
    ds_read_b128 v[112:115], v7 offset:24576
    v_mfma_f32_16x16x32_bf16 v[76:79], a[12:15], v[124:127], v[76:79]
    v_mfma_f32_16x16x32_bf16 v[80:83], a[16:19], v[124:127], v[80:83]
    s_waitcnt lgkmcnt(4)
    buffer_load_dwordx4 a[124:127], v3, s[4:7], s33 offen offset:3072
    v_mfma_f32_16x16x32_bf16 v[72:75], a[20:23], v[96:99], v[72:75]
    s_add_u32 s33, s62, 24576
    ds_read_b128 v[116:119], v7 offset:26624
    v_mfma_f32_16x16x32_bf16 v[76:79], a[24:27], v[96:99], v[76:79]
    buffer_load_dword v29, v5, s[4:7], s31 offen sc1
    v_mfma_f32_16x16x32_bf16 v[80:83], a[28:31], v[96:99], v[80:83]
    v_add_f32 v144, v144, v146
    v_add_f32 v145, v145, v147
    v_mfma_f32_16x16x32_bf16 v[72:75], a[32:35], v[100:103], v[72:75]
    ds_read_b128 v[120:123], v7 offset:28672
    v_permlane16_swap_b32 v144, v145
    v_mfma_f32_16x16x32_bf16 v[76:79], a[36:39], v[100:103], v[76:79]
    buffer_load_dwordx4 a[128:131], v1, s[4:7], s33 offen offset:0
    v_mfma_f32_16x16x32_bf16 v[80:83], a[40:43], v[100:103], v[80:83]
    s_waitcnt lgkmcnt(3)
    v_add_f32 v144, v144, v145
    v_mov_b32 v145, v144
    v_mfma_f32_16x16x32_bf16 v[84:87], v[208:211], v[104:107], 0
    ds_read_b128 v[124:127], v7 offset:30720
    v_permlane32_swap_b32 v144, v145
    v_mfma_f32_16x16x32_bf16 v[88:91], v[204:207], v[104:107], 0
    buffer_load_dwordx4 a[132:135], v1, s[4:7], s33 offen offset:1024
    v_mfma_f32_16x16x32_bf16 v[92:95], v[200:203], v[104:107], 0
    v_add_f32 v144, v144, v145
    v_mov_b32 v145, v144
    v_mfma_f32_16x16x32_bf16 v[84:87], v[196:199], v[108:111], v[84:87]
    ds_read_b128 v[96:99], v7 offset:32768
    v_permlane16_swap_b32 v144, v145
    v_mfma_f32_16x16x32_bf16 v[88:91], v[192:195], v[108:111], v[88:91]
    buffer_load_dwordx4 a[136:139], v1, s[4:7], s33 offen offset:2048
    v_mfma_f32_16x16x32_bf16 v[92:95], v[188:191], v[108:111], v[92:95]
    s_waitcnt lgkmcnt(3)
    v_mul_f32 v146, s64, v144
    v_mul_f32 v145, s64, v145
    v_mfma_f32_16x16x32_bf16 v[84:87], v[184:187], v[112:115], v[84:87]
    ds_read_b128 v[100:103], v7 offset:34816
    v_fma_f32 v145, -v146, v146, v145
    v_mfma_f32_16x16x32_bf16 v[88:91], v[180:183], v[112:115], v[88:91]
    v_max_f32 v145, 0, v145
    v_add_f32 v145, s65, v145
    v_mfma_f32_16x16x32_bf16 v[92:95], v[176:179], v[112:115], v[92:95]
    buffer_load_dwordx4 a[140:143], v1, s[4:7], s33 offen offset:3072
    v_mfma_f32_16x16x32_bf16 v[84:87], a[160:163], v[116:119], v[84:87]
    ds_read_b128 v[104:107], v7 offset:36864
    v_mfma_f32_16x16x32_bf16 v[88:91], a[164:167], v[116:119], v[88:91]
    v_rsq_f32 v147, v145
    v_mfma_f32_16x16x32_bf16 v[92:95], a[168:171], v[116:119], v[92:95]
    s_waitcnt lgkmcnt(3)
    buffer_load_dwordx4 a[144:147], v2, s[4:7], s33 offen offset:0
    v_mfma_f32_16x16x32_bf16 v[84:87], a[172:175], v[120:123], v[84:87]
    ds_read_b128 v[108:111], v7 offset:38912
    v_add_u32 v144, s0, v17
    v_mfma_f32_16x16x32_bf16 v[88:91], a[176:179], v[120:123], v[88:91]
    ds_write_b64 v144, v[146:147] offset:0
    v_mfma_f32_16x16x32_bf16 v[92:95], a[180:183], v[120:123], v[92:95]
    v_mfma_f32_16x16x32_bf16 v[84:87], a[184:187], v[124:127], v[84:87]
    s_waitcnt vmcnt(12)
    s_barrier
    ds_read_b128 v[112:115], v6 offset:0
    v_mfma_f32_16x16x32_bf16 v[88:91], a[188:191], v[124:127], v[88:91]
    buffer_load_dwordx4 a[148:151], v2, s[4:7], s33 offen offset:1024
    v_mfma_f32_16x16x32_bf16 v[92:95], a[244:247], v[124:127], v[92:95]
    s_waitcnt lgkmcnt(4)
    v_mfma_f32_16x16x32_bf16 v[84:87], a[248:251], v[96:99], v[84:87]
    ds_read_b128 v[116:119], v6 offset:2048
    v_mfma_f32_16x16x32_bf16 v[88:91], a[0:3], v[96:99], v[88:91]
    buffer_load_dwordx4 a[152:155], v2, s[4:7], s33 offen offset:2048
    v_mfma_f32_16x16x32_bf16 v[92:95], a[4:7], v[96:99], v[92:95]
    v_mfma_f32_16x16x32_bf16 v[84:87], a[8:11], v[100:103], v[84:87]
    ds_read_b128 v[120:123], v6 offset:4096
    v_mfma_f32_16x16x32_bf16 v[88:91], a[12:15], v[100:103], v[88:91]
    buffer_load_dwordx4 a[156:159], v2, s[4:7], s33 offen offset:3072
    v_mfma_f32_16x16x32_bf16 v[92:95], a[16:19], v[100:103], v[92:95]
    s_waitcnt lgkmcnt(4)
    v_mfma_f32_16x16x32_bf16 v[84:87], a[20:23], v[104:107], v[84:87]
    ds_read_b128 v[124:127], v6 offset:6144
    v_mfma_f32_16x16x32_bf16 v[88:91], a[24:27], v[104:107], v[88:91]
    ds_write_b128 v18, v[72:75] offset:0
    v_mfma_f32_16x16x32_bf16 v[92:95], a[28:31], v[104:107], v[92:95]
    buffer_load_dwordx4 a[252:255], v3, s[4:7], s33 offen offset:0
    v_mfma_f32_16x16x32_bf16 v[84:87], a[32:35], v[108:111], v[84:87]
    ds_read_b128 v[96:99], v6 offset:8192
    v_mfma_f32_16x16x32_bf16 v[88:91], a[36:39], v[108:111], v[88:91]
    ds_write_b128 v18, v[76:79] offset:1024
    v_mfma_f32_16x16x32_bf16 v[92:95], a[40:43], v[108:111], v[92:95]
    s_waitcnt lgkmcnt(5)
    buffer_load_dwordx4 v[252:255], v3, s[4:7], s33 offen offset:1024
    ds_write_b128 v18, v[80:83] offset:2048
    v_mfma_f32_16x16x32_bf16 v[48:51], v[208:211], v[112:115], 0
    s_waitcnt vmcnt(10)
poll_64:
    v_cmp_le_u32 vcc, 9, v29
    s_nop 0
    s_andn2_b64 s[56:57], s[38:39], vcc
    s_cbranch_scc1 pollr_63
    s_cmp_lg_u32 s28, 0
    s_cbranch_scc1 acq_65
polld_66:
    ds_read_b128 v[100:103], v6 offset:10240
    v_mfma_f32_16x16x32_bf16 v[52:55], v[204:207], v[112:115], 0
    s_add_u32 m0, s72, 4096
    v_mfma_f32_16x16x32_bf16 v[56:59], v[200:203], v[112:115], 0
    v_mfma_f32_16x16x32_bf16 v[48:51], v[196:199], v[116:119], v[48:51]
    ds_read_b128 v[104:107], v6 offset:12288
    v_mfma_f32_16x16x32_bf16 v[52:55], v[192:195], v[116:119], v[52:55]
    buffer_load_dwordx4 v1, s[16:19], m0 offen offset:0 sc1 lds
    v_mfma_f32_16x16x32_bf16 v[56:59], v[188:191], v[116:119], v[56:59]
    s_waitcnt lgkmcnt(6)
    ds_write_b128 v18, v[84:87] offset:3072
    v_mfma_f32_16x16x32_bf16 v[48:51], v[184:187], v[120:123], v[48:51]
    s_add_u32 m0, s72, 8192
    ds_read_b128 v[108:111], v6 offset:14336
    v_mfma_f32_16x16x32_bf16 v[52:55], v[180:183], v[120:123], v[52:55]
    buffer_load_dwordx4 v1, s[16:19], m0 offen offset:0 sc1 lds
    v_mfma_f32_16x16x32_bf16 v[56:59], v[176:179], v[120:123], v[56:59]
    s_add_u32 m0, s72, 12288
    ds_write_b128 v18, v[88:91] offset:4096
    v_mfma_f32_16x16x32_bf16 v[48:51], a[160:163], v[124:127], v[48:51]
    ds_read_b128 v[112:115], v6 offset:16384
    v_mfma_f32_16x16x32_bf16 v[52:55], a[164:167], v[124:127], v[52:55]
    buffer_load_dwordx4 v1, s[16:19], m0 offen offset:0 sc1 lds
    v_mfma_f32_16x16x32_bf16 v[56:59], a[168:171], v[124:127], v[56:59]
    s_waitcnt lgkmcnt(5)
    ds_write_b128 v18, v[92:95] offset:5120
    v_mfma_f32_16x16x32_bf16 v[48:51], a[172:175], v[96:99], v[48:51]
    s_add_u32 m0, s72, 16384
    ds_read_b128 v[116:119], v6 offset:18432
    v_mfma_f32_16x16x32_bf16 v[52:55], a[176:179], v[96:99], v[52:55]
    v_mfma_f32_16x16x32_bf16 v[56:59], a[180:183], v[96:99], v[56:59]
    buffer_load_dwordx4 v1, s[16:19], m0 offen offset:0 sc1 lds
    v_mfma_f32_16x16x32_bf16 v[48:51], a[184:187], v[100:103], v[48:51]
    s_add_u32 m0, s72, 20480
    s_waitcnt lgkmcnt(1)
    s_barrier
    ds_read_b128 v[120:123], v6 offset:20480
    v_mfma_f32_16x16x32_bf16 v[52:55], a[188:191], v[100:103], v[52:55]
    v_add_u32 v46, s69, v17
    ds_read_b64 v[46:47], v46 offset:0
    ds_read_b128 v[72:75], v19 offset:0
    v_mfma_f32_16x16x32_bf16 v[56:59], a[244:247], v[100:103], v[56:59]
    buffer_load_dwordx4 v1, s[16:19], m0 offen offset:0 sc1 lds
    ds_read_b128 v[76:79], v19 offset:1024
    v_mfma_f32_16x16x32_bf16 v[48:51], a[248:251], v[104:107], v[48:51]
    s_add_u32 s88, s98, 65536
    ds_read_b128 v[124:127], v6 offset:22528
    ds_read_b128 v[80:83], v19 offset:2048
    v_add_u32 v162, s69, v17
    v_mfma_f32_16x16x32_bf16 v[52:55], a[0:3], v[104:107], v[52:55]
    ds_read_b64 v[162:163], v162 offset:128
    ds_read_b128 v[84:87], v19 offset:3072
    ds_read_b128 v[88:91], v19 offset:4096
    v_mfma_f32_16x16x32_bf16 v[56:59], a[4:7], v[104:107], v[56:59]
    ds_read_b128 v[92:95], v19 offset:5120
    v_mfma_f32_16x16x32_bf16 v[48:51], a[8:11], v[108:111], v[48:51]
    ds_read_b128 v[96:99], v6 offset:24576
    buffer_load_dwordx4 v[144:147], v1, s[4:7], s88 offen sc1
    v_mfma_f32_16x16x32_bf16 v[52:55], a[12:15], v[108:111], v[52:55]
    s_add_u32 m0, s73, 4096
    v_mfma_f32_16x16x32_bf16 v[56:59], a[16:19], v[108:111], v[56:59]
    s_waitcnt lgkmcnt(11)
    v_mfma_f32_16x16x32_bf16 v[48:51], a[20:23], v[112:115], v[48:51]
    ds_read_b128 v[100:103], v6 offset:26624
    buffer_load_dwordx4 v1, s[16:19], m0 offen offset:0 sc1 lds
    v_mfma_f32_16x16x32_bf16 v[52:55], a[24:27], v[112:115], v[52:55]
    s_add_u32 m0, s73, 8192
    s_waitcnt lgkmcnt(6)
    v_fma_f32 v72, -v128, v46, v72
    v_fma_f32 v73, -v129, v46, v73
    v_mfma_f32_16x16x32_bf16 v[56:59], a[28:31], v[112:115], v[56:59]
    v_fma_f32 v74, -v130, v46, v74
    v_fma_f32 v75, -v131, v46, v75
    v_fma_f32 v72, v72, v47, v132
    v_mfma_f32_16x16x32_bf16 v[48:51], a[32:35], v[116:119], v[48:51]
    ds_read_b128 v[104:107], v6 offset:28672
    v_fma_f32 v73, v73, v47, v133
    v_mfma_f32_16x16x32_bf16 v[52:55], a[36:39], v[116:119], v[52:55]
    buffer_load_dwordx4 v1, s[16:19], m0 offen offset:0 sc1 lds
    v_mfma_f32_16x16x32_bf16 v[56:59], a[40:43], v[116:119], v[56:59]
    s_add_u32 m0, s73, 12288
    v_fma_f32 v74, v74, v47, v134
    v_fma_f32 v75, v75, v47, v135
    v_mfma_f32_16x16x32_bf16 v[60:63], v[208:211], v[120:123], 0
    ds_read_b128 v[108:111], v6 offset:30720
    v_fma_f32 v76, -v136, v46, v76
    v_mfma_f32_16x16x32_bf16 v[64:67], v[204:207], v[120:123], 0
    v_fma_f32 v77, -v137, v46, v77
    v_fma_f32 v78, -v138, v46, v78
    v_mfma_f32_16x16x32_bf16 v[68:71], v[200:203], v[120:123], 0
    buffer_load_dwordx4 v1, s[16:19], m0 offen offset:0 sc1 lds
    v_mfma_f32_16x16x32_bf16 v[60:63], v[196:199], v[124:127], v[60:63]
    s_add_u32 m0, s73, 16384
    ds_read_b128 v[112:115], v6 offset:32768
    v_fma_f32 v79, -v139, v46, v79
    v_fma_f32 v76, v76, v47, v140
    v_mfma_f32_16x16x32_bf16 v[64:67], v[192:195], v[124:127], v[64:67]
    v_fma_f32 v77, v77, v47, v141
    v_fma_f32 v78, v78, v47, v142
    v_fma_f32 v79, v79, v47, v143
    v_mfma_f32_16x16x32_bf16 v[68:71], v[188:191], v[124:127], v[68:71]
    s_waitcnt lgkmcnt(3)
    buffer_load_dwordx4 v1, s[16:19], m0 offen offset:0 sc1 lds
    v_fma_f32 v80, -v148, v46, v80
    v_mfma_f32_16x16x32_bf16 v[60:63], v[184:187], v[96:99], v[60:63]
    s_add_u32 m0, s73, 20480
    ds_read_b128 v[116:119], v6 offset:34816
    v_fma_f32 v81, -v149, v46, v81
    v_fma_f32 v82, -v150, v46, v82
    v_mfma_f32_16x16x32_bf16 v[64:67], v[180:183], v[96:99], v[64:67]
    v_fma_f32 v83, -v151, v46, v83
    v_fma_f32 v80, v80, v47, v152
    v_fma_f32 v81, v81, v47, v153
    v_mfma_f32_16x16x32_bf16 v[68:71], v[176:179], v[96:99], v[68:71]
    v_fma_f32 v82, v82, v47, v154
    v_fma_f32 v83, v83, v47, v155
    v_fma_f32 v84, -v128, v162, v84
    v_mfma_f32_16x16x32_bf16 v[60:63], a[160:163], v[100:103], v[60:63]
    ds_read_b128 v[120:123], v6 offset:36864
    buffer_load_dwordx4 v1, s[16:19], m0 offen offset:0 sc1 lds
    v_mfma_f32_16x16x32_bf16 v[64:67], a[164:167], v[100:103], v[64:67]
    v_fma_f32 v85, -v129, v162, v85
    v_fma_f32 v86, -v130, v162, v86
    v_fma_f32 v87, -v131, v162, v87
    v_mfma_f32_16x16x32_bf16 v[68:71], a[168:171], v[100:103], v[68:71]
    s_waitcnt lgkmcnt(3)
    v_fma_f32 v84, v84, v163, v132
    v_fma_f32 v85, v85, v163, v133
    v_fma_f32 v86, v86, v163, v134
    v_mfma_f32_16x16x32_bf16 v[60:63], a[172:175], v[104:107], v[60:63]
    ds_read_b128 v[124:127], v6 offset:38912
    buffer_load_dwordx4 a[192:195], v3, s[4:7], s33 offen offset:2048
    v_mfma_f32_16x16x32_bf16 v[64:67], a[176:179], v[104:107], v[64:67]
    v_fma_f32 v87, v87, v163, v135
    v_fma_f32 v88, -v136, v162, v88
    v_fma_f32 v89, -v137, v162, v89
    v_mfma_f32_16x16x32_bf16 v[68:71], a[180:183], v[104:107], v[68:71]
    v_fma_f32 v90, -v138, v162, v90
    v_fma_f32 v91, -v139, v162, v91
    v_fma_f32 v88, v88, v163, v140
    v_mfma_f32_16x16x32_bf16 v[60:63], a[184:187], v[108:111], v[60:63]
    s_waitcnt vmcnt(7)
    s_barrier
    ds_read_b128 v[96:99], v7 offset:0
    v_fma_f32 v89, v89, v163, v141
    v_mfma_f32_16x16x32_bf16 v[64:67], a[188:191], v[108:111], v[64:67]
    s_add_u32 m0, s70, 4096
    s_nop 0
    buffer_load_dwordx4 v1, s[16:19], m0 offen offset:0 sc1 lds
    v_mfma_f32_16x16x32_bf16 v[68:71], a[244:247], v[108:111], v[68:71]
    s_waitcnt lgkmcnt(3)
    v_fma_f32 v90, v90, v163, v142
    v_fma_f32 v91, v91, v163, v143
    v_fma_f32 v92, -v148, v162, v92
    v_mfma_f32_16x16x32_bf16 v[60:63], a[248:251], v[112:115], v[60:63]
    s_add_u32 m0, s70, 8192
    ds_read_b128 v[100:103], v7 offset:2048
    v_fma_f32 v93, -v149, v162, v93
    v_fma_f32 v94, -v150, v162, v94
    v_mfma_f32_16x16x32_bf16 v[64:67], a[0:3], v[112:115], v[64:67]
    buffer_load_dwordx4 v1, s[16:19], m0 offen offset:0 sc1 lds
    v_fma_f32 v95, -v151, v162, v95
    v_mfma_f32_16x16x32_bf16 v[68:71], a[4:7], v[112:115], v[68:71]
    s_add_u32 m0, s70, 12288
    v_fma_f32 v92, v92, v163, v152
    v_fma_f32 v93, v93, v163, v153
    v_mfma_f32_16x16x32_bf16 v[60:63], a[8:11], v[116:119], v[60:63]
    ds_read_b128 v[104:107], v7 offset:4096
    v_fma_f32 v94, v94, v163, v154
    v_mfma_f32_16x16x32_bf16 v[64:67], a[12:15], v[116:119], v[64:67]
    v_fma_f32 v95, v95, v163, v155
    s_add_u32 s90, s94, 0
    v_mfma_f32_16x16x32_bf16 v[68:71], a[16:19], v[116:119], v[68:71]
    s_waitcnt lgkmcnt(3)
    buffer_load_dwordx4 v1, s[16:19], m0 offen offset:0 sc1 lds
    v_mfma_f32_16x16x32_bf16 v[60:63], a[20:23], v[120:123], v[60:63]
    s_add_u32 m0, s70, 16384
    ds_read_b128 v[108:111], v7 offset:6144
    v_fma_f32 v48, v48, v47, v72
    v_mfma_f32_16x16x32_bf16 v[64:67], a[24:27], v[120:123], v[64:67]
    v_fma_f32 v49, v49, v47, v73
    v_fma_f32 v50, v50, v47, v74
    v_mfma_f32_16x16x32_bf16 v[68:71], a[28:31], v[120:123], v[68:71]
    buffer_load_dwordx4 v1, s[16:19], m0 offen offset:0 sc1 lds
    v_mfma_f32_16x16x32_bf16 v[60:63], a[32:35], v[124:127], v[60:63]
    s_add_u32 m0, s70, 20480
    ds_read_b128 v[112:115], v7 offset:8192
    v_fma_f32 v51, v51, v47, v75
    v_mfma_f32_16x16x32_bf16 v[64:67], a[36:39], v[124:127], v[64:67]
    v_fma_f32 v52, v52, v47, v76
    v_fma_f32 v53, v53, v47, v77
    v_mfma_f32_16x16x32_bf16 v[68:71], a[40:43], v[124:127], v[68:71]
    s_waitcnt lgkmcnt(3)
    v_fma_f32 v54, v54, v47, v78
    v_fma_f32 v55, v55, v47, v79
    v_fma_f32 v56, v56, v47, v80
    v_fma_f32 v57, v57, v47, v81
    v_fma_f32 v58, v58, v47, v82
    v_fma_f32 v59, v59, v47, v83
    v_mfma_f32_16x16x32_bf16 v[72:75], v[208:211], v[96:99], 0
    ds_read_b128 v[116:119], v7 offset:10240
    v_mul_f32 v48, v48, abs(v48)
    v_mfma_f32_16x16x32_bf16 v[76:79], v[204:207], v[96:99], 0
    buffer_load_dwordx4 v1, s[16:19], m0 offen offset:0 sc1 lds
    v_mfma_f32_16x16x32_bf16 v[80:83], v[200:203], v[96:99], 0
    v_mul_f32 v49, v49, abs(v49)
    v_mul_f32 v50, v50, abs(v50)
    v_mfma_f32_16x16x32_bf16 v[72:75], v[196:199], v[100:103], v[72:75]
    ds_read_b128 v[120:123], v7 offset:12288
    v_mul_f32 v51, v51, abs(v51)
    v_cvt_pk_bf16_f32 v156, v48, v49
    v_mfma_f32_16x16x32_bf16 v[76:79], v[192:195], v[100:103], v[76:79]
    buffer_load_dwordx4 a[196:199], v3, s[4:7], s33 offen offset:3072
    v_cvt_pk_bf16_f32 v157, v50, v51
    v_mfma_f32_16x16x32_bf16 v[80:83], v[188:191], v[100:103], v[80:83]
    s_waitcnt lgkmcnt(3)
    v_pk_max_i16 v156, v156, 0
    v_pk_max_i16 v157, v157, 0
    v_mul_f32 v52, v52, abs(v52)
    v_mfma_f32_16x16x32_bf16 v[72:75], v[184:187], v[104:107], v[72:75]
    s_add_u32 s33, s62, 36864
    ds_read_b128 v[124:127], v7 offset:14336
    v_mul_f32 v53, v53, abs(v53)
    v_mul_f32 v54, v54, abs(v54)
    v_mfma_f32_16x16x32_bf16 v[76:79], v[180:183], v[104:107], v[76:79]
    buffer_load_dwordx4 a[200:203], v1, s[4:7], s33 offen offset:0
    v_mul_f32 v55, v55, abs(v55)
    v_mfma_f32_16x16x32_bf16 v[80:83], v[176:179], v[104:107], v[80:83]
    v_cvt_pk_bf16_f32 v158, v52, v53
    v_cvt_pk_bf16_f32 v159, v54, v55
    v_pk_max_i16 v158, v158, 0
    v_mfma_f32_16x16x32_bf16 v[72:75], a[160:163], v[108:111], v[72:75]
    ds_read_b128 v[96:99], v7 offset:16384
    v_pk_max_i16 v159, v159, 0
    buffer_store_dwordx4 v[156:159], v27, s[4:7], s90 offen
    v_mfma_f32_16x16x32_bf16 v[76:79], a[164:167], v[108:111], v[76:79]
    v_mul_f32 v56, v56, abs(v56)
    v_mul_f32 v57, v57, abs(v57)
    v_mul_f32 v58, v58, abs(v58)
    v_mfma_f32_16x16x32_bf16 v[80:83], a[168:171], v[108:111], v[80:83]
    s_waitcnt lgkmcnt(3)
    buffer_load_dwordx4 a[204:207], v1, s[4:7], s33 offen offset:1024
    v_mul_f32 v59, v59, abs(v59)
    v_mfma_f32_16x16x32_bf16 v[72:75], a[172:175], v[112:115], v[72:75]
    ds_read_b128 v[100:103], v7 offset:18432
    v_cvt_pk_bf16_f32 v160, v56, v57
    v_cvt_pk_bf16_f32 v161, v58, v59
    v_mfma_f32_16x16x32_bf16 v[76:79], a[176:179], v[112:115], v[76:79]
    v_pk_max_i16 v160, v160, 0
    v_pk_max_i16 v161, v161, 0
    v_mfma_f32_16x16x32_bf16 v[80:83], a[180:183], v[112:115], v[80:83]
    buffer_load_dwordx4 a[208:211], v1, s[4:7], s33 offen offset:2048
    v_mfma_f32_16x16x32_bf16 v[72:75], a[184:187], v[116:119], v[72:75]
    s_waitcnt vmcnt(11)
    s_barrier
    ds_read_b128 v[104:107], v7 offset:20480
    v_mfma_f32_16x16x32_bf16 v[76:79], a[188:191], v[116:119], v[76:79]
    s_add_u32 m0, s71, 4096
    s_nop 0
    buffer_load_dwordx4 v1, s[16:19], m0 offen offset:0 sc1 lds
    v_mfma_f32_16x16x32_bf16 v[80:83], a[244:247], v[116:119], v[80:83]
    s_waitcnt lgkmcnt(3)
    buffer_store_dwordx2 v[160:161], v26, s[4:7], s90 offen offset:1024
    v_mfma_f32_16x16x32_bf16 v[72:75], a[248:251], v[120:123], v[72:75]
    s_add_u32 m0, s71, 8192
    ds_read_b128 v[108:111], v7 offset:22528
    s_add_u32 s90, s94, 49152
    v_mfma_f32_16x16x32_bf16 v[76:79], a[0:3], v[120:123], v[76:79]
    buffer_load_dwordx4 v1, s[16:19], m0 offen offset:0 sc1 lds
    v_mfma_f32_16x16x32_bf16 v[80:83], a[4:7], v[120:123], v[80:83]
    s_add_u32 m0, s71, 12288
    s_nop 0
    buffer_load_dwordx4 v1, s[16:19], m0 offen offset:0 sc1 lds
    v_mfma_f32_16x16x32_bf16 v[72:75], a[8:11], v[124:127], v[72:75]
    s_add_u32 m0, s71, 16384
    ds_read_b128 v[112:115], v7 offset:24576
    v_fma_f32 v60, v60, v163, v84
    v_mfma_f32_16x16x32_bf16 v[76:79], a[12:15], v[124:127], v[76:79]
    buffer_load_dwordx4 v1, s[16:19], m0 offen offset:0 sc1 lds
    v_mfma_f32_16x16x32_bf16 v[80:83], a[16:19], v[124:127], v[80:83]
    s_waitcnt lgkmcnt(3)
    v_fma_f32 v61, v61, v163, v85
    v_fma_f32 v62, v62, v163, v86
    v_mfma_f32_16x16x32_bf16 v[72:75], a[20:23], v[96:99], v[72:75]
    s_add_u32 m0, s71, 20480
    ds_read_b128 v[116:119], v7 offset:26624
    v_fma_f32 v63, v63, v163, v87
    v_mfma_f32_16x16x32_bf16 v[76:79], a[24:27], v[96:99], v[76:79]
    buffer_load_dwordx4 v1, s[16:19], m0 offen offset:0 sc1 lds
    v_mfma_f32_16x16x32_bf16 v[80:83], a[28:31], v[96:99], v[80:83]
    s_lshl_b32 s88, s27, 2
    v_fma_f32 v64, v64, v163, v88
    v_fma_f32 v65, v65, v163, v89
    v_mfma_f32_16x16x32_bf16 v[72:75], a[32:35], v[100:103], v[72:75]
    s_add_u32 s88, s88, s24
    ds_read_b128 v[120:123], v7 offset:28672
    v_fma_f32 v66, v66, v163, v90
    v_mfma_f32_16x16x32_bf16 v[76:79], a[36:39], v[100:103], v[76:79]
    s_lshl_b32 s88, s88, 11
    v_fma_f32 v67, v67, v163, v91
    v_fma_f32 v68, v68, v163, v92
    v_mfma_f32_16x16x32_bf16 v[80:83], a[40:43], v[100:103], v[80:83]
    s_waitcnt lgkmcnt(3)
    v_lshlrev_b32 v31, 5, v5
    v_and_b32 v31, 0x780, v31
    buffer_load_dword v0, v31, s[20:23], s88 offen
    v_fma_f32 v69, v69, v163, v93
    v_fma_f32 v70, v70, v163, v94
    v_fma_f32 v71, v71, v163, v95
    v_mfma_f32_16x16x32_bf16 v[84:87], v[208:211], v[104:107], 0
    ds_read_b128 v[124:127], v7 offset:30720
    v_mul_f32 v60, v60, abs(v60)
    v_mfma_f32_16x16x32_bf16 v[88:91], v[204:207], v[104:107], 0
    v_mul_f32 v61, v61, abs(v61)
    v_mul_f32 v62, v62, abs(v62)
    v_mfma_f32_16x16x32_bf16 v[92:95], v[200:203], v[104:107], 0
    buffer_load_dwordx4 a[212:215], v1, s[4:7], s33 offen offset:3072
    v_mfma_f32_16x16x32_bf16 v[84:87], v[196:199], v[108:111], v[84:87]
    ds_read_b128 v[96:99], v7 offset:32768
    v_mul_f32 v63, v63, abs(v63)
    v_mfma_f32_16x16x32_bf16 v[88:91], v[192:195], v[108:111], v[88:91]
    v_cvt_pk_bf16_f32 v156, v60, v61
    v_cvt_pk_bf16_f32 v157, v62, v63
    v_mfma_f32_16x16x32_bf16 v[92:95], v[188:191], v[108:111], v[92:95]
    s_waitcnt lgkmcnt(3)
    buffer_load_dwordx4 a[216:219], v2, s[4:7], s33 offen offset:0
    v_mfma_f32_16x16x32_bf16 v[84:87], v[184:187], v[112:115], v[84:87]
    ds_read_b128 v[100:103], v7 offset:34816
    v_pk_max_i16 v156, v156, 0
    v_mfma_f32_16x16x32_bf16 v[88:91], v[180:183], v[112:115], v[88:91]
    v_pk_max_i16 v157, v157, 0
    v_mul_f32 v64, v64, abs(v64)
    v_mfma_f32_16x16x32_bf16 v[92:95], v[176:179], v[112:115], v[92:95]
    v_mul_f32 v65, v65, abs(v65)
    v_mul_f32 v66, v66, abs(v66)
    v_mfma_f32_16x16x32_bf16 v[84:87], a[160:163], v[116:119], v[84:87]
    ds_read_b128 v[104:107], v7 offset:36864
    v_mul_f32 v67, v67, abs(v67)
    v_mfma_f32_16x16x32_bf16 v[88:91], a[164:167], v[116:119], v[88:91]
    buffer_load_dwordx4 a[220:223], v2, s[4:7], s33 offen offset:1024
    v_mfma_f32_16x16x32_bf16 v[92:95], a[168:171], v[116:119], v[92:95]
    s_waitcnt lgkmcnt(3)
    v_cvt_pk_bf16_f32 v158, v64, v65
    v_cvt_pk_bf16_f32 v159, v66, v67
    v_mfma_f32_16x16x32_bf16 v[84:87], a[172:175], v[120:123], v[84:87]
    ds_read_b128 v[108:111], v7 offset:38912
    v_pk_max_i16 v158, v158, 0
    v_mfma_f32_16x16x32_bf16 v[88:91], a[176:179], v[120:123], v[88:91]
    buffer_load_dwordx4 a[224:227], v2, s[4:7], s33 offen offset:2048
    v_mfma_f32_16x16x32_bf16 v[92:95], a[180:183], v[120:123], v[92:95]
    v_pk_max_i16 v159, v159, 0
    buffer_store_dwordx4 v[156:159], v27, s[4:7], s90 offen
    v_mfma_f32_16x16x32_bf16 v[84:87], a[184:187], v[124:127], v[84:87]
    s_waitcnt vmcnt(17)
    s_barrier
    ds_read_b128 v[112:115], v6 offset:0
    v_mfma_f32_16x16x32_bf16 v[88:91], a[188:191], v[124:127], v[88:91]
    buffer_load_dwordx4 a[228:231], v2, s[4:7], s33 offen offset:3072
    v_mfma_f32_16x16x32_bf16 v[92:95], a[244:247], v[124:127], v[92:95]
    s_waitcnt lgkmcnt(3)
    v_mul_f32 v68, v68, abs(v68)
    v_mul_f32 v69, v69, abs(v69)
    v_mfma_f32_16x16x32_bf16 v[84:87], a[248:251], v[96:99], v[84:87]
    ds_read_b128 v[116:119], v6 offset:2048
    v_mul_f32 v70, v70, abs(v70)
    v_mfma_f32_16x16x32_bf16 v[88:91], a[0:3], v[96:99], v[88:91]
    v_mul_f32 v71, v71, abs(v71)
    v_cvt_pk_bf16_f32 v160, v68, v69
    v_mfma_f32_16x16x32_bf16 v[92:95], a[4:7], v[96:99], v[92:95]
    buffer_load_dwordx4 a[232:235], v3, s[4:7], s33 offen offset:0
    v_mfma_f32_16x16x32_bf16 v[84:87], a[8:11], v[100:103], v[84:87]
    ds_read_b128 v[120:123], v6 offset:4096
    v_cvt_pk_bf16_f32 v161, v70, v71
    v_mfma_f32_16x16x32_bf16 v[88:91], a[12:15], v[100:103], v[88:91]
    v_pk_max_i16 v160, v160, 0
    v_pk_max_i16 v161, v161, 0
    v_mfma_f32_16x16x32_bf16 v[92:95], a[16:19], v[100:103], v[92:95]
    s_waitcnt lgkmcnt(3)
    buffer_load_dwordx4 a[236:239], v3, s[4:7], s33 offen offset:1024
    v_mfma_f32_16x16x32_bf16 v[84:87], a[20:23], v[104:107], v[84:87]
    ds_read_b128 v[124:127], v6 offset:6144
    v_mfma_f32_16x16x32_bf16 v[88:91], a[24:27], v[104:107], v[88:91]
    ds_write_b128 v18, v[72:75] offset:0
    v_mfma_f32_16x16x32_bf16 v[92:95], a[28:31], v[104:107], v[92:95]
    v_mfma_f32_16x16x32_bf16 v[84:87], a[32:35], v[108:111], v[84:87]
    ds_read_b128 v[96:99], v6 offset:8192
    v_mfma_f32_16x16x32_bf16 v[88:91], a[36:39], v[108:111], v[88:91]
    buffer_load_dwordx4 a[240:243], v3, s[4:7], s33 offen offset:2048
    v_mfma_f32_16x16x32_bf16 v[92:95], a[40:43], v[108:111], v[92:95]
    s_waitcnt lgkmcnt(4)
    ds_write_b128 v18, v[76:79] offset:1024
    ds_write_b128 v18, v[80:83] offset:2048
    v_mfma_f32_16x16x32_bf16 v[48:51], v[208:211], v[112:115], 0
    ds_read_b128 v[100:103], v6 offset:10240
    v_mfma_f32_16x16x32_bf16 v[52:55], v[204:207], v[112:115], 0
    buffer_load_dwordx4 v[248:251], v3, s[4:7], s33 offen offset:3072
    v_mfma_f32_16x16x32_bf16 v[56:59], v[200:203], v[112:115], 0
    s_add_u32 s33, s62, 49152
    v_mfma_f32_16x16x32_bf16 v[48:51], v[196:199], v[116:119], v[48:51]
    ds_read_b128 v[104:107], v6 offset:12288
    v_mfma_f32_16x16x32_bf16 v[52:55], v[192:195], v[116:119], v[52:55]
    buffer_load_dwordx4 v[244:247], v1, s[4:7], s33 offen offset:0
    v_mfma_f32_16x16x32_bf16 v[56:59], v[188:191], v[116:119], v[56:59]
    s_waitcnt lgkmcnt(6)
    ds_write_b128 v18, v[84:87] offset:3072
    ds_write_b128 v18, v[88:91] offset:4096
    ds_write_b128 v18, v[92:95] offset:5120
    buffer_store_dwordx2 v[160:161], v26, s[4:7], s90 offen offset:1024
    v_mfma_f32_16x16x32_bf16 v[48:51], v[184:187], v[120:123], v[48:51]
    ds_read_b128 v[108:111], v6 offset:14336
    v_mfma_f32_16x16x32_bf16 v[52:55], v[180:183], v[120:123], v[52:55]
    v_mov_b32 v30, 10
    s_mov_b64 exec, 1
    s_cmp_lg_u32 s28, 0
    s_waitcnt vmcnt(0)
    s_cbranch_scc1 pubs_67
    buffer_store_dword v30, off, s[4:7], s32
pubd_68:
    s_mov_b64 exec, -1
    v_mfma_f32_16x16x32_bf16 v[56:59], v[176:179], v[120:123], v[56:59]
    buffer_load_dwordx4 v[240:243], v1, s[4:7], s33 offen offset:1024
    v_mfma_f32_16x16x32_bf16 v[48:51], a[160:163], v[124:127], v[48:51]
    ds_read_b128 v[112:115], v6 offset:16384
    v_add_f32 v144, v144, v146
    v_mfma_f32_16x16x32_bf16 v[52:55], a[164:167], v[124:127], v[52:55]
    v_add_f32 v145, v145, v147
    v_mfma_f32_16x16x32_bf16 v[56:59], a[168:171], v[124:127], v[56:59]
    s_waitcnt lgkmcnt(6)
    buffer_load_dwordx4 v[236:239], v1, s[4:7], s33 offen offset:2048
    v_mfma_f32_16x16x32_bf16 v[48:51], a[172:175], v[96:99], v[48:51]
    ds_read_b128 v[116:119], v6 offset:18432
    v_permlane16_swap_b32 v144, v145
    v_mfma_f32_16x16x32_bf16 v[52:55], a[176:179], v[96:99], v[52:55]
    v_add_f32 v144, v144, v145
    v_mov_b32 v145, v144
    v_mfma_f32_16x16x32_bf16 v[56:59], a[180:183], v[96:99], v[56:59]
    s_nop 0
    v_permlane32_swap_b32 v144, v145
    v_add_f32 v144, v144, v145
    v_mfma_f32_16x16x32_bf16 v[48:51], a[184:187], v[100:103], v[48:51]
    v_mov_b32 v145, v144
    s_nop 1
    v_permlane16_swap_b32 v144, v145
    v_mul_f32 v146, s64, v144
    v_mul_f32 v145, s64, v145
    v_fma_f32 v145, -v146, v146, v145
    v_max_f32 v145, 0, v145
    v_add_f32 v145, s65, v145
    v_rsq_f32 v147, v145
    v_add_u32 v144, s0, v17
    ds_write_b64 v144, v[146:147] offset:512
    s_waitcnt lgkmcnt(0)
    s_barrier
    ds_read_b128 v[120:123], v6 offset:20480
    v_mfma_f32_16x16x32_bf16 v[52:55], a[188:191], v[100:103], v[52:55]
    buffer_load_dwordx4 v[232:235], v1, s[4:7], s33 offen offset:3072
    v_add_u32 v46, s69, v17
    v_mfma_f32_16x16x32_bf16 v[56:59], a[244:247], v[100:103], v[56:59]
    ds_read_b64 v[46:47], v46 offset:512
    ds_read_b128 v[72:75], v19 offset:0
    ds_read_b128 v[76:79], v19 offset:1024
    v_mfma_f32_16x16x32_bf16 v[48:51], a[248:251], v[104:107], v[48:51]
    ds_read_b128 v[124:127], v6 offset:22528
    ds_read_b128 v[80:83], v19 offset:2048
    v_add_u32 v162, s69, v17
    v_mfma_f32_16x16x32_bf16 v[52:55], a[0:3], v[104:107], v[52:55]
    buffer_load_dwordx4 v[228:231], v2, s[4:7], s33 offen offset:0
    ds_read_b64 v[162:163], v162 offset:640
    v_mfma_f32_16x16x32_bf16 v[56:59], a[4:7], v[104:107], v[56:59]
    ds_read_b128 v[84:87], v19 offset:3072
    ds_read_b128 v[88:91], v19 offset:4096
    ds_read_b128 v[92:95], v19 offset:5120
    v_mfma_f32_16x16x32_bf16 v[48:51], a[8:11], v[108:111], v[48:51]
    ds_read_b128 v[96:99], v6 offset:24576
    v_mfma_f32_16x16x32_bf16 v[52:55], a[12:15], v[108:111], v[52:55]
    buffer_load_dwordx4 v[224:227], v2, s[4:7], s33 offen offset:1024
    v_mfma_f32_16x16x32_bf16 v[56:59], a[16:19], v[108:111], v[56:59]
    v_mfma_f32_16x16x32_bf16 v[48:51], a[20:23], v[112:115], v[48:51]
    ds_read_b128 v[100:103], v6 offset:26624
    v_mfma_f32_16x16x32_bf16 v[52:55], a[24:27], v[112:115], v[52:55]
    s_waitcnt lgkmcnt(6)
    v_fma_f32 v72, -v128, v46, v72
    v_fma_f32 v73, -v129, v46, v73
    v_fma_f32 v74, -v130, v46, v74
    v_mfma_f32_16x16x32_bf16 v[56:59], a[28:31], v[112:115], v[56:59]
    buffer_load_dwordx4 v[220:223], v2, s[4:7], s33 offen offset:2048
    v_fma_f32 v75, -v131, v46, v75
    v_mfma_f32_16x16x32_bf16 v[48:51], a[32:35], v[116:119], v[48:51]
    ds_read_b128 v[104:107], v6 offset:28672
    v_fma_f32 v72, v72, v47, v132
    v_mfma_f32_16x16x32_bf16 v[52:55], a[36:39], v[116:119], v[52:55]
    v_fma_f32 v73, v73, v47, v133
    v_fma_f32 v74, v74, v47, v134
    v_mfma_f32_16x16x32_bf16 v[56:59], a[40:43], v[116:119], v[56:59]
    buffer_load_dwordx4 v[216:219], v2, s[4:7], s33 offen offset:3072
    v_mfma_f32_16x16x32_bf16 v[60:63], v[208:211], v[120:123], 0
    ds_read_b128 v[108:111], v6 offset:30720
    v_fma_f32 v75, v75, v47, v135
    v_mfma_f32_16x16x32_bf16 v[64:67], v[204:207], v[120:123], 0
    v_fma_f32 v76, -v136, v46, v76
    v_fma_f32 v77, -v137, v46, v77
    v_mfma_f32_16x16x32_bf16 v[68:71], v[200:203], v[120:123], 0
    v_fma_f32 v78, -v138, v46, v78
    v_fma_f32 v79, -v139, v46, v79
    v_mfma_f32_16x16x32_bf16 v[60:63], v[196:199], v[124:127], v[60:63]
    ds_read_b128 v[112:115], v6 offset:32768
    buffer_load_dwordx4 v[212:215], v3, s[4:7], s33 offen offset:0
    v_mfma_f32_16x16x32_bf16 v[64:67], v[192:195], v[124:127], v[64:67]
    v_fma_f32 v76, v76, v47, v140
    v_fma_f32 v77, v77, v47, v141
    v_fma_f32 v78, v78, v47, v142
    v_mfma_f32_16x16x32_bf16 v[68:71], v[188:191], v[124:127], v[68:71]
    s_waitcnt lgkmcnt(3)
    v_fma_f32 v79, v79, v47, v143
    v_fma_f32 v80, -v148, v46, v80
    v_fma_f32 v81, -v149, v46, v81
    v_mfma_f32_16x16x32_bf16 v[60:63], v[184:187], v[96:99], v[60:63]
    ds_read_b128 v[116:119], v6 offset:34816
    buffer_load_dwordx4 v[208:211], v3, s[4:7], s33 offen offset:1024
    v_mfma_f32_16x16x32_bf16 v[64:67], v[180:183], v[96:99], v[64:67]
    v_fma_f32 v82, -v150, v46, v82
    v_fma_f32 v83, -v151, v46, v83
    v_fma_f32 v80, v80, v47, v152
    v_mfma_f32_16x16x32_bf16 v[68:71], v[176:179], v[96:99], v[68:71]
    v_fma_f32 v81, v81, v47, v153
    v_fma_f32 v82, v82, v47, v154
    v_fma_f32 v83, v83, v47, v155
    v_mfma_f32_16x16x32_bf16 v[60:63], a[160:163], v[100:103], v[60:63]
    ds_read_b128 v[120:123], v6 offset:36864
    v_fma_f32 v84, -v128, v162, v84
    v_fma_f32 v85, -v129, v162, v85
    v_mfma_f32_16x16x32_bf16 v[64:67], a[164:167], v[100:103], v[64:67]
    buffer_load_dwordx4 v[204:207], v3, s[4:7], s33 offen offset:2048
    v_fma_f32 v86, -v130, v162, v86
    v_mfma_f32_16x16x32_bf16 v[68:71], a[168:171], v[100:103], v[68:71]
    s_waitcnt lgkmcnt(3)
    v_fma_f32 v87, -v131, v162, v87
    v_fma_f32 v84, v84, v163, v132
    v_fma_f32 v85, v85, v163, v133
    v_mfma_f32_16x16x32_bf16 v[60:63], a[172:175], v[104:107], v[60:63]
    ds_read_b128 v[124:127], v6 offset:38912
    v_fma_f32 v86, v86, v163, v134
    v_fma_f32 v87, v87, v163, v135
    v_mfma_f32_16x16x32_bf16 v[64:67], a[176:179], v[104:107], v[64:67]
    v_fma_f32 v88, -v136, v162, v88
    v_fma_f32 v89, -v137, v162, v89
    v_fma_f32 v90, -v138, v162, v90
    v_mfma_f32_16x16x32_bf16 v[68:71], a[180:183], v[104:107], v[68:71]
    buffer_load_dwordx4 v[200:203], v3, s[4:7], s33 offen offset:3072
    v_fma_f32 v91, -v139, v162, v91
    v_mfma_f32_16x16x32_bf16 v[60:63], a[184:187], v[108:111], v[60:63]
    v_fma_f32 v88, v88, v163, v140
    v_fma_f32 v89, v89, v163, v141
    v_fma_f32 v90, v90, v163, v142
    v_mfma_f32_16x16x32_bf16 v[64:67], a[188:191], v[108:111], v[64:67]
    v_fma_f32 v91, v91, v163, v143
    v_fma_f32 v92, -v148, v162, v92
    v_fma_f32 v93, -v149, v162, v93
    v_mfma_f32_16x16x32_bf16 v[68:71], a[244:247], v[108:111], v[68:71]
    s_waitcnt lgkmcnt(2)
    v_fma_f32 v94, -v150, v162, v94
    v_fma_f32 v95, -v151, v162, v95
    v_fma_f32 v92, v92, v163, v152
    v_mfma_f32_16x16x32_bf16 v[60:63], a[248:251], v[112:115], v[60:63]
    v_fma_f32 v93, v93, v163, v153
    v_fma_f32 v94, v94, v163, v154
    v_mfma_f32_16x16x32_bf16 v[64:67], a[0:3], v[112:115], v[64:67]
    v_fma_f32 v95, v95, v163, v155
    s_add_u32 s90, s94, 3145728
    v_mfma_f32_16x16x32_bf16 v[68:71], a[4:7], v[112:115], v[68:71]
    v_fma_f32 v48, v48, v47, v72
    v_fma_f32 v49, v49, v47, v73
    v_mfma_f32_16x16x32_bf16 v[60:63], a[8:11], v[116:119], v[60:63]
    v_fma_f32 v50, v50, v47, v74
    v_fma_f32 v51, v51, v47, v75
    v_mfma_f32_16x16x32_bf16 v[64:67], a[12:15], v[116:119], v[64:67]
    v_fma_f32 v52, v52, v47, v76
    v_fma_f32 v53, v53, v47, v77
    v_mfma_f32_16x16x32_bf16 v[68:71], a[16:19], v[116:119], v[68:71]
    s_waitcnt lgkmcnt(0)
    v_fma_f32 v54, v54, v47, v78
    v_fma_f32 v55, v55, v47, v79
    v_mfma_f32_16x16x32_bf16 v[60:63], a[20:23], v[120:123], v[60:63]
    v_fma_f32 v56, v56, v47, v80
    v_fma_f32 v57, v57, v47, v81
    v_mfma_f32_16x16x32_bf16 v[64:67], a[24:27], v[120:123], v[64:67]
    v_fma_f32 v58, v58, v47, v82
    v_fma_f32 v59, v59, v47, v83
    v_mfma_f32_16x16x32_bf16 v[68:71], a[28:31], v[120:123], v[68:71]
    v_mul_f32 v48, v48, abs(v48)
    v_mul_f32 v49, v49, abs(v49)
    v_mfma_f32_16x16x32_bf16 v[60:63], a[32:35], v[124:127], v[60:63]
    v_mul_f32 v50, v50, abs(v50)
    v_mul_f32 v51, v51, abs(v51)
    v_mfma_f32_16x16x32_bf16 v[64:67], a[36:39], v[124:127], v[64:67]
    v_cvt_pk_bf16_f32 v156, v48, v49
    v_cvt_pk_bf16_f32 v157, v50, v51
    v_mfma_f32_16x16x32_bf16 v[68:71], a[40:43], v[124:127], v[68:71]
    v_pk_max_i16 v156, v156, 0
    v_pk_max_i16 v157, v157, 0
    buffer_load_dword v29, v5, s[4:7], s31 offen sc1
    v_mul_f32 v52, v52, abs(v52)
    v_mul_f32 v53, v53, abs(v53)
    v_mul_f32 v54, v54, abs(v54)
    v_mul_f32 v55, v55, abs(v55)
    v_cvt_pk_bf16_f32 v158, v52, v53
    v_cvt_pk_bf16_f32 v159, v54, v55
    v_pk_max_i16 v158, v158, 0
    v_pk_max_i16 v159, v159, 0
    buffer_store_dwordx4 v[156:159], v27, s[4:7], s90 offen
    v_mul_f32 v56, v56, abs(v56)
    v_mul_f32 v57, v57, abs(v57)
    v_mul_f32 v58, v58, abs(v58)
    v_mul_f32 v59, v59, abs(v59)
    v_cvt_pk_bf16_f32 v160, v56, v57
    v_cvt_pk_bf16_f32 v161, v58, v59
    v_pk_max_i16 v160, v160, 0
    v_pk_max_i16 v161, v161, 0
    buffer_store_dwordx2 v[160:161], v26, s[4:7], s90 offen offset:1024
    s_add_u32 s90, s94, 3194880
    v_pk_fma_f32 v[60:61], v[60:61], v[162:163], v[84:85] op_sel:[0,1,0] op_sel_hi:[1,1,1]
    v_pk_fma_f32 v[62:63], v[62:63], v[162:163], v[86:87] op_sel:[0,1,0] op_sel_hi:[1,1,1]
    v_pk_fma_f32 v[64:65], v[64:65], v[162:163], v[88:89] op_sel:[0,1,0] op_sel_hi:[1,1,1]
    v_pk_fma_f32 v[66:67], v[66:67], v[162:163], v[90:91] op_sel:[0,1,0] op_sel_hi:[1,1,1]
    v_pk_fma_f32 v[68:69], v[68:69], v[162:163], v[92:93] op_sel:[0,1,0] op_sel_hi:[1,1,1]
    v_pk_fma_f32 v[70:71], v[70:71], v[162:163], v[94:95] op_sel:[0,1,0] op_sel_hi:[1,1,1]
    v_mul_f32 v60, v60, abs(v60)
    v_mul_f32 v61, v61, abs(v61)
    v_mul_f32 v62, v62, abs(v62)
    v_mul_f32 v63, v63, abs(v63)
    v_cvt_pk_bf16_f32 v156, v60, v61
    v_cvt_pk_bf16_f32 v157, v62, v63
    v_pk_max_i16 v156, v156, 0
    v_pk_max_i16 v157, v157, 0
    v_mul_f32 v64, v64, abs(v64)
    v_mul_f32 v65, v65, abs(v65)
    v_mul_f32 v66, v66, abs(v66)
    v_mul_f32 v67, v67, abs(v67)
    v_cvt_pk_bf16_f32 v158, v64, v65
    v_cvt_pk_bf16_f32 v159, v66, v67
    v_pk_max_i16 v158, v158, 0
    v_pk_max_i16 v159, v159, 0
    buffer_store_dwordx4 v[156:159], v27, s[4:7], s90 offen
    v_mul_f32 v68, v68, abs(v68)
    v_mul_f32 v69, v69, abs(v69)
    v_mul_f32 v70, v70, abs(v70)
    v_mul_f32 v71, v71, abs(v71)
    v_cvt_pk_bf16_f32 v160, v68, v69
    v_cvt_pk_bf16_f32 v161, v70, v71
    v_pk_max_i16 v160, v160, 0
    v_pk_max_i16 v161, v161, 0
    buffer_store_dwordx2 v[160:161], v26, s[4:7], s90 offen offset:1024
    s_barrier
    s_waitcnt vmcnt(4)
poll_70:
    v_cmp_le_u32 vcc, 10, v29
    s_nop 0
    s_andn2_b64 s[56:57], s[34:35], vcc
    s_cbranch_scc1 pollr_69
    s_cmp_lg_u32 s28, 0
    s_cbranch_scc1 acq_71
polld_72:
    s_add_u32 m0, s83, 4096
    s_nop 0
    buffer_load_dwordx4 v1, s[4:7], s79 offen offset:0 sc1 lds
    s_add_u32 m0, s83, 5120
    s_nop 0
    buffer_load_dwordx4 v1, s[4:7], s80 offen offset:0 sc1 lds
    s_add_u32 m0, s83, 6144
    s_nop 0
    buffer_load_dwordx4 v1, s[4:7], s81 offen offset:0 sc1 lds
    s_add_u32 m0, s83, 6144
    s_nop 0
    buffer_load_dwordx4 v1, s[4:7], s79 offen offset:1024 sc1 lds
    s_add_u32 m0, s83, 7168
    s_nop 0
    buffer_load_dwordx4 v1, s[4:7], s80 offen offset:1024 sc1 lds
    s_add_u32 m0, s83, 8192
    s_nop 0
    buffer_load_dwordx4 v1, s[4:7], s81 offen offset:1024 sc1 lds
    v_mov_b32 v30, 11
    s_mov_b64 exec, 1
    s_cmp_lg_u32 s28, 0
    s_waitcnt vmcnt(6)
    s_cbranch_scc1 pubs_73
    buffer_store_dword v30, off, s[4:7], s32
pubd_74:
    s_mov_b64 exec, -1
    s_barrier
    s_waitcnt vmcnt(6)
    ds_read_b128 v[128:131], v33 offset:0
    s_waitcnt vmcnt(5)
    ds_read_b128 v[132:135], v33 offset:1024
    s_waitcnt vmcnt(4)
    ds_read_b128 v[136:139], v33 offset:2048
    s_waitcnt lgkmcnt(2)
    v_mfma_f32_16x16x32_bf16 v[68:71], a[44:47], v[128:131], 0
    s_add_u32 m0, s83, 10240
    s_waitcnt vmcnt(3)
    ds_read_b128 v[140:143], v33 offset:3072
    v_mfma_f32_16x16x32_bf16 v[72:75], a[48:51], v[128:131], 0
    buffer_load_dwordx4 v1, s[4:7], s78 offen offset:0 sc1 lds
    v_mfma_f32_16x16x32_bf16 v[76:79], v[164:167], v[128:131], 0
    s_add_u32 m0, s83, 10240
    s_nop 0
    buffer_load_dwordx4 v1, s[4:7], s78 offen offset:1024 sc1 lds
    v_mfma_f32_16x16x32_bf16 v[80:83], v[168:171], v[128:131], 0
    s_add_u32 m0, s83, 10240
    ds_read_b128 v[144:147], v24 offset:1536
    ds_read_b128 v[148:151], v24 offset:1600
    v_mfma_f32_16x16x32_bf16 v[84:87], v[172:175], v[128:131], 0
    s_waitcnt lgkmcnt(4)
    buffer_load_dwordx4 v1, s[4:7], s79 offen offset:2048 sc1 lds
    v_mfma_f32_16x16x32_bf16 v[88:91], a[44:47], v[132:135], 0
    s_add_u32 m0, s83, 11264
    s_waitcnt vmcnt(5)
    ds_read_b128 v[128:131], v33 offset:4096
    v_mfma_f32_16x16x32_bf16 v[92:95], a[48:51], v[132:135], 0
    buffer_load_dwordx4 v1, s[4:7], s80 offen offset:2048 sc1 lds
    v_mfma_f32_16x16x32_bf16 v[96:99], v[164:167], v[132:135], 0
    s_add_u32 m0, s83, 12288
    s_nop 0
    buffer_load_dwordx4 v1, s[4:7], s81 offen offset:2048 sc1 lds
    v_mfma_f32_16x16x32_bf16 v[100:103], v[168:171], v[132:135], 0
    s_add_u32 m0, s83, 13312
    ds_read_b128 v[152:155], v24 offset:1664
    ds_read_b128 v[156:159], v24 offset:1728
    v_mfma_f32_16x16x32_bf16 v[104:107], v[172:175], v[132:135], 0
    s_waitcnt lgkmcnt(6)
    buffer_load_dwordx4 v1, s[4:7], s78 offen offset:2048 sc1 lds
    v_mfma_f32_16x16x32_bf16 v[108:111], a[44:47], v[136:139], 0
    s_add_u32 m0, s83, 13312
    s_waitcnt vmcnt(7)
    ds_read_b128 v[132:135], v33 offset:5120
    v_mfma_f32_16x16x32_bf16 v[112:115], a[48:51], v[136:139], 0
    buffer_load_dwordx4 v1, s[4:7], s79 offen offset:3072 sc1 lds
    v_mfma_f32_16x16x32_bf16 v[116:119], v[164:167], v[136:139], 0
    s_add_u32 m0, s83, 14336
    s_nop 0
    buffer_load_dwordx4 v1, s[4:7], s80 offen offset:3072 sc1 lds
    v_mfma_f32_16x16x32_bf16 v[120:123], v[168:171], v[136:139], 0
    s_add_u32 m0, s83, 15360
    ds_read_b128 v[160:163], v24 offset:1792
    v_lshlrev_b32 v48, 16, v36
    v_mfma_f32_16x16x32_bf16 v[124:127], v[172:175], v[136:139], 0
    s_waitcnt lgkmcnt(7)
    v_and_b32 v49, 0xffff0000, v36
    v_lshlrev_b32 v50, 16, v37
    v_mfma_f32_16x16x32_bf16 v[68:71], a[52:55], v[140:143], v[68:71]
    s_waitcnt vmcnt(7)
    ds_read_b128 v[136:139], v33 offset:6144
    v_and_b32 v51, 0xffff0000, v37
    v_mfma_f32_16x16x32_bf16 v[72:75], a[56:59], v[140:143], v[72:75]
    buffer_load_dwordx4 v1, s[4:7], s81 offen offset:3072 sc1 lds
    v_mfma_f32_16x16x32_bf16 v[76:79], a[60:63], v[140:143], v[76:79]
    s_add_u32 m0, s83, 16384
    v_lshlrev_b32 v52, 16, v38
    v_and_b32 v53, 0xffff0000, v38
    v_mfma_f32_16x16x32_bf16 v[80:83], a[64:67], v[140:143], v[80:83]
    v_lshlrev_b32 v54, 16, v39
    v_and_b32 v55, 0xffff0000, v39
    v_mfma_f32_16x16x32_bf16 v[84:87], a[68:71], v[140:143], v[84:87]
    s_waitcnt lgkmcnt(5)
    buffer_load_dwordx4 v1, s[4:7], s78 offen offset:3072 sc1 lds
    v_mfma_f32_16x16x32_bf16 v[88:91], a[52:55], v[128:131], v[88:91]
    s_add_u32 m0, s83, 20480
    s_waitcnt vmcnt(8)
    ds_read_b128 v[140:143], v33 offset:7168
    v_mfma_f32_16x16x32_bf16 v[92:95], a[56:59], v[128:131], v[92:95]
    v_lshlrev_b32 v56, 16, v40
    v_and_b32 v57, 0xffff0000, v40
    v_mfma_f32_16x16x32_bf16 v[96:99], a[60:63], v[128:131], v[96:99]
    buffer_load_dwordx4 v2, s[4:7], s79 offen offset:0 sc1 lds
    v_mfma_f32_16x16x32_bf16 v[100:103], a[64:67], v[128:131], v[100:103]
    s_add_u32 m0, s83, 21504
    v_lshlrev_b32 v58, 16, v41
    v_and_b32 v59, 0xffff0000, v41
    v_mfma_f32_16x16x32_bf16 v[104:107], a[68:71], v[128:131], v[104:107]
    s_waitcnt lgkmcnt(3)
    v_lshlrev_b32 v60, 16, v42
    v_and_b32 v61, 0xffff0000, v42
    v_mfma_f32_16x16x32_bf16 v[108:111], a[52:55], v[132:135], v[108:111]
    s_waitcnt vmcnt(8)
    ds_read_b128 v[128:131], v33 offset:8192
    v_lshlrev_b32 v62, 16, v43
    v_mfma_f32_16x16x32_bf16 v[112:115], a[56:59], v[132:135], v[112:115]
    buffer_load_dwordx4 v2, s[4:7], s80 offen offset:0 sc1 lds
    v_mfma_f32_16x16x32_bf16 v[116:119], a[60:63], v[132:135], v[116:119]
    s_add_u32 m0, s83, 22528
    v_and_b32 v63, 0xffff0000, v43
    v_lshlrev_b32 v64, 16, v44
    v_mfma_f32_16x16x32_bf16 v[120:123], a[64:67], v[132:135], v[120:123]
    v_and_b32 v65, 0xffff0000, v44
    v_lshlrev_b32 v66, 16, v45
    v_mfma_f32_16x16x32_bf16 v[124:127], a[68:71], v[132:135], v[124:127]
    s_waitcnt lgkmcnt(2)
    buffer_load_dwordx4 v2, s[4:7], s81 offen offset:0 sc1 lds
    v_and_b32 v67, 0xffff0000, v45
    v_add_f32 v48, v48, v144
    v_add_f32 v49, v49, v145
    v_add_f32 v50, v50, v146
    v_add_f32 v51, v51, v147
    v_add_f32 v52, v52, v148
    v_add_f32 v53, v53, v149
    v_add_f32 v54, v54, v150
    v_add_f32 v55, v55, v151
    v_add_f32 v56, v56, v152
    v_add_f32 v57, v57, v153
    v_add_f32 v58, v58, v154
    v_add_f32 v59, v59, v155
    v_add_f32 v60, v60, v156
    v_add_f32 v61, v61, v157
    v_add_f32 v62, v62, v158
    v_add_f32 v63, v63, v159
    v_add_f32 v64, v64, v160
    v_add_f32 v65, v65, v161
    v_add_f32 v66, v66, v162
    v_add_f32 v67, v67, v163
    v_mfma_f32_16x16x32_bf16 v[48:51], a[44:47], v[136:139], v[48:51]
    s_add_u32 m0, s83, 23552
    s_waitcnt vmcnt(9)
    ds_read_b128 v[132:135], v33 offset:9216
    v_mfma_f32_16x16x32_bf16 v[52:55], a[48:51], v[136:139], v[52:55]
    v_lshrrev_b32 v144, 2, v5
    v_and_b32 v144, 15, v144
    v_mfma_f32_16x16x32_bf16 v[56:59], v[164:167], v[136:139], v[56:59]
    v_mul_u32_u24 v144, 1280, v144
    v_add_u32 v144, v144, v24
    v_mfma_f32_16x16x32_bf16 v[60:63], v[168:171], v[136:139], v[60:63]
    buffer_load_dwordx4 v2, s[4:7], s78 offen offset:0 sc1 lds
    v_mfma_f32_16x16x32_bf16 v[64:67], v[172:175], v[136:139], v[64:67]
    s_waitcnt lgkmcnt(2)
    v_sub_u32 v145, v25, v1
    v_add_u32 v145, v145, v144
    v_mfma_f32_16x16x32_bf16 v[48:51], a[52:55], v[140:143], v[48:51]
    s_add_u32 m0, s83, 3072
    s_waitcnt vmcnt(9)
    ds_read_b128 v[136:139], v33 offset:10240
    v_mfma_f32_16x16x32_bf16 v[52:55], a[56:59], v[140:143], v[52:55]
    s_add_u32 s89, s68, s24
    buffer_load_dwordx4 v2, s[4:7], s79 offen offset:1024 sc1 lds
    v_mfma_f32_16x16x32_bf16 v[56:59], a[60:63], v[140:143], v[56:59]
    s_add_u32 m0, s83, 4096
    s_mul_i32 s90, s89, 20480
    s_add_u32 s90, s90, 7372800
    v_mfma_f32_16x16x32_bf16 v[60:63], a[64:67], v[140:143], v[60:63]
    s_add_u32 s89, s24, 4
    s_and_b32 s89, s89, 7
    s_lshl_b32 s91, s25, 3
    v_mfma_f32_16x16x32_bf16 v[64:67], a[68:71], v[140:143], v[64:67]
    s_waitcnt lgkmcnt(2)
    s_add_u32 s89, s89, s91
    s_mul_i32 s89, s89, 20480
    v_mfma_f32_16x16x32_bf16 v[68:71], a[72:75], v[128:131], v[68:71]
    s_sub_u32 s91, s95, s90
    s_waitcnt vmcnt(9)
    ds_read_b128 v[140:143], v33 offset:11264
    v_mfma_f32_16x16x32_bf16 v[72:75], a[76:79], v[128:131], v[72:75]
    s_lshr_b32 s91, s91, 4
    buffer_load_dwordx4 v2, s[4:7], s80 offen offset:1024 sc1 lds
    v_mfma_f32_16x16x32_bf16 v[76:79], a[80:83], v[128:131], v[76:79]
    s_add_u32 m0, s83, 5120
    s_add_u32 s91, s91, s89
    s_sub_u32 s92, s96, s90
    v_mfma_f32_16x16x32_bf16 v[80:83], a[84:87], v[128:131], v[80:83]
    s_lshr_b32 s92, s92, 4
    s_add_u32 s92, s92, s89
    v_mfma_f32_16x16x32_bf16 v[84:87], a[88:91], v[128:131], v[84:87]
    s_waitcnt lgkmcnt(2)
    buffer_load_dwordx4 v2, s[4:7], s81 offen offset:1024 sc1 lds
    v_mfma_f32_16x16x32_bf16 v[88:91], a[72:75], v[132:135], v[88:91]
    s_add_u32 m0, s83, 6144
    s_waitcnt vmcnt(10)
    ds_read_b128 v[128:131], v33 offset:12288
    v_mfma_f32_16x16x32_bf16 v[92:95], a[76:79], v[132:135], v[92:95]
    v_mfma_f32_16x16x32_bf16 v[96:99], a[80:83], v[132:135], v[96:99]
    buffer_load_dwordx4 v2, s[4:7], s78 offen offset:1024 sc1 lds
    v_mfma_f32_16x16x32_bf16 v[100:103], a[84:87], v[132:135], v[100:103]
    s_add_u32 m0, s83, 6144
    v_mfma_f32_16x16x32_bf16 v[104:107], a[88:91], v[132:135], v[104:107]
    s_waitcnt lgkmcnt(2)
    v_mfma_f32_16x16x32_bf16 v[108:111], a[72:75], v[136:139], v[108:111]
    s_waitcnt vmcnt(10)
    ds_read_b128 v[132:135], v33 offset:13312
    v_mfma_f32_16x16x32_bf16 v[112:115], a[76:79], v[136:139], v[112:115]
    buffer_load_dwordx4 v2, s[4:7], s79 offen offset:2048 sc1 lds
    v_mfma_f32_16x16x32_bf16 v[116:119], a[80:83], v[136:139], v[116:119]
    s_add_u32 m0, s83, 7168
    v_mfma_f32_16x16x32_bf16 v[120:123], a[84:87], v[136:139], v[120:123]
    v_mfma_f32_16x16x32_bf16 v[124:127], a[88:91], v[136:139], v[124:127]
    s_waitcnt lgkmcnt(2)
    buffer_load_dwordx4 v2, s[4:7], s80 offen offset:2048 sc1 lds
    v_mfma_f32_16x16x32_bf16 v[48:51], a[72:75], v[140:143], v[48:51]
    s_add_u32 m0, s83, 8192
    s_waitcnt vmcnt(11)
    ds_read_b128 v[136:139], v33 offset:14336
    v_mfma_f32_16x16x32_bf16 v[52:55], a[76:79], v[140:143], v[52:55]
    v_mfma_f32_16x16x32_bf16 v[56:59], a[80:83], v[140:143], v[56:59]
    v_mfma_f32_16x16x32_bf16 v[60:63], a[84:87], v[140:143], v[60:63]
    buffer_load_dwordx4 v2, s[4:7], s81 offen offset:2048 sc1 lds
    v_mfma_f32_16x16x32_bf16 v[64:67], a[88:91], v[140:143], v[64:67]
    s_waitcnt lgkmcnt(2)
    v_mfma_f32_16x16x32_bf16 v[68:71], a[92:95], v[128:131], v[68:71]
    s_add_u32 m0, s83, 9216
    s_waitcnt vmcnt(11)
    ds_read_b128 v[140:143], v33 offset:15360
    v_mfma_f32_16x16x32_bf16 v[72:75], a[96:99], v[128:131], v[72:75]
    buffer_load_dwordx4 v2, s[4:7], s78 offen offset:2048 sc1 lds
    v_mfma_f32_16x16x32_bf16 v[76:79], a[100:103], v[128:131], v[76:79]
    s_add_u32 m0, s83, 9216
    v_mfma_f32_16x16x32_bf16 v[80:83], a[104:107], v[128:131], v[80:83]
    v_mfma_f32_16x16x32_bf16 v[84:87], a[108:111], v[128:131], v[84:87]
    s_waitcnt lgkmcnt(2)
    v_mfma_f32_16x16x32_bf16 v[88:91], a[92:95], v[132:135], v[88:91]
    s_waitcnt vmcnt(11)
    ds_read_b128 v[128:131], v33 offset:16384
    v_mfma_f32_16x16x32_bf16 v[92:95], a[96:99], v[132:135], v[92:95]
    buffer_load_dwordx4 v2, s[4:7], s79 offen offset:3072 sc1 lds
    v_mfma_f32_16x16x32_bf16 v[96:99], a[100:103], v[132:135], v[96:99]
    s_add_u32 m0, s83, 10240
    v_mfma_f32_16x16x32_bf16 v[100:103], a[104:107], v[132:135], v[100:103]
    v_mfma_f32_16x16x32_bf16 v[104:107], a[108:111], v[132:135], v[104:107]
    s_waitcnt lgkmcnt(2)
    buffer_load_dwordx4 v2, s[4:7], s80 offen offset:3072 sc1 lds
    v_mfma_f32_16x16x32_bf16 v[108:111], a[92:95], v[136:139], v[108:111]
    s_add_u32 m0, s83, 11264
    s_waitcnt vmcnt(12)
    ds_read_b128 v[132:135], v33 offset:17408
    v_mfma_f32_16x16x32_bf16 v[112:115], a[96:99], v[136:139], v[112:115]
    v_mfma_f32_16x16x32_bf16 v[116:119], a[100:103], v[136:139], v[116:119]
    buffer_load_dwordx4 v2, s[4:7], s81 offen offset:3072 sc1 lds
    v_mfma_f32_16x16x32_bf16 v[120:123], a[104:107], v[136:139], v[120:123]
    s_add_u32 m0, s83, 12288
    v_mfma_f32_16x16x32_bf16 v[124:127], a[108:111], v[136:139], v[124:127]
    s_waitcnt lgkmcnt(2)
    v_mfma_f32_16x16x32_bf16 v[48:51], a[92:95], v[140:143], v[48:51]
    s_waitcnt vmcnt(12)
    ds_read_b128 v[136:139], v33 offset:18432
    v_mfma_f32_16x16x32_bf16 v[52:55], a[96:99], v[140:143], v[52:55]
    buffer_load_dwordx4 v2, s[4:7], s78 offen offset:3072 sc1 lds
    v_mfma_f32_16x16x32_bf16 v[56:59], a[100:103], v[140:143], v[56:59]
    s_add_u32 m0, s83, 16384
    v_mfma_f32_16x16x32_bf16 v[60:63], a[104:107], v[140:143], v[60:63]
    v_mfma_f32_16x16x32_bf16 v[64:67], a[108:111], v[140:143], v[64:67]
    s_waitcnt lgkmcnt(2)
    buffer_load_dwordx4 v3, s[4:7], s79 offen offset:0 sc1 lds
    v_mfma_f32_16x16x32_bf16 v[68:71], a[112:115], v[128:131], v[68:71]
    s_add_u32 m0, s83, 16384
    s_waitcnt vmcnt(13)
    ds_read_b128 v[140:143], v33 offset:19456
    v_mfma_f32_16x16x32_bf16 v[72:75], a[116:119], v[128:131], v[72:75]
    v_mfma_f32_16x16x32_bf16 v[76:79], a[120:123], v[128:131], v[76:79]
    v_mfma_f32_16x16x32_bf16 v[80:83], a[124:127], v[128:131], v[80:83]
    buffer_load_dwordx4 v3, s[4:7], s79 offen offset:1024 sc1 lds
    v_mfma_f32_16x16x32_bf16 v[84:87], a[128:131], v[128:131], v[84:87]
    s_waitcnt lgkmcnt(2)
    v_mfma_f32_16x16x32_bf16 v[88:91], a[112:115], v[132:135], v[88:91]
    s_add_u32 m0, s83, 16384
    s_waitcnt vmcnt(13)
    ds_read_b128 v[128:131], v33 offset:0
    v_mfma_f32_16x16x32_bf16 v[92:95], a[116:119], v[132:135], v[92:95]
    buffer_load_dwordx4 v3, s[4:7], s79 offen offset:2048 sc1 lds
    v_mfma_f32_16x16x32_bf16 v[96:99], a[120:123], v[132:135], v[96:99]
    s_add_u32 m0, s83, 16384
    v_mfma_f32_16x16x32_bf16 v[100:103], a[124:127], v[132:135], v[100:103]
    v_mfma_f32_16x16x32_bf16 v[104:107], a[128:131], v[132:135], v[104:107]
    s_waitcnt lgkmcnt(2)
    v_mfma_f32_16x16x32_bf16 v[108:111], a[112:115], v[136:139], v[108:111]
    s_waitcnt vmcnt(13)
    ds_read_b128 v[132:135], v33 offset:1024
    v_mfma_f32_16x16x32_bf16 v[112:115], a[116:119], v[136:139], v[112:115]
    buffer_load_dwordx4 v3, s[4:7], s79 offen offset:3072 sc1 lds
    v_mfma_f32_16x16x32_bf16 v[116:119], a[120:123], v[136:139], v[116:119]
    s_add_u32 m0, s83, 20480
    v_mfma_f32_16x16x32_bf16 v[120:123], a[124:127], v[136:139], v[120:123]
    v_mfma_f32_16x16x32_bf16 v[124:127], a[128:131], v[136:139], v[124:127]
    s_waitcnt lgkmcnt(2)
    buffer_load_dwordx4 v3, s[4:7], s80 offen offset:0 sc1 lds
    v_mfma_f32_16x16x32_bf16 v[48:51], a[112:115], v[140:143], v[48:51]
    s_add_u32 m0, s83, 20480
    s_waitcnt vmcnt(14)
    ds_read_b128 v[136:139], v33 offset:2048
    v_mfma_f32_16x16x32_bf16 v[52:55], a[116:119], v[140:143], v[52:55]
    v_mfma_f32_16x16x32_bf16 v[56:59], a[120:123], v[140:143], v[56:59]
    buffer_load_dwordx4 v3, s[4:7], s80 offen offset:1024 sc1 lds
    v_mfma_f32_16x16x32_bf16 v[60:63], a[124:127], v[140:143], v[60:63]
    s_add_u32 m0, s83, 20480
    v_mfma_f32_16x16x32_bf16 v[64:67], a[128:131], v[140:143], v[64:67]
    s_waitcnt lgkmcnt(2)
    v_mfma_f32_16x16x32_bf16 v[68:71], a[132:135], v[128:131], v[68:71]
    s_waitcnt vmcnt(14)
    ds_read_b128 v[140:143], v33 offset:3072
    v_mfma_f32_16x16x32_bf16 v[72:75], a[136:139], v[128:131], v[72:75]
    buffer_load_dwordx4 v3, s[4:7], s80 offen offset:2048 sc1 lds
    v_mfma_f32_16x16x32_bf16 v[76:79], a[140:143], v[128:131], v[76:79]
    s_add_u32 m0, s83, 20480
    v_mfma_f32_16x16x32_bf16 v[80:83], a[144:147], v[128:131], v[80:83]
    v_mfma_f32_16x16x32_bf16 v[84:87], a[148:151], v[128:131], v[84:87]
    s_waitcnt lgkmcnt(2)
    buffer_load_dwordx4 v3, s[4:7], s80 offen offset:3072 sc1 lds
    v_mfma_f32_16x16x32_bf16 v[88:91], a[132:135], v[132:135], v[88:91]
    s_add_u32 m0, s83, 4096
    s_waitcnt vmcnt(15)
    ds_read_b128 v[128:131], v33 offset:4096
    v_mfma_f32_16x16x32_bf16 v[92:95], a[136:139], v[132:135], v[92:95]
    v_mfma_f32_16x16x32_bf16 v[96:99], a[140:143], v[132:135], v[96:99]
    v_mfma_f32_16x16x32_bf16 v[100:103], a[144:147], v[132:135], v[100:103]
    buffer_load_dwordx4 v3, s[4:7], s81 offen offset:0 sc1 lds
    v_mfma_f32_16x16x32_bf16 v[104:107], a[148:151], v[132:135], v[104:107]
    s_waitcnt lgkmcnt(2)
    v_mfma_f32_16x16x32_bf16 v[108:111], a[132:135], v[136:139], v[108:111]
    s_add_u32 m0, s83, 4096
    s_waitcnt vmcnt(15)
    ds_read_b128 v[132:135], v33 offset:5120
    v_mfma_f32_16x16x32_bf16 v[112:115], a[136:139], v[136:139], v[112:115]
    buffer_load_dwordx4 v3, s[4:7], s81 offen offset:1024 sc1 lds
    v_mfma_f32_16x16x32_bf16 v[116:119], a[140:143], v[136:139], v[116:119]
    s_add_u32 m0, s83, 4096
    v_mfma_f32_16x16x32_bf16 v[120:123], a[144:147], v[136:139], v[120:123]
    v_mfma_f32_16x16x32_bf16 v[124:127], a[148:151], v[136:139], v[124:127]
    s_waitcnt lgkmcnt(2)
    v_mfma_f32_16x16x32_bf16 v[48:51], a[132:135], v[140:143], v[48:51]
    s_waitcnt vmcnt(15)
    ds_read_b128 v[136:139], v33 offset:6144
    v_mfma_f32_16x16x32_bf16 v[52:55], a[136:139], v[140:143], v[52:55]
    buffer_load_dwordx4 v3, s[4:7], s81 offen offset:2048 sc1 lds
    v_mfma_f32_16x16x32_bf16 v[56:59], a[140:143], v[140:143], v[56:59]
    s_add_u32 m0, s83, 4096
    v_mfma_f32_16x16x32_bf16 v[60:63], a[144:147], v[140:143], v[60:63]
    v_mfma_f32_16x16x32_bf16 v[64:67], a[148:151], v[140:143], v[64:67]
    s_waitcnt lgkmcnt(2)
    buffer_load_dwordx4 v3, s[4:7], s81 offen offset:3072 sc1 lds
    v_mfma_f32_16x16x32_bf16 v[68:71], a[152:155], v[128:131], v[68:71]
    s_add_u32 m0, s83, 8192
    s_waitcnt vmcnt(16)
    ds_read_b128 v[140:143], v33 offset:7168
    v_mfma_f32_16x16x32_bf16 v[72:75], a[156:159], v[128:131], v[72:75]
    v_mfma_f32_16x16x32_bf16 v[76:79], a[252:255], v[128:131], v[76:79]
    buffer_load_dwordx4 v3, s[4:7], s78 offen offset:0 sc1 lds
    v_mfma_f32_16x16x32_bf16 v[80:83], v[252:255], v[128:131], v[80:83]
    v_mfma_f32_16x16x32_bf16 v[84:87], a[192:195], v[128:131], v[84:87]
    s_waitcnt lgkmcnt(2)
    v_mfma_f32_16x16x32_bf16 v[88:91], a[152:155], v[132:135], v[88:91]
    s_add_u32 m0, s83, 8192
    s_waitcnt vmcnt(16)
    ds_read_b128 v[128:131], v33 offset:8192
    v_mfma_f32_16x16x32_bf16 v[92:95], a[156:159], v[132:135], v[92:95]
    buffer_load_dwordx4 v3, s[4:7], s78 offen offset:1024 sc1 lds
    v_mfma_f32_16x16x32_bf16 v[96:99], a[252:255], v[132:135], v[96:99]
    v_mfma_f32_16x16x32_bf16 v[100:103], v[252:255], v[132:135], v[100:103]
    v_mfma_f32_16x16x32_bf16 v[104:107], a[192:195], v[132:135], v[104:107]
    s_waitcnt lgkmcnt(2)
    v_mfma_f32_16x16x32_bf16 v[108:111], a[152:155], v[136:139], v[108:111]
    s_add_u32 m0, s83, 8192
    s_waitcnt vmcnt(16)
    ds_read_b128 v[132:135], v33 offset:9216
    v_mfma_f32_16x16x32_bf16 v[112:115], a[156:159], v[136:139], v[112:115]
    buffer_load_dwordx4 v3, s[4:7], s78 offen offset:2048 sc1 lds
    v_mfma_f32_16x16x32_bf16 v[116:119], a[252:255], v[136:139], v[116:119]
    v_mfma_f32_16x16x32_bf16 v[120:123], v[252:255], v[136:139], v[120:123]
    v_mfma_f32_16x16x32_bf16 v[124:127], a[192:195], v[136:139], v[124:127]
    s_waitcnt lgkmcnt(2)
    v_mfma_f32_16x16x32_bf16 v[48:51], a[152:155], v[140:143], v[48:51]
    s_add_u32 m0, s83, 8192
    s_waitcnt vmcnt(16)
    ds_read_b128 v[136:139], v33 offset:10240
    v_mfma_f32_16x16x32_bf16 v[52:55], a[156:159], v[140:143], v[52:55]
    buffer_load_dwordx4 v3, s[4:7], s78 offen offset:3072 sc1 lds
    v_mfma_f32_16x16x32_bf16 v[56:59], a[252:255], v[140:143], v[56:59]
    v_mfma_f32_16x16x32_bf16 v[60:63], v[252:255], v[140:143], v[60:63]
    v_mfma_f32_16x16x32_bf16 v[64:67], a[192:195], v[140:143], v[64:67]
    s_waitcnt lgkmcnt(2)
    v_mfma_f32_16x16x32_bf16 v[68:71], a[196:199], v[128:131], v[68:71]
    s_waitcnt vmcnt(16)
    ds_read_b128 v[140:143], v33 offset:11264
    v_mfma_f32_16x16x32_bf16 v[72:75], a[200:203], v[128:131], v[72:75]
    v_mfma_f32_16x16x32_bf16 v[76:79], a[204:207], v[128:131], v[76:79]
    v_mfma_f32_16x16x32_bf16 v[80:83], a[208:211], v[128:131], v[80:83]
    v_mfma_f32_16x16x32_bf16 v[84:87], a[212:215], v[128:131], v[84:87]
    s_waitcnt lgkmcnt(2)
    v_mfma_f32_16x16x32_bf16 v[88:91], a[196:199], v[132:135], v[88:91]
    s_waitcnt vmcnt(15)
    ds_read_b128 v[128:131], v33 offset:12288
    v_mfma_f32_16x16x32_bf16 v[92:95], a[200:203], v[132:135], v[92:95]
    v_mfma_f32_16x16x32_bf16 v[96:99], a[204:207], v[132:135], v[96:99]
    v_mfma_f32_16x16x32_bf16 v[100:103], a[208:211], v[132:135], v[100:103]
    v_mfma_f32_16x16x32_bf16 v[104:107], a[212:215], v[132:135], v[104:107]
    s_waitcnt lgkmcnt(2)
    v_mfma_f32_16x16x32_bf16 v[108:111], a[196:199], v[136:139], v[108:111]
    s_waitcnt vmcnt(14)
    ds_read_b128 v[132:135], v33 offset:13312
    v_mfma_f32_16x16x32_bf16 v[112:115], a[200:203], v[136:139], v[112:115]
    v_mfma_f32_16x16x32_bf16 v[116:119], a[204:207], v[136:139], v[116:119]
    v_mfma_f32_16x16x32_bf16 v[120:123], a[208:211], v[136:139], v[120:123]
    v_mfma_f32_16x16x32_bf16 v[124:127], a[212:215], v[136:139], v[124:127]
    s_waitcnt lgkmcnt(2)
    v_mfma_f32_16x16x32_bf16 v[48:51], a[196:199], v[140:143], v[48:51]
    s_waitcnt vmcnt(13)
    ds_read_b128 v[136:139], v33 offset:14336
    v_mfma_f32_16x16x32_bf16 v[52:55], a[200:203], v[140:143], v[52:55]
    v_mfma_f32_16x16x32_bf16 v[56:59], a[204:207], v[140:143], v[56:59]
    v_mfma_f32_16x16x32_bf16 v[60:63], a[208:211], v[140:143], v[60:63]
    v_mfma_f32_16x16x32_bf16 v[64:67], a[212:215], v[140:143], v[64:67]
    s_waitcnt lgkmcnt(2)
    v_mfma_f32_16x16x32_bf16 v[68:71], a[216:219], v[128:131], v[68:71]
    s_waitcnt vmcnt(12)
    ds_read_b128 v[140:143], v33 offset:15360
    v_mfma_f32_16x16x32_bf16 v[72:75], a[220:223], v[128:131], v[72:75]
    v_mfma_f32_16x16x32_bf16 v[76:79], a[224:227], v[128:131], v[76:79]
    v_mfma_f32_16x16x32_bf16 v[80:83], a[228:231], v[128:131], v[80:83]
    v_mfma_f32_16x16x32_bf16 v[84:87], a[232:235], v[128:131], v[84:87]
    s_waitcnt lgkmcnt(2)
    v_mfma_f32_16x16x32_bf16 v[68:71], a[236:239], v[132:135], v[68:71]
    s_waitcnt vmcnt(11)
    ds_read_b128 v[128:131], v33 offset:16384
    v_mfma_f32_16x16x32_bf16 v[72:75], a[240:243], v[132:135], v[72:75]
    v_mfma_f32_16x16x32_bf16 v[76:79], v[248:251], v[132:135], v[76:79]
    v_mfma_f32_16x16x32_bf16 v[80:83], v[244:247], v[132:135], v[80:83]
    v_mfma_f32_16x16x32_bf16 v[84:87], v[240:243], v[132:135], v[84:87]
    s_waitcnt lgkmcnt(2)
    v_mfma_f32_16x16x32_bf16 v[68:71], v[236:239], v[136:139], v[68:71]
    s_waitcnt vmcnt(10)
    ds_read_b128 v[132:135], v33 offset:17408
    v_mfma_f32_16x16x32_bf16 v[72:75], v[232:235], v[136:139], v[72:75]
    v_mfma_f32_16x16x32_bf16 v[76:79], v[228:231], v[136:139], v[76:79]
    v_mfma_f32_16x16x32_bf16 v[80:83], v[224:227], v[136:139], v[80:83]
    v_mfma_f32_16x16x32_bf16 v[84:87], v[220:223], v[136:139], v[84:87]
    s_waitcnt lgkmcnt(2)
    v_mfma_f32_16x16x32_bf16 v[68:71], v[216:219], v[140:143], v[68:71]
    s_waitcnt vmcnt(9)
    ds_read_b128 v[136:139], v33 offset:18432
    v_mfma_f32_16x16x32_bf16 v[72:75], v[212:215], v[140:143], v[72:75]
    v_mfma_f32_16x16x32_bf16 v[76:79], v[208:211], v[140:143], v[76:79]
    v_mfma_f32_16x16x32_bf16 v[80:83], v[204:207], v[140:143], v[80:83]
    v_mfma_f32_16x16x32_bf16 v[84:87], v[200:203], v[140:143], v[84:87]
    s_waitcnt lgkmcnt(2)
    v_mfma_f32_16x16x32_bf16 v[88:91], a[216:219], v[128:131], v[88:91]
    s_waitcnt vmcnt(8)
    ds_read_b128 v[140:143], v33 offset:19456
    v_mfma_f32_16x16x32_bf16 v[92:95], a[220:223], v[128:131], v[92:95]
    v_mfma_f32_16x16x32_bf16 v[96:99], a[224:227], v[128:131], v[96:99]
    ds_write_b128 v20, v[68:71] offset:0
    v_mfma_f32_16x16x32_bf16 v[100:103], a[228:231], v[128:131], v[100:103]
    v_mfma_f32_16x16x32_bf16 v[104:107], a[232:235], v[128:131], v[104:107]
    s_waitcnt lgkmcnt(3)
    v_mfma_f32_16x16x32_bf16 v[88:91], a[236:239], v[132:135], v[88:91]
    s_waitcnt vmcnt(7)
    ds_read_b128 v[128:131], v33 offset:0
    v_mfma_f32_16x16x32_bf16 v[92:95], a[240:243], v[132:135], v[92:95]
    ds_write_b128 v20, v[72:75] offset:1024
    v_mfma_f32_16x16x32_bf16 v[96:99], v[248:251], v[132:135], v[96:99]
    v_mfma_f32_16x16x32_bf16 v[100:103], v[244:247], v[132:135], v[100:103]
    v_mfma_f32_16x16x32_bf16 v[104:107], v[240:243], v[132:135], v[104:107]
    s_waitcnt lgkmcnt(4)
    ds_write_b128 v20, v[76:79] offset:2048
    v_mfma_f32_16x16x32_bf16 v[88:91], v[236:239], v[136:139], v[88:91]
    s_waitcnt vmcnt(6)
    ds_read_b128 v[132:135], v33 offset:1024
    v_mfma_f32_16x16x32_bf16 v[92:95], v[232:235], v[136:139], v[92:95]
    v_mfma_f32_16x16x32_bf16 v[96:99], v[228:231], v[136:139], v[96:99]
    ds_write_b128 v20, v[80:83] offset:3072
    v_mfma_f32_16x16x32_bf16 v[100:103], v[224:227], v[136:139], v[100:103]
    v_mfma_f32_16x16x32_bf16 v[104:107], v[220:223], v[136:139], v[104:107]
    s_waitcnt lgkmcnt(6)
    v_mfma_f32_16x16x32_bf16 v[88:91], v[216:219], v[140:143], v[88:91]
    s_waitcnt vmcnt(5)
    ds_read_b128 v[136:139], v33 offset:2048
    v_mfma_f32_16x16x32_bf16 v[92:95], v[212:215], v[140:143], v[92:95]
    ds_write_b128 v20, v[84:87] offset:4096
    v_mfma_f32_16x16x32_bf16 v[96:99], v[208:211], v[140:143], v[96:99]
    v_mfma_f32_16x16x32_bf16 v[100:103], v[204:207], v[140:143], v[100:103]
    v_mfma_f32_16x16x32_bf16 v[104:107], v[200:203], v[140:143], v[104:107]
    s_waitcnt lgkmcnt(6)
    v_mfma_f32_16x16x32_bf16 v[108:111], a[216:219], v[128:131], v[108:111]
    s_waitcnt vmcnt(4)
    ds_read_b128 v[140:143], v33 offset:3072
    v_mfma_f32_16x16x32_bf16 v[112:115], a[220:223], v[128:131], v[112:115]
    v_mfma_f32_16x16x32_bf16 v[116:119], a[224:227], v[128:131], v[116:119]
    ds_write_b128 v21, v[88:91] offset:0
    v_mfma_f32_16x16x32_bf16 v[120:123], a[228:231], v[128:131], v[120:123]
    v_mfma_f32_16x16x32_bf16 v[124:127], a[232:235], v[128:131], v[124:127]
    s_waitcnt lgkmcnt(5)
    v_mfma_f32_16x16x32_bf16 v[108:111], a[236:239], v[132:135], v[108:111]
    s_waitcnt vmcnt(3)
    ds_read_b128 v[128:131], v33 offset:4096
    v_mfma_f32_16x16x32_bf16 v[112:115], a[240:243], v[132:135], v[112:115]
    ds_write_b128 v21, v[92:95] offset:1024
    v_mfma_f32_16x16x32_bf16 v[116:119], v[248:251], v[132:135], v[116:119]
    v_mfma_f32_16x16x32_bf16 v[120:123], v[244:247], v[132:135], v[120:123]
    v_mfma_f32_16x16x32_bf16 v[124:127], v[240:243], v[132:135], v[124:127]
    s_waitcnt lgkmcnt(5)
    ds_write_b128 v21, v[96:99] offset:2048
    v_mfma_f32_16x16x32_bf16 v[108:111], v[236:239], v[136:139], v[108:111]
    s_waitcnt vmcnt(2)
    ds_read_b128 v[132:135], v33 offset:5120
    v_mfma_f32_16x16x32_bf16 v[112:115], v[232:235], v[136:139], v[112:115]
    v_mfma_f32_16x16x32_bf16 v[116:119], v[228:231], v[136:139], v[116:119]
    ds_write_b128 v21, v[100:103] offset:3072
    v_mfma_f32_16x16x32_bf16 v[120:123], v[224:227], v[136:139], v[120:123]
    v_mfma_f32_16x16x32_bf16 v[124:127], v[220:223], v[136:139], v[124:127]
    s_waitcnt lgkmcnt(6)
    v_mfma_f32_16x16x32_bf16 v[108:111], v[216:219], v[140:143], v[108:111]
    s_waitcnt vmcnt(1)
    ds_read_b128 v[136:139], v33 offset:6144
    v_mfma_f32_16x16x32_bf16 v[112:115], v[212:215], v[140:143], v[112:115]
    ds_write_b128 v21, v[104:107] offset:4096
    v_mfma_f32_16x16x32_bf16 v[116:119], v[208:211], v[140:143], v[116:119]
    v_mfma_f32_16x16x32_bf16 v[120:123], v[204:207], v[140:143], v[120:123]
    v_mfma_f32_16x16x32_bf16 v[124:127], v[200:203], v[140:143], v[124:127]
    s_waitcnt lgkmcnt(6)
    s_waitcnt lgkmcnt(0)
    s_barrier
    v_mfma_f32_16x16x32_bf16 v[48:51], a[216:219], v[128:131], v[48:51]
    s_waitcnt vmcnt(0)
    ds_read_b128 v[140:143], v33 offset:7168
    ds_read_b128 v[68:71], v23 offset:0
    v_mfma_f32_16x16x32_bf16 v[52:55], a[220:223], v[128:131], v[52:55]
    ds_read_b128 v[88:91], v23 offset:5120
    v_mfma_f32_16x16x32_bf16 v[56:59], a[224:227], v[128:131], v[56:59]
    ds_write_b128 v22, v[108:111] offset:0
    v_mfma_f32_16x16x32_bf16 v[60:63], a[228:231], v[128:131], v[60:63]
    ds_read_b128 v[72:75], v23 offset:1024
    ds_read_b128 v[92:95], v23 offset:6144
    v_mfma_f32_16x16x32_bf16 v[64:67], a[232:235], v[128:131], v[64:67]
    ds_write_b128 v22, v[112:115] offset:1024
    v_mfma_f32_16x16x32_bf16 v[48:51], a[236:239], v[132:135], v[48:51]
    ds_read_b128 v[76:79], v23 offset:2048
    ds_read_b128 v[96:99], v23 offset:7168
    v_mfma_f32_16x16x32_bf16 v[52:55], a[240:243], v[132:135], v[52:55]
    ds_write_b128 v22, v[116:119] offset:2048
    v_mfma_f32_16x16x32_bf16 v[56:59], v[248:251], v[132:135], v[56:59]
    ds_read_b128 v[80:83], v23 offset:3072
    ds_read_b128 v[100:103], v23 offset:8192
    v_mfma_f32_16x16x32_bf16 v[60:63], v[244:247], v[132:135], v[60:63]
    ds_write_b128 v22, v[120:123] offset:3072
    v_mfma_f32_16x16x32_bf16 v[64:67], v[240:243], v[132:135], v[64:67]
    ds_read_b128 v[84:87], v23 offset:4096
    ds_read_b128 v[104:107], v23 offset:9216
    v_mfma_f32_16x16x32_bf16 v[48:51], v[236:239], v[136:139], v[48:51]
    ds_write_b128 v22, v[124:127] offset:4096
    v_mfma_f32_16x16x32_bf16 v[52:55], v[232:235], v[136:139], v[52:55]
    s_waitcnt lgkmcnt(13)
    v_add_f32 v68, v68, v88
    v_add_f32 v69, v69, v89
    v_mfma_f32_16x16x32_bf16 v[56:59], v[228:231], v[136:139], v[56:59]
    v_add_f32 v70, v70, v90
    v_add_f32 v71, v71, v91
    v_mfma_f32_16x16x32_bf16 v[60:63], v[224:227], v[136:139], v[60:63]
    s_waitcnt lgkmcnt(10)
    v_add_f32 v72, v72, v92
    v_add_f32 v73, v73, v93
    v_mfma_f32_16x16x32_bf16 v[64:67], v[220:223], v[136:139], v[64:67]
    v_add_f32 v74, v74, v94
    v_add_f32 v75, v75, v95
    v_mfma_f32_16x16x32_bf16 v[48:51], v[216:219], v[140:143], v[48:51]
    s_waitcnt lgkmcnt(7)
    v_add_f32 v76, v76, v96
    v_add_f32 v77, v77, v97
    v_mfma_f32_16x16x32_bf16 v[52:55], v[212:215], v[140:143], v[52:55]
    v_add_f32 v78, v78, v98
    v_add_f32 v79, v79, v99
    v_mfma_f32_16x16x32_bf16 v[56:59], v[208:211], v[140:143], v[56:59]
    s_waitcnt lgkmcnt(4)
    v_add_f32 v80, v80, v100
    v_add_f32 v81, v81, v101
    v_mfma_f32_16x16x32_bf16 v[60:63], v[204:207], v[140:143], v[60:63]
    v_add_f32 v82, v82, v102
    v_add_f32 v83, v83, v103
    v_mfma_f32_16x16x32_bf16 v[64:67], v[200:203], v[140:143], v[64:67]
    s_waitcnt lgkmcnt(1)
    v_add_f32 v84, v84, v104
    v_add_f32 v85, v85, v105
    s_waitcnt lgkmcnt(0)
    s_barrier
    ds_read_b128 v[108:111], v23 offset:10240
    ds_read_b128 v[112:115], v23 offset:11264
    ds_read_b128 v[116:119], v23 offset:12288
    ds_read_b128 v[120:123], v23 offset:13312
    ds_read_b128 v[124:127], v23 offset:14336
    v_add_f32 v86, v86, v106
    v_add_f32 v87, v87, v107
    v_pk_add_f32 v[48:49], v[48:49], v[68:69]
    v_pk_add_f32 v[50:51], v[50:51], v[70:71]
    v_pk_add_f32 v[52:53], v[52:53], v[72:73]
    v_pk_add_f32 v[54:55], v[54:55], v[74:75]
    v_pk_add_f32 v[56:57], v[56:57], v[76:77]
    v_pk_add_f32 v[58:59], v[58:59], v[78:79]
    v_pk_add_f32 v[60:61], v[60:61], v[80:81]
    v_pk_add_f32 v[62:63], v[62:63], v[82:83]
    v_pk_add_f32 v[64:65], v[64:65], v[84:85]
    v_pk_add_f32 v[66:67], v[66:67], v[86:87]
    s_waitcnt lgkmcnt(4)
    v_pk_add_f32 v[48:49], v[48:49], v[108:109]
    v_pk_add_f32 v[50:51], v[50:51], v[110:111]
    v_cvt_pk_bf16_f32 v36, v48, v49
    v_cvt_pk_bf16_f32 v37, v50, v51
    s_waitcnt lgkmcnt(3)
    v_pk_add_f32 v[52:53], v[52:53], v[112:113]
    v_pk_add_f32 v[54:55], v[54:55], v[114:115]
    v_cvt_pk_bf16_f32 v38, v52, v53
    v_cvt_pk_bf16_f32 v39, v54, v55
    buffer_store_dwordx4 v[36:39], v144, s[8:11], s91 offen
    s_waitcnt lgkmcnt(2)
    v_pk_add_f32 v[56:57], v[56:57], v[116:117]
    v_pk_add_f32 v[58:59], v[58:59], v[118:119]
    v_cvt_pk_bf16_f32 v40, v56, v57
    v_cvt_pk_bf16_f32 v41, v58, v59
    s_waitcnt lgkmcnt(1)
    v_pk_add_f32 v[60:61], v[60:61], v[120:121]
    v_pk_add_f32 v[62:63], v[62:63], v[122:123]
    v_cvt_pk_bf16_f32 v42, v60, v61
    v_cvt_pk_bf16_f32 v43, v62, v63
    buffer_store_dwordx4 v[40:43], v144, s[8:11], s91 offen offset:64
    s_waitcnt lgkmcnt(0)
    v_pk_add_f32 v[64:65], v[64:65], v[124:125]
    v_pk_add_f32 v[66:67], v[66:67], v[126:127]
    v_cvt_pk_bf16_f32 v44, v64, v65
    v_cvt_pk_bf16_f32 v45, v66, v67
    buffer_store_dwordx2 v[44:45], v145, s[8:11], s92 offen
    s_endpgm
pollr_1:
    buffer_load_dword v29, v5, s[4:7], s101 offen sc1
    s_sub_u32 s29, s29, 1
    s_waitcnt vmcnt(0)
    s_cbranch_scc0 poll_2
    s_endpgm
pollr_5:
    buffer_load_dword v29, v5, s[4:7], s87 offen sc1
    s_sub_u32 s29, s29, 1
    s_waitcnt vmcnt(0)
    s_cbranch_scc0 poll_6
    s_endpgm
pubs_9:
    buffer_wbl2 sc1
    s_waitcnt vmcnt(0)
    buffer_store_dword v30, off, s[4:7], s32 sc1
    s_branch pubd_10
pollr_11:
    buffer_load_dword v29, v5, s[4:7], s31 offen sc1
    s_sub_u32 s29, s29, 1
    s_waitcnt vmcnt(0)
    s_cbranch_scc0 poll_12
    s_endpgm
acq_13:
    buffer_inv sc1
    s_waitcnt vmcnt(0)
    s_branch polld_14
pubs_15:
    buffer_wbl2 sc1
    s_waitcnt vmcnt(0)
    buffer_store_dword v30, off, s[4:7], s32 sc1
    s_branch pubd_16
pubs_17:
    buffer_wbl2 sc1
    s_waitcnt vmcnt(0)
    buffer_store_dword v30, off, s[4:7], s32 sc1
    s_branch pubd_18
pollr_19:
    buffer_load_dword v29, v5, s[4:7], s31 offen sc1
    s_sub_u32 s29, s29, 1
    s_waitcnt vmcnt(0)
    s_cbranch_scc0 poll_20
    s_endpgm
acq_21:
    buffer_inv sc1
    s_waitcnt vmcnt(0)
    s_branch polld_22
pollr_23:
    buffer_load_dword v29, v5, s[4:7], s31 offen sc1
    s_sub_u32 s29, s29, 1
    s_waitcnt vmcnt(0)
    s_cbranch_scc0 poll_24
    s_endpgm
acq_25:
    buffer_inv sc1
    s_waitcnt vmcnt(0)
    s_branch polld_26
pubs_27:
    buffer_wbl2 sc1
    s_waitcnt vmcnt(0)
    buffer_store_dword v30, off, s[4:7], s32 sc1
    s_branch pubd_28
pollr_29:
    buffer_load_dword v29, v5, s[4:7], s31 offen sc1
    s_sub_u32 s29, s29, 1
    s_waitcnt vmcnt(0)
    s_cbranch_scc0 poll_30
    s_endpgm
acq_31:
    buffer_inv sc1
    s_waitcnt vmcnt(0)
    s_branch polld_32
pubs_33:
    buffer_wbl2 sc1
    s_waitcnt vmcnt(0)
    buffer_store_dword v30, off, s[4:7], s32 sc1
    s_branch pubd_34
pubs_35:
    buffer_wbl2 sc1
    s_waitcnt vmcnt(0)
    buffer_store_dword v30, off, s[4:7], s32 sc1
    s_branch pubd_36
pollr_37:
    buffer_load_dword v29, v5, s[4:7], s31 offen sc1
    s_sub_u32 s29, s29, 1
    s_waitcnt vmcnt(0)
    s_cbranch_scc0 poll_38
    s_endpgm
acq_39:
    buffer_inv sc1
    s_waitcnt vmcnt(0)
    s_branch polld_40
pollr_41:
    buffer_load_dword v29, v5, s[4:7], s31 offen sc1
    s_sub_u32 s29, s29, 1
    s_waitcnt vmcnt(0)
    s_cbranch_scc0 poll_42
    s_endpgm
acq_43:
    buffer_inv sc1
    s_waitcnt vmcnt(0)
    s_branch polld_44
pollr_45:
    buffer_load_dword v29, v5, s[4:7], s87 offen sc1
    s_sub_u32 s29, s29, 1
    s_waitcnt vmcnt(0)
    s_cbranch_scc0 poll_46
    s_endpgm
pubs_49:
    buffer_wbl2 sc1
    s_waitcnt vmcnt(0)
    buffer_store_dword v30, off, s[4:7], s32 sc1
    s_branch pubd_50
pollr_51:
    buffer_load_dword v29, v5, s[4:7], s31 offen sc1
    s_sub_u32 s29, s29, 1
    s_waitcnt vmcnt(0)
    s_cbranch_scc0 poll_52
    s_endpgm
acq_53:
    buffer_inv sc1
    s_waitcnt vmcnt(0)
    s_branch polld_54
pubs_55:
    buffer_wbl2 sc1
    s_waitcnt vmcnt(0)
    buffer_store_dword v30, off, s[4:7], s32 sc1
    s_branch pubd_56
pubs_57:
    buffer_wbl2 sc1
    s_waitcnt vmcnt(0)
    buffer_store_dword v30, off, s[4:7], s32 sc1
    s_branch pubd_58
pollr_59:
    buffer_load_dword v29, v5, s[4:7], s31 offen sc1
    s_sub_u32 s29, s29, 1
    s_waitcnt vmcnt(0)
    s_cbranch_scc0 poll_60
    s_endpgm
acq_61:
    buffer_inv sc1
    s_waitcnt vmcnt(0)
    s_branch polld_62
pollr_63:
    buffer_load_dword v29, v5, s[4:7], s31 offen sc1
    s_sub_u32 s29, s29, 1
    s_waitcnt vmcnt(0)
    s_cbranch_scc0 poll_64
    s_endpgm
acq_65:
    buffer_inv sc1
    s_waitcnt vmcnt(0)
    s_branch polld_66
pubs_67:
    buffer_wbl2 sc1
    s_waitcnt vmcnt(0)
    buffer_store_dword v30, off, s[4:7], s32 sc1
    s_branch pubd_68
pollr_69:
    buffer_load_dword v29, v5, s[4:7], s31 offen sc1
    s_sub_u32 s29, s29, 1
    s_waitcnt vmcnt(0)
    s_cbranch_scc0 poll_70
    s_endpgm
acq_71:
    buffer_inv sc1
    s_waitcnt vmcnt(0)
    s_branch polld_72
pubs_73:
    buffer_wbl2 sc1
    s_waitcnt vmcnt(0)
    buffer_store_dword v30, off, s[4:7], s32 sc1
    s_branch pubd_74
main_typeb:
prog_1:
    s_getpc_b64 s[20:21]
    s_mov_b32 s22, main_end-prog_1-4
    s_mov_b32 s23, 0x20000
    s_waitcnt vmcnt(18)
    s_barrier
    ds_read_b128 v[96:99], v9 offset:40960
    ds_read_b128 v[100:103], v9 offset:0
    ds_read_b128 v[104:107], v9 offset:41472
    ds_read_b128 v[108:111], v9 offset:512
    ds_read_b128 v[112:115], v9 offset:41984
    ds_read_b128 v[116:119], v9 offset:1024
    s_waitcnt lgkmcnt(4)
    v_mfma_f32_32x32x16_bf16 v[48:63], a[0:3], v[96:99], 0
    s_add_u32 s99, s99, 4096
    ds_read_b128 v[120:123], v9 offset:42496
    buffer_load_dwordx4 a[64:67], v165, s[4:7], s99 offen offset:0
    v_mfma_f32_32x32x16_bf16 v[64:79], a[0:3], v[100:103], 0
    s_waitcnt lgkmcnt(3)
    ds_read_b128 v[124:127], v9 offset:1536
    buffer_load_dwordx4 a[68:71], v165, s[4:7], s99 offen offset:1024
    v_mfma_f32_32x32x16_bf16 v[48:63], a[4:7], v[104:107], v[48:63]
    s_add_u32 m0, s82, 12288
    ds_read_b128 v[96:99], v9 offset:43008
    buffer_load_dwordx4 v1, s[12:15], m0 offen offset:0 sc1 lds
    v_mfma_f32_32x32x16_bf16 v[64:79], a[4:7], v[108:111], v[64:79]
    s_waitcnt lgkmcnt(3)
    ds_read_b128 v[100:103], v9 offset:2048
    s_add_u32 m0, s82, 13312
    s_nop 0
    buffer_load_dwordx4 v1, s[12:15], m0 offen offset:0 sc1 lds
    s_waitcnt vmcnt(20)
    v_mfma_f32_32x32x16_bf16 v[48:63], a[8:11], v[112:115], v[48:63]
    s_add_u32 m0, s82, 53248
    ds_read_b128 v[104:107], v9 offset:43520
    buffer_load_dwordx4 v1, s[12:15], m0 offen offset:0 sc1 lds
    v_mfma_f32_32x32x16_bf16 v[64:79], a[8:11], v[116:119], v[64:79]
    s_waitcnt lgkmcnt(3)
    ds_read_b128 v[108:111], v9 offset:2560
    v_mfma_f32_32x32x16_bf16 v[48:63], a[12:15], v[120:123], v[48:63]
    s_add_u32 m0, s82, 54272
    ds_read_b128 v[112:115], v9 offset:44032
    buffer_load_dwordx4 v1, s[12:15], m0 offen offset:0 sc1 lds
    v_mfma_f32_32x32x16_bf16 v[64:79], a[12:15], v[124:127], v[64:79]
    s_waitcnt lgkmcnt(3)
    ds_read_b128 v[116:119], v9 offset:3072
    buffer_load_dwordx4 a[72:75], v165, s[4:7], s99 offen offset:2048
    s_waitcnt vmcnt(21)
    v_mfma_f32_32x32x16_bf16 v[48:63], a[16:19], v[96:99], v[48:63]
    ds_read_b128 v[120:123], v9 offset:44544
    buffer_load_dwordx4 a[76:79], v165, s[4:7], s99 offen offset:3072
    v_mfma_f32_32x32x16_bf16 v[64:79], a[16:19], v[100:103], v[64:79]
    s_waitcnt lgkmcnt(3)
    ds_read_b128 v[124:127], v9 offset:3584
    s_add_u32 s99, s99, 4096
    buffer_load_dwordx4 a[80:83], v165, s[4:7], s99 offen offset:0
    v_mfma_f32_32x32x16_bf16 v[48:63], a[20:23], v[104:107], v[48:63]
    s_waitcnt vmcnt(15)
    s_barrier
    ds_read_b128 v[96:99], v9 offset:45056
    buffer_load_dwordx4 a[84:87], v165, s[4:7], s99 offen offset:1024
    v_mfma_f32_32x32x16_bf16 v[64:79], a[20:23], v[108:111], v[64:79]
    s_waitcnt lgkmcnt(3)
    ds_read_b128 v[100:103], v9 offset:4096
    v_mfma_f32_32x32x16_bf16 v[48:63], a[24:27], v[112:115], v[48:63]
    ds_read_b128 v[104:107], v9 offset:45568
    buffer_load_dwordx4 a[88:91], v165, s[4:7], s99 offen offset:2048
    v_mfma_f32_32x32x16_bf16 v[64:79], a[24:27], v[116:119], v[64:79]
    s_waitcnt lgkmcnt(3)
    ds_read_b128 v[108:111], v9 offset:4608
    buffer_load_dwordx4 a[92:95], v165, s[4:7], s99 offen offset:3072
    v_mfma_f32_32x32x16_bf16 v[48:63], a[28:31], v[120:123], v[48:63]
    ds_read_b128 v[112:115], v9 offset:46080
    buffer_load_dwordx4 v[176:179], v197, s[4:7], 0 offen
    v_mfma_f32_32x32x16_bf16 v[64:79], a[28:31], v[124:127], v[64:79]
    s_waitcnt lgkmcnt(3)
    ds_read_b128 v[116:119], v9 offset:5120
    s_mov_b32 s88, 32768
    buffer_load_dwordx4 v[180:183], v200, s[4:7], s88 offen
    v_mfma_f32_32x32x16_bf16 v[48:63], a[32:35], v[96:99], v[48:63]
    s_mov_b32 s88, 65536
    ds_read_b128 v[120:123], v9 offset:46592
    buffer_load_dwordx4 v[184:187], v200, s[4:7], s88 offen
    v_mfma_f32_32x32x16_bf16 v[64:79], a[32:35], v[100:103], v[64:79]
    s_waitcnt lgkmcnt(3)
    ds_read_b128 v[124:127], v9 offset:5632
    v_mfma_f32_32x32x16_bf16 v[48:63], a[36:39], v[104:107], v[48:63]
    s_mov_b32 s88, 98304
    ds_read_b128 v[96:99], v9 offset:47104
    buffer_load_dwordx4 v[188:191], v200, s[4:7], s88 offen
    v_mfma_f32_32x32x16_bf16 v[64:79], a[36:39], v[108:111], v[64:79]
    s_waitcnt lgkmcnt(3)
    ds_read_b128 v[100:103], v9 offset:6144
    s_mov_b32 s88, 131072
    buffer_load_dwordx4 v[192:195], v200, s[4:7], s88 offen
    s_waitcnt vmcnt(21)
    v_mfma_f32_32x32x16_bf16 v[48:63], a[40:43], v[112:115], v[48:63]
    s_add_u32 s88, s98, 0
    ds_read_b128 v[104:107], v9 offset:47616
    buffer_load_dwordx4 v[144:147], v1, s[4:7], s88 offen sc1
    v_mfma_f32_32x32x16_bf16 v[64:79], a[40:43], v[116:119], v[64:79]
    s_waitcnt lgkmcnt(3)
    ds_read_b128 v[108:111], v9 offset:6656
    s_add_u32 s88, s98, 65536
    buffer_load_dwordx4 v[148:151], v1, s[4:7], s88 offen sc1
    v_mfma_f32_32x32x16_bf16 v[48:63], a[44:47], v[120:123], v[48:63]
    s_add_u32 s99, s99, 4096
    ds_read_b128 v[112:115], v9 offset:48128
    buffer_load_dwordx4 a[96:99], v165, s[4:7], s99 offen offset:0
    v_mfma_f32_32x32x16_bf16 v[64:79], a[44:47], v[124:127], v[64:79]
    s_waitcnt lgkmcnt(3)
    ds_read_b128 v[116:119], v9 offset:7168
    s_waitcnt vmcnt(22)
    v_mfma_f32_32x32x16_bf16 v[48:63], a[48:51], v[96:99], v[48:63]
    ds_read_b128 v[120:123], v9 offset:48640
    buffer_load_dwordx4 a[100:103], v165, s[4:7], s99 offen offset:1024
    v_mfma_f32_32x32x16_bf16 v[64:79], a[48:51], v[100:103], v[64:79]
    s_waitcnt lgkmcnt(3)
    ds_read_b128 v[124:127], v9 offset:7680
    s_add_u32 m0, s82, 16384
    s_nop 0
    buffer_load_dwordx4 v1, s[12:15], m0 offen offset:0 sc1 lds
    v_mfma_f32_32x32x16_bf16 v[48:63], a[52:55], v[104:107], v[48:63]
    s_add_u32 m0, s82, 17408
    s_waitcnt vmcnt(16)
    s_barrier
    ds_read_b128 v[96:99], v9 offset:49152
    buffer_load_dwordx4 v1, s[12:15], m0 offen offset:0 sc1 lds
    v_mfma_f32_32x32x16_bf16 v[64:79], a[52:55], v[108:111], v[64:79]
    s_waitcnt lgkmcnt(3)
    ds_read_b128 v[100:103], v9 offset:8192
    s_add_u32 m0, s82, 57344
    s_nop 0
    buffer_load_dwordx4 v1, s[12:15], m0 offen offset:0 sc1 lds
    v_mfma_f32_32x32x16_bf16 v[48:63], a[56:59], v[112:115], v[48:63]
    s_add_u32 m0, s82, 58368
    ds_read_b128 v[104:107], v9 offset:49664
    buffer_load_dwordx4 v1, s[12:15], m0 offen offset:0 sc1 lds
    v_mfma_f32_32x32x16_bf16 v[64:79], a[56:59], v[116:119], v[64:79]
    s_waitcnt lgkmcnt(3)
    ds_read_b128 v[108:111], v9 offset:8704
    v_mfma_f32_32x32x16_bf16 v[48:63], a[60:63], v[120:123], v[48:63]
    ds_read_b128 v[112:115], v9 offset:50176
    buffer_load_dwordx4 a[104:107], v165, s[4:7], s99 offen offset:2048
    v_mfma_f32_32x32x16_bf16 v[64:79], a[60:63], v[124:127], v[64:79]
    s_waitcnt lgkmcnt(3)
    ds_read_b128 v[116:119], v9 offset:9216
    buffer_load_dwordx4 a[108:111], v165, s[4:7], s99 offen offset:3072
    v_mfma_f32_32x32x16_bf16 v[48:63], a[64:67], v[96:99], v[48:63]
    s_add_u32 s99, s99, 4096
    ds_read_b128 v[120:123], v9 offset:50688
    buffer_load_dwordx4 a[112:115], v165, s[4:7], s99 offen offset:0
    v_mfma_f32_32x32x16_bf16 v[64:79], a[64:67], v[100:103], v[64:79]
    s_waitcnt lgkmcnt(3)
    ds_read_b128 v[124:127], v9 offset:9728
    buffer_load_dwordx4 a[116:119], v165, s[4:7], s99 offen offset:1024
    v_mfma_f32_32x32x16_bf16 v[48:63], a[68:71], v[104:107], v[48:63]
    ds_read_b128 v[96:99], v9 offset:51200
    buffer_load_dwordx4 a[120:123], v165, s[4:7], s99 offen offset:2048
    v_mfma_f32_32x32x16_bf16 v[64:79], a[68:71], v[108:111], v[64:79]
    s_waitcnt lgkmcnt(3)
    ds_read_b128 v[100:103], v9 offset:10240
    s_waitcnt vmcnt(22)
    v_mfma_f32_32x32x16_bf16 v[48:63], a[72:75], v[112:115], v[48:63]
    ds_read_b128 v[104:107], v9 offset:51712
    buffer_load_dwordx4 a[124:127], v165, s[4:7], s99 offen offset:3072
    v_mfma_f32_32x32x16_bf16 v[64:79], a[72:75], v[116:119], v[64:79]
    s_waitcnt lgkmcnt(3)
    ds_read_b128 v[108:111], v9 offset:10752
    s_add_u32 s99, s99, 4096
    buffer_load_dwordx4 a[128:131], v165, s[4:7], s99 offen offset:0
    v_mfma_f32_32x32x16_bf16 v[48:63], a[76:79], v[120:123], v[48:63]
    ds_read_b128 v[112:115], v9 offset:52224
    buffer_load_dwordx4 a[132:135], v165, s[4:7], s99 offen offset:1024
    v_mfma_f32_32x32x16_bf16 v[64:79], a[76:79], v[124:127], v[64:79]
    s_waitcnt lgkmcnt(3)
    ds_read_b128 v[116:119], v9 offset:11264
    s_add_u32 m0, s82, 20480
    s_nop 0
    buffer_load_dwordx4 v1, s[12:15], m0 offen offset:0 sc1 lds
    s_waitcnt vmcnt(24)
    v_mfma_f32_32x32x16_bf16 v[48:63], a[80:83], v[96:99], v[48:63]
    s_add_u32 m0, s82, 21504
    ds_read_b128 v[120:123], v9 offset:52736
    buffer_load_dwordx4 v1, s[12:15], m0 offen offset:0 sc1 lds
    s_waitcnt vmcnt(18)
    v_add_f32 v176, v176, v180
    v_add_f32 v177, v177, v181
    v_mfma_f32_32x32x16_bf16 v[64:79], a[80:83], v[100:103], v[64:79]
    s_waitcnt lgkmcnt(3)
    ds_read_b128 v[124:127], v9 offset:11776
    v_add_f32 v178, v178, v182
    v_add_f32 v179, v179, v183
    v_add_f32 v184, v184, v188
    v_add_f32 v185, v185, v189
    v_add_f32 v186, v186, v190
    v_mfma_f32_32x32x16_bf16 v[48:63], a[84:87], v[104:107], v[48:63]
    s_add_u32 m0, s82, 61440
    s_waitcnt vmcnt(10)
    s_barrier
    ds_read_b128 v[96:99], v9 offset:53248
    buffer_load_dwordx4 v1, s[12:15], m0 offen offset:0 sc1 lds
    v_add_f32 v187, v187, v191
    v_mfma_f32_32x32x16_bf16 v[64:79], a[84:87], v[108:111], v[64:79]
    s_waitcnt lgkmcnt(3)
    ds_read_b128 v[100:103], v9 offset:12288
    s_add_u32 m0, s82, 62464
    s_nop 0
    buffer_load_dwordx4 v1, s[12:15], m0 offen offset:0 sc1 lds
    v_add_f32 v176, v176, v192
    v_mfma_f32_32x32x16_bf16 v[48:63], a[88:91], v[112:115], v[48:63]
    ds_read_b128 v[104:107], v9 offset:53760
    buffer_load_dwordx4 a[136:139], v165, s[4:7], s99 offen offset:2048
    v_add_f32 v177, v177, v193
    v_add_f32 v178, v178, v194
    v_add_f32 v179, v179, v195
    v_mfma_f32_32x32x16_bf16 v[64:79], a[88:91], v[116:119], v[64:79]
    s_waitcnt lgkmcnt(3)
    ds_read_b128 v[108:111], v9 offset:12800
    buffer_load_dwordx4 a[140:143], v165, s[4:7], s99 offen offset:3072
    v_add_f32 v176, v176, v184
    v_add_f32 v177, v177, v185
    v_add_f32 v178, v178, v186
    v_mfma_f32_32x32x16_bf16 v[48:63], a[92:95], v[120:123], v[48:63]
    s_add_u32 s99, s99, 4096
    ds_read_b128 v[112:115], v9 offset:54272
    buffer_load_dwordx4 a[144:147], v165, s[4:7], s99 offen offset:0
    v_add_f32 v179, v179, v187
    v_min_u32 v196, 2032, v196
    v_mfma_f32_32x32x16_bf16 v[64:79], a[92:95], v[124:127], v[64:79]
    s_waitcnt lgkmcnt(3)
    ds_read_b128 v[116:119], v9 offset:13312
    ds_write_b128 v196, v[176:179]
    v_mfma_f32_32x32x16_bf16 v[48:63], a[96:99], v[96:99], v[48:63]
    ds_read_b128 v[120:123], v9 offset:54784
    buffer_load_dwordx4 a[148:151], v165, s[4:7], s99 offen offset:1024
    v_add_f32 v144, v144, v146
    v_add_f32 v145, v145, v147
    s_nop 1
    v_permlane16_swap_b32 v144, v145
    v_mfma_f32_32x32x16_bf16 v[64:79], a[96:99], v[100:103], v[64:79]
    s_waitcnt lgkmcnt(4)
    ds_read_b128 v[124:127], v9 offset:13824
    buffer_load_dwordx4 a[152:155], v165, s[4:7], s99 offen offset:2048
    v_add_f32 v144, v144, v145
    v_mov_b32 v145, v144
    s_nop 1
    v_permlane32_swap_b32 v144, v145
    v_mfma_f32_32x32x16_bf16 v[48:63], a[100:103], v[104:107], v[48:63]
    ds_read_b128 v[96:99], v9 offset:55296
    buffer_load_dwordx4 a[156:159], v165, s[4:7], s99 offen offset:3072
    v_add_f32 v144, v144, v145
    v_mov_b32 v145, v144
    s_nop 1
    v_permlane16_swap_b32 v144, v145
    v_mfma_f32_32x32x16_bf16 v[64:79], a[100:103], v[108:111], v[64:79]
    s_waitcnt lgkmcnt(4)
    ds_read_b128 v[100:103], v9 offset:14336
    v_mul_f32 v146, s64, v144
    v_mul_f32 v145, s64, v145
    v_fma_f32 v145, -v146, v146, v145
    v_max_f32 v145, 0, v145
    v_add_f32 v145, s65, v145
    s_waitcnt vmcnt(16)
    v_mfma_f32_32x32x16_bf16 v[48:63], a[104:107], v[112:115], v[48:63]
    v_lshrrev_b32 v32, 2, v5
    ds_read_b128 v[104:107], v9 offset:55808
    v_and_b32 v31, 31, v32
    v_min_u32 v31, 9, v31
    v_lshlrev_b32 v31, 7, v31
    v_lshrrev_b32 v32, 5, v32
    s_mov_b32 s88, 3145728
    v_mad_u32_u24 v31, v32, s88, v31
    s_mul_i32 s88, s26, 0
    s_add_u32 s88, s88, s93
    buffer_load_dword v0, v31, s[4:7], s88 offen offset:0
    v_mfma_f32_32x32x16_bf16 v[64:79], a[104:107], v[116:119], v[64:79]
    s_waitcnt lgkmcnt(3)
    ds_read_b128 v[108:111], v9 offset:14848
    buffer_load_dword v0, v5, s[4:7], s31 offen sc1
    v_rsq_f32 v147, v145
    v_add_u32 v144, s0, v17
    v_mfma_f32_32x32x16_bf16 v[48:63], a[108:111], v[120:123], v[48:63]
    ds_read_b128 v[112:115], v9 offset:56320
    buffer_load_dwordx4 v[36:39], v1, s[4:7], s95 offen
    ds_write_b64 v144, v[146:147] offset:0
    v_mfma_f32_32x32x16_bf16 v[64:79], a[108:111], v[124:127], v[64:79]
    s_waitcnt lgkmcnt(4)
    ds_read_b128 v[116:119], v9 offset:15360
    buffer_load_dwordx4 v[40:43], v1, s[4:7], s95 offen offset:1024
    v_add_f32 v148, v148, v150
    v_add_f32 v149, v149, v151
    s_nop 1
    v_permlane16_swap_b32 v148, v149
    s_waitcnt vmcnt(18)
    v_mfma_f32_32x32x16_bf16 v[48:63], a[112:115], v[96:99], v[48:63]
    ds_read_b128 v[120:123], v9 offset:56832
    buffer_load_dwordx2 v[44:45], v25, s[4:7], s96 offen
    v_add_f32 v148, v148, v149
    v_mov_b32 v149, v148
    s_nop 1
    v_permlane32_swap_b32 v148, v149
    v_mfma_f32_32x32x16_bf16 v[64:79], a[112:115], v[100:103], v[64:79]
    s_waitcnt lgkmcnt(4)
    ds_read_b128 v[124:127], v9 offset:15872
    v_add_f32 v148, v148, v149
    v_mov_b32 v149, v148
    s_nop 1
    v_permlane16_swap_b32 v148, v149
    v_mfma_f32_32x32x16_bf16 v[48:63], a[116:119], v[104:107], v[48:63]
    v_mul_f32 v150, s64, v148
    v_mul_f32 v149, s64, v149
    v_fma_f32 v149, -v150, v150, v149
    v_max_f32 v149, 0, v149
    v_add_f32 v149, s65, v149
    v_rsq_f32 v151, v149
    v_add_u32 v148, s0, v17
    ds_write_b64 v148, v[150:151] offset:512
    s_waitcnt vmcnt(11)
    s_waitcnt lgkmcnt(0)
    s_barrier
    ds_read_b128 v[96:99], v9 offset:57344
    v_mfma_f32_32x32x16_bf16 v[64:79], a[116:119], v[108:111], v[64:79]
    s_add_u32 m0, s82, 45056
    ds_read_b128 v[100:103], v9 offset:16384
    s_add_u32 s88, s82, 4096
    buffer_load_dwordx4 v1, s[16:19], s88 offen offset:0 sc1 lds
    v_mfma_f32_32x32x16_bf16 v[48:63], a[120:123], v[112:115], v[48:63]
    s_add_u32 m0, s82, 46080
    ds_read_b128 v[104:107], v9 offset:57856
    s_add_u32 s88, s82, 5120
    buffer_load_dwordx4 v1, s[16:19], s88 offen offset:0 sc1 lds
    v_mfma_f32_32x32x16_bf16 v[64:79], a[120:123], v[116:119], v[64:79]
    s_add_u32 m0, s82, 49152
    ds_read_b128 v[108:111], v9 offset:16896
    s_add_u32 s88, s82, 8192
    buffer_load_dwordx4 v1, s[16:19], s88 offen offset:0 sc1 lds
    v_mfma_f32_32x32x16_bf16 v[48:63], a[124:127], v[120:123], v[48:63]
    s_add_u32 m0, s82, 50176
    ds_read_b128 v[112:115], v9 offset:58368
    s_add_u32 s88, s82, 9216
    buffer_load_dwordx4 v1, s[16:19], s88 offen offset:0 sc1 lds
    v_mfma_f32_32x32x16_bf16 v[64:79], a[124:127], v[124:127], v[64:79]
    s_waitcnt lgkmcnt(3)
    ds_read_b128 v[116:119], v9 offset:17408
    s_add_u32 m0, s82, 53248
    s_add_u32 s88, s82, 12288
    buffer_load_dwordx4 v1, s[16:19], s88 offen offset:0 sc1 lds
    v_mfma_f32_32x32x16_bf16 v[48:63], a[128:131], v[96:99], v[48:63]
    s_add_u32 m0, s82, 54272
    ds_read_b128 v[120:123], v9 offset:58880
    v_lshrrev_b32 v140, 3, v5
    v_and_b32 v140, 16, v140
    v_add_u32 v140, s0, v140
    ds_read_b128 v[128:131], v140 offset:0
    ds_read_b128 v[132:135], v140 offset:32
    v_mfma_f32_32x32x16_bf16 v[64:79], a[128:131], v[100:103], v[64:79]
    s_waitcnt lgkmcnt(5)
    ds_read_b128 v[124:127], v9 offset:17920
    s_add_u32 s88, s82, 13312
    buffer_load_dwordx4 v1, s[16:19], s88 offen offset:0 sc1 lds
    ds_read_b128 v[136:139], v140 offset:64
    ds_read_b128 v[140:143], v140 offset:96
    v_mfma_f32_32x32x16_bf16 v[48:63], a[132:135], v[104:107], v[48:63]
    s_add_u32 m0, s82, 4096
    ds_read_b128 v[96:99], v9 offset:59392
    s_add_u32 s88, s82, 45056
    buffer_load_dwordx4 v1, s[16:19], s88 offen offset:0 sc1 lds
    v_and_b32 v154, 124, v5
    v_lshlrev_b32 v154, 1, v154
    v_mfma_f32_32x32x16_bf16 v[64:79], a[132:135], v[108:111], v[64:79]
    s_waitcnt lgkmcnt(7)
    ds_read_b128 v[100:103], v9 offset:18432
    s_add_u32 m0, s82, 5120
    s_add_u32 s88, s82, 46080
    buffer_load_dwordx4 v1, s[16:19], s88 offen offset:0 sc1 lds
    v_add_u32 v154, 2048, v154
    s_waitcnt vmcnt(17)
    v_mfma_f32_32x32x16_bf16 v[48:63], a[136:139], v[112:115], v[48:63]
    s_add_u32 m0, s82, 8192
    ds_read_b128 v[104:107], v9 offset:59904
    s_add_u32 s88, s82, 49152
    buffer_load_dwordx4 v1, s[16:19], s88 offen offset:0 sc1 lds
    ds_read_b64 v[152:153], v154 offset:256
    buffer_load_dword v29, v5, s[4:7], s101 offen sc1
    v_mfma_f32_32x32x16_bf16 v[64:79], a[136:139], v[116:119], v[64:79]
    s_waitcnt lgkmcnt(6)
    ds_read_b128 v[108:111], v9 offset:18944
    s_add_u32 m0, s82, 9216
    s_add_u32 s88, s82, 50176
    buffer_load_dwordx4 v1, s[16:19], s88 offen offset:0 sc1 lds
    v_mfma_f32_32x32x16_bf16 v[48:63], a[140:143], v[120:123], v[48:63]
    s_add_u32 m0, s82, 12288
    ds_read_b128 v[112:115], v9 offset:60416
    v_mfma_f32_32x32x16_bf16 v[64:79], a[140:143], v[124:127], v[64:79]
    s_waitcnt lgkmcnt(4)
    ds_read_b128 v[116:119], v9 offset:19456
    s_add_u32 s88, s82, 53248
    buffer_load_dwordx4 v1, s[16:19], s88 offen offset:0 sc1 lds
    s_waitcnt vmcnt(19)
    v_mfma_f32_32x32x16_bf16 v[48:63], a[144:147], v[96:99], v[48:63]
    s_add_u32 m0, s82, 13312
    ds_read_b128 v[120:123], v9 offset:60928
    s_add_u32 s88, s82, 54272
    buffer_load_dwordx4 v1, s[16:19], s88 offen offset:0 sc1 lds
    v_mfma_f32_32x32x16_bf16 v[64:79], a[144:147], v[100:103], v[64:79]
    s_waitcnt lgkmcnt(3)
    ds_read_b128 v[124:127], v9 offset:19968
    v_mfma_f32_32x32x16_bf16 v[48:63], a[148:151], v[104:107], v[48:63]
    s_waitcnt vmcnt(7)
    s_barrier
    ds_read_b128 v[96:99], v9 offset:40960
    v_mfma_f32_32x32x16_bf16 v[64:79], a[148:151], v[108:111], v[64:79]
    s_waitcnt lgkmcnt(3)
    ds_read_b128 v[100:103], v9 offset:41472
    v_mfma_f32_32x32x16_bf16 v[48:63], a[152:155], v[112:115], v[48:63]
    ds_read_b128 v[104:107], v9 offset:41984
    v_mfma_f32_32x32x16_bf16 v[64:79], a[152:155], v[116:119], v[64:79]
    s_waitcnt lgkmcnt(3)
    ds_read_b128 v[108:111], v9 offset:42496
    v_mfma_f32_32x32x16_bf16 v[48:63], a[156:159], v[120:123], v[48:63]
    ds_read_b128 v[112:115], v9 offset:43008
    v_mfma_f32_32x32x16_bf16 v[64:79], a[156:159], v[124:127], v[64:79]
    s_waitcnt lgkmcnt(3)
    ds_read_b128 v[116:119], v9 offset:43520
    s_barrier
    s_add_u32 m0, s82, 57344
    s_add_u32 s88, s82, 16384
    buffer_load_dwordx4 v1, s[16:19], s88 offen offset:0 sc1 lds
    s_nop 3
    v_pk_fma_f32 v[48:49], v[128:129], v[152:153], v[48:49] op_sel_hi:[1,0,1] neg_lo:[0,1,0] neg_hi:[0,1,0]
    v_pk_fma_f32 v[50:51], v[130:131], v[152:153], v[50:51] op_sel_hi:[1,0,1] neg_lo:[0,1,0] neg_hi:[0,1,0]
    s_add_u32 m0, s82, 58368
    s_add_u32 s88, s82, 17408
    buffer_load_dwordx4 v1, s[16:19], s88 offen offset:0 sc1 lds
    v_pk_mul_f32 v[48:49], v[48:49], v[152:153] op_sel:[0,1] op_sel_hi:[1,1]
    v_pk_mul_f32 v[50:51], v[50:51], v[152:153] op_sel:[0,1] op_sel_hi:[1,1]
    v_cvt_pk_bf16_f32 v48, v48, v49
    v_cvt_pk_bf16_f32 v49, v50, v51
    ds_write_b64 v8, v[48:49] offset:29568
    s_add_u32 m0, s82, 61440
    s_add_u32 s88, s82, 20480
    buffer_load_dwordx4 v1, s[16:19], s88 offen offset:0 sc1 lds
    v_pk_fma_f32 v[52:53], v[132:133], v[152:153], v[52:53] op_sel_hi:[1,0,1] neg_lo:[0,1,0] neg_hi:[0,1,0]
    v_pk_fma_f32 v[54:55], v[134:135], v[152:153], v[54:55] op_sel_hi:[1,0,1] neg_lo:[0,1,0] neg_hi:[0,1,0]
    v_pk_mul_f32 v[52:53], v[52:53], v[152:153] op_sel:[0,1] op_sel_hi:[1,1]
    v_pk_mul_f32 v[54:55], v[54:55], v[152:153] op_sel:[0,1] op_sel_hi:[1,1]
    v_cvt_pk_bf16_f32 v52, v52, v53
    v_cvt_pk_bf16_f32 v53, v54, v55
    s_add_u32 m0, s82, 62464
    s_add_u32 s88, s82, 21504
    buffer_load_dwordx4 v1, s[16:19], s88 offen offset:0 sc1 lds
    ds_write_b64 v8, v[52:53] offset:29584
    v_pk_fma_f32 v[56:57], v[136:137], v[152:153], v[56:57] op_sel_hi:[1,0,1] neg_lo:[0,1,0] neg_hi:[0,1,0]
    v_pk_fma_f32 v[58:59], v[138:139], v[152:153], v[58:59] op_sel_hi:[1,0,1] neg_lo:[0,1,0] neg_hi:[0,1,0]
    v_pk_mul_f32 v[56:57], v[56:57], v[152:153] op_sel:[0,1] op_sel_hi:[1,1]
    v_pk_mul_f32 v[58:59], v[58:59], v[152:153] op_sel:[0,1] op_sel_hi:[1,1]
    v_cvt_pk_bf16_f32 v56, v56, v57
    v_cvt_pk_bf16_f32 v57, v58, v59
    ds_write_b64 v8, v[56:57] offset:29600
    s_add_u32 m0, s82, 16384
    s_add_u32 s88, s82, 57344
    buffer_load_dwordx4 v1, s[16:19], s88 offen offset:0 sc1 lds
    v_pk_fma_f32 v[60:61], v[140:141], v[152:153], v[60:61] op_sel_hi:[1,0,1] neg_lo:[0,1,0] neg_hi:[0,1,0]
    v_pk_fma_f32 v[62:63], v[142:143], v[152:153], v[62:63] op_sel_hi:[1,0,1] neg_lo:[0,1,0] neg_hi:[0,1,0]
    v_pk_mul_f32 v[60:61], v[60:61], v[152:153] op_sel:[0,1] op_sel_hi:[1,1]
    v_pk_mul_f32 v[62:63], v[62:63], v[152:153] op_sel:[0,1] op_sel_hi:[1,1]
    v_cvt_pk_bf16_f32 v60, v60, v61
    v_cvt_pk_bf16_f32 v61, v62, v63
    ds_write_b64 v8, v[60:61] offset:29616
    v_mfma_f32_32x32x16_bf16 v[80:95], a[0:3], v[96:99], 0
    s_add_u32 m0, s82, 17408
    ds_read_b128 v[120:123], v9 offset:44032
    s_add_u32 s88, s82, 58368
    buffer_load_dwordx4 v1, s[16:19], s88 offen offset:0 sc1 lds
    v_mfma_f32_32x32x16_bf16 v[80:95], a[4:7], v[100:103], v[80:95]
    s_waitcnt lgkmcnt(7)
    ds_read_b128 v[124:127], v9 offset:44544
    v_mfma_f32_32x32x16_bf16 v[80:95], a[8:11], v[104:107], v[80:95]
    s_add_u32 m0, s82, 20480
    ds_read_b128 v[96:99], v9 offset:45056
    s_add_u32 s88, s82, 61440
    buffer_load_dwordx4 v1, s[16:19], s88 offen offset:0 sc1 lds
    v_mfma_f32_32x32x16_bf16 v[80:95], a[12:15], v[108:111], v[80:95]
    s_waitcnt lgkmcnt(7)
    ds_read_b128 v[100:103], v9 offset:45568
    s_waitcnt lgkmcnt(4)
    s_barrier
    v_add_u32 v156, 33792, v4
    ds_read2_b64 v[156:159], v156 offset1:1
    s_add_u32 s91, s85, 0
    v_mfma_f32_32x32x16_bf16 v[80:95], a[16:19], v[112:115], v[80:95]
    s_add_u32 m0, s82, 21504
    ds_read_b128 v[104:107], v9 offset:46080
    s_add_u32 s88, s82, 62464
    buffer_load_dwordx4 v1, s[16:19], s88 offen offset:0 sc1 lds
    v_mfma_f32_32x32x16_bf16 v[80:95], a[20:23], v[116:119], v[80:95]
    s_waitcnt lgkmcnt(4)
    ds_read_b128 v[108:111], v9 offset:46592
    v_mfma_f32_32x32x16_bf16 v[80:95], a[24:27], v[120:123], v[80:95]
    s_add_u32 s33, s60, 0
    ds_read_b128 v[112:115], v9 offset:47104
    buffer_load_dwordx4 a[160:163], v1, s[4:7], s33 offen offset:0
    v_mfma_f32_32x32x16_bf16 v[80:95], a[28:31], v[124:127], v[80:95]
    s_waitcnt lgkmcnt(4)
    ds_read_b128 v[116:119], v9 offset:47616
    v_mfma_f32_32x32x16_bf16 v[80:95], a[32:35], v[96:99], v[80:95]
    s_waitcnt lgkmcnt(4)
    ds_read_b128 v[120:123], v9 offset:48128
    buffer_load_dwordx4 a[164:167], v1, s[4:7], s33 offen offset:1024
    buffer_store_dwordx4 v[156:159], v1, s[4:7], s91 offen sc1
    v_mfma_f32_32x32x16_bf16 v[80:95], a[36:39], v[100:103], v[80:95]
    s_waitcnt lgkmcnt(3)
    ds_read_b128 v[124:127], v9 offset:48640
    s_waitcnt vmcnt(14)
poll_76:
    v_cmp_le_u32 vcc, 1, v29
    s_nop 0
    s_andn2_b64 s[56:57], s[42:43], vcc
    s_cbranch_scc1 pollr_75
    v_cmp_ne_u32 vcc, s100, v29
    s_nop 0
    s_and_b64 s[56:57], s[42:43], vcc
    s_cselect_b32 s28, 1, 0
    v_mfma_f32_32x32x16_bf16 v[80:95], a[40:43], v[104:107], v[80:95]
    ds_read_b128 v[96:99], v9 offset:49152
    buffer_load_dwordx4 a[168:171], v1, s[4:7], s33 offen offset:2048
    v_mfma_f32_32x32x16_bf16 v[80:95], a[44:47], v[108:111], v[80:95]
    s_waitcnt lgkmcnt(3)
    ds_read_b128 v[100:103], v9 offset:49664
    v_mfma_f32_32x32x16_bf16 v[80:95], a[48:51], v[112:115], v[80:95]
    v_lshrrev_b32 v32, 2, v5
    ds_read_b128 v[104:107], v9 offset:50176
    v_and_b32 v31, 31, v32
    v_min_u32 v31, 2, v31
    v_lshlrev_b32 v31, 7, v31
    v_lshrrev_b32 v32, 5, v32
    s_mov_b32 s88, 3145728
    v_mad_u32_u24 v31, v32, s88, v31
    s_mul_i32 s88, s26, 1792
    s_add_u32 s88, s88, s93
    buffer_load_dword v0, v31, s[4:7], s88 offen offset:0
    v_mfma_f32_32x32x16_bf16 v[80:95], a[52:55], v[116:119], v[80:95]
    s_waitcnt lgkmcnt(3)
    ds_read_b128 v[108:111], v9 offset:50688
    v_mfma_f32_32x32x16_bf16 v[80:95], a[56:59], v[120:123], v[80:95]
    ds_read_b128 v[112:115], v9 offset:51200
    buffer_load_dwordx4 a[172:175], v1, s[4:7], s33 offen offset:3072
    v_mfma_f32_32x32x16_bf16 v[80:95], a[60:63], v[124:127], v[80:95]
    s_waitcnt lgkmcnt(3)
    ds_read_b128 v[116:119], v9 offset:51712
    v_mfma_f32_32x32x16_bf16 v[80:95], a[64:67], v[96:99], v[80:95]
    v_lshrrev_b32 v32, 2, v5
    ds_read_b128 v[120:123], v9 offset:52224
    v_and_b32 v31, 31, v32
    v_min_u32 v31, 2, v31
    v_lshlrev_b32 v31, 7, v31
    v_lshrrev_b32 v32, 5, v32
    s_mov_b32 s88, 3145728
    v_mad_u32_u24 v31, v32, s88, v31
    s_mul_i32 s88, s26, 1792
    s_add_u32 s88, s88, s93
    buffer_load_dword v0, v31, s[4:7], s88 offen offset:384
    v_mfma_f32_32x32x16_bf16 v[80:95], a[68:71], v[100:103], v[80:95]
    s_waitcnt lgkmcnt(3)
    ds_read_b128 v[124:127], v9 offset:52736
    v_mfma_f32_32x32x16_bf16 v[80:95], a[72:75], v[104:107], v[80:95]
    s_waitcnt vmcnt(11)
    s_barrier
    ds_read_b128 v[96:99], v9 offset:53248
    buffer_load_dwordx4 a[176:179], v2, s[4:7], s33 offen offset:0
    v_mfma_f32_32x32x16_bf16 v[80:95], a[76:79], v[108:111], v[80:95]
    s_waitcnt lgkmcnt(3)
    ds_read_b128 v[100:103], v9 offset:53760
    v_mfma_f32_32x32x16_bf16 v[80:95], a[80:83], v[112:115], v[80:95]
    v_lshrrev_b32 v32, 2, v5
    ds_read_b128 v[104:107], v9 offset:54272
    v_and_b32 v31, 31, v32
    v_min_u32 v31, 2, v31
    v_lshlrev_b32 v31, 7, v31
    v_lshrrev_b32 v32, 5, v32
    s_mov_b32 s88, 3145728
    v_mad_u32_u24 v31, v32, s88, v31
    s_mul_i32 s88, s26, 1792
    s_add_u32 s88, s88, s93
    buffer_load_dword v0, v31, s[4:7], s88 offen offset:768
    v_mfma_f32_32x32x16_bf16 v[80:95], a[84:87], v[116:119], v[80:95]
    s_waitcnt lgkmcnt(3)
    ds_read_b128 v[108:111], v9 offset:54784
    ds_read_b64 v[152:153], v154 offset:0
    v_mfma_f32_32x32x16_bf16 v[80:95], a[88:91], v[120:123], v[80:95]
    ds_read_b128 v[112:115], v9 offset:55296
    buffer_load_dwordx4 a[180:183], v2, s[4:7], s33 offen offset:1024
    v_mfma_f32_32x32x16_bf16 v[80:95], a[92:95], v[124:127], v[80:95]
    s_waitcnt lgkmcnt(4)
    ds_read_b128 v[116:119], v9 offset:55808
    v_mfma_f32_32x32x16_bf16 v[80:95], a[96:99], v[96:99], v[80:95]
    v_lshrrev_b32 v32, 2, v5
    ds_read_b128 v[120:123], v9 offset:56320
    v_and_b32 v31, 31, v32
    v_min_u32 v31, 2, v31
    v_lshlrev_b32 v31, 7, v31
    v_lshrrev_b32 v32, 5, v32
    s_mov_b32 s88, 3145728
    v_mad_u32_u24 v31, v32, s88, v31
    s_mul_i32 s88, s26, 1792
    s_add_u32 s88, s88, s93
    buffer_load_dword v0, v31, s[4:7], s88 offen offset:1152
    v_mfma_f32_32x32x16_bf16 v[80:95], a[100:103], v[100:103], v[80:95]
    s_waitcnt lgkmcnt(4)
    ds_read_b128 v[124:127], v9 offset:56832
    v_mfma_f32_32x32x16_bf16 v[80:95], a[104:107], v[104:107], v[80:95]
    s_waitcnt lgkmcnt(4)
    ds_read_b128 v[96:99], v9 offset:57344
    buffer_load_dwordx4 a[184:187], v2, s[4:7], s33 offen offset:2048
    v_fma_f32 v64, -v128, v152, v64
    v_fma_f32 v65, -v129, v152, v65
    v_fma_f32 v66, -v130, v152, v66
    v_mfma_f32_32x32x16_bf16 v[80:95], a[108:111], v[108:111], v[80:95]
    s_waitcnt lgkmcnt(3)
    ds_read_b128 v[100:103], v9 offset:57856
    v_fma_f32 v67, -v131, v152, v67
    v_mul_f32 v64, v64, v153
    v_mul_f32 v65, v65, v153
    v_mul_f32 v66, v66, v153
    v_mul_f32 v67, v67, v153
    v_mfma_f32_32x32x16_bf16 v[80:95], a[112:115], v[112:115], v[80:95]
    v_lshrrev_b32 v32, 2, v5
    ds_read_b128 v[104:107], v9 offset:58368
    v_and_b32 v31, 31, v32
    v_min_u32 v31, 2, v31
    v_lshlrev_b32 v31, 7, v31
    v_lshrrev_b32 v32, 5, v32
    s_mov_b32 s88, 3145728
    v_mad_u32_u24 v31, v32, s88, v31
    s_mul_i32 s88, s26, 1792
    s_add_u32 s88, s88, s93
    buffer_load_dword v0, v31, s[4:7], s88 offen offset:1536
    v_mfma_f32_32x32x16_bf16 v[80:95], a[116:119], v[116:119], v[80:95]
    s_waitcnt lgkmcnt(3)
    ds_read_b128 v[108:111], v9 offset:58880
    v_cvt_pk_bf16_f32 v64, v64, v65
    v_cvt_pk_bf16_f32 v65, v66, v67
    ds_write_b64 v8, v[64:65] offset:21120
    v_mfma_f32_32x32x16_bf16 v[80:95], a[120:123], v[120:123], v[80:95]
    s_lshl_b32 s88, s27, 2
    ds_read_b128 v[112:115], v9 offset:59392
    s_add_u32 s88, s88, s24
    s_lshl_b32 s88, s88, 11
    v_lshlrev_b32 v31, 5, v5
    v_and_b32 v31, 0x780, v31
    buffer_load_dword v0, v31, s[20:23], s88 offen
    v_mfma_f32_32x32x16_bf16 v[80:95], a[124:127], v[124:127], v[80:95]
    s_waitcnt lgkmcnt(4)
    ds_read_b128 v[116:119], v9 offset:59904
    v_fma_f32 v68, -v132, v152, v68
    v_fma_f32 v69, -v133, v152, v69
    v_fma_f32 v70, -v134, v152, v70
    v_fma_f32 v71, -v135, v152, v71
    v_mul_f32 v68, v68, v153
    v_mfma_f32_32x32x16_bf16 v[80:95], a[128:131], v[96:99], v[80:95]
    v_lshrrev_b32 v32, 2, v5
    ds_read_b128 v[120:123], v9 offset:60416
    v_and_b32 v31, 31, v32
    v_min_u32 v31, 2, v31
    v_lshlrev_b32 v31, 7, v31
    v_lshrrev_b32 v32, 5, v32
    s_mov_b32 s88, 3145728
    v_mad_u32_u24 v31, v32, s88, v31
    s_mul_i32 s88, s26, 1792
    s_add_u32 s88, s88, s93
    buffer_load_dword v0, v31, s[4:7], s88 offen offset:1920
    v_mfma_f32_32x32x16_bf16 v[80:95], a[132:135], v[100:103], v[80:95]
    s_waitcnt lgkmcnt(4)
    ds_read_b128 v[124:127], v9 offset:60928
    v_mul_f32 v69, v69, v153
    v_mul_f32 v70, v70, v153
    v_mul_f32 v71, v71, v153
    v_cvt_pk_bf16_f32 v68, v68, v69
    v_cvt_pk_bf16_f32 v69, v70, v71
    v_mfma_f32_32x32x16_bf16 v[80:95], a[136:139], v[104:107], v[80:95]
    s_waitcnt vmcnt(15)
    s_barrier
    ds_read_b128 v[96:99], v9 offset:0
    buffer_load_dwordx4 a[188:191], v2, s[4:7], s33 offen offset:3072
    ds_write_b64 v8, v[68:69] offset:21136
    v_mfma_f32_32x32x16_bf16 v[80:95], a[140:143], v[108:111], v[80:95]
    s_waitcnt lgkmcnt(4)
    ds_read_b128 v[100:103], v9 offset:512
    v_fma_f32 v72, -v136, v152, v72
    v_fma_f32 v73, -v137, v152, v73
    v_fma_f32 v74, -v138, v152, v74
    v_fma_f32 v75, -v139, v152, v75
    v_mul_f32 v72, v72, v153
    v_mfma_f32_32x32x16_bf16 v[80:95], a[144:147], v[112:115], v[80:95]
    v_lshrrev_b32 v32, 2, v5
    ds_read_b128 v[104:107], v9 offset:1024
    v_and_b32 v31, 31, v32
    v_min_u32 v31, 2, v31
    v_lshlrev_b32 v31, 7, v31
    v_lshrrev_b32 v32, 5, v32
    s_mov_b32 s88, 3145728
    v_mad_u32_u24 v31, v32, s88, v31
    s_mul_i32 s88, s26, 1792
    s_add_u32 s88, s88, s93
    buffer_load_dword v0, v31, s[4:7], s88 offen offset:2304
    v_mfma_f32_32x32x16_bf16 v[80:95], a[148:151], v[116:119], v[80:95]
    s_waitcnt lgkmcnt(4)
    ds_read_b128 v[108:111], v9 offset:1536
    v_mul_f32 v73, v73, v153
    v_mul_f32 v74, v74, v153
    v_mul_f32 v75, v75, v153
    v_cvt_pk_bf16_f32 v72, v72, v73
    v_cvt_pk_bf16_f32 v73, v74, v75
    v_mfma_f32_32x32x16_bf16 v[80:95], a[152:155], v[120:123], v[80:95]
    ds_read_b128 v[112:115], v9 offset:2048
    buffer_load_dwordx4 a[192:195], v3, s[4:7], s33 offen offset:0
    ds_write_b64 v8, v[72:73] offset:21152
    v_mfma_f32_32x32x16_bf16 v[80:95], a[156:159], v[124:127], v[80:95]
    s_waitcnt lgkmcnt(4)
    ds_read_b128 v[116:119], v9 offset:2560
    v_fma_f32 v76, -v140, v152, v76
    v_fma_f32 v77, -v141, v152, v77
    v_fma_f32 v78, -v142, v152, v78
    v_fma_f32 v79, -v143, v152, v79
    v_mul_f32 v76, v76, v153
    v_mfma_f32_32x32x16_bf16 v[48:63], a[0:3], v[96:99], 0
    v_lshrrev_b32 v32, 2, v5
    ds_read_b128 v[120:123], v9 offset:3072
    v_and_b32 v31, 31, v32
    v_min_u32 v31, 2, v31
    v_lshlrev_b32 v31, 7, v31
    v_lshrrev_b32 v32, 5, v32
    s_mov_b32 s88, 3145728
    v_mad_u32_u24 v31, v32, s88, v31
    s_mul_i32 s88, s26, 1792
    s_add_u32 s88, s88, s93
    buffer_load_dword v0, v31, s[4:7], s88 offen offset:2688
    v_mfma_f32_32x32x16_bf16 v[48:63], a[4:7], v[100:103], v[48:63]
    s_waitcnt lgkmcnt(4)
    ds_read_b128 v[124:127], v9 offset:3584
    v_mul_f32 v77, v77, v153
    v_mul_f32 v78, v78, v153
    v_mul_f32 v79, v79, v153
    v_cvt_pk_bf16_f32 v76, v76, v77
    v_cvt_pk_bf16_f32 v77, v78, v79
    ds_write_b64 v8, v[76:77] offset:21168
    v_mfma_f32_32x32x16_bf16 v[48:63], a[8:11], v[104:107], v[48:63]
    ds_read_b128 v[96:99], v9 offset:4096
    buffer_load_dwordx4 a[196:199], v3, s[4:7], s33 offen offset:1024
    ds_read_b64 v[152:153], v154 offset:512
    v_mfma_f32_32x32x16_bf16 v[48:63], a[12:15], v[108:111], v[48:63]
    s_waitcnt lgkmcnt(5)
    ds_read_b128 v[100:103], v9 offset:4608
    v_mfma_f32_32x32x16_bf16 v[48:63], a[16:19], v[112:115], v[48:63]
    v_mov_b32 v30, 1
    s_mov_b64 exec, 1
    s_waitcnt vmcnt(17)
    buffer_store_dword v30, off, s[4:7], s3 sc1
    s_mov_b64 exec, -1
    ds_read_b128 v[104:107], v9 offset:5120
    v_mfma_f32_32x32x16_bf16 v[48:63], a[20:23], v[116:119], v[48:63]
    s_waitcnt lgkmcnt(5)
    ds_read_b128 v[108:111], v9 offset:5632
    buffer_load_dwordx4 a[200:203], v3, s[4:7], s33 offen offset:2048
    v_mfma_f32_32x32x16_bf16 v[48:63], a[24:27], v[120:123], v[48:63]
    ds_read_b128 v[112:115], v9 offset:6144
    v_mfma_f32_32x32x16_bf16 v[48:63], a[28:31], v[124:127], v[48:63]
    s_waitcnt lgkmcnt(3)
    ds_read_b128 v[116:119], v9 offset:6656
    buffer_load_dwordx4 a[204:207], v3, s[4:7], s33 offen offset:3072
    v_fma_f32 v80, -v128, v152, v80
    v_fma_f32 v81, -v129, v152, v81
    v_fma_f32 v82, -v130, v152, v82
    v_fma_f32 v83, -v131, v152, v83
    v_mul_f32 v80, v80, v153
    v_mfma_f32_32x32x16_bf16 v[48:63], a[32:35], v[96:99], v[48:63]
    s_add_u32 s33, s60, 12288
    ds_read_b128 v[120:123], v9 offset:7168
    v_mul_f32 v81, v81, v153
    v_mul_f32 v82, v82, v153
    v_mul_f32 v83, v83, v153
    v_cvt_pk_bf16_f32 v80, v80, v81
    v_cvt_pk_bf16_f32 v81, v82, v83
    ds_write_b64 v8, v[80:81] offset:12672
    v_mfma_f32_32x32x16_bf16 v[48:63], a[36:39], v[100:103], v[48:63]
    s_waitcnt lgkmcnt(4)
    ds_read_b128 v[124:127], v9 offset:7680
    buffer_load_dwordx4 a[208:211], v1, s[4:7], s33 offen offset:0
    v_fma_f32 v84, -v132, v152, v84
    v_fma_f32 v85, -v133, v152, v85
    v_fma_f32 v86, -v134, v152, v86
    v_fma_f32 v87, -v135, v152, v87
    v_mul_f32 v84, v84, v153
    v_mfma_f32_32x32x16_bf16 v[48:63], a[40:43], v[104:107], v[48:63]
    ds_read_b128 v[96:99], v9 offset:8192
    v_mul_f32 v85, v85, v153
    v_mul_f32 v86, v86, v153
    v_mul_f32 v87, v87, v153
    v_cvt_pk_bf16_f32 v84, v84, v85
    v_cvt_pk_bf16_f32 v85, v86, v87
    ds_write_b64 v8, v[84:85] offset:12688
    v_mfma_f32_32x32x16_bf16 v[48:63], a[44:47], v[108:111], v[48:63]
    s_waitcnt lgkmcnt(5)
    ds_read_b128 v[100:103], v9 offset:8704
    buffer_load_dwordx4 a[212:215], v1, s[4:7], s33 offen offset:1024
    v_fma_f32 v88, -v136, v152, v88
    v_fma_f32 v89, -v137, v152, v89
    v_fma_f32 v90, -v138, v152, v90
    v_fma_f32 v91, -v139, v152, v91
    v_mul_f32 v88, v88, v153
    v_mfma_f32_32x32x16_bf16 v[48:63], a[48:51], v[112:115], v[48:63]
    ds_read_b128 v[104:107], v9 offset:9216
    v_mul_f32 v89, v89, v153
    v_mul_f32 v90, v90, v153
    v_mul_f32 v91, v91, v153
    v_cvt_pk_bf16_f32 v88, v88, v89
    v_cvt_pk_bf16_f32 v89, v90, v91
    ds_write_b64 v8, v[88:89] offset:12704
    v_mfma_f32_32x32x16_bf16 v[48:63], a[52:55], v[116:119], v[48:63]
    s_waitcnt lgkmcnt(5)
    ds_read_b128 v[108:111], v9 offset:9728
    buffer_load_dwordx4 a[216:219], v1, s[4:7], s33 offen offset:2048
    v_fma_f32 v92, -v140, v152, v92
    v_fma_f32 v93, -v141, v152, v93
    v_fma_f32 v94, -v142, v152, v94
    v_fma_f32 v95, -v143, v152, v95
    v_mul_f32 v92, v92, v153
    v_mfma_f32_32x32x16_bf16 v[48:63], a[56:59], v[120:123], v[48:63]
    ds_read_b128 v[112:115], v9 offset:10240
    v_mul_f32 v93, v93, v153
    v_mul_f32 v94, v94, v153
    v_mul_f32 v95, v95, v153
    v_cvt_pk_bf16_f32 v92, v92, v93
    v_cvt_pk_bf16_f32 v93, v94, v95
    ds_write_b64 v8, v[92:93] offset:12720
    v_mfma_f32_32x32x16_bf16 v[48:63], a[60:63], v[124:127], v[48:63]
    s_waitcnt lgkmcnt(5)
    ds_read_b128 v[116:119], v9 offset:10752
    buffer_load_dwordx4 a[220:223], v1, s[4:7], s33 offen offset:3072
    buffer_load_dword v29, v5, s[4:7], s87 offen sc1
    v_mfma_f32_32x32x16_bf16 v[48:63], a[64:67], v[96:99], v[48:63]
    ds_read_b128 v[120:123], v9 offset:11264
    v_mfma_f32_32x32x16_bf16 v[48:63], a[68:71], v[100:103], v[48:63]
    s_waitcnt lgkmcnt(4)
    ds_read_b128 v[124:127], v9 offset:11776
    buffer_load_dwordx4 a[224:227], v2, s[4:7], s33 offen offset:0
    s_waitcnt lgkmcnt(3)
    s_barrier
    ds_read2_b64 v[160:163], v11 offset0:10 offset1:14
    ds_read2_b64 v[164:167], v10 offset0:0 offset1:4
    ds_read2_b64 v[168:171], v11 offset0:0 offset1:4
    v_mfma_f32_32x32x16_bf16 v[48:63], a[72:75], v[104:107], v[48:63]
    ds_read_b128 v[96:99], v9 offset:12288
    ds_read2_b64 v[172:175], v11 offset0:15 offset1:19
    ds_read2_b64 v[80:83], v10 offset0:5 offset1:9
    ds_read2_b64 v[84:87], v11 offset0:5 offset1:9
    s_add_u32 s89, s93, 0
    v_mfma_f32_32x32x16_bf16 v[48:63], a[76:79], v[108:111], v[48:63]
    s_waitcnt lgkmcnt(9)
    ds_read_b128 v[100:103], v9 offset:12800
    buffer_load_dwordx4 a[228:231], v2, s[4:7], s33 offen offset:1024
    v_mfma_f32_32x32x16_bf16 v[48:63], a[80:83], v[112:115], v[48:63]
    ds_read_b128 v[104:107], v9 offset:13312
    v_mfma_f32_32x32x16_bf16 v[48:63], a[84:87], v[116:119], v[48:63]
    s_waitcnt lgkmcnt(9)
    ds_read_b128 v[108:111], v9 offset:13824
    buffer_load_dwordx4 a[232:235], v2, s[4:7], s33 offen offset:2048
    v_mfma_f32_32x32x16_bf16 v[48:63], a[88:91], v[120:123], v[48:63]
    ds_read_b128 v[112:115], v9 offset:14336
    v_mfma_f32_32x32x16_bf16 v[48:63], a[92:95], v[124:127], v[48:63]
    s_waitcnt lgkmcnt(3)
    ds_read_b128 v[116:119], v9 offset:14848
    buffer_load_dwordx4 a[236:239], v2, s[4:7], s33 offen offset:3072
    v_cndmask_b32 v162, 0, v162, s[50:51]
    v_cndmask_b32 v163, 0, v163, s[50:51]
    v_cndmask_b32 v174, 0, v174, s[50:51]
    v_cndmask_b32 v175, 0, v175, s[50:51]
    v_mfma_f32_32x32x16_bf16 v[48:63], a[96:99], v[96:99], v[48:63]
    v_mfma_f32_16x16x32_bf16 v[88:91], v[164:167], v[160:163], 0
    v_mfma_f32_16x16x32_bf16 v[92:95], v[168:171], v[160:163], 0
    v_mfma_f32_16x16x32_bf16 v[160:163], v[80:83], v[172:175], 0
    v_mfma_f32_16x16x32_bf16 v[164:167], v[84:87], v[172:175], 0
    ds_read_b128 v[120:123], v9 offset:15360
    ds_read_b64_tr_b16 v[80:81], v12 offset:0
    ds_read_b64_tr_b16 v[82:83], v12 offset:4224
    ds_read_b64_tr_b16 v[84:85], v12 offset:32
    ds_read_b64_tr_b16 v[86:87], v12 offset:4256
    v_cndmask_b32 v88, v88, v89, s[44:45]
    v_cndmask_b32 v90, v90, v91, s[44:45]
    v_cndmask_b32 v92, v92, v93, s[44:45]
    v_mfma_f32_32x32x16_bf16 v[48:63], a[100:103], v[100:103], v[48:63]
    s_waitcnt lgkmcnt(7)
    ds_read_b128 v[124:127], v9 offset:15872
    buffer_load_dwordx4 a[240:243], v3, s[4:7], s33 offen offset:0
    v_cndmask_b32 v94, v94, v95, s[44:45]
    v_cndmask_b32 v168, v92, v88, s[46:47]
    v_cndmask_b32 v169, v94, v90, s[48:49]
    v_max_f32 v172, v168, v169
    v_cndmask_b32 v160, v160, v161, s[44:45]
    v_mfma_f32_32x32x16_bf16 v[48:63], a[104:107], v[104:107], v[48:63]
    ds_read_b128 v[96:99], v9 offset:16384
    v_cndmask_b32 v162, v162, v163, s[44:45]
    v_cndmask_b32 v164, v164, v165, s[44:45]
    v_cndmask_b32 v166, v166, v167, s[44:45]
    v_cndmask_b32 v170, v164, v160, s[46:47]
    v_cndmask_b32 v171, v166, v162, s[48:49]
    v_max_f32 v173, v170, v171
    s_nop 1
    v_permlane16_swap_b32 v172, v173
    v_mfma_f32_32x32x16_bf16 v[48:63], a[108:111], v[108:111], v[48:63]
    s_waitcnt lgkmcnt(7)
    ds_read_b128 v[100:103], v9 offset:16896
    buffer_load_dwordx4 a[244:247], v3, s[4:7], s33 offen offset:1024
    v_max_f32 v172, v172, v173
    v_mov_b32 v173, v172
    ds_read_b64_tr_b16 v[88:89], v12 offset:40
    ds_read_b64_tr_b16 v[90:91], v12 offset:4264
    v_permlane32_swap_b32 v172, v173
    v_mfma_f32_32x32x16_bf16 v[48:63], a[112:115], v[112:115], v[48:63]
    ds_read_b128 v[104:107], v9 offset:17408
    v_max_f32 v172, v172, v173
    v_mov_b32 v173, v172
    ds_read_b64_tr_b16 v[92:93], v12 offset:72
    ds_read_b64_tr_b16 v[94:95], v12 offset:4296
    v_permlane16_swap_b32 v172, v173
    v_mul_f32 v172, s63, v172
    v_mul_f32 v173, s63, v173
    v_mfma_f32_32x32x16_bf16 v[48:63], a[116:119], v[116:119], v[48:63]
    s_waitcnt lgkmcnt(7)
    ds_read_b128 v[108:111], v9 offset:17920
    buffer_load_dwordx4 a[248:251], v3, s[4:7], s33 offen offset:2048
    v_fma_f32 v168, v168, s63, -v172
    v_fma_f32 v169, v169, s63, -v172
    v_fma_f32 v170, v170, s63, -v173
    v_fma_f32 v171, v171, s63, -v173
    s_waitcnt vmcnt(7)
poll_80:
    v_cmp_le_u32 vcc, 1, v29
    s_nop 0
    s_andn2_b64 s[56:57], s[40:41], vcc
    s_cbranch_scc1 pollr_79
    s_add_u32 s91, s86, 0
    buffer_load_dwordx4 v[156:159], v1, s[4:7], s91 offen sc1
    v_mfma_f32_32x32x16_bf16 v[48:63], a[120:123], v[120:123], v[48:63]
    ds_read_b128 v[112:115], v9 offset:18432
    v_exp_f32 v168, v168
    v_exp_f32 v169, v169
    v_exp_f32 v170, v170
    v_mfma_f32_32x32x16_bf16 v[48:63], a[124:127], v[124:127], v[48:63]
    s_waitcnt lgkmcnt(7)
    ds_read_b128 v[116:119], v9 offset:18944
    buffer_load_dwordx4 a[252:255], v3, s[4:7], s33 offen offset:3072
    v_exp_f32 v171, v171
    v_add_f32 v172, v168, v169
    v_add_f32 v173, v170, v171
    s_nop 1
    v_permlane16_swap_b32 v172, v173
    v_mfma_f32_32x32x16_bf16 v[48:63], a[128:131], v[96:99], v[48:63]
    s_add_u32 s33, s60, 24576
    ds_read_b128 v[120:123], v9 offset:19456
    v_add_f32 v172, v172, v173
    v_mov_b32 v173, v172
    v_add_u32 v10, s1, v10
    v_add_u32 v11, s1, v11
    v_permlane32_swap_b32 v172, v173
    v_add_f32 v172, v172, v173
    v_mov_b32 v173, v172
    v_mfma_f32_32x32x16_bf16 v[48:63], a[132:135], v[100:103], v[48:63]
    s_waitcnt lgkmcnt(3)
    ds_read_b128 v[124:127], v9 offset:19968
    buffer_load_dwordx4 v[252:255], v1, s[4:7], s33 offen offset:0
    v_add_u32 v12, s1, v12
    v_permlane16_swap_b32 v172, v173
    v_rcp_f32 v172, v172
    v_mfma_f32_32x32x16_bf16 v[48:63], a[136:139], v[104:107], v[48:63]
    s_add_u32 s33, s61, 0
    v_rcp_f32 v173, v173
    v_mul_f32 v168, v168, v172
    v_mul_f32 v169, v169, v172
    v_mul_f32 v170, v170, v173
    v_mul_f32 v171, v171, v173
    v_cvt_pk_bf16_f32 v168, v168, v168
    v_cvt_pk_bf16_f32 v169, v169, v169
    v_mfma_f32_32x32x16_bf16 v[48:63], a[140:143], v[108:111], v[48:63]
    s_waitcnt lgkmcnt(2)
    buffer_load_dwordx4 v[248:251], v1, s[4:7], s33 offen offset:0
    v_and_b32 v160, v13, v168
    v_and_b32 v161, v14, v169
    v_and_b32 v162, v15, v168
    v_and_b32 v163, v16, v169
    v_cvt_pk_bf16_f32 v170, v170, v170
    v_mfma_f32_32x32x16_bf16 v[48:63], a[144:147], v[112:115], v[48:63]
    v_cvt_pk_bf16_f32 v171, v171, v171
    v_and_b32 v164, v13, v170
    v_and_b32 v165, v14, v171
    v_and_b32 v166, v15, v170
    v_and_b32 v167, v16, v171
    v_mfma_f32_32x32x16_bf16 v[48:63], a[148:151], v[116:119], v[48:63]
    s_waitcnt lgkmcnt(0)
    buffer_load_dwordx4 v[244:247], v1, s[4:7], s33 offen offset:1024
    v_mfma_f32_16x16x32_bf16 v[168:171], v[80:83], v[160:163], 0
    v_mfma_f32_16x16x32_bf16 v[172:175], v[84:87], v[160:163], 0
    v_mfma_f32_16x16x32_bf16 v[80:83], v[88:91], v[164:167], 0
    v_mfma_f32_16x16x32_bf16 v[84:87], v[92:95], v[164:167], 0
    v_mfma_f32_32x32x16_bf16 v[48:63], a[152:155], v[120:123], v[48:63]
    v_mfma_f32_32x32x16_bf16 v[48:63], a[156:159], v[124:127], v[48:63]
    buffer_load_dwordx4 v[240:243], v1, s[4:7], s33 offen offset:2048
    s_nop 1
    v_cvt_pk_bf16_f32 v88, v168, v169
    v_cvt_pk_bf16_f32 v89, v170, v171
    v_cvt_pk_bf16_f32 v90, v80, v81
    v_cvt_pk_bf16_f32 v91, v82, v83
    buffer_store_dwordx4 v[88:91], v1, s[4:7], s89 offen
    v_cvt_pk_bf16_f32 v92, v172, v173
    v_cvt_pk_bf16_f32 v93, v174, v175
    v_cvt_pk_bf16_f32 v94, v84, v85
    v_cvt_pk_bf16_f32 v95, v86, v87
    buffer_load_dwordx4 v[236:239], v1, s[4:7], s33 offen offset:3072
    s_mov_b64 exec, s[42:43]
    buffer_store_dwordx4 v[92:95], v1, s[4:7], s89 offen offset:1024
    s_mov_b64 exec, -1
    ds_read_b64 v[152:153], v154 offset:768
    s_waitcnt lgkmcnt(0)
    v_pk_fma_f32 v[48:49], v[128:129], v[152:153], v[48:49] op_sel_hi:[1,0,1] neg_lo:[0,1,0] neg_hi:[0,1,0]
    v_pk_fma_f32 v[50:51], v[130:131], v[152:153], v[50:51] op_sel_hi:[1,0,1] neg_lo:[0,1,0] neg_hi:[0,1,0]
    v_pk_mul_f32 v[48:49], v[48:49], v[152:153] op_sel:[0,1] op_sel_hi:[1,1]
    v_pk_mul_f32 v[50:51], v[50:51], v[152:153] op_sel:[0,1] op_sel_hi:[1,1]
    v_cvt_pk_bf16_f32 v48, v48, v49
    v_cvt_pk_bf16_f32 v49, v50, v51
    ds_write_b64 v8, v[48:49] offset:4224
    v_pk_fma_f32 v[52:53], v[132:133], v[152:153], v[52:53] op_sel_hi:[1,0,1] neg_lo:[0,1,0] neg_hi:[0,1,0]
    buffer_load_dwordx4 v[232:235], v2, s[4:7], s33 offen offset:0
    v_pk_fma_f32 v[54:55], v[134:135], v[152:153], v[54:55] op_sel_hi:[1,0,1] neg_lo:[0,1,0] neg_hi:[0,1,0]
    v_pk_mul_f32 v[52:53], v[52:53], v[152:153] op_sel:[0,1] op_sel_hi:[1,1]
    v_pk_mul_f32 v[54:55], v[54:55], v[152:153] op_sel:[0,1] op_sel_hi:[1,1]
    v_cvt_pk_bf16_f32 v52, v52, v53
    v_cvt_pk_bf16_f32 v53, v54, v55
    ds_write_b64 v8, v[52:53] offset:4240
    v_pk_fma_f32 v[56:57], v[136:137], v[152:153], v[56:57] op_sel_hi:[1,0,1] neg_lo:[0,1,0] neg_hi:[0,1,0]
    v_pk_fma_f32 v[58:59], v[138:139], v[152:153], v[58:59] op_sel_hi:[1,0,1] neg_lo:[0,1,0] neg_hi:[0,1,0]
    v_pk_mul_f32 v[56:57], v[56:57], v[152:153] op_sel:[0,1] op_sel_hi:[1,1]
    v_pk_mul_f32 v[58:59], v[58:59], v[152:153] op_sel:[0,1] op_sel_hi:[1,1]
    buffer_load_dwordx4 v[228:231], v2, s[4:7], s33 offen offset:1024
    v_cvt_pk_bf16_f32 v56, v56, v57
    v_cvt_pk_bf16_f32 v57, v58, v59
    ds_write_b64 v8, v[56:57] offset:4256
    v_pk_fma_f32 v[60:61], v[140:141], v[152:153], v[60:61] op_sel_hi:[1,0,1] neg_lo:[0,1,0] neg_hi:[0,1,0]
    v_pk_fma_f32 v[62:63], v[142:143], v[152:153], v[62:63] op_sel_hi:[1,0,1] neg_lo:[0,1,0] neg_hi:[0,1,0]
    v_pk_mul_f32 v[60:61], v[60:61], v[152:153] op_sel:[0,1] op_sel_hi:[1,1]
    v_pk_mul_f32 v[62:63], v[62:63], v[152:153] op_sel:[0,1] op_sel_hi:[1,1]
    v_cvt_pk_bf16_f32 v60, v60, v61
    v_cvt_pk_bf16_f32 v61, v62, v63
    ds_write_b64 v8, v[60:61] offset:4272
    buffer_load_dwordx4 v[224:227], v2, s[4:7], s33 offen offset:2048
    s_waitcnt vmcnt(11)
    ds_write2_b64 v4, v[156:157], v[158:159] offset1:1
    v_mov_b32 v30, 1
    s_mov_b64 exec, 1
    s_cmp_lg_u32 s28, 0
    s_waitcnt vmcnt(3)
    s_cbranch_scc1 pubs_83
    buffer_store_dword v30, off, s[4:7], s32
pubd_84:
    s_mov_b64 exec, -1
    s_waitcnt lgkmcnt(0)
    s_barrier
    ds_read2_b64 v[160:163], v11 offset0:10 offset1:14
    ds_read2_b64 v[164:167], v10 offset0:0 offset1:4
    ds_read2_b64 v[168:171], v11 offset0:0 offset1:4
    ds_read2_b64 v[172:175], v11 offset0:15 offset1:19
    ds_read2_b64 v[80:83], v10 offset0:5 offset1:9
    ds_read2_b64 v[84:87], v11 offset0:5 offset1:9
    s_add_u32 s89, s93, 3145728
    s_waitcnt lgkmcnt(5)
    v_cndmask_b32 v162, 0, v162, s[50:51]
    v_cndmask_b32 v163, 0, v163, s[50:51]
    s_waitcnt lgkmcnt(2)
    v_cndmask_b32 v174, 0, v174, s[50:51]
    buffer_load_dwordx4 v[220:223], v2, s[4:7], s33 offen offset:3072
    v_cndmask_b32 v175, 0, v175, s[50:51]
    s_waitcnt lgkmcnt(0)
    v_mfma_f32_16x16x32_bf16 v[88:91], v[164:167], v[160:163], 0
    v_mfma_f32_16x16x32_bf16 v[92:95], v[168:171], v[160:163], 0
    v_mfma_f32_16x16x32_bf16 v[160:163], v[80:83], v[172:175], 0
    v_mfma_f32_16x16x32_bf16 v[164:167], v[84:87], v[172:175], 0
    ds_read_b64_tr_b16 v[80:81], v12 offset:0
    ds_read_b64_tr_b16 v[82:83], v12 offset:4224
    ds_read_b64_tr_b16 v[84:85], v12 offset:32
    ds_read_b64_tr_b16 v[86:87], v12 offset:4256
    v_mov_b32 v174, s66
    v_cndmask_b32 v88, v88, v89, s[44:45]
    v_cndmask_b32 v90, v90, v91, s[44:45]
    v_cndmask_b32 v92, v92, v93, s[44:45]
    v_cndmask_b32 v94, v94, v95, s[44:45]
    buffer_load_dwordx4 v[216:219], v3, s[4:7], s33 offen offset:0
    v_cndmask_b32 v168, v92, v88, s[46:47]
    v_cndmask_b32 v169, v94, v90, s[48:49]
    v_cndmask_b32 v168, v168, v174, s[52:53]
    v_cndmask_b32 v169, v169, v174, s[54:55]
    v_max_f32 v172, v168, v169
    v_cndmask_b32 v160, v160, v161, s[44:45]
    v_cndmask_b32 v162, v162, v163, s[44:45]
    v_cndmask_b32 v164, v164, v165, s[44:45]
    v_cndmask_b32 v166, v166, v167, s[44:45]
    v_cndmask_b32 v170, v164, v160, s[46:47]
    v_cndmask_b32 v171, v166, v162, s[48:49]
    v_cndmask_b32 v170, v170, v174, s[52:53]
    v_cndmask_b32 v171, v171, v174, s[54:55]
    buffer_load_dwordx4 v[212:215], v3, s[4:7], s33 offen offset:1024
    v_max_f32 v173, v170, v171
    s_nop 1
    v_permlane16_swap_b32 v172, v173
    v_max_f32 v172, v172, v173
    v_mov_b32 v173, v172
    ds_read_b64_tr_b16 v[88:89], v12 offset:40
    ds_read_b64_tr_b16 v[90:91], v12 offset:4264
    v_permlane32_swap_b32 v172, v173
    v_max_f32 v172, v172, v173
    v_mov_b32 v173, v172
    ds_read_b64_tr_b16 v[92:93], v12 offset:72
    ds_read_b64_tr_b16 v[94:95], v12 offset:4296
    v_permlane16_swap_b32 v172, v173
    v_mul_f32 v172, s63, v172
    buffer_load_dwordx4 v[208:211], v3, s[4:7], s33 offen offset:2048
    v_mul_f32 v173, s63, v173
    v_fma_f32 v168, v168, s63, -v172
    v_fma_f32 v169, v169, s63, -v172
    v_fma_f32 v170, v170, s63, -v173
    v_fma_f32 v171, v171, s63, -v173
    v_exp_f32 v168, v168
    v_exp_f32 v169, v169
    v_exp_f32 v170, v170
    v_exp_f32 v171, v171
    v_add_f32 v172, v168, v169
    v_add_f32 v173, v170, v171
    s_nop 1
    v_permlane16_swap_b32 v172, v173
    v_add_f32 v172, v172, v173
    buffer_load_dwordx4 v[204:207], v3, s[4:7], s33 offen offset:3072
    v_mov_b32 v173, v172
    v_subrev_u32 v10, s1, v10
    v_subrev_u32 v11, s1, v11
    v_permlane32_swap_b32 v172, v173
    v_add_f32 v172, v172, v173
    v_mov_b32 v173, v172
    v_subrev_u32 v12, s1, v12
    s_nop 0
    v_permlane16_swap_b32 v172, v173
    v_rcp_f32 v172, v172
    v_rcp_f32 v173, v173
    v_mul_f32 v168, v168, v172
    v_mul_f32 v169, v169, v172
    v_mul_f32 v170, v170, v173
    s_add_u32 s33, s61, 12288
    buffer_load_dwordx4 v[200:203], v1, s[4:7], s33 offen offset:0
    v_mul_f32 v171, v171, v173
    v_cvt_pk_bf16_f32 v168, v168, v168
    v_cvt_pk_bf16_f32 v169, v169, v169
    v_and_b32 v160, v13, v168
    v_and_b32 v161, v14, v169
    v_and_b32 v162, v15, v168
    v_and_b32 v163, v16, v169
    v_cvt_pk_bf16_f32 v170, v170, v170
    v_cvt_pk_bf16_f32 v171, v171, v171
    v_and_b32 v164, v13, v170
    v_and_b32 v165, v14, v171
    v_and_b32 v166, v15, v170
    v_and_b32 v167, v16, v171
    buffer_load_dwordx4 v[196:199], v1, s[4:7], s33 offen offset:1024
    s_waitcnt lgkmcnt(0)
    v_mfma_f32_16x16x32_bf16 v[168:171], v[80:83], v[160:163], 0
    v_mfma_f32_16x16x32_bf16 v[172:175], v[84:87], v[160:163], 0
    v_mfma_f32_16x16x32_bf16 v[80:83], v[88:91], v[164:167], 0
    v_mfma_f32_16x16x32_bf16 v[84:87], v[92:95], v[164:167], 0
    s_nop 4
    v_cvt_pk_bf16_f32 v88, v168, v169
    v_cvt_pk_bf16_f32 v89, v170, v171
    v_cvt_pk_bf16_f32 v90, v80, v81
    v_cvt_pk_bf16_f32 v91, v82, v83
    buffer_store_dwordx4 v[88:91], v1, s[4:7], s89 offen
    v_cvt_pk_bf16_f32 v92, v172, v173
    v_cvt_pk_bf16_f32 v93, v174, v175
    v_cvt_pk_bf16_f32 v94, v84, v85
    v_cvt_pk_bf16_f32 v95, v86, v87
    s_mov_b64 exec, s[42:43]
    buffer_store_dwordx4 v[92:95], v1, s[4:7], s89 offen offset:1024
    s_mov_b64 exec, -1
    v_mov_b32 v30, 2
    s_mov_b64 exec, 1
    s_cmp_lg_u32 s28, 0
    s_waitcnt vmcnt(0)
    s_cbranch_scc1 pubs_85
    buffer_store_dword v30, off, s[4:7], s32
pubd_86:
    s_mov_b64 exec, -1
    s_barrier
    buffer_load_dwordx4 v[164:167], v1, s[4:7], s33 offen offset:2048
    buffer_load_dwordx4 v[168:171], v1, s[4:7], s33 offen offset:3072
    buffer_load_dwordx4 v[172:175], v2, s[4:7], s33 offen offset:0
    buffer_load_dword v29, v5, s[4:7], s31 offen sc1
    s_waitcnt vmcnt(0)
poll_88:
    v_cmp_le_u32 vcc, 2, v29
    s_nop 0
    s_andn2_b64 s[56:57], s[34:35], vcc
    s_cbranch_scc1 pollr_87
    s_cmp_lg_u32 s28, 0
    s_cbranch_scc1 acq_89
polld_90:
    s_add_u32 m0, s83, 4096
    s_nop 0
    buffer_load_dwordx4 v1, s[4:7], s75 offen offset:0 sc1 lds
    s_add_u32 m0, s83, 5120
    s_nop 0
    buffer_load_dwordx4 v1, s[4:7], s76 offen offset:0 sc1 lds
    s_add_u32 m0, s83, 6144
    s_nop 0
    buffer_load_dwordx4 v1, s[4:7], s77 offen offset:0 sc1 lds
    s_add_u32 m0, s83, 6144
    s_nop 0
    buffer_load_dwordx4 v1, s[4:7], s75 offen offset:1024 sc1 lds
    s_add_u32 m0, s83, 7168
    s_nop 0
    buffer_load_dwordx4 v1, s[4:7], s76 offen offset:1024 sc1 lds
    s_add_u32 m0, s83, 8192
    s_nop 0
    buffer_load_dwordx4 v1, s[4:7], s77 offen offset:1024 sc1 lds
    s_add_u32 m0, s83, 10240
    s_nop 0
    buffer_load_dwordx4 v1, s[4:7], s74 offen offset:0 sc1 lds
    s_add_u32 m0, s83, 10240
    s_nop 0
    buffer_load_dwordx4 v1, s[4:7], s74 offen offset:1024 sc1 lds
    s_waitcnt vmcnt(7)
    ds_read_b128 v[128:131], v33 offset:0
    s_waitcnt vmcnt(6)
    ds_read_b128 v[132:135], v33 offset:1024
    s_waitcnt vmcnt(5)
    ds_read_b128 v[136:139], v33 offset:2048
    s_waitcnt lgkmcnt(2)
    v_mfma_f32_16x16x32_bf16 v[68:71], a[160:163], v[128:131], 0
    s_add_u32 m0, s83, 10240
    s_waitcnt vmcnt(4)
    ds_read_b128 v[140:143], v33 offset:3072
    v_mfma_f32_16x16x32_bf16 v[72:75], a[164:167], v[128:131], 0
    buffer_load_dwordx4 v1, s[4:7], s75 offen offset:2048 sc1 lds
    v_mfma_f32_16x16x32_bf16 v[76:79], a[168:171], v[128:131], 0
    s_add_u32 m0, s83, 10240
    s_nop 0
    buffer_load_dwordx4 v1, s[4:7], s75 offen offset:3072 sc1 lds
    v_mfma_f32_16x16x32_bf16 v[80:83], a[172:175], v[128:131], 0
    s_add_u32 m0, s83, 14336
    v_lshlrev_b32 v48, 16, v36
    v_and_b32 v49, 0xffff0000, v36
    v_mfma_f32_16x16x32_bf16 v[84:87], a[176:179], v[128:131], 0
    s_waitcnt lgkmcnt(2)
    buffer_load_dwordx4 v2, s[4:7], s75 offen offset:0 sc1 lds
    v_mfma_f32_16x16x32_bf16 v[88:91], a[160:163], v[132:135], 0
    s_add_u32 m0, s83, 13312
    s_waitcnt vmcnt(6)
    ds_read_b128 v[128:131], v33 offset:4096
    v_mfma_f32_16x16x32_bf16 v[92:95], a[164:167], v[132:135], 0
    buffer_load_dwordx4 v1, s[4:7], s76 offen offset:2048 sc1 lds
    v_mfma_f32_16x16x32_bf16 v[96:99], a[168:171], v[132:135], 0
    s_add_u32 m0, s83, 13312
    s_nop 0
    buffer_load_dwordx4 v1, s[4:7], s76 offen offset:3072 sc1 lds
    v_mfma_f32_16x16x32_bf16 v[100:103], a[172:175], v[132:135], 0
    s_add_u32 m0, s83, 17408
    v_lshlrev_b32 v50, 16, v37
    v_and_b32 v51, 0xffff0000, v37
    v_mfma_f32_16x16x32_bf16 v[104:107], a[176:179], v[132:135], 0
    s_waitcnt lgkmcnt(2)
    v_lshlrev_b32 v52, 16, v38
    v_and_b32 v53, 0xffff0000, v38
    v_mfma_f32_16x16x32_bf16 v[108:111], a[160:163], v[136:139], 0
    s_waitcnt vmcnt(7)
    ds_read_b128 v[132:135], v33 offset:5120
    v_lshlrev_b32 v54, 16, v39
    v_mfma_f32_16x16x32_bf16 v[112:115], a[164:167], v[136:139], 0
    buffer_load_dwordx4 v2, s[4:7], s76 offen offset:0 sc1 lds
    v_mfma_f32_16x16x32_bf16 v[116:119], a[168:171], v[136:139], 0
    s_add_u32 m0, s83, 16384
    v_and_b32 v55, 0xffff0000, v39
    v_lshlrev_b32 v56, 16, v40
    v_mfma_f32_16x16x32_bf16 v[120:123], a[172:175], v[136:139], 0
    v_and_b32 v57, 0xffff0000, v40
    v_lshlrev_b32 v58, 16, v41
    v_mfma_f32_16x16x32_bf16 v[124:127], a[176:179], v[136:139], 0
    s_waitcnt lgkmcnt(2)
    buffer_load_dwordx4 v1, s[4:7], s77 offen offset:2048 sc1 lds
    v_mfma_f32_16x16x32_bf16 v[68:71], a[180:183], v[140:143], v[68:71]
    s_add_u32 m0, s83, 16384
    s_waitcnt vmcnt(8)
    ds_read_b128 v[136:139], v33 offset:6144
    v_mfma_f32_16x16x32_bf16 v[72:75], a[184:187], v[140:143], v[72:75]
    v_and_b32 v59, 0xffff0000, v41
    v_lshlrev_b32 v60, 16, v42
    v_mfma_f32_16x16x32_bf16 v[76:79], a[188:191], v[140:143], v[76:79]
    buffer_load_dwordx4 v1, s[4:7], s77 offen offset:3072 sc1 lds
    v_mfma_f32_16x16x32_bf16 v[80:83], a[192:195], v[140:143], v[80:83]
    s_add_u32 m0, s83, 20480
    v_and_b32 v61, 0xffff0000, v42
    v_lshlrev_b32 v62, 16, v43
    v_mfma_f32_16x16x32_bf16 v[84:87], a[196:199], v[140:143], v[84:87]
    s_waitcnt lgkmcnt(2)
    v_and_b32 v63, 0xffff0000, v43
    v_lshlrev_b32 v64, 16, v44
    v_mfma_f32_16x16x32_bf16 v[88:91], a[180:183], v[128:131], v[88:91]
    s_waitcnt vmcnt(8)
    ds_read_b128 v[140:143], v33 offset:7168
    v_and_b32 v65, 0xffff0000, v44
    v_mfma_f32_16x16x32_bf16 v[92:95], a[184:187], v[128:131], v[92:95]
    buffer_load_dwordx4 v2, s[4:7], s77 offen offset:0 sc1 lds
    v_mfma_f32_16x16x32_bf16 v[96:99], a[188:191], v[128:131], v[96:99]
    s_add_u32 m0, s83, 19456
    v_lshlrev_b32 v66, 16, v45
    v_and_b32 v67, 0xffff0000, v45
    v_mfma_f32_16x16x32_bf16 v[100:103], a[192:195], v[128:131], v[100:103]
    v_mfma_f32_16x16x32_bf16 v[104:107], a[196:199], v[128:131], v[104:107]
    s_waitcnt lgkmcnt(2)
    buffer_load_dwordx4 v1, s[4:7], s74 offen offset:2048 sc1 lds
    v_mfma_f32_16x16x32_bf16 v[108:111], a[180:183], v[132:135], v[108:111]
    s_add_u32 m0, s83, 19456
    s_waitcnt vmcnt(9)
    ds_read_b128 v[128:131], v33 offset:8192
    v_mfma_f32_16x16x32_bf16 v[112:115], a[184:187], v[132:135], v[112:115]
    v_mfma_f32_16x16x32_bf16 v[116:119], a[188:191], v[132:135], v[116:119]
    v_mfma_f32_16x16x32_bf16 v[120:123], a[192:195], v[132:135], v[120:123]
    buffer_load_dwordx4 v1, s[4:7], s74 offen offset:3072 sc1 lds
    v_mfma_f32_16x16x32_bf16 v[124:127], a[196:199], v[132:135], v[124:127]
    s_waitcnt lgkmcnt(2)
    v_mfma_f32_16x16x32_bf16 v[48:51], a[160:163], v[136:139], v[48:51]
    s_add_u32 m0, s83, 23552
    s_waitcnt vmcnt(9)
    ds_read_b128 v[132:135], v33 offset:9216
    v_mfma_f32_16x16x32_bf16 v[52:55], a[164:167], v[136:139], v[52:55]
    buffer_load_dwordx4 v2, s[4:7], s74 offen offset:0 sc1 lds
    v_mfma_f32_16x16x32_bf16 v[56:59], a[168:171], v[136:139], v[56:59]
    v_mfma_f32_16x16x32_bf16 v[60:63], a[172:175], v[136:139], v[60:63]
    v_mfma_f32_16x16x32_bf16 v[64:67], a[176:179], v[136:139], v[64:67]
    s_waitcnt lgkmcnt(2)
    v_mfma_f32_16x16x32_bf16 v[48:51], a[180:183], v[140:143], v[48:51]
    s_waitcnt vmcnt(9)
    ds_read_b128 v[136:139], v33 offset:10240
    v_mfma_f32_16x16x32_bf16 v[52:55], a[184:187], v[140:143], v[52:55]
    buffer_load_dwordx4 v[192:195], v2, s[4:7], s33 offen offset:1024
    v_mfma_f32_16x16x32_bf16 v[56:59], a[188:191], v[140:143], v[56:59]
    v_mfma_f32_16x16x32_bf16 v[60:63], a[192:195], v[140:143], v[60:63]
    v_mfma_f32_16x16x32_bf16 v[64:67], a[196:199], v[140:143], v[64:67]
    s_waitcnt lgkmcnt(2)
    buffer_load_dwordx4 v[188:191], v2, s[4:7], s33 offen offset:2048
    v_mfma_f32_16x16x32_bf16 v[68:71], a[200:203], v[128:131], v[68:71]
    s_waitcnt vmcnt(10)
    ds_read_b128 v[140:143], v33 offset:11264
    v_mfma_f32_16x16x32_bf16 v[72:75], a[204:207], v[128:131], v[72:75]
    v_mfma_f32_16x16x32_bf16 v[76:79], a[208:211], v[128:131], v[76:79]
    buffer_load_dwordx4 v[184:187], v2, s[4:7], s33 offen offset:3072
    v_mfma_f32_16x16x32_bf16 v[80:83], a[212:215], v[128:131], v[80:83]
    v_mfma_f32_16x16x32_bf16 v[84:87], a[216:219], v[128:131], v[84:87]
    s_waitcnt lgkmcnt(2)
    v_mfma_f32_16x16x32_bf16 v[68:71], a[220:223], v[132:135], v[68:71]
    s_waitcnt vmcnt(10)
    ds_read_b128 v[128:131], v33 offset:12288
    v_mfma_f32_16x16x32_bf16 v[72:75], a[224:227], v[132:135], v[72:75]
    buffer_load_dwordx4 v[180:183], v3, s[4:7], s33 offen offset:0
    v_mfma_f32_16x16x32_bf16 v[76:79], a[228:231], v[132:135], v[76:79]
    v_mfma_f32_16x16x32_bf16 v[80:83], a[232:235], v[132:135], v[80:83]
    v_mfma_f32_16x16x32_bf16 v[84:87], a[236:239], v[132:135], v[84:87]
    s_waitcnt lgkmcnt(2)
    buffer_load_dwordx4 v[176:179], v3, s[4:7], s33 offen offset:1024
    v_mfma_f32_16x16x32_bf16 v[68:71], a[240:243], v[136:139], v[68:71]
    s_waitcnt vmcnt(11)
    ds_read_b128 v[132:135], v33 offset:13312
    v_mfma_f32_16x16x32_bf16 v[72:75], a[244:247], v[136:139], v[72:75]
    v_mfma_f32_16x16x32_bf16 v[76:79], a[248:251], v[136:139], v[76:79]
    v_mfma_f32_16x16x32_bf16 v[80:83], a[252:255], v[136:139], v[80:83]
    buffer_load_dwordx4 a[160:163], v3, s[4:7], s33 offen offset:2048
    v_mfma_f32_16x16x32_bf16 v[84:87], v[252:255], v[136:139], v[84:87]
    s_waitcnt lgkmcnt(2)
    v_mfma_f32_16x16x32_bf16 v[88:91], a[200:203], v[140:143], v[88:91]
    s_waitcnt vmcnt(11)
    ds_read_b128 v[136:139], v33 offset:14336
    v_mfma_f32_16x16x32_bf16 v[92:95], a[204:207], v[140:143], v[92:95]
    buffer_load_dwordx4 a[164:167], v3, s[4:7], s33 offen offset:3072
    v_mfma_f32_16x16x32_bf16 v[96:99], a[208:211], v[140:143], v[96:99]
    s_add_u32 s33, s61, 24576
    ds_write_b128 v20, v[68:71] offset:0
    v_mfma_f32_16x16x32_bf16 v[100:103], a[212:215], v[140:143], v[100:103]
    v_mfma_f32_16x16x32_bf16 v[104:107], a[216:219], v[140:143], v[104:107]
    s_waitcnt lgkmcnt(3)
    v_mfma_f32_16x16x32_bf16 v[88:91], a[220:223], v[128:131], v[88:91]
    s_waitcnt vmcnt(11)
    ds_read_b128 v[140:143], v33 offset:15360
    v_mfma_f32_16x16x32_bf16 v[92:95], a[224:227], v[128:131], v[92:95]
    buffer_load_dwordx4 a[168:171], v1, s[4:7], s33 offen offset:0
    v_mfma_f32_16x16x32_bf16 v[96:99], a[228:231], v[128:131], v[96:99]
    ds_write_b128 v20, v[72:75] offset:1024
    v_mfma_f32_16x16x32_bf16 v[100:103], a[232:235], v[128:131], v[100:103]
    v_mfma_f32_16x16x32_bf16 v[104:107], a[236:239], v[128:131], v[104:107]
    s_waitcnt lgkmcnt(4)
    buffer_load_dwordx4 a[172:175], v1, s[4:7], s33 offen offset:1024
    v_mfma_f32_16x16x32_bf16 v[88:91], a[240:243], v[132:135], v[88:91]
    s_waitcnt vmcnt(12)
    ds_read_b128 v[128:131], v33 offset:16384
    v_mfma_f32_16x16x32_bf16 v[92:95], a[244:247], v[132:135], v[92:95]
    ds_write_b128 v20, v[76:79] offset:2048
    v_mfma_f32_16x16x32_bf16 v[96:99], a[248:251], v[132:135], v[96:99]
    v_mfma_f32_16x16x32_bf16 v[100:103], a[252:255], v[132:135], v[100:103]
    buffer_load_dwordx4 a[176:179], v1, s[4:7], s33 offen offset:2048
    v_mfma_f32_16x16x32_bf16 v[104:107], v[252:255], v[132:135], v[104:107]
    s_waitcnt lgkmcnt(5)
    ds_write_b128 v20, v[80:83] offset:3072
    v_mfma_f32_16x16x32_bf16 v[108:111], a[200:203], v[136:139], v[108:111]
    s_waitcnt vmcnt(12)
    ds_read_b128 v[132:135], v33 offset:17408
    v_mfma_f32_16x16x32_bf16 v[112:115], a[204:207], v[136:139], v[112:115]
    v_mfma_f32_16x16x32_bf16 v[116:119], a[208:211], v[136:139], v[116:119]
    ds_write_b128 v20, v[84:87] offset:4096
    v_mfma_f32_16x16x32_bf16 v[120:123], a[212:215], v[136:139], v[120:123]
    v_mfma_f32_16x16x32_bf16 v[124:127], a[216:219], v[136:139], v[124:127]
    s_waitcnt lgkmcnt(6)
    buffer_load_dwordx4 a[180:183], v1, s[4:7], s33 offen offset:3072
    v_mfma_f32_16x16x32_bf16 v[108:111], a[220:223], v[140:143], v[108:111]
    s_waitcnt vmcnt(12)
    ds_read_b128 v[136:139], v33 offset:18432
    v_mfma_f32_16x16x32_bf16 v[112:115], a[224:227], v[140:143], v[112:115]
    v_mfma_f32_16x16x32_bf16 v[116:119], a[228:231], v[140:143], v[116:119]
    ds_write_b128 v21, v[88:91] offset:0
    v_mfma_f32_16x16x32_bf16 v[120:123], a[232:235], v[140:143], v[120:123]
    v_mfma_f32_16x16x32_bf16 v[124:127], a[236:239], v[140:143], v[124:127]
    s_waitcnt lgkmcnt(6)
    v_mfma_f32_16x16x32_bf16 v[108:111], a[240:243], v[128:131], v[108:111]
    s_waitcnt vmcnt(11)
    ds_read_b128 v[140:143], v33 offset:19456
    v_mfma_f32_16x16x32_bf16 v[112:115], a[244:247], v[128:131], v[112:115]
    buffer_load_dwordx4 a[184:187], v2, s[4:7], s33 offen offset:0
    v_mfma_f32_16x16x32_bf16 v[116:119], a[248:251], v[128:131], v[116:119]
    ds_write_b128 v21, v[92:95] offset:1024
    v_mfma_f32_16x16x32_bf16 v[120:123], a[252:255], v[128:131], v[120:123]
    v_mfma_f32_16x16x32_bf16 v[124:127], v[252:255], v[128:131], v[124:127]
    s_waitcnt lgkmcnt(5)
    ds_write_b128 v21, v[96:99] offset:2048
    ds_write_b128 v21, v[100:103] offset:3072
    buffer_load_dwordx4 a[188:191], v2, s[4:7], s33 offen offset:1024
    ds_write_b128 v21, v[104:107] offset:4096
    s_waitcnt lgkmcnt(0)
    s_barrier
    v_mfma_f32_16x16x32_bf16 v[48:51], a[200:203], v[132:135], v[48:51]
    s_add_u32 s33, s62, 0
    ds_read_b128 v[68:71], v23 offset:0
    ds_read_b128 v[88:91], v23 offset:5120
    v_mfma_f32_16x16x32_bf16 v[52:55], a[204:207], v[132:135], v[52:55]
    ds_write_b128 v22, v[108:111] offset:0
    v_mfma_f32_16x16x32_bf16 v[56:59], a[208:211], v[132:135], v[56:59]
    buffer_load_dwordx4 a[192:195], v1, s[4:7], s33 offen offset:0
    v_mfma_f32_16x16x32_bf16 v[60:63], a[212:215], v[132:135], v[60:63]
    ds_read_b128 v[72:75], v23 offset:1024
    ds_read_b128 v[92:95], v23 offset:6144
    v_mfma_f32_16x16x32_bf16 v[64:67], a[216:219], v[132:135], v[64:67]
    ds_write_b128 v22, v[112:115] offset:1024
    v_mfma_f32_16x16x32_bf16 v[48:51], a[220:223], v[136:139], v[48:51]
    ds_read_b128 v[76:79], v23 offset:2048
    ds_read_b128 v[96:99], v23 offset:7168
    v_mfma_f32_16x16x32_bf16 v[52:55], a[224:227], v[136:139], v[52:55]
    buffer_load_dwordx4 a[196:199], v1, s[4:7], s33 offen offset:1024
    v_mfma_f32_16x16x32_bf16 v[56:59], a[228:231], v[136:139], v[56:59]
    ds_write_b128 v22, v[116:119] offset:2048
    v_mfma_f32_16x16x32_bf16 v[60:63], a[232:235], v[136:139], v[60:63]
    ds_read_b128 v[80:83], v23 offset:3072
    ds_read_b128 v[100:103], v23 offset:8192
    v_mfma_f32_16x16x32_bf16 v[64:67], a[236:239], v[136:139], v[64:67]
    ds_write_b128 v22, v[120:123] offset:3072
    v_mfma_f32_16x16x32_bf16 v[48:51], a[240:243], v[140:143], v[48:51]
    buffer_load_dwordx4 a[200:203], v1, s[4:7], s33 offen offset:2048
    v_mfma_f32_16x16x32_bf16 v[52:55], a[244:247], v[140:143], v[52:55]
    ds_read_b128 v[84:87], v23 offset:4096
    ds_read_b128 v[104:107], v23 offset:9216
    v_mfma_f32_16x16x32_bf16 v[56:59], a[248:251], v[140:143], v[56:59]
    ds_write_b128 v22, v[124:127] offset:4096
    v_mfma_f32_16x16x32_bf16 v[60:63], a[252:255], v[140:143], v[60:63]
    s_waitcnt lgkmcnt(13)
    v_add_f32 v68, v68, v88
    v_add_f32 v69, v69, v89
    v_mfma_f32_16x16x32_bf16 v[64:67], v[252:255], v[140:143], v[64:67]
    buffer_load_dwordx4 a[204:207], v1, s[4:7], s33 offen offset:3072
    s_waitcnt lgkmcnt(0)
    s_barrier
    ds_read_b128 v[108:111], v23 offset:10240
    ds_read_b128 v[112:115], v23 offset:11264
    ds_read_b128 v[116:119], v23 offset:12288
    ds_read_b128 v[120:123], v23 offset:13312
    ds_read_b128 v[124:127], v23 offset:14336
    buffer_load_dword v29, v5, s[4:7], s31 offen sc1
    v_add_f32 v70, v70, v90
    v_add_f32 v71, v71, v91
    v_add_f32 v72, v72, v92
    v_add_f32 v73, v73, v93
    v_add_f32 v74, v74, v94
    v_add_f32 v75, v75, v95
    v_add_f32 v76, v76, v96
    v_add_f32 v77, v77, v97
    v_add_f32 v78, v78, v98
    v_add_f32 v79, v79, v99
    buffer_load_dwordx4 a[208:211], v2, s[4:7], s33 offen offset:0
    v_add_f32 v80, v80, v100
    v_add_f32 v81, v81, v101
    v_add_f32 v82, v82, v102
    v_add_f32 v83, v83, v103
    v_add_f32 v84, v84, v104
    v_add_f32 v85, v85, v105
    v_add_f32 v86, v86, v106
    v_add_f32 v87, v87, v107
    v_pk_add_f32 v[48:49], v[48:49], v[68:69]
    v_pk_add_f32 v[50:51], v[50:51], v[70:71]
    v_pk_add_f32 v[52:53], v[52:53], v[72:73]
    v_pk_add_f32 v[54:55], v[54:55], v[74:75]
    v_pk_add_f32 v[56:57], v[56:57], v[76:77]
    buffer_load_dwordx4 a[212:215], v2, s[4:7], s33 offen offset:1024
    v_pk_add_f32 v[58:59], v[58:59], v[78:79]
    v_pk_add_f32 v[60:61], v[60:61], v[80:81]
    v_pk_add_f32 v[62:63], v[62:63], v[82:83]
    v_pk_add_f32 v[64:65], v[64:65], v[84:85]
    v_pk_add_f32 v[66:67], v[66:67], v[86:87]
    s_waitcnt lgkmcnt(4)
    v_pk_add_f32 v[48:49], v[48:49], v[108:109]
    v_pk_add_f32 v[50:51], v[50:51], v[110:111]
    v_cvt_pk_bf16_f32 v36, v48, v49
    v_cvt_pk_bf16_f32 v37, v50, v51
    s_waitcnt lgkmcnt(3)
    v_pk_add_f32 v[52:53], v[52:53], v[112:113]
    v_pk_add_f32 v[54:55], v[54:55], v[114:115]
    v_cvt_pk_bf16_f32 v38, v52, v53
    v_cvt_pk_bf16_f32 v39, v54, v55
    buffer_store_dwordx4 v[36:39], v1, s[4:7], s95 offen
    s_waitcnt lgkmcnt(2)
    v_pk_add_f32 v[56:57], v[56:57], v[116:117]
    buffer_load_dwordx4 a[216:219], v2, s[4:7], s33 offen offset:2048
    v_pk_add_f32 v[58:59], v[58:59], v[118:119]
    v_cvt_pk_bf16_f32 v40, v56, v57
    v_cvt_pk_bf16_f32 v41, v58, v59
    s_waitcnt lgkmcnt(1)
    v_pk_add_f32 v[60:61], v[60:61], v[120:121]
    v_pk_add_f32 v[62:63], v[62:63], v[122:123]
    v_cvt_pk_bf16_f32 v42, v60, v61
    v_cvt_pk_bf16_f32 v43, v62, v63
    buffer_store_dwordx4 v[40:43], v1, s[4:7], s95 offen offset:1024
    s_waitcnt lgkmcnt(0)
    v_pk_add_f32 v[64:65], v[64:65], v[124:125]
    v_pk_add_f32 v[66:67], v[66:67], v[126:127]
    v_cvt_pk_bf16_f32 v44, v64, v65
    v_cvt_pk_bf16_f32 v45, v66, v67
    buffer_store_dwordx2 v[44:45], v25, s[4:7], s96 offen
    v_dot2_f32_bf16 v31, v36, s30, 0
    v_dot2_f32_bf16 v32, v36, v36, 0
    v_dot2_f32_bf16 v31, v37, s30, v31
    v_dot2_f32_bf16 v32, v37, v37, v32
    buffer_load_dwordx4 a[220:223], v2, s[4:7], s33 offen offset:3072
    v_dot2_f32_bf16 v31, v38, s30, v31
    v_dot2_f32_bf16 v32, v38, v38, v32
    v_dot2_f32_bf16 v31, v39, s30, v31
    v_dot2_f32_bf16 v32, v39, v39, v32
    v_dot2_f32_bf16 v31, v40, s30, v31
    v_dot2_f32_bf16 v32, v40, v40, v32
    v_dot2_f32_bf16 v31, v41, s30, v31
    v_dot2_f32_bf16 v32, v41, v41, v32
    v_dot2_f32_bf16 v31, v42, s30, v31
    v_dot2_f32_bf16 v32, v42, v42, v32
    v_dot2_f32_bf16 v31, v43, s30, v31
    v_dot2_f32_bf16 v32, v43, v43, v32
    v_dot2_f32_bf16 v31, v44, s30, v31
    v_dot2_f32_bf16 v32, v44, v44, v32
    buffer_load_dwordx4 a[224:227], v3, s[4:7], s33 offen offset:0
    v_dot2_f32_bf16 v31, v45, s30, v31
    v_dot2_f32_bf16 v32, v45, v45, v32
    s_nop 2
    v_permlane16_swap_b32 v31, v32
    v_add_f32 v31, v31, v32
    v_mov_b32 v32, v31
    s_nop 1
    v_permlane32_swap_b32 v31, v32
    v_add_f32 v34, v31, v32
    s_mov_b64 exec, s[36:37]
    buffer_store_dword v34, v28, s[4:7], s97 offen
    s_mov_b64 exec, -1
    s_waitcnt vmcnt(9)
poll_92:
    v_cmp_le_u32 vcc, 3, v29
    s_nop 0
    s_andn2_b64 s[56:57], s[36:37], vcc
    s_cbranch_scc1 pollr_91
    s_cmp_lg_u32 s28, 0
    s_cbranch_scc1 acq_93
polld_94:
    s_add_u32 m0, s72, 4096
    s_nop 0
    buffer_load_dwordx4 v1, s[12:15], m0 offen offset:0 sc1 lds
    s_add_u32 m0, s72, 8192
    s_nop 0
    buffer_load_dwordx4 v1, s[12:15], m0 offen offset:0 sc1 lds
    s_add_u32 m0, s72, 12288
    s_nop 0
    buffer_load_dwordx4 v1, s[12:15], m0 offen offset:0 sc1 lds
    s_add_u32 m0, s72, 16384
    s_nop 0
    buffer_load_dwordx4 v1, s[12:15], m0 offen offset:0 sc1 lds
    s_add_u32 m0, s72, 20480
    s_nop 0
    buffer_load_dwordx4 v1, s[12:15], m0 offen offset:0 sc1 lds
    s_add_u32 s88, s98, 0
    buffer_load_dwordx4 v[144:147], v1, s[4:7], s88 offen sc1
    v_mov_b32 v30, 3
    s_mov_b64 exec, 1
    s_cmp_lg_u32 s28, 0
    s_waitcnt vmcnt(6)
    s_cbranch_scc1 pubs_95
    buffer_store_dword v30, off, s[4:7], s32
pubd_96:
    s_mov_b64 exec, -1
    s_waitcnt vmcnt(2)
    s_barrier
    ds_read_b128 v[96:99], v7 offset:0
    ds_read_b128 v[100:103], v7 offset:2048
    ds_read_b128 v[104:107], v7 offset:4096
    ds_read_b128 v[108:111], v7 offset:6144
    ds_read_b128 v[112:115], v7 offset:8192
    s_waitcnt lgkmcnt(3)
    v_mfma_f32_16x16x32_bf16 v[72:75], v[248:251], v[96:99], 0
    s_add_u32 m0, s73, 4096
    ds_read_b128 v[116:119], v7 offset:10240
    v_mfma_f32_16x16x32_bf16 v[76:79], v[244:247], v[96:99], 0
    buffer_load_dwordx4 v1, s[12:15], m0 offen offset:0 sc1 lds
    v_mfma_f32_16x16x32_bf16 v[80:83], v[240:243], v[96:99], 0
    s_add_u32 m0, s73, 8192
    s_nop 0
    buffer_load_dwordx4 v1, s[12:15], m0 offen offset:0 sc1 lds
    v_mfma_f32_16x16x32_bf16 v[72:75], v[236:239], v[100:103], v[72:75]
    s_add_u32 m0, s73, 12288
    ds_read_b128 v[120:123], v7 offset:12288
    s_lshr_b32 s92, s24, 1
    v_mfma_f32_16x16x32_bf16 v[76:79], v[232:235], v[100:103], v[76:79]
    s_mul_i32 s92, s92, 192
    buffer_load_dwordx4 v1, s[12:15], m0 offen offset:0 sc1 lds
    v_mfma_f32_16x16x32_bf16 v[80:83], v[228:231], v[100:103], v[80:83]
    s_waitcnt lgkmcnt(3)
    v_add_u32 v156, s92, v24
    ds_read_b128 v[128:131], v156 offset:480
    v_mfma_f32_16x16x32_bf16 v[72:75], v[224:227], v[104:107], v[72:75]
    s_add_u32 m0, s73, 16384
    ds_read_b128 v[124:127], v7 offset:14336
    ds_read_b128 v[132:135], v156 offset:864
    v_mfma_f32_16x16x32_bf16 v[76:79], v[220:223], v[104:107], v[76:79]
    buffer_load_dwordx4 v1, s[12:15], m0 offen offset:0 sc1 lds
    v_mfma_f32_16x16x32_bf16 v[80:83], v[216:219], v[104:107], v[80:83]
    s_add_u32 m0, s73, 20480
    s_nop 0
    buffer_load_dwordx4 v1, s[12:15], m0 offen offset:0 sc1 lds
    v_mfma_f32_16x16x32_bf16 v[72:75], v[212:215], v[108:111], v[72:75]
    s_add_u32 m0, s70, 4096
    ds_read_b128 v[96:99], v7 offset:16384
    ds_read_b128 v[136:139], v156 offset:544
    v_mfma_f32_16x16x32_bf16 v[76:79], v[208:211], v[108:111], v[76:79]
    buffer_load_dwordx4 v1, s[12:15], m0 offen offset:0 sc1 lds
    v_mfma_f32_16x16x32_bf16 v[80:83], v[204:207], v[108:111], v[80:83]
    s_waitcnt lgkmcnt(6)
    ds_read_b128 v[140:143], v156 offset:928
    ds_read_b128 v[148:151], v156 offset:608
    v_mfma_f32_16x16x32_bf16 v[72:75], v[200:203], v[112:115], v[72:75]
    s_add_u32 m0, s70, 8192
    ds_read_b128 v[100:103], v7 offset:18432
    ds_read_b128 v[152:155], v156 offset:992
    v_mfma_f32_16x16x32_bf16 v[76:79], v[196:199], v[112:115], v[76:79]
    buffer_load_dwordx4 v1, s[12:15], m0 offen offset:0 sc1 lds
    v_mfma_f32_16x16x32_bf16 v[80:83], v[164:167], v[112:115], v[80:83]
    s_add_u32 m0, s70, 12288
    s_nop 0
    buffer_load_dwordx4 v1, s[12:15], m0 offen offset:0 sc1 lds
    v_mfma_f32_16x16x32_bf16 v[72:75], v[168:171], v[116:119], v[72:75]
    s_add_u32 m0, s70, 16384
    s_waitcnt vmcnt(3)
    s_barrier
    ds_read_b128 v[104:107], v7 offset:20480
    v_mfma_f32_16x16x32_bf16 v[76:79], v[172:175], v[116:119], v[76:79]
    buffer_load_dwordx4 v1, s[12:15], m0 offen offset:0 sc1 lds
    v_mfma_f32_16x16x32_bf16 v[80:83], v[192:195], v[116:119], v[80:83]
    s_waitcnt lgkmcnt(8)
    v_mfma_f32_16x16x32_bf16 v[72:75], v[188:191], v[120:123], v[72:75]
    s_add_u32 m0, s70, 20480
    ds_read_b128 v[108:111], v7 offset:22528
    v_mfma_f32_16x16x32_bf16 v[76:79], v[184:187], v[120:123], v[76:79]
    buffer_load_dwordx4 v1, s[12:15], m0 offen offset:0 sc1 lds
    v_mfma_f32_16x16x32_bf16 v[80:83], v[180:183], v[120:123], v[80:83]
    s_add_u32 m0, s71, 4096
    s_nop 0
    buffer_load_dwordx4 v1, s[12:15], m0 offen offset:0 sc1 lds
    v_mfma_f32_16x16x32_bf16 v[72:75], v[176:179], v[124:127], v[72:75]
    s_add_u32 m0, s71, 8192
    ds_read_b128 v[112:115], v7 offset:24576
    v_mfma_f32_16x16x32_bf16 v[76:79], a[160:163], v[124:127], v[76:79]
    buffer_load_dwordx4 v1, s[12:15], m0 offen offset:0 sc1 lds
    v_mfma_f32_16x16x32_bf16 v[80:83], a[164:167], v[124:127], v[80:83]
    s_waitcnt lgkmcnt(4)
    v_mfma_f32_16x16x32_bf16 v[72:75], a[168:171], v[96:99], v[72:75]
    s_add_u32 m0, s71, 12288
    ds_read_b128 v[116:119], v7 offset:26624
    v_mfma_f32_16x16x32_bf16 v[76:79], a[172:175], v[96:99], v[76:79]
    buffer_load_dword v29, v5, s[4:7], s31 offen sc1
    v_mfma_f32_16x16x32_bf16 v[80:83], a[176:179], v[96:99], v[80:83]
    buffer_load_dwordx4 v1, s[12:15], m0 offen offset:0 sc1 lds
    v_mfma_f32_16x16x32_bf16 v[72:75], a[180:183], v[100:103], v[72:75]
    s_add_u32 m0, s71, 16384
    ds_read_b128 v[120:123], v7 offset:28672
    v_add_f32 v144, v144, v146
    v_mfma_f32_16x16x32_bf16 v[76:79], a[184:187], v[100:103], v[76:79]
    buffer_load_dwordx4 v1, s[12:15], m0 offen offset:0 sc1 lds
    v_mfma_f32_16x16x32_bf16 v[80:83], a[188:191], v[100:103], v[80:83]
    s_waitcnt lgkmcnt(3)
    v_add_f32 v145, v145, v147
    v_mfma_f32_16x16x32_bf16 v[84:87], v[248:251], v[104:107], 0
    s_add_u32 m0, s71, 20480
    ds_read_b128 v[124:127], v7 offset:30720
    v_permlane16_swap_b32 v144, v145
    v_mfma_f32_16x16x32_bf16 v[88:91], v[244:247], v[104:107], 0
    buffer_load_dwordx4 v1, s[12:15], m0 offen offset:0 sc1 lds
    v_mfma_f32_16x16x32_bf16 v[92:95], v[240:243], v[104:107], 0
    v_add_f32 v144, v144, v145
    v_mov_b32 v145, v144
    v_mfma_f32_16x16x32_bf16 v[84:87], v[236:239], v[108:111], v[84:87]
    ds_read_b128 v[96:99], v7 offset:32768
    v_permlane32_swap_b32 v144, v145
    v_mfma_f32_16x16x32_bf16 v[88:91], v[232:235], v[108:111], v[88:91]
    buffer_load_dwordx4 a[228:231], v3, s[4:7], s33 offen offset:1024
    v_mfma_f32_16x16x32_bf16 v[92:95], v[228:231], v[108:111], v[92:95]
    s_waitcnt lgkmcnt(3)
    v_add_f32 v144, v144, v145
    v_mov_b32 v145, v144
    v_mfma_f32_16x16x32_bf16 v[84:87], v[224:227], v[112:115], v[84:87]
    ds_read_b128 v[100:103], v7 offset:34816
    v_permlane16_swap_b32 v144, v145
    v_mfma_f32_16x16x32_bf16 v[88:91], v[220:223], v[112:115], v[88:91]
    buffer_load_dwordx4 a[232:235], v3, s[4:7], s33 offen offset:2048
    v_mfma_f32_16x16x32_bf16 v[92:95], v[216:219], v[112:115], v[92:95]
    v_mul_f32 v146, s64, v144
    v_mul_f32 v145, s64, v145
    v_mfma_f32_16x16x32_bf16 v[84:87], v[212:215], v[116:119], v[84:87]
    ds_read_b128 v[104:107], v7 offset:36864
    v_fma_f32 v145, -v146, v146, v145
    v_mfma_f32_16x16x32_bf16 v[88:91], v[208:211], v[116:119], v[88:91]
    v_max_f32 v145, 0, v145
    v_add_f32 v145, s65, v145
    v_mfma_f32_16x16x32_bf16 v[92:95], v[204:207], v[116:119], v[92:95]
    s_waitcnt lgkmcnt(3)
    buffer_load_dwordx4 a[236:239], v3, s[4:7], s33 offen offset:3072
    v_mfma_f32_16x16x32_bf16 v[84:87], v[200:203], v[120:123], v[84:87]
    s_add_u32 s33, s62, 12288
    ds_read_b128 v[108:111], v7 offset:38912
    v_mfma_f32_16x16x32_bf16 v[88:91], v[196:199], v[120:123], v[88:91]
    v_rsq_f32 v147, v145
    v_mfma_f32_16x16x32_bf16 v[92:95], v[164:167], v[120:123], v[92:95]
    buffer_load_dwordx4 a[240:243], v1, s[4:7], s33 offen offset:0
    v_mfma_f32_16x16x32_bf16 v[84:87], v[168:171], v[124:127], v[84:87]
    s_waitcnt vmcnt(10)
    s_barrier
    ds_read_b128 v[112:115], v6 offset:0
    v_mfma_f32_16x16x32_bf16 v[88:91], v[172:175], v[124:127], v[88:91]
    v_add_u32 v144, s0, v17
    v_mfma_f32_16x16x32_bf16 v[92:95], v[192:195], v[124:127], v[92:95]
    s_waitcnt lgkmcnt(3)
    ds_write_b64 v144, v[146:147] offset:0
    v_mfma_f32_16x16x32_bf16 v[84:87], v[188:191], v[96:99], v[84:87]
    ds_read_b128 v[116:119], v6 offset:2048
    v_mfma_f32_16x16x32_bf16 v[88:91], v[184:187], v[96:99], v[88:91]
    buffer_load_dwordx4 a[244:247], v1, s[4:7], s33 offen offset:1024
    v_mfma_f32_16x16x32_bf16 v[92:95], v[180:183], v[96:99], v[92:95]
    v_mfma_f32_16x16x32_bf16 v[84:87], v[176:179], v[100:103], v[84:87]
    ds_read_b128 v[120:123], v6 offset:4096
    v_mfma_f32_16x16x32_bf16 v[88:91], a[160:163], v[100:103], v[88:91]
    buffer_load_dwordx4 a[248:251], v1, s[4:7], s33 offen offset:2048
    v_mfma_f32_16x16x32_bf16 v[92:95], a[164:167], v[100:103], v[92:95]
    s_waitcnt lgkmcnt(4)
    v_mfma_f32_16x16x32_bf16 v[84:87], a[168:171], v[104:107], v[84:87]
    ds_read_b128 v[124:127], v6 offset:6144
    v_mfma_f32_16x16x32_bf16 v[88:91], a[172:175], v[104:107], v[88:91]
    buffer_load_dwordx4 a[252:255], v1, s[4:7], s33 offen offset:3072
    v_mfma_f32_16x16x32_bf16 v[92:95], a[176:179], v[104:107], v[92:95]
    ds_write_b128 v18, v[72:75] offset:0
    v_mfma_f32_16x16x32_bf16 v[84:87], a[180:183], v[108:111], v[84:87]
    ds_read_b128 v[96:99], v6 offset:8192
    v_mfma_f32_16x16x32_bf16 v[88:91], a[184:187], v[108:111], v[88:91]
    ds_write_b128 v18, v[76:79] offset:1024
    v_mfma_f32_16x16x32_bf16 v[92:95], a[188:191], v[108:111], v[92:95]
    s_waitcnt lgkmcnt(5)
    buffer_load_dwordx4 v[252:255], v2, s[4:7], s33 offen offset:0
    ds_write_b128 v18, v[80:83] offset:2048
    v_mfma_f32_16x16x32_bf16 v[48:51], v[248:251], v[112:115], 0
    s_waitcnt vmcnt(11)
poll_98:
    v_cmp_le_u32 vcc, 3, v29
    s_nop 0
    s_andn2_b64 s[56:57], s[38:39], vcc
    s_cbranch_scc1 pollr_97
    s_cmp_lg_u32 s28, 0
    s_cbranch_scc1 acq_99
polld_100:
    ds_read_b128 v[100:103], v6 offset:10240
    v_mfma_f32_16x16x32_bf16 v[52:55], v[244:247], v[112:115], 0
    s_add_u32 m0, s72, 4096
    v_mfma_f32_16x16x32_bf16 v[56:59], v[240:243], v[112:115], 0
    buffer_load_dwordx4 v1, s[16:19], m0 offen offset:0 sc1 lds
    v_mfma_f32_16x16x32_bf16 v[48:51], v[236:239], v[116:119], v[48:51]
    s_add_u32 m0, s72, 8192
    ds_read_b128 v[104:107], v6 offset:12288
    v_mfma_f32_16x16x32_bf16 v[52:55], v[232:235], v[116:119], v[52:55]
    ds_write_b128 v18, v[84:87] offset:3072
    v_mfma_f32_16x16x32_bf16 v[56:59], v[228:231], v[116:119], v[56:59]
    s_waitcnt lgkmcnt(7)
    v_mfma_f32_16x16x32_bf16 v[48:51], v[224:227], v[120:123], v[48:51]
    ds_read_b128 v[108:111], v6 offset:14336
    v_mfma_f32_16x16x32_bf16 v[52:55], v[220:223], v[120:123], v[52:55]
    buffer_load_dwordx4 v1, s[16:19], m0 offen offset:0 sc1 lds
    v_mfma_f32_16x16x32_bf16 v[56:59], v[216:219], v[120:123], v[56:59]
    s_add_u32 m0, s72, 12288
    ds_write_b128 v18, v[88:91] offset:4096
    v_mfma_f32_16x16x32_bf16 v[48:51], v[212:215], v[124:127], v[48:51]
    ds_read_b128 v[112:115], v6 offset:16384
    v_mfma_f32_16x16x32_bf16 v[52:55], v[208:211], v[124:127], v[52:55]
    buffer_load_dwordx4 v1, s[16:19], m0 offen offset:0 sc1 lds
    v_mfma_f32_16x16x32_bf16 v[56:59], v[204:207], v[124:127], v[56:59]
    s_waitcnt lgkmcnt(5)
    ds_write_b128 v18, v[92:95] offset:5120
    v_mfma_f32_16x16x32_bf16 v[48:51], v[200:203], v[96:99], v[48:51]
    s_add_u32 m0, s72, 16384
    ds_read_b128 v[116:119], v6 offset:18432
    v_mfma_f32_16x16x32_bf16 v[52:55], v[196:199], v[96:99], v[52:55]
    buffer_load_dwordx4 v1, s[16:19], m0 offen offset:0 sc1 lds
    v_mfma_f32_16x16x32_bf16 v[56:59], v[164:167], v[96:99], v[56:59]
    s_add_u32 m0, s72, 20480
    v_mfma_f32_16x16x32_bf16 v[48:51], v[168:171], v[100:103], v[48:51]
    s_waitcnt lgkmcnt(1)
    s_waitcnt vmcnt(12)
    s_barrier
    ds_read_b128 v[120:123], v6 offset:20480
    v_mfma_f32_16x16x32_bf16 v[52:55], v[172:175], v[100:103], v[52:55]
    v_add_u32 v46, s69, v17
    ds_read_b64 v[46:47], v46 offset:0
    ds_read_b128 v[72:75], v19 offset:0
    v_mfma_f32_16x16x32_bf16 v[56:59], v[192:195], v[100:103], v[56:59]
    buffer_load_dwordx4 v1, s[16:19], m0 offen offset:0 sc1 lds
    ds_read_b128 v[76:79], v19 offset:1024
    v_mfma_f32_16x16x32_bf16 v[48:51], v[188:191], v[104:107], v[48:51]
    s_add_u32 s88, s98, 65536
    ds_read_b128 v[124:127], v6 offset:22528
    ds_read_b128 v[80:83], v19 offset:2048
    v_add_u32 v162, s69, v17
    v_mfma_f32_16x16x32_bf16 v[52:55], v[184:187], v[104:107], v[52:55]
    ds_read_b64 v[162:163], v162 offset:128
    ds_read_b128 v[84:87], v19 offset:3072
    ds_read_b128 v[88:91], v19 offset:4096
    v_mfma_f32_16x16x32_bf16 v[56:59], v[180:183], v[104:107], v[56:59]
    buffer_load_dwordx4 v[144:147], v1, s[4:7], s88 offen sc1
    ds_read_b128 v[92:95], v19 offset:5120
    v_mfma_f32_16x16x32_bf16 v[48:51], v[176:179], v[108:111], v[48:51]
    s_add_u32 m0, s73, 4096
    ds_read_b128 v[96:99], v6 offset:24576
    v_mfma_f32_16x16x32_bf16 v[52:55], a[160:163], v[108:111], v[52:55]
    v_mfma_f32_16x16x32_bf16 v[56:59], a[164:167], v[108:111], v[56:59]
    s_waitcnt lgkmcnt(11)
    v_mfma_f32_16x16x32_bf16 v[48:51], a[168:171], v[112:115], v[48:51]
    ds_read_b128 v[100:103], v6 offset:26624
    buffer_load_dwordx4 v1, s[16:19], m0 offen offset:0 sc1 lds
    v_mfma_f32_16x16x32_bf16 v[52:55], a[172:175], v[112:115], v[52:55]
    s_add_u32 m0, s73, 8192
    s_waitcnt lgkmcnt(6)
    v_fma_f32 v72, -v128, v46, v72
    v_fma_f32 v73, -v129, v46, v73
    v_mfma_f32_16x16x32_bf16 v[56:59], a[176:179], v[112:115], v[56:59]
    v_fma_f32 v74, -v130, v46, v74
    v_fma_f32 v75, -v131, v46, v75
    v_fma_f32 v72, v72, v47, v132
    v_mfma_f32_16x16x32_bf16 v[48:51], a[180:183], v[116:119], v[48:51]
    ds_read_b128 v[104:107], v6 offset:28672
    v_fma_f32 v73, v73, v47, v133
    v_mfma_f32_16x16x32_bf16 v[52:55], a[184:187], v[116:119], v[52:55]
    buffer_load_dwordx4 v1, s[16:19], m0 offen offset:0 sc1 lds
    v_mfma_f32_16x16x32_bf16 v[56:59], a[188:191], v[116:119], v[56:59]
    s_add_u32 m0, s73, 12288
    v_fma_f32 v74, v74, v47, v134
    v_fma_f32 v75, v75, v47, v135
    v_mfma_f32_16x16x32_bf16 v[60:63], v[248:251], v[120:123], 0
    ds_read_b128 v[108:111], v6 offset:30720
    v_fma_f32 v76, -v136, v46, v76
    v_mfma_f32_16x16x32_bf16 v[64:67], v[244:247], v[120:123], 0
    buffer_load_dwordx4 v1, s[16:19], m0 offen offset:0 sc1 lds
    v_mfma_f32_16x16x32_bf16 v[68:71], v[240:243], v[120:123], 0
    s_add_u32 m0, s73, 16384
    v_fma_f32 v77, -v137, v46, v77
    v_fma_f32 v78, -v138, v46, v78
    v_mfma_f32_16x16x32_bf16 v[60:63], v[236:239], v[124:127], v[60:63]
    ds_read_b128 v[112:115], v6 offset:32768
    v_fma_f32 v79, -v139, v46, v79
    v_fma_f32 v76, v76, v47, v140
    v_mfma_f32_16x16x32_bf16 v[64:67], v[232:235], v[124:127], v[64:67]
    v_fma_f32 v77, v77, v47, v141
    v_fma_f32 v78, v78, v47, v142
    v_fma_f32 v79, v79, v47, v143
    v_mfma_f32_16x16x32_bf16 v[68:71], v[228:231], v[124:127], v[68:71]
    s_waitcnt lgkmcnt(3)
    buffer_load_dwordx4 v1, s[16:19], m0 offen offset:0 sc1 lds
    v_fma_f32 v80, -v148, v46, v80
    v_mfma_f32_16x16x32_bf16 v[60:63], v[224:227], v[96:99], v[60:63]
    s_add_u32 m0, s73, 20480
    ds_read_b128 v[116:119], v6 offset:34816
    v_fma_f32 v81, -v149, v46, v81
    v_fma_f32 v82, -v150, v46, v82
    v_mfma_f32_16x16x32_bf16 v[64:67], v[220:223], v[96:99], v[64:67]
    v_fma_f32 v83, -v151, v46, v83
    v_fma_f32 v80, v80, v47, v152
    v_fma_f32 v81, v81, v47, v153
    v_mfma_f32_16x16x32_bf16 v[68:71], v[216:219], v[96:99], v[68:71]
    buffer_load_dwordx4 v1, s[16:19], m0 offen offset:0 sc1 lds
    v_fma_f32 v82, v82, v47, v154
    v_mfma_f32_16x16x32_bf16 v[60:63], v[212:215], v[100:103], v[60:63]
    ds_read_b128 v[120:123], v6 offset:36864
    v_fma_f32 v83, v83, v47, v155
    v_fma_f32 v84, -v128, v162, v84
    v_mfma_f32_16x16x32_bf16 v[64:67], v[208:211], v[100:103], v[64:67]
    v_fma_f32 v85, -v129, v162, v85
    v_fma_f32 v86, -v130, v162, v86
    v_fma_f32 v87, -v131, v162, v87
    v_mfma_f32_16x16x32_bf16 v[68:71], v[204:207], v[100:103], v[68:71]
    s_waitcnt lgkmcnt(3)
    v_fma_f32 v84, v84, v163, v132
    v_fma_f32 v85, v85, v163, v133
    v_fma_f32 v86, v86, v163, v134
    v_mfma_f32_16x16x32_bf16 v[60:63], v[200:203], v[104:107], v[60:63]
    ds_read_b128 v[124:127], v6 offset:38912
    s_add_u32 m0, s84, 84992
    s_nop 0
    buffer_load_dwordx4 v2, s[4:7], s33 offen offset:1024 lds
    v_mfma_f32_16x16x32_bf16 v[64:67], v[196:199], v[104:107], v[64:67]
    v_fma_f32 v87, v87, v163, v135
    v_fma_f32 v88, -v136, v162, v88
    v_fma_f32 v89, -v137, v162, v89
    v_mfma_f32_16x16x32_bf16 v[68:71], v[164:167], v[104:107], v[68:71]
    v_fma_f32 v90, -v138, v162, v90
    v_fma_f32 v91, -v139, v162, v91
    v_fma_f32 v88, v88, v163, v140
    v_mfma_f32_16x16x32_bf16 v[60:63], v[168:171], v[108:111], v[60:63]
    s_waitcnt vmcnt(7)
    s_barrier
    ds_read_b128 v[96:99], v7 offset:0
    v_fma_f32 v89, v89, v163, v141
    v_mfma_f32_16x16x32_bf16 v[64:67], v[172:175], v[108:111], v[64:67]
    s_add_u32 m0, s70, 4096
    s_nop 0
    buffer_load_dwordx4 v1, s[16:19], m0 offen offset:0 sc1 lds
    v_mfma_f32_16x16x32_bf16 v[68:71], v[192:195], v[108:111], v[68:71]
    s_waitcnt lgkmcnt(3)
    v_fma_f32 v90, v90, v163, v142
    v_fma_f32 v91, v91, v163, v143
    v_fma_f32 v92, -v148, v162, v92
    v_mfma_f32_16x16x32_bf16 v[60:63], v[188:191], v[112:115], v[60:63]
    s_add_u32 m0, s70, 8192
    ds_read_b128 v[100:103], v7 offset:2048
    v_fma_f32 v93, -v149, v162, v93
    v_fma_f32 v94, -v150, v162, v94
    v_mfma_f32_16x16x32_bf16 v[64:67], v[184:187], v[112:115], v[64:67]
    buffer_load_dwordx4 v1, s[16:19], m0 offen offset:0 sc1 lds
    v_fma_f32 v95, -v151, v162, v95
    v_mfma_f32_16x16x32_bf16 v[68:71], v[180:183], v[112:115], v[68:71]
    s_add_u32 m0, s70, 12288
    v_fma_f32 v92, v92, v163, v152
    v_fma_f32 v93, v93, v163, v153
    v_mfma_f32_16x16x32_bf16 v[60:63], v[176:179], v[116:119], v[60:63]
    ds_read_b128 v[104:107], v7 offset:4096
    v_fma_f32 v94, v94, v163, v154
    v_mfma_f32_16x16x32_bf16 v[64:67], a[160:163], v[116:119], v[64:67]
    buffer_load_dwordx4 v1, s[16:19], m0 offen offset:0 sc1 lds
    v_mfma_f32_16x16x32_bf16 v[68:71], a[164:167], v[116:119], v[68:71]
    s_waitcnt lgkmcnt(3)
    v_fma_f32 v95, v95, v163, v155
    s_add_u32 s90, s94, 0
    v_mfma_f32_16x16x32_bf16 v[60:63], a[168:171], v[120:123], v[60:63]
    s_add_u32 m0, s70, 16384
    ds_read_b128 v[108:111], v7 offset:6144
    v_fma_f32 v48, v48, v47, v72
    v_mfma_f32_16x16x32_bf16 v[64:67], a[172:175], v[120:123], v[64:67]
    v_fma_f32 v49, v49, v47, v73
    v_fma_f32 v50, v50, v47, v74
    v_mfma_f32_16x16x32_bf16 v[68:71], a[176:179], v[120:123], v[68:71]
    buffer_load_dwordx4 v1, s[16:19], m0 offen offset:0 sc1 lds
    v_mfma_f32_16x16x32_bf16 v[60:63], a[180:183], v[124:127], v[60:63]
    s_add_u32 m0, s70, 20480
    ds_read_b128 v[112:115], v7 offset:8192
    v_fma_f32 v51, v51, v47, v75
    v_mfma_f32_16x16x32_bf16 v[64:67], a[184:187], v[124:127], v[64:67]
    v_fma_f32 v52, v52, v47, v76
    v_fma_f32 v53, v53, v47, v77
    v_mfma_f32_16x16x32_bf16 v[68:71], a[188:191], v[124:127], v[68:71]
    s_waitcnt lgkmcnt(3)
    buffer_load_dwordx4 v1, s[16:19], m0 offen offset:0 sc1 lds
    v_fma_f32 v54, v54, v47, v78
    v_fma_f32 v55, v55, v47, v79
    v_fma_f32 v56, v56, v47, v80
    v_fma_f32 v57, v57, v47, v81
    v_fma_f32 v58, v58, v47, v82
    v_fma_f32 v59, v59, v47, v83
    v_mfma_f32_16x16x32_bf16 v[72:75], v[248:251], v[96:99], 0
    ds_read_b128 v[116:119], v7 offset:10240
    v_mul_f32 v48, v48, abs(v48)
    v_mfma_f32_16x16x32_bf16 v[76:79], v[244:247], v[96:99], 0
    v_mul_f32 v49, v49, abs(v49)
    v_mul_f32 v50, v50, abs(v50)
    v_mfma_f32_16x16x32_bf16 v[80:83], v[240:243], v[96:99], 0
    v_mul_f32 v51, v51, abs(v51)
    v_cvt_pk_bf16_f32 v156, v48, v49
    v_mfma_f32_16x16x32_bf16 v[72:75], v[236:239], v[100:103], v[72:75]
    ds_read_b128 v[120:123], v7 offset:12288
    s_add_u32 m0, s84, 88064
    s_nop 0
    buffer_load_dwordx4 v2, s[4:7], s33 offen offset:2048 lds
    v_mfma_f32_16x16x32_bf16 v[76:79], v[232:235], v[100:103], v[76:79]
    v_cvt_pk_bf16_f32 v157, v50, v51
    v_pk_max_i16 v156, v156, 0
    v_pk_max_i16 v157, v157, 0
    v_mfma_f32_16x16x32_bf16 v[80:83], v[228:231], v[100:103], v[80:83]
    s_waitcnt lgkmcnt(3)
    v_mul_f32 v52, v52, abs(v52)
    v_mul_f32 v53, v53, abs(v53)
    v_mul_f32 v54, v54, abs(v54)
    v_mfma_f32_16x16x32_bf16 v[72:75], v[224:227], v[104:107], v[72:75]
    ds_read_b128 v[124:127], v7 offset:14336
    v_mul_f32 v55, v55, abs(v55)
    v_cvt_pk_bf16_f32 v158, v52, v53
    v_mfma_f32_16x16x32_bf16 v[76:79], v[220:223], v[104:107], v[76:79]
    s_add_u32 m0, s84, 91136
    s_nop 0
    buffer_load_dwordx4 v2, s[4:7], s33 offen offset:3072 lds
    v_mfma_f32_16x16x32_bf16 v[80:83], v[216:219], v[104:107], v[80:83]
    v_cvt_pk_bf16_f32 v159, v54, v55
    v_pk_max_i16 v158, v158, 0
    v_pk_max_i16 v159, v159, 0
    v_mfma_f32_16x16x32_bf16 v[72:75], v[212:215], v[108:111], v[72:75]
    ds_read_b128 v[96:99], v7 offset:16384
    buffer_store_dwordx4 v[156:159], v27, s[4:7], s90 offen
    v_mfma_f32_16x16x32_bf16 v[76:79], v[208:211], v[108:111], v[76:79]
    s_add_u32 m0, s84, 98304
    s_nop 0
    buffer_load_dwordx4 v3, s[4:7], s33 offen offset:0 lds
    v_mfma_f32_16x16x32_bf16 v[80:83], v[204:207], v[108:111], v[80:83]
    s_waitcnt lgkmcnt(3)
    v_mul_f32 v56, v56, abs(v56)
    v_mul_f32 v57, v57, abs(v57)
    v_mul_f32 v58, v58, abs(v58)
    v_mfma_f32_16x16x32_bf16 v[72:75], v[200:203], v[112:115], v[72:75]
    ds_read_b128 v[100:103], v7 offset:18432
    v_mul_f32 v59, v59, abs(v59)
    v_cvt_pk_bf16_f32 v160, v56, v57
    v_mfma_f32_16x16x32_bf16 v[76:79], v[196:199], v[112:115], v[76:79]
    v_cvt_pk_bf16_f32 v161, v58, v59
    v_pk_max_i16 v160, v160, 0
    v_pk_max_i16 v161, v161, 0
    v_mfma_f32_16x16x32_bf16 v[80:83], v[164:167], v[112:115], v[80:83]
    s_add_u32 m0, s84, 101376
    s_nop 0
    buffer_load_dwordx4 v3, s[4:7], s33 offen offset:1024 lds
    v_mfma_f32_16x16x32_bf16 v[72:75], v[168:171], v[116:119], v[72:75]
    s_waitcnt vmcnt(11)
    s_barrier
    ds_read_b128 v[104:107], v7 offset:20480
    v_mfma_f32_16x16x32_bf16 v[76:79], v[172:175], v[116:119], v[76:79]
    s_add_u32 m0, s71, 4096
    s_nop 0
    buffer_load_dwordx4 v1, s[16:19], m0 offen offset:0 sc1 lds
    v_mfma_f32_16x16x32_bf16 v[80:83], v[192:195], v[116:119], v[80:83]
    s_waitcnt lgkmcnt(3)
    buffer_store_dwordx2 v[160:161], v26, s[4:7], s90 offen offset:1024
    v_mfma_f32_16x16x32_bf16 v[72:75], v[188:191], v[120:123], v[72:75]
    s_add_u32 m0, s71, 8192
    ds_read_b128 v[108:111], v7 offset:22528
    s_add_u32 s90, s94, 49152
    v_mfma_f32_16x16x32_bf16 v[76:79], v[184:187], v[120:123], v[76:79]
    buffer_load_dwordx4 v1, s[16:19], m0 offen offset:0 sc1 lds
    v_mfma_f32_16x16x32_bf16 v[80:83], v[180:183], v[120:123], v[80:83]
    s_add_u32 m0, s71, 12288
    s_nop 0
    buffer_load_dwordx4 v1, s[16:19], m0 offen offset:0 sc1 lds
    v_mfma_f32_16x16x32_bf16 v[72:75], v[176:179], v[124:127], v[72:75]
    s_add_u32 m0, s71, 16384
    ds_read_b128 v[112:115], v7 offset:24576
    v_fma_f32 v60, v60, v163, v84
    v_mfma_f32_16x16x32_bf16 v[76:79], a[160:163], v[124:127], v[76:79]
    buffer_load_dwordx4 v1, s[16:19], m0 offen offset:0 sc1 lds
    v_mfma_f32_16x16x32_bf16 v[80:83], a[164:167], v[124:127], v[80:83]
    s_waitcnt lgkmcnt(3)
    v_fma_f32 v61, v61, v163, v85
    v_fma_f32 v62, v62, v163, v86
    v_mfma_f32_16x16x32_bf16 v[72:75], a[168:171], v[96:99], v[72:75]
    s_add_u32 m0, s71, 20480
    ds_read_b128 v[116:119], v7 offset:26624
    v_fma_f32 v63, v63, v163, v87
    v_mfma_f32_16x16x32_bf16 v[76:79], a[172:175], v[96:99], v[76:79]
    buffer_load_dwordx4 v1, s[16:19], m0 offen offset:0 sc1 lds
    v_mfma_f32_16x16x32_bf16 v[80:83], a[176:179], v[96:99], v[80:83]
    s_lshl_b32 s88, s27, 2
    v_fma_f32 v64, v64, v163, v88
    v_fma_f32 v65, v65, v163, v89
    v_mfma_f32_16x16x32_bf16 v[72:75], a[180:183], v[100:103], v[72:75]
    s_add_u32 s88, s88, s24
    ds_read_b128 v[120:123], v7 offset:28672
    v_fma_f32 v66, v66, v163, v90
    v_mfma_f32_16x16x32_bf16 v[76:79], a[184:187], v[100:103], v[76:79]
    s_lshl_b32 s88, s88, 11
    v_fma_f32 v67, v67, v163, v91
    v_fma_f32 v68, v68, v163, v92
    v_mfma_f32_16x16x32_bf16 v[80:83], a[188:191], v[100:103], v[80:83]
    s_waitcnt lgkmcnt(3)
    v_lshlrev_b32 v31, 5, v5
    v_and_b32 v31, 0x780, v31
    buffer_load_dword v0, v31, s[20:23], s88 offen
    v_fma_f32 v69, v69, v163, v93
    v_fma_f32 v70, v70, v163, v94
    v_fma_f32 v71, v71, v163, v95
    v_mfma_f32_16x16x32_bf16 v[84:87], v[248:251], v[104:107], 0
    ds_read_b128 v[124:127], v7 offset:30720
    v_mul_f32 v60, v60, abs(v60)
    v_mfma_f32_16x16x32_bf16 v[88:91], v[244:247], v[104:107], 0
    v_mul_f32 v61, v61, abs(v61)
    v_mul_f32 v62, v62, abs(v62)
    v_mfma_f32_16x16x32_bf16 v[92:95], v[240:243], v[104:107], 0
    s_add_u32 m0, s84, 129024
    s_nop 0
    buffer_load_dwordx4 v3, s[4:7], s33 offen offset:2048 lds
    v_mfma_f32_16x16x32_bf16 v[84:87], v[236:239], v[108:111], v[84:87]
    ds_read_b128 v[96:99], v7 offset:32768
    v_mul_f32 v63, v63, abs(v63)
    v_mfma_f32_16x16x32_bf16 v[88:91], v[232:235], v[108:111], v[88:91]
    v_cvt_pk_bf16_f32 v156, v60, v61
    v_cvt_pk_bf16_f32 v157, v62, v63
    v_mfma_f32_16x16x32_bf16 v[92:95], v[228:231], v[108:111], v[92:95]
    s_waitcnt lgkmcnt(3)
    s_add_u32 m0, s84, 132096
    s_nop 0
    buffer_load_dwordx4 v3, s[4:7], s33 offen offset:3072 lds
    v_mfma_f32_16x16x32_bf16 v[84:87], v[224:227], v[112:115], v[84:87]
    s_add_u32 s33, s62, 24576
    ds_read_b128 v[100:103], v7 offset:34816
    v_pk_max_i16 v156, v156, 0
    v_mfma_f32_16x16x32_bf16 v[88:91], v[220:223], v[112:115], v[88:91]
    v_pk_max_i16 v157, v157, 0
    v_mul_f32 v64, v64, abs(v64)
    v_mfma_f32_16x16x32_bf16 v[92:95], v[216:219], v[112:115], v[92:95]
    v_mul_f32 v65, v65, abs(v65)
    v_mul_f32 v66, v66, abs(v66)
    v_mfma_f32_16x16x32_bf16 v[84:87], v[212:215], v[116:119], v[84:87]
    ds_read_b128 v[104:107], v7 offset:36864
    v_mul_f32 v67, v67, abs(v67)
    v_mfma_f32_16x16x32_bf16 v[88:91], v[208:211], v[116:119], v[88:91]
    s_add_u32 m0, s84, 139264
    s_nop 0
    buffer_load_dwordx4 v1, s[4:7], s33 offen offset:0 lds
    v_mfma_f32_16x16x32_bf16 v[92:95], v[204:207], v[116:119], v[92:95]
    s_waitcnt lgkmcnt(3)
    v_cvt_pk_bf16_f32 v158, v64, v65
    v_cvt_pk_bf16_f32 v159, v66, v67
    v_mfma_f32_16x16x32_bf16 v[84:87], v[200:203], v[120:123], v[84:87]
    ds_read_b128 v[108:111], v7 offset:38912
    v_pk_max_i16 v158, v158, 0
    v_mfma_f32_16x16x32_bf16 v[88:91], v[196:199], v[120:123], v[88:91]
    s_add_u32 m0, s84, 142336
    s_nop 0
    buffer_load_dwordx4 v1, s[4:7], s33 offen offset:1024 lds
    v_mfma_f32_16x16x32_bf16 v[92:95], v[164:167], v[120:123], v[92:95]
    v_pk_max_i16 v159, v159, 0
    buffer_store_dwordx4 v[156:159], v27, s[4:7], s90 offen
    v_mfma_f32_16x16x32_bf16 v[84:87], v[168:171], v[124:127], v[84:87]
    s_waitcnt vmcnt(17)
    s_barrier
    ds_read_b128 v[112:115], v6 offset:0
    v_mfma_f32_16x16x32_bf16 v[88:91], v[172:175], v[124:127], v[88:91]
    s_add_u32 m0, s84, 145408
    s_nop 0
    buffer_load_dwordx4 v1, s[4:7], s33 offen offset:2048 lds
    v_mfma_f32_16x16x32_bf16 v[92:95], v[192:195], v[124:127], v[92:95]
    s_waitcnt lgkmcnt(3)
    v_mul_f32 v68, v68, abs(v68)
    v_mul_f32 v69, v69, abs(v69)
    v_mfma_f32_16x16x32_bf16 v[84:87], v[188:191], v[96:99], v[84:87]
    ds_read_b128 v[116:119], v6 offset:2048
    v_mul_f32 v70, v70, abs(v70)
    v_mfma_f32_16x16x32_bf16 v[88:91], v[184:187], v[96:99], v[88:91]
    v_mul_f32 v71, v71, abs(v71)
    v_cvt_pk_bf16_f32 v160, v68, v69
    v_mfma_f32_16x16x32_bf16 v[92:95], v[180:183], v[96:99], v[92:95]
    s_add_u32 m0, s84, 148480
    s_nop 0
    buffer_load_dwordx4 v1, s[4:7], s33 offen offset:3072 lds
    v_mfma_f32_16x16x32_bf16 v[84:87], v[176:179], v[100:103], v[84:87]
    ds_read_b128 v[120:123], v6 offset:4096
    v_cvt_pk_bf16_f32 v161, v70, v71
    v_mfma_f32_16x16x32_bf16 v[88:91], a[160:163], v[100:103], v[88:91]
    v_pk_max_i16 v160, v160, 0
    v_pk_max_i16 v161, v161, 0
    v_mfma_f32_16x16x32_bf16 v[92:95], a[164:167], v[100:103], v[92:95]
    s_waitcnt lgkmcnt(3)
    s_add_u32 m0, s84, 155648
    s_nop 0
    buffer_load_dwordx4 v2, s[4:7], s33 offen offset:0 lds
    v_mfma_f32_16x16x32_bf16 v[84:87], a[168:171], v[104:107], v[84:87]
    ds_read_b128 v[124:127], v6 offset:6144
    v_mfma_f32_16x16x32_bf16 v[88:91], a[172:175], v[104:107], v[88:91]
    ds_write_b128 v18, v[72:75] offset:0
    v_mfma_f32_16x16x32_bf16 v[92:95], a[176:179], v[104:107], v[92:95]
    v_mfma_f32_16x16x32_bf16 v[84:87], a[180:183], v[108:111], v[84:87]
    ds_read_b128 v[96:99], v6 offset:8192
    v_mfma_f32_16x16x32_bf16 v[88:91], a[184:187], v[108:111], v[88:91]
    s_add_u32 m0, s84, 158720
    s_nop 0
    buffer_load_dwordx4 v2, s[4:7], s33 offen offset:1024 lds
    v_mfma_f32_16x16x32_bf16 v[92:95], a[188:191], v[108:111], v[92:95]
    s_waitcnt lgkmcnt(4)
    ds_write_b128 v18, v[76:79] offset:1024
    ds_write_b128 v18, v[80:83] offset:2048
    v_mfma_f32_16x16x32_bf16 v[48:51], v[248:251], v[112:115], 0
    ds_read_b128 v[100:103], v6 offset:10240
    v_mfma_f32_16x16x32_bf16 v[52:55], v[244:247], v[112:115], 0
    v_mfma_f32_16x16x32_bf16 v[56:59], v[240:243], v[112:115], 0
    v_mfma_f32_16x16x32_bf16 v[48:51], v[236:239], v[116:119], v[48:51]
    ds_read_b128 v[104:107], v6 offset:12288
    v_mfma_f32_16x16x32_bf16 v[52:55], v[232:235], v[116:119], v[52:55]
    ds_write_b128 v18, v[84:87] offset:3072
    v_mfma_f32_16x16x32_bf16 v[56:59], v[228:231], v[116:119], v[56:59]
    s_waitcnt lgkmcnt(7)
    ds_write_b128 v18, v[88:91] offset:4096
    ds_write_b128 v18, v[92:95] offset:5120
    buffer_store_dwordx2 v[160:161], v26, s[4:7], s90 offen offset:1024
    v_mfma_f32_16x16x32_bf16 v[48:51], v[224:227], v[120:123], v[48:51]
    v_mov_b32 v30, 4
    s_mov_b64 exec, 1
    s_cmp_lg_u32 s28, 0
    s_waitcnt vmcnt(0)
    s_cbranch_scc1 pubs_101
    buffer_store_dword v30, off, s[4:7], s32
pubd_102:
    s_mov_b64 exec, -1
    ds_read_b128 v[108:111], v6 offset:14336
    v_mfma_f32_16x16x32_bf16 v[52:55], v[220:223], v[120:123], v[52:55]
    v_add_f32 v144, v144, v146
    v_add_f32 v145, v145, v147
    v_mfma_f32_16x16x32_bf16 v[56:59], v[216:219], v[120:123], v[56:59]
    s_nop 0
    v_permlane16_swap_b32 v144, v145
    v_add_f32 v144, v144, v145
    v_mfma_f32_16x16x32_bf16 v[48:51], v[212:215], v[124:127], v[48:51]
    ds_read_b128 v[112:115], v6 offset:16384
    v_mov_b32 v145, v144
    v_mfma_f32_16x16x32_bf16 v[52:55], v[208:211], v[124:127], v[52:55]
    s_nop 0
    v_permlane32_swap_b32 v144, v145
    v_add_f32 v144, v144, v145
    v_mfma_f32_16x16x32_bf16 v[56:59], v[204:207], v[124:127], v[56:59]
    s_waitcnt lgkmcnt(6)
    v_mov_b32 v145, v144
    v_mfma_f32_16x16x32_bf16 v[48:51], v[200:203], v[96:99], v[48:51]
    ds_read_b128 v[116:119], v6 offset:18432
    v_permlane16_swap_b32 v144, v145
    v_mfma_f32_16x16x32_bf16 v[52:55], v[196:199], v[96:99], v[52:55]
    v_mul_f32 v146, s64, v144
    v_mul_f32 v145, s64, v145
    v_mfma_f32_16x16x32_bf16 v[56:59], v[164:167], v[96:99], v[56:59]
    v_fma_f32 v145, -v146, v146, v145
    v_max_f32 v145, 0, v145
    v_mfma_f32_16x16x32_bf16 v[48:51], v[168:171], v[100:103], v[48:51]
    v_add_f32 v145, s65, v145
    v_rsq_f32 v147, v145
    v_add_u32 v144, s0, v17
    ds_write_b64 v144, v[146:147] offset:512
    s_waitcnt lgkmcnt(0)
    s_barrier
    ds_read_b128 v[120:123], v6 offset:20480
    v_mfma_f32_16x16x32_bf16 v[52:55], v[172:175], v[100:103], v[52:55]
    v_add_u32 v46, s69, v17
    ds_read_b64 v[46:47], v46 offset:512
    ds_read_b128 v[72:75], v19 offset:0
    v_mfma_f32_16x16x32_bf16 v[56:59], v[192:195], v[100:103], v[56:59]
    ds_read_b128 v[76:79], v19 offset:1024
    ds_read_b128 v[80:83], v19 offset:2048
    v_add_u32 v162, s69, v17
    v_mfma_f32_16x16x32_bf16 v[48:51], v[188:191], v[104:107], v[48:51]
    ds_read_b128 v[124:127], v6 offset:22528
    ds_read_b64 v[162:163], v162 offset:640
    ds_read_b128 v[84:87], v19 offset:3072
    v_mfma_f32_16x16x32_bf16 v[52:55], v[184:187], v[104:107], v[52:55]
    ds_read_b128 v[88:91], v19 offset:4096
    ds_read_b128 v[92:95], v19 offset:5120
    v_mfma_f32_16x16x32_bf16 v[56:59], v[180:183], v[104:107], v[56:59]
    v_mfma_f32_16x16x32_bf16 v[48:51], v[176:179], v[108:111], v[48:51]
    ds_read_b128 v[96:99], v6 offset:24576
    v_mfma_f32_16x16x32_bf16 v[52:55], a[160:163], v[108:111], v[52:55]
    v_mfma_f32_16x16x32_bf16 v[56:59], a[164:167], v[108:111], v[56:59]
    v_mfma_f32_16x16x32_bf16 v[48:51], a[168:171], v[112:115], v[48:51]
    s_waitcnt lgkmcnt(6)
    ds_read_b128 v[100:103], v6 offset:26624
    v_fma_f32 v72, -v128, v46, v72
    v_fma_f32 v73, -v129, v46, v73
    v_mfma_f32_16x16x32_bf16 v[52:55], a[172:175], v[112:115], v[52:55]
    v_fma_f32 v74, -v130, v46, v74
    v_fma_f32 v75, -v131, v46, v75
    v_fma_f32 v72, v72, v47, v132
    v_mfma_f32_16x16x32_bf16 v[56:59], a[176:179], v[112:115], v[56:59]
    v_fma_f32 v73, v73, v47, v133
    v_fma_f32 v74, v74, v47, v134
    v_mfma_f32_16x16x32_bf16 v[48:51], a[180:183], v[116:119], v[48:51]
    ds_read_b128 v[104:107], v6 offset:28672
    v_fma_f32 v75, v75, v47, v135
    v_mfma_f32_16x16x32_bf16 v[52:55], a[184:187], v[116:119], v[52:55]
    v_fma_f32 v76, -v136, v46, v76
    v_fma_f32 v77, -v137, v46, v77
    v_mfma_f32_16x16x32_bf16 v[56:59], a[188:191], v[116:119], v[56:59]
    s_waitcnt lgkmcnt(7)
    v_fma_f32 v78, -v138, v46, v78
    v_fma_f32 v79, -v139, v46, v79
    v_mfma_f32_16x16x32_bf16 v[60:63], v[248:251], v[120:123], 0
    ds_read_b128 v[108:111], v6 offset:30720
    v_fma_f32 v76, v76, v47, v140
    v_mfma_f32_16x16x32_bf16 v[64:67], v[244:247], v[120:123], 0
    v_fma_f32 v77, v77, v47, v141
    v_fma_f32 v78, v78, v47, v142
    v_mfma_f32_16x16x32_bf16 v[68:71], v[240:243], v[120:123], 0
    buffer_load_dwordx4 v[248:251], v2, s[4:7], s33 offen offset:2048
    v_mfma_f32_16x16x32_bf16 v[60:63], v[236:239], v[124:127], v[60:63]
    ds_read_b128 v[112:115], v6 offset:32768
    v_fma_f32 v79, v79, v47, v143
    v_fma_f32 v80, -v148, v46, v80
    v_mfma_f32_16x16x32_bf16 v[64:67], v[232:235], v[124:127], v[64:67]
    v_fma_f32 v81, -v149, v46, v81
    v_fma_f32 v82, -v150, v46, v82
    v_fma_f32 v83, -v151, v46, v83
    v_mfma_f32_16x16x32_bf16 v[68:71], v[228:231], v[124:127], v[68:71]
    s_waitcnt lgkmcnt(3)
    buffer_load_dwordx4 v[244:247], v2, s[4:7], s33 offen offset:3072
    v_fma_f32 v80, v80, v47, v152
    v_mfma_f32_16x16x32_bf16 v[60:63], v[224:227], v[96:99], v[60:63]
    ds_read_b128 v[116:119], v6 offset:34816
    v_fma_f32 v81, v81, v47, v153
    v_fma_f32 v82, v82, v47, v154
    v_mfma_f32_16x16x32_bf16 v[64:67], v[220:223], v[96:99], v[64:67]
    v_fma_f32 v83, v83, v47, v155
    v_fma_f32 v84, -v128, v162, v84
    v_fma_f32 v85, -v129, v162, v85
    v_mfma_f32_16x16x32_bf16 v[68:71], v[216:219], v[96:99], v[68:71]
    buffer_load_dwordx4 v[240:243], v3, s[4:7], s33 offen offset:0
    v_fma_f32 v86, -v130, v162, v86
    v_mfma_f32_16x16x32_bf16 v[60:63], v[212:215], v[100:103], v[60:63]
    ds_read_b128 v[120:123], v6 offset:36864
    v_fma_f32 v87, -v131, v162, v87
    v_fma_f32 v84, v84, v163, v132
    v_mfma_f32_16x16x32_bf16 v[64:67], v[208:211], v[100:103], v[64:67]
    v_fma_f32 v85, v85, v163, v133
    v_fma_f32 v86, v86, v163, v134
    v_fma_f32 v87, v87, v163, v135
    v_mfma_f32_16x16x32_bf16 v[68:71], v[204:207], v[100:103], v[68:71]
    s_waitcnt lgkmcnt(3)
    v_fma_f32 v88, -v136, v162, v88
    v_fma_f32 v89, -v137, v162, v89
    v_fma_f32 v90, -v138, v162, v90
    v_mfma_f32_16x16x32_bf16 v[60:63], v[200:203], v[104:107], v[60:63]
    ds_read_b128 v[124:127], v6 offset:38912
    buffer_load_dwordx4 v[236:239], v3, s[4:7], s33 offen offset:1024
    v_mfma_f32_16x16x32_bf16 v[64:67], v[196:199], v[104:107], v[64:67]
    v_fma_f32 v91, -v139, v162, v91
    v_fma_f32 v88, v88, v163, v140
    v_fma_f32 v89, v89, v163, v141
    v_mfma_f32_16x16x32_bf16 v[68:71], v[164:167], v[104:107], v[68:71]
    v_fma_f32 v90, v90, v163, v142
    v_fma_f32 v91, v91, v163, v143
    v_fma_f32 v92, -v148, v162, v92
    v_mfma_f32_16x16x32_bf16 v[60:63], v[168:171], v[108:111], v[60:63]
    buffer_load_dwordx4 v[232:235], v3, s[4:7], s33 offen offset:2048
    v_fma_f32 v93, -v149, v162, v93
    v_mfma_f32_16x16x32_bf16 v[64:67], v[172:175], v[108:111], v[64:67]
    v_fma_f32 v94, -v150, v162, v94
    v_fma_f32 v95, -v151, v162, v95
    v_fma_f32 v92, v92, v163, v152
    v_mfma_f32_16x16x32_bf16 v[68:71], v[192:195], v[108:111], v[68:71]
    s_waitcnt lgkmcnt(2)
    v_fma_f32 v93, v93, v163, v153
    v_fma_f32 v94, v94, v163, v154
    v_mfma_f32_16x16x32_bf16 v[60:63], v[188:191], v[112:115], v[60:63]
    v_fma_f32 v95, v95, v163, v155
    s_add_u32 s90, s94, 3145728
    v_mfma_f32_16x16x32_bf16 v[64:67], v[184:187], v[112:115], v[64:67]
    buffer_load_dwordx4 v[228:231], v3, s[4:7], s33 offen offset:3072
    v_mfma_f32_16x16x32_bf16 v[68:71], v[180:183], v[112:115], v[68:71]
    s_add_u32 s33, s62, 36864
    v_fma_f32 v48, v48, v47, v72
    v_fma_f32 v49, v49, v47, v73
    v_mfma_f32_16x16x32_bf16 v[60:63], v[176:179], v[116:119], v[60:63]
    v_fma_f32 v50, v50, v47, v74
    v_fma_f32 v51, v51, v47, v75
    v_mfma_f32_16x16x32_bf16 v[64:67], a[160:163], v[116:119], v[64:67]
    buffer_load_dwordx4 v[224:227], v1, s[4:7], s33 offen offset:0
    v_mfma_f32_16x16x32_bf16 v[68:71], a[164:167], v[116:119], v[68:71]
    s_waitcnt lgkmcnt(0)
    v_fma_f32 v52, v52, v47, v76
    v_fma_f32 v53, v53, v47, v77
    v_mfma_f32_16x16x32_bf16 v[60:63], a[168:171], v[120:123], v[60:63]
    v_fma_f32 v54, v54, v47, v78
    v_fma_f32 v55, v55, v47, v79
    v_mfma_f32_16x16x32_bf16 v[64:67], a[172:175], v[120:123], v[64:67]
    v_fma_f32 v56, v56, v47, v80
    v_fma_f32 v57, v57, v47, v81
    v_mfma_f32_16x16x32_bf16 v[68:71], a[176:179], v[120:123], v[68:71]
    buffer_load_dwordx4 v[220:223], v1, s[4:7], s33 offen offset:1024
    v_mfma_f32_16x16x32_bf16 v[60:63], a[180:183], v[124:127], v[60:63]
    v_fma_f32 v58, v58, v47, v82
    v_fma_f32 v59, v59, v47, v83
    v_mfma_f32_16x16x32_bf16 v[64:67], a[184:187], v[124:127], v[64:67]
    v_mul_f32 v48, v48, abs(v48)
    v_mul_f32 v49, v49, abs(v49)
    v_mfma_f32_16x16x32_bf16 v[68:71], a[188:191], v[124:127], v[68:71]
    v_mul_f32 v50, v50, abs(v50)
    v_mul_f32 v51, v51, abs(v51)
    v_cvt_pk_bf16_f32 v156, v48, v49
    buffer_load_dwordx4 v[216:219], v1, s[4:7], s33 offen offset:2048
    v_cvt_pk_bf16_f32 v157, v50, v51
    v_pk_max_i16 v156, v156, 0
    v_pk_max_i16 v157, v157, 0
    v_mul_f32 v52, v52, abs(v52)
    v_mul_f32 v53, v53, abs(v53)
    v_mul_f32 v54, v54, abs(v54)
    v_mul_f32 v55, v55, abs(v55)
    v_cvt_pk_bf16_f32 v158, v52, v53
    v_cvt_pk_bf16_f32 v159, v54, v55
    v_pk_max_i16 v158, v158, 0
    v_pk_max_i16 v159, v159, 0
    buffer_store_dwordx4 v[156:159], v27, s[4:7], s90 offen
    v_mul_f32 v56, v56, abs(v56)
    buffer_load_dwordx4 v[212:215], v1, s[4:7], s33 offen offset:3072
    v_mul_f32 v57, v57, abs(v57)
    v_mul_f32 v58, v58, abs(v58)
    v_mul_f32 v59, v59, abs(v59)
    v_cvt_pk_bf16_f32 v160, v56, v57
    v_cvt_pk_bf16_f32 v161, v58, v59
    v_pk_max_i16 v160, v160, 0
    v_pk_max_i16 v161, v161, 0
    buffer_store_dwordx2 v[160:161], v26, s[4:7], s90 offen offset:1024
    s_add_u32 s90, s94, 3194880
    v_pk_fma_f32 v[60:61], v[60:61], v[162:163], v[84:85] op_sel:[0,1,0] op_sel_hi:[1,1,1]
    v_pk_fma_f32 v[62:63], v[62:63], v[162:163], v[86:87] op_sel:[0,1,0] op_sel_hi:[1,1,1]
    v_pk_fma_f32 v[64:65], v[64:65], v[162:163], v[88:89] op_sel:[0,1,0] op_sel_hi:[1,1,1]
    buffer_load_dwordx4 v[208:211], v2, s[4:7], s33 offen offset:0
    v_pk_fma_f32 v[66:67], v[66:67], v[162:163], v[90:91] op_sel:[0,1,0] op_sel_hi:[1,1,1]
    v_pk_fma_f32 v[68:69], v[68:69], v[162:163], v[92:93] op_sel:[0,1,0] op_sel_hi:[1,1,1]
    v_pk_fma_f32 v[70:71], v[70:71], v[162:163], v[94:95] op_sel:[0,1,0] op_sel_hi:[1,1,1]
    v_mul_f32 v60, v60, abs(v60)
    v_mul_f32 v61, v61, abs(v61)
    v_mul_f32 v62, v62, abs(v62)
    v_mul_f32 v63, v63, abs(v63)
    v_cvt_pk_bf16_f32 v156, v60, v61
    v_cvt_pk_bf16_f32 v157, v62, v63
    v_pk_max_i16 v156, v156, 0
    v_pk_max_i16 v157, v157, 0
    v_mul_f32 v64, v64, abs(v64)
    buffer_load_dwordx4 v[204:207], v2, s[4:7], s33 offen offset:1024
    v_mul_f32 v65, v65, abs(v65)
    v_mul_f32 v66, v66, abs(v66)
    v_mul_f32 v67, v67, abs(v67)
    v_cvt_pk_bf16_f32 v158, v64, v65
    v_cvt_pk_bf16_f32 v159, v66, v67
    v_pk_max_i16 v158, v158, 0
    v_pk_max_i16 v159, v159, 0
    buffer_store_dwordx4 v[156:159], v27, s[4:7], s90 offen
    v_mul_f32 v68, v68, abs(v68)
    v_mul_f32 v69, v69, abs(v69)
    v_mul_f32 v70, v70, abs(v70)
    v_mul_f32 v71, v71, abs(v71)
    v_cvt_pk_bf16_f32 v160, v68, v69
    buffer_load_dwordx4 v[200:203], v2, s[4:7], s33 offen offset:2048
    v_cvt_pk_bf16_f32 v161, v70, v71
    v_pk_max_i16 v160, v160, 0
    v_pk_max_i16 v161, v161, 0
    buffer_store_dwordx2 v[160:161], v26, s[4:7], s90 offen offset:1024
    buffer_load_dwordx4 v[196:199], v2, s[4:7], s33 offen offset:3072
    buffer_load_dwordx4 v[164:167], v3, s[4:7], s33 offen offset:0
    buffer_load_dwordx4 v[168:171], v3, s[4:7], s33 offen offset:1024
    buffer_load_dwordx4 v[172:175], v3, s[4:7], s33 offen offset:2048
    buffer_load_dwordx4 v[192:195], v3, s[4:7], s33 offen offset:3072
    s_add_u32 s33, s62, 49152
    buffer_load_dwordx4 v[188:191], v1, s[4:7], s33 offen offset:0
    v_mov_b32 v30, 5
    s_mov_b64 exec, 1
    s_cmp_lg_u32 s28, 0
    s_waitcnt vmcnt(6)
    s_cbranch_scc1 pubs_103
    buffer_store_dword v30, off, s[4:7], s32
pubd_104:
    s_mov_b64 exec, -1
    s_barrier
    buffer_load_dword v29, v5, s[4:7], s31 offen sc1
    s_waitcnt vmcnt(0)
poll_106:
    v_cmp_le_u32 vcc, 5, v29
    s_nop 0
    s_andn2_b64 s[56:57], s[34:35], vcc
    s_cbranch_scc1 pollr_105
    s_cmp_lg_u32 s28, 0
    s_cbranch_scc1 acq_107
polld_108:
    s_add_u32 m0, s83, 4096
    s_nop 0
    buffer_load_dwordx4 v1, s[4:7], s79 offen offset:0 sc1 lds
    s_add_u32 m0, s83, 5120
    s_nop 0
    buffer_load_dwordx4 v1, s[4:7], s80 offen offset:0 sc1 lds
    s_add_u32 m0, s83, 6144
    s_nop 0
    buffer_load_dwordx4 v1, s[4:7], s81 offen offset:0 sc1 lds
    s_add_u32 m0, s83, 6144
    s_nop 0
    buffer_load_dwordx4 v1, s[4:7], s79 offen offset:1024 sc1 lds
    s_add_u32 m0, s83, 7168
    s_nop 0
    buffer_load_dwordx4 v1, s[4:7], s80 offen offset:1024 sc1 lds
    s_add_u32 m0, s83, 8192
    s_nop 0
    buffer_load_dwordx4 v1, s[4:7], s81 offen offset:1024 sc1 lds
    s_add_u32 m0, s83, 10240
    s_nop 0
    buffer_load_dwordx4 v1, s[4:7], s78 offen offset:0 sc1 lds
    s_add_u32 m0, s83, 10240
    s_nop 0
    buffer_load_dwordx4 v1, s[4:7], s78 offen offset:1024 sc1 lds
    s_waitcnt vmcnt(7)
    ds_read_b128 v[128:131], v33 offset:0
    s_waitcnt vmcnt(6)
    ds_read_b128 v[132:135], v33 offset:1024
    s_waitcnt vmcnt(5)
    ds_read_b128 v[136:139], v33 offset:2048
    s_waitcnt lgkmcnt(2)
    v_mfma_f32_16x16x32_bf16 v[68:71], a[192:195], v[128:131], 0
    s_add_u32 m0, s83, 10240
    s_waitcnt vmcnt(4)
    ds_read_b128 v[140:143], v33 offset:3072
    v_mfma_f32_16x16x32_bf16 v[72:75], a[196:199], v[128:131], 0
    s_add_u32 s89, s84, 86016
    buffer_load_dwordx4 v1, s[4:7], s79 offen offset:2048 sc1 lds
    v_mfma_f32_16x16x32_bf16 v[76:79], a[200:203], v[128:131], 0
    s_add_u32 m0, s83, 11264
    s_nop 0
    buffer_load_dwordx4 v1, s[4:7], s80 offen offset:2048 sc1 lds
    v_mfma_f32_16x16x32_bf16 v[80:83], a[204:207], v[128:131], 0
    s_add_u32 m0, s83, 12288
    v_add_u32 v35, s89, v1
    v_add_u32 v34, 45056, v35
    v_mfma_f32_16x16x32_bf16 v[84:87], a[208:211], v[128:131], 0
    s_waitcnt lgkmcnt(2)
    buffer_load_dwordx4 v1, s[4:7], s81 offen offset:2048 sc1 lds
    v_mfma_f32_16x16x32_bf16 v[88:91], a[192:195], v[132:135], 0
    s_add_u32 m0, s83, 13312
    s_waitcnt vmcnt(6)
    ds_read_b128 v[128:131], v33 offset:4096
    v_mfma_f32_16x16x32_bf16 v[92:95], a[196:199], v[132:135], 0
    buffer_load_dwordx4 v1, s[4:7], s78 offen offset:2048 sc1 lds
    v_mfma_f32_16x16x32_bf16 v[96:99], a[200:203], v[132:135], 0
    s_add_u32 m0, s83, 13312
    s_nop 0
    buffer_load_dwordx4 v1, s[4:7], s79 offen offset:3072 sc1 lds
    v_mfma_f32_16x16x32_bf16 v[100:103], a[204:207], v[132:135], 0
    s_add_u32 m0, s83, 14336
    ds_read_b128 v[144:147], v24 offset:1536
    ds_read_b128 v[148:151], v24 offset:1600
    v_mfma_f32_16x16x32_bf16 v[104:107], a[208:211], v[132:135], 0
    s_waitcnt lgkmcnt(4)
    ds_read_b128 v[152:155], v24 offset:1664
    ds_read_b128 v[156:159], v24 offset:1728
    v_mfma_f32_16x16x32_bf16 v[108:111], a[192:195], v[136:139], 0
    s_waitcnt vmcnt(7)
    ds_read_b128 v[132:135], v33 offset:5120
    ds_read_b128 v[160:163], v24 offset:1792
    v_mfma_f32_16x16x32_bf16 v[112:115], a[196:199], v[136:139], 0
    buffer_load_dwordx4 v1, s[4:7], s80 offen offset:3072 sc1 lds
    v_mfma_f32_16x16x32_bf16 v[116:119], a[200:203], v[136:139], 0
    s_add_u32 m0, s83, 15360
    v_lshlrev_b32 v48, 16, v36
    v_and_b32 v49, 0xffff0000, v36
    v_mfma_f32_16x16x32_bf16 v[120:123], a[204:207], v[136:139], 0
    v_lshlrev_b32 v50, 16, v37
    v_and_b32 v51, 0xffff0000, v37
    v_mfma_f32_16x16x32_bf16 v[124:127], a[208:211], v[136:139], 0
    s_waitcnt lgkmcnt(7)
    buffer_load_dwordx4 v1, s[4:7], s81 offen offset:3072 sc1 lds
    v_mfma_f32_16x16x32_bf16 v[68:71], a[212:215], v[140:143], v[68:71]
    s_add_u32 m0, s83, 16384
    s_waitcnt vmcnt(8)
    ds_read_b128 v[136:139], v33 offset:6144
    v_mfma_f32_16x16x32_bf16 v[72:75], a[216:219], v[140:143], v[72:75]
    v_lshlrev_b32 v52, 16, v38
    v_and_b32 v53, 0xffff0000, v38
    v_mfma_f32_16x16x32_bf16 v[76:79], a[220:223], v[140:143], v[76:79]
    buffer_load_dwordx4 v1, s[4:7], s78 offen offset:3072 sc1 lds
    v_mfma_f32_16x16x32_bf16 v[80:83], a[224:227], v[140:143], v[80:83]
    s_add_u32 m0, s83, 20480
    v_lshlrev_b32 v54, 16, v39
    v_and_b32 v55, 0xffff0000, v39
    v_mfma_f32_16x16x32_bf16 v[84:87], a[228:231], v[140:143], v[84:87]
    s_waitcnt lgkmcnt(7)
    v_lshlrev_b32 v56, 16, v40
    v_and_b32 v57, 0xffff0000, v40
    v_mfma_f32_16x16x32_bf16 v[88:91], a[212:215], v[128:131], v[88:91]
    s_waitcnt vmcnt(8)
    ds_read_b128 v[140:143], v33 offset:7168
    v_lshlrev_b32 v58, 16, v41
    v_mfma_f32_16x16x32_bf16 v[92:95], a[216:219], v[128:131], v[92:95]
    buffer_load_dwordx4 v2, s[4:7], s79 offen offset:0 sc1 lds
    v_mfma_f32_16x16x32_bf16 v[96:99], a[220:223], v[128:131], v[96:99]
    s_add_u32 m0, s83, 21504
    v_and_b32 v59, 0xffff0000, v41
    v_lshlrev_b32 v60, 16, v42
    v_mfma_f32_16x16x32_bf16 v[100:103], a[224:227], v[128:131], v[100:103]
    v_and_b32 v61, 0xffff0000, v42
    v_lshlrev_b32 v62, 16, v43
    v_mfma_f32_16x16x32_bf16 v[104:107], a[228:231], v[128:131], v[104:107]
    s_waitcnt lgkmcnt(3)
    buffer_load_dwordx4 v2, s[4:7], s80 offen offset:0 sc1 lds
    v_mfma_f32_16x16x32_bf16 v[108:111], a[212:215], v[132:135], v[108:111]
    s_add_u32 m0, s83, 22528
    s_waitcnt vmcnt(9)
    ds_read_b128 v[128:131], v33 offset:8192
    v_mfma_f32_16x16x32_bf16 v[112:115], a[216:219], v[132:135], v[112:115]
    v_and_b32 v63, 0xffff0000, v43
    v_lshlrev_b32 v64, 16, v44
    v_mfma_f32_16x16x32_bf16 v[116:119], a[220:223], v[132:135], v[116:119]
    v_and_b32 v65, 0xffff0000, v44
    v_lshlrev_b32 v66, 16, v45
    v_mfma_f32_16x16x32_bf16 v[120:123], a[224:227], v[132:135], v[120:123]
    buffer_load_dwordx4 v2, s[4:7], s81 offen offset:0 sc1 lds
    v_mfma_f32_16x16x32_bf16 v[124:127], a[228:231], v[132:135], v[124:127]
    s_waitcnt lgkmcnt(2)
    v_and_b32 v67, 0xffff0000, v45
    v_add_f32 v48, v48, v144
    v_add_f32 v49, v49, v145
    v_add_f32 v50, v50, v146
    v_add_f32 v51, v51, v147
    v_add_f32 v52, v52, v148
    v_add_f32 v53, v53, v149
    v_add_f32 v54, v54, v150
    v_add_f32 v55, v55, v151
    v_add_f32 v56, v56, v152
    v_add_f32 v57, v57, v153
    v_add_f32 v58, v58, v154
    v_add_f32 v59, v59, v155
    v_add_f32 v60, v60, v156
    v_add_f32 v61, v61, v157
    v_add_f32 v62, v62, v158
    v_add_f32 v63, v63, v159
    v_add_f32 v64, v64, v160
    v_add_f32 v65, v65, v161
    v_add_f32 v66, v66, v162
    v_add_f32 v67, v67, v163
    v_mfma_f32_16x16x32_bf16 v[48:51], a[192:195], v[136:139], v[48:51]
    s_add_u32 m0, s83, 23552
    s_waitcnt vmcnt(9)
    ds_read_b128 v[132:135], v33 offset:9216
    v_mfma_f32_16x16x32_bf16 v[52:55], a[196:199], v[136:139], v[52:55]
    buffer_load_dwordx4 v2, s[4:7], s78 offen offset:0 sc1 lds
    v_mfma_f32_16x16x32_bf16 v[56:59], a[200:203], v[136:139], v[56:59]
    s_add_u32 m0, s83, 3072
    v_mfma_f32_16x16x32_bf16 v[60:63], a[204:207], v[136:139], v[60:63]
    v_mfma_f32_16x16x32_bf16 v[64:67], a[208:211], v[136:139], v[64:67]
    s_waitcnt lgkmcnt(2)
    ds_read_b128 a[192:195], v35 offset:0
    ds_read_b128 a[196:199], v35 offset:4096
    v_mfma_f32_16x16x32_bf16 v[48:51], a[212:215], v[140:143], v[48:51]
    s_waitcnt vmcnt(9)
    ds_read_b128 v[136:139], v33 offset:10240
    ds_read_b128 a[200:203], v35 offset:8192
    v_mfma_f32_16x16x32_bf16 v[52:55], a[216:219], v[140:143], v[52:55]
    buffer_load_dwordx4 v2, s[4:7], s79 offen offset:1024 sc1 lds
    v_mfma_f32_16x16x32_bf16 v[56:59], a[220:223], v[140:143], v[56:59]
    s_add_u32 m0, s83, 4096
    ds_read_b128 a[204:207], v35 offset:12288
    ds_read_b128 a[208:211], v35 offset:16384
    v_mfma_f32_16x16x32_bf16 v[60:63], a[224:227], v[140:143], v[60:63]
    v_mfma_f32_16x16x32_bf16 v[64:67], a[228:231], v[140:143], v[64:67]
    s_waitcnt lgkmcnt(7)
    buffer_load_dwordx4 v2, s[4:7], s80 offen offset:1024 sc1 lds
    v_mfma_f32_16x16x32_bf16 v[68:71], a[232:235], v[128:131], v[68:71]
    s_add_u32 m0, s83, 5120
    s_waitcnt vmcnt(10)
    ds_read_b128 v[140:143], v33 offset:11264
    v_mfma_f32_16x16x32_bf16 v[72:75], a[236:239], v[128:131], v[72:75]
    ds_read_b128 a[212:215], v34 offset:0
    ds_read_b128 a[216:219], v34 offset:4096
    v_mfma_f32_16x16x32_bf16 v[76:79], a[240:243], v[128:131], v[76:79]
    buffer_load_dwordx4 v2, s[4:7], s81 offen offset:1024 sc1 lds
    v_mfma_f32_16x16x32_bf16 v[80:83], a[244:247], v[128:131], v[80:83]
    s_add_u32 m0, s83, 6144
    ds_read_b128 a[220:223], v34 offset:8192
    ds_read_b128 a[224:227], v34 offset:12288
    v_mfma_f32_16x16x32_bf16 v[84:87], a[248:251], v[128:131], v[84:87]
    s_waitcnt lgkmcnt(11)
    ds_read_b128 a[228:231], v34 offset:16384
    v_mfma_f32_16x16x32_bf16 v[88:91], a[232:235], v[132:135], v[88:91]
    s_waitcnt vmcnt(10)
    ds_read_b128 v[128:131], v33 offset:12288
    v_mfma_f32_16x16x32_bf16 v[92:95], a[236:239], v[132:135], v[92:95]
    buffer_load_dwordx4 v2, s[4:7], s78 offen offset:1024 sc1 lds
    v_mfma_f32_16x16x32_bf16 v[96:99], a[240:243], v[132:135], v[96:99]
    s_add_u32 m0, s83, 6144
    v_mfma_f32_16x16x32_bf16 v[100:103], a[244:247], v[132:135], v[100:103]
    v_mfma_f32_16x16x32_bf16 v[104:107], a[248:251], v[132:135], v[104:107]
    s_waitcnt lgkmcnt(10)
    buffer_load_dwordx4 v2, s[4:7], s79 offen offset:2048 sc1 lds
    v_mfma_f32_16x16x32_bf16 v[108:111], a[232:235], v[136:139], v[108:111]
    s_add_u32 m0, s83, 7168
    s_waitcnt vmcnt(11)
    ds_read_b128 v[132:135], v33 offset:13312
    v_mfma_f32_16x16x32_bf16 v[112:115], a[236:239], v[136:139], v[112:115]
    v_mfma_f32_16x16x32_bf16 v[116:119], a[240:243], v[136:139], v[116:119]
    v_mfma_f32_16x16x32_bf16 v[120:123], a[244:247], v[136:139], v[120:123]
    buffer_load_dwordx4 v2, s[4:7], s80 offen offset:2048 sc1 lds
    v_mfma_f32_16x16x32_bf16 v[124:127], a[248:251], v[136:139], v[124:127]
    s_waitcnt lgkmcnt(7)
    v_mfma_f32_16x16x32_bf16 v[48:51], a[232:235], v[140:143], v[48:51]
    s_add_u32 m0, s83, 8192
    s_waitcnt vmcnt(11)
    ds_read_b128 v[136:139], v33 offset:14336
    v_mfma_f32_16x16x32_bf16 v[52:55], a[236:239], v[140:143], v[52:55]
    buffer_load_dwordx4 v2, s[4:7], s81 offen offset:2048 sc1 lds
    v_mfma_f32_16x16x32_bf16 v[56:59], a[240:243], v[140:143], v[56:59]
    s_add_u32 m0, s83, 9216
    v_mfma_f32_16x16x32_bf16 v[60:63], a[244:247], v[140:143], v[60:63]
    v_mfma_f32_16x16x32_bf16 v[64:67], a[248:251], v[140:143], v[64:67]
    s_waitcnt lgkmcnt(2)
    ds_read_b128 a[232:235], v34 offset:20480
    ds_read_b128 a[236:239], v34 offset:24576
    v_mfma_f32_16x16x32_bf16 v[68:71], a[252:255], v[128:131], v[68:71]
    s_waitcnt vmcnt(11)
    ds_read_b128 v[140:143], v33 offset:15360
    ds_read_b128 a[240:243], v34 offset:28672
    v_mfma_f32_16x16x32_bf16 v[72:75], v[252:255], v[128:131], v[72:75]
    buffer_load_dwordx4 v2, s[4:7], s78 offen offset:2048 sc1 lds
    v_mfma_f32_16x16x32_bf16 v[76:79], a[192:195], v[128:131], v[76:79]
    s_add_u32 m0, s83, 9216
    v_mfma_f32_16x16x32_bf16 v[80:83], a[196:199], v[128:131], v[80:83]
    v_mfma_f32_16x16x32_bf16 v[84:87], a[200:203], v[128:131], v[84:87]
    s_waitcnt lgkmcnt(5)
    buffer_load_dwordx4 v2, s[4:7], s79 offen offset:3072 sc1 lds
    v_mfma_f32_16x16x32_bf16 v[88:91], a[252:255], v[132:135], v[88:91]
    s_add_u32 m0, s83, 10240
    s_waitcnt vmcnt(12)
    ds_read_b128 v[128:131], v33 offset:16384
    v_mfma_f32_16x16x32_bf16 v[92:95], v[252:255], v[132:135], v[92:95]
    v_mfma_f32_16x16x32_bf16 v[96:99], a[192:195], v[132:135], v[96:99]
    buffer_load_dwordx4 v2, s[4:7], s80 offen offset:3072 sc1 lds
    v_mfma_f32_16x16x32_bf16 v[100:103], a[196:199], v[132:135], v[100:103]
    s_add_u32 m0, s83, 11264
    v_mfma_f32_16x16x32_bf16 v[104:107], a[200:203], v[132:135], v[104:107]
    s_waitcnt lgkmcnt(5)
    v_mfma_f32_16x16x32_bf16 v[108:111], a[252:255], v[136:139], v[108:111]
    s_waitcnt vmcnt(12)
    ds_read_b128 v[132:135], v33 offset:17408
    v_mfma_f32_16x16x32_bf16 v[112:115], v[252:255], v[136:139], v[112:115]
    buffer_load_dwordx4 v[184:187], v1, s[4:7], s33 offen offset:1024
    v_mfma_f32_16x16x32_bf16 v[116:119], a[192:195], v[136:139], v[116:119]
    v_mfma_f32_16x16x32_bf16 v[120:123], a[196:199], v[136:139], v[120:123]
    v_mfma_f32_16x16x32_bf16 v[124:127], a[200:203], v[136:139], v[124:127]
    s_waitcnt lgkmcnt(3)
    buffer_load_dwordx4 v2, s[4:7], s81 offen offset:3072 sc1 lds
    v_mfma_f32_16x16x32_bf16 v[48:51], a[252:255], v[140:143], v[48:51]
    s_add_u32 m0, s83, 12288
    s_waitcnt vmcnt(13)
    ds_read_b128 v[136:139], v33 offset:18432
    v_mfma_f32_16x16x32_bf16 v[52:55], v[252:255], v[140:143], v[52:55]
    v_mfma_f32_16x16x32_bf16 v[56:59], a[192:195], v[140:143], v[56:59]
    v_mfma_f32_16x16x32_bf16 v[60:63], a[196:199], v[140:143], v[60:63]
    buffer_load_dwordx4 v[180:183], v1, s[4:7], s33 offen offset:2048
    v_mfma_f32_16x16x32_bf16 v[64:67], a[200:203], v[140:143], v[64:67]
    s_waitcnt lgkmcnt(2)
    v_mfma_f32_16x16x32_bf16 v[68:71], a[204:207], v[128:131], v[68:71]
    s_waitcnt vmcnt(13)
    ds_read_b128 v[140:143], v33 offset:19456
    v_mfma_f32_16x16x32_bf16 v[72:75], a[208:211], v[128:131], v[72:75]
    buffer_load_dwordx4 v[176:179], v1, s[4:7], s33 offen offset:3072
    v_mfma_f32_16x16x32_bf16 v[76:79], a[212:215], v[128:131], v[76:79]
    v_mfma_f32_16x16x32_bf16 v[80:83], a[216:219], v[128:131], v[80:83]
    v_mfma_f32_16x16x32_bf16 v[84:87], a[220:223], v[128:131], v[84:87]
    s_waitcnt lgkmcnt(2)
    v_mfma_f32_16x16x32_bf16 v[88:91], a[204:207], v[132:135], v[88:91]
    s_waitcnt vmcnt(13)
    ds_read_b128 v[128:131], v33 offset:0
    v_mfma_f32_16x16x32_bf16 v[92:95], a[208:211], v[132:135], v[92:95]
    buffer_load_dwordx4 a[160:163], v2, s[4:7], s33 offen offset:0
    v_mfma_f32_16x16x32_bf16 v[96:99], a[212:215], v[132:135], v[96:99]
    v_mfma_f32_16x16x32_bf16 v[100:103], a[216:219], v[132:135], v[100:103]
    v_mfma_f32_16x16x32_bf16 v[104:107], a[220:223], v[132:135], v[104:107]
    s_waitcnt lgkmcnt(2)
    buffer_load_dwordx4 a[164:167], v2, s[4:7], s33 offen offset:1024
    v_mfma_f32_16x16x32_bf16 v[108:111], a[204:207], v[136:139], v[108:111]
    s_waitcnt vmcnt(14)
    ds_read_b128 v[132:135], v33 offset:1024
    v_mfma_f32_16x16x32_bf16 v[112:115], a[208:211], v[136:139], v[112:115]
    v_mfma_f32_16x16x32_bf16 v[116:119], a[212:215], v[136:139], v[116:119]
    buffer_load_dwordx4 a[168:171], v2, s[4:7], s33 offen offset:2048
    v_mfma_f32_16x16x32_bf16 v[120:123], a[216:219], v[136:139], v[120:123]
    v_mfma_f32_16x16x32_bf16 v[124:127], a[220:223], v[136:139], v[124:127]
    s_waitcnt lgkmcnt(2)
    v_mfma_f32_16x16x32_bf16 v[48:51], a[204:207], v[140:143], v[48:51]
    s_waitcnt vmcnt(14)
    ds_read_b128 v[136:139], v33 offset:2048
    v_mfma_f32_16x16x32_bf16 v[52:55], a[208:211], v[140:143], v[52:55]
    buffer_load_dwordx4 v2, s[4:7], s78 offen offset:3072 sc1 lds
    v_mfma_f32_16x16x32_bf16 v[56:59], a[212:215], v[140:143], v[56:59]
    s_add_u32 m0, s83, 16384
    v_mfma_f32_16x16x32_bf16 v[60:63], a[216:219], v[140:143], v[60:63]
    v_mfma_f32_16x16x32_bf16 v[64:67], a[220:223], v[140:143], v[64:67]
    s_waitcnt lgkmcnt(2)
    buffer_load_dwordx4 a[172:175], v2, s[4:7], s33 offen offset:3072
    v_mfma_f32_16x16x32_bf16 v[68:71], a[224:227], v[128:131], v[68:71]
    s_waitcnt vmcnt(15)
    ds_read_b128 v[140:143], v33 offset:3072
    v_mfma_f32_16x16x32_bf16 v[72:75], a[228:231], v[128:131], v[72:75]
    buffer_load_dwordx4 a[176:179], v3, s[4:7], s33 offen offset:0
    v_mfma_f32_16x16x32_bf16 v[76:79], a[232:235], v[128:131], v[76:79]
    buffer_load_dwordx4 a[180:183], v3, s[4:7], s33 offen offset:1024
    v_mfma_f32_16x16x32_bf16 v[80:83], a[236:239], v[128:131], v[80:83]
    buffer_load_dwordx4 a[184:187], v3, s[4:7], s33 offen offset:2048
    v_mfma_f32_16x16x32_bf16 v[84:87], a[240:243], v[128:131], v[84:87]
    s_waitcnt lgkmcnt(2)
    buffer_load_dwordx4 a[188:191], v3, s[4:7], s33 offen offset:3072
    v_mfma_f32_16x16x32_bf16 v[88:91], a[224:227], v[132:135], v[88:91]
    s_add_u32 s33, s60, 0
    s_waitcnt vmcnt(18)
    ds_read_b128 v[128:131], v33 offset:4096
    v_mfma_f32_16x16x32_bf16 v[92:95], a[228:231], v[132:135], v[92:95]
    buffer_load_dwordx4 v3, s[4:7], s79 offen offset:0 sc1 lds
    v_mfma_f32_16x16x32_bf16 v[96:99], a[232:235], v[132:135], v[96:99]
    s_add_u32 m0, s83, 16384
    v_mfma_f32_16x16x32_bf16 v[100:103], a[236:239], v[132:135], v[100:103]
    v_mfma_f32_16x16x32_bf16 v[104:107], a[240:243], v[132:135], v[104:107]
    s_waitcnt lgkmcnt(2)
    buffer_load_dwordx4 v3, s[4:7], s79 offen offset:1024 sc1 lds
    v_mfma_f32_16x16x32_bf16 v[108:111], a[224:227], v[136:139], v[108:111]
    s_add_u32 m0, s83, 16384
    s_waitcnt vmcnt(19)
    ds_read_b128 v[132:135], v33 offset:5120
    v_mfma_f32_16x16x32_bf16 v[112:115], a[228:231], v[136:139], v[112:115]
    v_mfma_f32_16x16x32_bf16 v[116:119], a[232:235], v[136:139], v[116:119]
    buffer_load_dwordx4 v3, s[4:7], s79 offen offset:2048 sc1 lds
    v_mfma_f32_16x16x32_bf16 v[120:123], a[236:239], v[136:139], v[120:123]
    s_add_u32 m0, s83, 16384
    v_mfma_f32_16x16x32_bf16 v[124:127], a[240:243], v[136:139], v[124:127]
    s_waitcnt lgkmcnt(2)
    v_mfma_f32_16x16x32_bf16 v[48:51], a[224:227], v[140:143], v[48:51]
    s_waitcnt vmcnt(19)
    ds_read_b128 v[136:139], v33 offset:6144
    v_mfma_f32_16x16x32_bf16 v[52:55], a[228:231], v[140:143], v[52:55]
    buffer_load_dwordx4 v3, s[4:7], s79 offen offset:3072 sc1 lds
    v_mfma_f32_16x16x32_bf16 v[56:59], a[232:235], v[140:143], v[56:59]
    s_add_u32 m0, s83, 20480
    v_mfma_f32_16x16x32_bf16 v[60:63], a[236:239], v[140:143], v[60:63]
    v_mfma_f32_16x16x32_bf16 v[64:67], a[240:243], v[140:143], v[64:67]
    s_waitcnt lgkmcnt(2)
    buffer_load_dwordx4 v3, s[4:7], s80 offen offset:0 sc1 lds
    v_mfma_f32_16x16x32_bf16 v[68:71], v[248:251], v[128:131], v[68:71]
    s_add_u32 m0, s83, 20480
    s_waitcnt vmcnt(20)
    ds_read_b128 v[140:143], v33 offset:7168
    v_mfma_f32_16x16x32_bf16 v[72:75], v[244:247], v[128:131], v[72:75]
    v_mfma_f32_16x16x32_bf16 v[76:79], v[240:243], v[128:131], v[76:79]
    v_mfma_f32_16x16x32_bf16 v[80:83], v[236:239], v[128:131], v[80:83]
    buffer_load_dwordx4 v3, s[4:7], s80 offen offset:1024 sc1 lds
    v_mfma_f32_16x16x32_bf16 v[84:87], v[232:235], v[128:131], v[84:87]
    s_waitcnt lgkmcnt(2)
    v_mfma_f32_16x16x32_bf16 v[88:91], v[248:251], v[132:135], v[88:91]
    s_add_u32 m0, s83, 20480
    s_waitcnt vmcnt(20)
    ds_read_b128 v[128:131], v33 offset:8192
    v_mfma_f32_16x16x32_bf16 v[92:95], v[244:247], v[132:135], v[92:95]
    buffer_load_dwordx4 v3, s[4:7], s80 offen offset:2048 sc1 lds
    v_mfma_f32_16x16x32_bf16 v[96:99], v[240:243], v[132:135], v[96:99]
    s_add_u32 m0, s83, 20480
    v_mfma_f32_16x16x32_bf16 v[100:103], v[236:239], v[132:135], v[100:103]
    v_mfma_f32_16x16x32_bf16 v[104:107], v[232:235], v[132:135], v[104:107]
    s_waitcnt lgkmcnt(2)
    v_mfma_f32_16x16x32_bf16 v[108:111], v[248:251], v[136:139], v[108:111]
    s_waitcnt vmcnt(20)
    ds_read_b128 v[132:135], v33 offset:9216
    v_mfma_f32_16x16x32_bf16 v[112:115], v[244:247], v[136:139], v[112:115]
    buffer_load_dwordx4 v3, s[4:7], s80 offen offset:3072 sc1 lds
    v_mfma_f32_16x16x32_bf16 v[116:119], v[240:243], v[136:139], v[116:119]
    s_add_u32 m0, s83, 4096
    v_mfma_f32_16x16x32_bf16 v[120:123], v[236:239], v[136:139], v[120:123]
    v_mfma_f32_16x16x32_bf16 v[124:127], v[232:235], v[136:139], v[124:127]
    s_waitcnt lgkmcnt(2)
    buffer_load_dwordx4 v3, s[4:7], s81 offen offset:0 sc1 lds
    v_mfma_f32_16x16x32_bf16 v[48:51], v[248:251], v[140:143], v[48:51]
    s_add_u32 m0, s83, 4096
    s_waitcnt vmcnt(20)
    ds_read_b128 v[136:139], v33 offset:10240
    v_mfma_f32_16x16x32_bf16 v[52:55], v[244:247], v[140:143], v[52:55]
    v_mfma_f32_16x16x32_bf16 v[56:59], v[240:243], v[140:143], v[56:59]
    buffer_load_dwordx4 v3, s[4:7], s81 offen offset:1024 sc1 lds
    v_mfma_f32_16x16x32_bf16 v[60:63], v[236:239], v[140:143], v[60:63]
    s_add_u32 m0, s83, 4096
    v_mfma_f32_16x16x32_bf16 v[64:67], v[232:235], v[140:143], v[64:67]
    s_waitcnt lgkmcnt(2)
    v_mfma_f32_16x16x32_bf16 v[68:71], v[228:231], v[128:131], v[68:71]
    s_waitcnt vmcnt(15)
    ds_read_b128 v[140:143], v33 offset:11264
    v_mfma_f32_16x16x32_bf16 v[72:75], v[224:227], v[128:131], v[72:75]
    buffer_load_dwordx4 v3, s[4:7], s81 offen offset:2048 sc1 lds
    v_mfma_f32_16x16x32_bf16 v[76:79], v[220:223], v[128:131], v[76:79]
    s_add_u32 m0, s83, 4096
    v_mfma_f32_16x16x32_bf16 v[80:83], v[216:219], v[128:131], v[80:83]
    v_mfma_f32_16x16x32_bf16 v[84:87], v[212:215], v[128:131], v[84:87]
    s_waitcnt lgkmcnt(2)
    buffer_load_dwordx4 v3, s[4:7], s81 offen offset:3072 sc1 lds
    v_mfma_f32_16x16x32_bf16 v[88:91], v[228:231], v[132:135], v[88:91]
    s_add_u32 m0, s83, 8192
    s_waitcnt vmcnt(11)
    ds_read_b128 v[128:131], v33 offset:12288
    v_mfma_f32_16x16x32_bf16 v[92:95], v[224:227], v[132:135], v[92:95]
    v_mfma_f32_16x16x32_bf16 v[96:99], v[220:223], v[132:135], v[96:99]
    v_mfma_f32_16x16x32_bf16 v[100:103], v[216:219], v[132:135], v[100:103]
    buffer_load_dwordx4 v3, s[4:7], s78 offen offset:0 sc1 lds
    v_mfma_f32_16x16x32_bf16 v[104:107], v[212:215], v[132:135], v[104:107]
    s_waitcnt lgkmcnt(2)
    v_mfma_f32_16x16x32_bf16 v[108:111], v[228:231], v[136:139], v[108:111]
    s_add_u32 m0, s83, 8192
    s_waitcnt vmcnt(11)
    ds_read_b128 v[132:135], v33 offset:13312
    v_mfma_f32_16x16x32_bf16 v[112:115], v[224:227], v[136:139], v[112:115]
    buffer_load_dwordx4 v3, s[4:7], s78 offen offset:1024 sc1 lds
    v_mfma_f32_16x16x32_bf16 v[116:119], v[220:223], v[136:139], v[116:119]
    s_add_u32 m0, s83, 8192
    v_mfma_f32_16x16x32_bf16 v[120:123], v[216:219], v[136:139], v[120:123]
    v_mfma_f32_16x16x32_bf16 v[124:127], v[212:215], v[136:139], v[124:127]
    s_waitcnt lgkmcnt(2)
    v_mfma_f32_16x16x32_bf16 v[48:51], v[228:231], v[140:143], v[48:51]
    s_waitcnt vmcnt(11)
    ds_read_b128 v[136:139], v33 offset:14336
    v_mfma_f32_16x16x32_bf16 v[52:55], v[224:227], v[140:143], v[52:55]
    buffer_load_dwordx4 v3, s[4:7], s78 offen offset:2048 sc1 lds
    v_mfma_f32_16x16x32_bf16 v[56:59], v[220:223], v[140:143], v[56:59]
    s_add_u32 m0, s83, 8192
    v_mfma_f32_16x16x32_bf16 v[60:63], v[216:219], v[140:143], v[60:63]
    v_mfma_f32_16x16x32_bf16 v[64:67], v[212:215], v[140:143], v[64:67]
    s_waitcnt lgkmcnt(2)
    buffer_load_dwordx4 v3, s[4:7], s78 offen offset:3072 sc1 lds
    v_mfma_f32_16x16x32_bf16 v[68:71], v[208:211], v[128:131], v[68:71]
    s_waitcnt vmcnt(12)
    ds_read_b128 v[140:143], v33 offset:15360
    v_mfma_f32_16x16x32_bf16 v[72:75], v[204:207], v[128:131], v[72:75]
    v_mfma_f32_16x16x32_bf16 v[76:79], v[200:203], v[128:131], v[76:79]
    buffer_load_dwordx4 a[244:247], v1, s[4:7], s33 offen offset:0
    v_mfma_f32_16x16x32_bf16 v[80:83], v[196:199], v[128:131], v[80:83]
    v_mfma_f32_16x16x32_bf16 v[84:87], v[164:167], v[128:131], v[84:87]
    s_waitcnt lgkmcnt(2)
    v_mfma_f32_16x16x32_bf16 v[68:71], v[168:171], v[132:135], v[68:71]
    s_waitcnt vmcnt(12)
    ds_read_b128 v[128:131], v33 offset:16384
    v_mfma_f32_16x16x32_bf16 v[72:75], v[172:175], v[132:135], v[72:75]
    buffer_load_dwordx4 a[248:251], v1, s[4:7], s33 offen offset:1024
    v_mfma_f32_16x16x32_bf16 v[76:79], v[192:195], v[132:135], v[76:79]
    v_mfma_f32_16x16x32_bf16 v[80:83], v[188:191], v[132:135], v[80:83]
    v_mfma_f32_16x16x32_bf16 v[84:87], v[184:187], v[132:135], v[84:87]
    s_waitcnt lgkmcnt(2)
    buffer_load_dwordx4 a[252:255], v1, s[4:7], s33 offen offset:2048
    v_mfma_f32_16x16x32_bf16 v[68:71], v[180:183], v[136:139], v[68:71]
    s_waitcnt vmcnt(13)
    ds_read_b128 v[132:135], v33 offset:17408
    v_mfma_f32_16x16x32_bf16 v[72:75], v[176:179], v[136:139], v[72:75]
    v_mfma_f32_16x16x32_bf16 v[76:79], a[160:163], v[136:139], v[76:79]
    v_mfma_f32_16x16x32_bf16 v[80:83], a[164:167], v[136:139], v[80:83]
    buffer_load_dwordx4 v[252:255], v1, s[4:7], s33 offen offset:3072
    v_mfma_f32_16x16x32_bf16 v[84:87], a[168:171], v[136:139], v[84:87]
    s_waitcnt lgkmcnt(2)
    v_mfma_f32_16x16x32_bf16 v[68:71], a[172:175], v[140:143], v[68:71]
    s_waitcnt vmcnt(13)
    ds_read_b128 v[136:139], v33 offset:18432
    v_mfma_f32_16x16x32_bf16 v[72:75], a[176:179], v[140:143], v[72:75]
    buffer_load_dwordx4 a[192:195], v2, s[4:7], s33 offen offset:0
    v_mfma_f32_16x16x32_bf16 v[76:79], a[180:183], v[140:143], v[76:79]
    v_mfma_f32_16x16x32_bf16 v[80:83], a[184:187], v[140:143], v[80:83]
    v_mfma_f32_16x16x32_bf16 v[84:87], a[188:191], v[140:143], v[84:87]
    s_waitcnt lgkmcnt(2)
    s_barrier
    v_mfma_f32_16x16x32_bf16 v[88:91], v[208:211], v[128:131], v[88:91]
    s_waitcnt vmcnt(13)
    ds_read_b128 v[140:143], v33 offset:19456
    v_mfma_f32_16x16x32_bf16 v[92:95], v[204:207], v[128:131], v[92:95]
    buffer_load_dwordx4 a[196:199], v2, s[4:7], s33 offen offset:1024
    v_mfma_f32_16x16x32_bf16 v[96:99], v[200:203], v[128:131], v[96:99]
    ds_write_b128 v20, v[68:71] offset:0
    v_mfma_f32_16x16x32_bf16 v[100:103], v[196:199], v[128:131], v[100:103]
    v_mfma_f32_16x16x32_bf16 v[104:107], v[164:167], v[128:131], v[104:107]
    s_waitcnt lgkmcnt(3)
    buffer_load_dwordx4 a[200:203], v2, s[4:7], s33 offen offset:2048
    v_mfma_f32_16x16x32_bf16 v[88:91], v[168:171], v[132:135], v[88:91]
    s_waitcnt vmcnt(14)
    ds_read_b128 v[128:131], v33 offset:0
    v_mfma_f32_16x16x32_bf16 v[92:95], v[172:175], v[132:135], v[92:95]
    ds_write_b128 v20, v[72:75] offset:1024
    v_mfma_f32_16x16x32_bf16 v[96:99], v[192:195], v[132:135], v[96:99]
    buffer_load_dwordx4 a[204:207], v2, s[4:7], s33 offen offset:3072
    v_mfma_f32_16x16x32_bf16 v[100:103], v[188:191], v[132:135], v[100:103]
    v_mfma_f32_16x16x32_bf16 v[104:107], v[184:187], v[132:135], v[104:107]
    s_waitcnt lgkmcnt(4)
    ds_write_b128 v20, v[76:79] offset:2048
    v_mfma_f32_16x16x32_bf16 v[88:91], v[180:183], v[136:139], v[88:91]
    s_waitcnt vmcnt(14)
    ds_read_b128 v[132:135], v33 offset:1024
    v_mfma_f32_16x16x32_bf16 v[92:95], v[176:179], v[136:139], v[92:95]
    buffer_load_dwordx4 a[208:211], v3, s[4:7], s33 offen offset:0
    v_mfma_f32_16x16x32_bf16 v[96:99], a[160:163], v[136:139], v[96:99]
    ds_write_b128 v20, v[80:83] offset:3072
    v_mfma_f32_16x16x32_bf16 v[100:103], a[164:167], v[136:139], v[100:103]
    v_mfma_f32_16x16x32_bf16 v[104:107], a[168:171], v[136:139], v[104:107]
    s_waitcnt lgkmcnt(6)
    buffer_load_dwordx4 a[212:215], v3, s[4:7], s33 offen offset:1024
    v_mfma_f32_16x16x32_bf16 v[88:91], a[172:175], v[140:143], v[88:91]
    s_waitcnt vmcnt(15)
    ds_read_b128 v[136:139], v33 offset:2048
    v_mfma_f32_16x16x32_bf16 v[92:95], a[176:179], v[140:143], v[92:95]
    ds_write_b128 v20, v[84:87] offset:4096
    v_mfma_f32_16x16x32_bf16 v[96:99], a[180:183], v[140:143], v[96:99]
    v_mfma_f32_16x16x32_bf16 v[100:103], a[184:187], v[140:143], v[100:103]
    buffer_load_dwordx4 a[216:219], v3, s[4:7], s33 offen offset:2048
    v_mfma_f32_16x16x32_bf16 v[104:107], a[188:191], v[140:143], v[104:107]
    s_waitcnt lgkmcnt(6)
    v_mfma_f32_16x16x32_bf16 v[108:111], v[208:211], v[128:131], v[108:111]
    s_waitcnt vmcnt(15)
    ds_read_b128 v[140:143], v33 offset:3072
    v_mfma_f32_16x16x32_bf16 v[112:115], v[204:207], v[128:131], v[112:115]
    buffer_load_dwordx4 a[220:223], v3, s[4:7], s33 offen offset:3072
    v_mfma_f32_16x16x32_bf16 v[116:119], v[200:203], v[128:131], v[116:119]
    s_add_u32 s33, s60, 12288
    ds_write_b128 v21, v[88:91] offset:0
    v_mfma_f32_16x16x32_bf16 v[120:123], v[196:199], v[128:131], v[120:123]
    v_mfma_f32_16x16x32_bf16 v[124:127], v[164:167], v[128:131], v[124:127]
    s_waitcnt lgkmcnt(5)
    v_mfma_f32_16x16x32_bf16 v[108:111], v[168:171], v[132:135], v[108:111]
    s_waitcnt vmcnt(15)
    ds_read_b128 v[128:131], v33 offset:4096
    v_mfma_f32_16x16x32_bf16 v[112:115], v[172:175], v[132:135], v[112:115]
    buffer_load_dwordx4 a[224:227], v1, s[4:7], s33 offen offset:0
    v_mfma_f32_16x16x32_bf16 v[116:119], v[192:195], v[132:135], v[116:119]
    ds_write_b128 v21, v[92:95] offset:1024
    v_mfma_f32_16x16x32_bf16 v[120:123], v[188:191], v[132:135], v[120:123]
    v_mfma_f32_16x16x32_bf16 v[124:127], v[184:187], v[132:135], v[124:127]
    s_waitcnt lgkmcnt(5)
    buffer_load_dwordx4 a[228:231], v1, s[4:7], s33 offen offset:1024
    v_mfma_f32_16x16x32_bf16 v[108:111], v[180:183], v[136:139], v[108:111]
    s_waitcnt vmcnt(16)
    ds_read_b128 v[132:135], v33 offset:5120
    v_mfma_f32_16x16x32_bf16 v[112:115], v[176:179], v[136:139], v[112:115]
    ds_write_b128 v21, v[96:99] offset:2048
    v_mfma_f32_16x16x32_bf16 v[116:119], a[160:163], v[136:139], v[116:119]
    buffer_load_dwordx4 a[232:235], v1, s[4:7], s33 offen offset:2048
    v_mfma_f32_16x16x32_bf16 v[120:123], a[164:167], v[136:139], v[120:123]
    v_mfma_f32_16x16x32_bf16 v[124:127], a[168:171], v[136:139], v[124:127]
    s_waitcnt lgkmcnt(5)
    ds_write_b128 v21, v[100:103] offset:3072
    v_mfma_f32_16x16x32_bf16 v[108:111], a[172:175], v[140:143], v[108:111]
    s_waitcnt vmcnt(16)
    ds_read_b128 v[136:139], v33 offset:6144
    v_mfma_f32_16x16x32_bf16 v[112:115], a[176:179], v[140:143], v[112:115]
    buffer_load_dwordx4 a[236:239], v1, s[4:7], s33 offen offset:3072
    v_mfma_f32_16x16x32_bf16 v[116:119], a[180:183], v[140:143], v[116:119]
    ds_write_b128 v21, v[104:107] offset:4096
    v_mfma_f32_16x16x32_bf16 v[120:123], a[184:187], v[140:143], v[120:123]
    v_mfma_f32_16x16x32_bf16 v[124:127], a[188:191], v[140:143], v[124:127]
    s_waitcnt lgkmcnt(6)
    buffer_load_dwordx4 a[240:243], v2, s[4:7], s33 offen offset:0
    s_waitcnt lgkmcnt(0)
    s_barrier
    v_mfma_f32_16x16x32_bf16 v[48:51], v[208:211], v[128:131], v[48:51]
    s_waitcnt vmcnt(17)
    ds_read_b128 v[140:143], v33 offset:7168
    ds_read_b128 v[68:71], v23 offset:0
    v_mfma_f32_16x16x32_bf16 v[52:55], v[204:207], v[128:131], v[52:55]
    ds_read_b128 v[88:91], v23 offset:5120
    v_mfma_f32_16x16x32_bf16 v[56:59], v[200:203], v[128:131], v[56:59]
    ds_write_b128 v22, v[108:111] offset:0
    v_mfma_f32_16x16x32_bf16 v[60:63], v[196:199], v[128:131], v[60:63]
    buffer_load_dwordx4 v[248:251], v2, s[4:7], s33 offen offset:1024
    v_mfma_f32_16x16x32_bf16 v[64:67], v[164:167], v[128:131], v[64:67]
    ds_read_b128 v[72:75], v23 offset:1024
    ds_read_b128 v[92:95], v23 offset:6144
    v_mfma_f32_16x16x32_bf16 v[48:51], v[168:171], v[132:135], v[48:51]
    ds_write_b128 v22, v[112:115] offset:1024
    v_mfma_f32_16x16x32_bf16 v[52:55], v[172:175], v[132:135], v[52:55]
    buffer_load_dwordx4 v[244:247], v2, s[4:7], s33 offen offset:2048
    v_mfma_f32_16x16x32_bf16 v[56:59], v[192:195], v[132:135], v[56:59]
    ds_read_b128 v[76:79], v23 offset:2048
    ds_read_b128 v[96:99], v23 offset:7168
    v_mfma_f32_16x16x32_bf16 v[60:63], v[188:191], v[132:135], v[60:63]
    ds_write_b128 v22, v[116:119] offset:2048
    v_mfma_f32_16x16x32_bf16 v[64:67], v[184:187], v[132:135], v[64:67]
    ds_read_b128 v[80:83], v23 offset:3072
    ds_read_b128 v[100:103], v23 offset:8192
    v_mfma_f32_16x16x32_bf16 v[48:51], v[180:183], v[136:139], v[48:51]
    buffer_load_dwordx4 v[240:243], v2, s[4:7], s33 offen offset:3072
    v_mfma_f32_16x16x32_bf16 v[52:55], v[176:179], v[136:139], v[52:55]
    ds_write_b128 v22, v[120:123] offset:3072
    v_mfma_f32_16x16x32_bf16 v[56:59], a[160:163], v[136:139], v[56:59]
    ds_read_b128 v[84:87], v23 offset:4096
    ds_read_b128 v[104:107], v23 offset:9216
    v_mfma_f32_16x16x32_bf16 v[60:63], a[164:167], v[136:139], v[60:63]
    ds_write_b128 v22, v[124:127] offset:4096
    v_mfma_f32_16x16x32_bf16 v[64:67], a[168:171], v[136:139], v[64:67]
    s_waitcnt lgkmcnt(15)
    buffer_load_dwordx4 v[236:239], v3, s[4:7], s33 offen offset:0
    v_mfma_f32_16x16x32_bf16 v[48:51], a[172:175], v[140:143], v[48:51]
    s_waitcnt lgkmcnt(13)
    v_add_f32 v68, v68, v88
    v_add_f32 v69, v69, v89
    v_mfma_f32_16x16x32_bf16 v[52:55], a[176:179], v[140:143], v[52:55]
    v_add_f32 v70, v70, v90
    v_add_f32 v71, v71, v91
    v_mfma_f32_16x16x32_bf16 v[56:59], a[180:183], v[140:143], v[56:59]
    s_waitcnt lgkmcnt(10)
    buffer_load_dwordx4 v[232:235], v3, s[4:7], s33 offen offset:1024
    v_mfma_f32_16x16x32_bf16 v[60:63], a[184:187], v[140:143], v[60:63]
    v_add_f32 v72, v72, v92
    v_add_f32 v73, v73, v93
    v_mfma_f32_16x16x32_bf16 v[64:67], a[188:191], v[140:143], v[64:67]
    v_add_f32 v74, v74, v94
    v_add_f32 v75, v75, v95
    s_waitcnt lgkmcnt(0)
    s_barrier
    ds_read_b128 v[108:111], v23 offset:10240
    ds_read_b128 v[112:115], v23 offset:11264
    ds_read_b128 v[116:119], v23 offset:12288
    ds_read_b128 v[120:123], v23 offset:13312
    ds_read_b128 v[124:127], v23 offset:14336
    buffer_load_dword v29, v5, s[4:7], s31 offen sc1
    v_add_f32 v76, v76, v96
    v_add_f32 v77, v77, v97
    v_add_f32 v78, v78, v98
    v_add_f32 v79, v79, v99
    buffer_load_dwordx4 v[228:231], v3, s[4:7], s33 offen offset:2048
    v_add_f32 v80, v80, v100
    v_add_f32 v81, v81, v101
    v_add_f32 v82, v82, v102
    v_add_f32 v83, v83, v103
    v_add_f32 v84, v84, v104
    v_add_f32 v85, v85, v105
    v_add_f32 v86, v86, v106
    v_add_f32 v87, v87, v107
    v_pk_add_f32 v[48:49], v[48:49], v[68:69]
    v_pk_add_f32 v[50:51], v[50:51], v[70:71]
    v_pk_add_f32 v[52:53], v[52:53], v[72:73]
    buffer_load_dwordx4 v[224:227], v3, s[4:7], s33 offen offset:3072
    v_pk_add_f32 v[54:55], v[54:55], v[74:75]
    v_pk_add_f32 v[56:57], v[56:57], v[76:77]
    v_pk_add_f32 v[58:59], v[58:59], v[78:79]
    v_pk_add_f32 v[60:61], v[60:61], v[80:81]
    v_pk_add_f32 v[62:63], v[62:63], v[82:83]
    v_pk_add_f32 v[64:65], v[64:65], v[84:85]
    v_pk_add_f32 v[66:67], v[66:67], v[86:87]
    s_waitcnt lgkmcnt(4)
    v_pk_add_f32 v[48:49], v[48:49], v[108:109]
    v_pk_add_f32 v[50:51], v[50:51], v[110:111]
    v_cvt_pk_bf16_f32 v36, v48, v49
    v_cvt_pk_bf16_f32 v37, v50, v51
    s_waitcnt lgkmcnt(3)
    v_pk_add_f32 v[52:53], v[52:53], v[112:113]
    v_pk_add_f32 v[54:55], v[54:55], v[114:115]
    s_add_u32 s33, s60, 24576
    buffer_load_dwordx4 v[220:223], v1, s[4:7], s33 offen offset:0
    v_cvt_pk_bf16_f32 v38, v52, v53
    v_cvt_pk_bf16_f32 v39, v54, v55
    buffer_store_dwordx4 v[36:39], v1, s[4:7], s95 offen
    s_waitcnt lgkmcnt(2)
    v_pk_add_f32 v[56:57], v[56:57], v[116:117]
    v_pk_add_f32 v[58:59], v[58:59], v[118:119]
    v_cvt_pk_bf16_f32 v40, v56, v57
    v_cvt_pk_bf16_f32 v41, v58, v59
    s_waitcnt lgkmcnt(1)
    v_pk_add_f32 v[60:61], v[60:61], v[120:121]
    v_pk_add_f32 v[62:63], v[62:63], v[122:123]
    v_cvt_pk_bf16_f32 v42, v60, v61
    v_cvt_pk_bf16_f32 v43, v62, v63
    buffer_store_dwordx4 v[40:43], v1, s[4:7], s95 offen offset:1024
    s_waitcnt lgkmcnt(0)
    v_pk_add_f32 v[64:65], v[64:65], v[124:125]
    v_pk_add_f32 v[66:67], v[66:67], v[126:127]
    v_cvt_pk_bf16_f32 v44, v64, v65
    s_add_u32 s33, s61, 0
    buffer_load_dwordx4 v[216:219], v1, s[4:7], s33 offen offset:0
    v_cvt_pk_bf16_f32 v45, v66, v67
    buffer_store_dwordx2 v[44:45], v25, s[4:7], s96 offen
    v_dot2_f32_bf16 v31, v36, s30, 0
    v_dot2_f32_bf16 v32, v36, v36, 0
    v_dot2_f32_bf16 v31, v37, s30, v31
    v_dot2_f32_bf16 v32, v37, v37, v32
    v_dot2_f32_bf16 v31, v38, s30, v31
    v_dot2_f32_bf16 v32, v38, v38, v32
    v_dot2_f32_bf16 v31, v39, s30, v31
    v_dot2_f32_bf16 v32, v39, v39, v32
    v_dot2_f32_bf16 v31, v40, s30, v31
    v_dot2_f32_bf16 v32, v40, v40, v32
    v_dot2_f32_bf16 v31, v41, s30, v31
    v_dot2_f32_bf16 v32, v41, v41, v32
    buffer_load_dwordx4 v[212:215], v1, s[4:7], s33 offen offset:1024
    v_dot2_f32_bf16 v31, v42, s30, v31
    v_dot2_f32_bf16 v32, v42, v42, v32
    v_dot2_f32_bf16 v31, v43, s30, v31
    v_dot2_f32_bf16 v32, v43, v43, v32
    v_dot2_f32_bf16 v31, v44, s30, v31
    v_dot2_f32_bf16 v32, v44, v44, v32
    v_dot2_f32_bf16 v31, v45, s30, v31
    v_dot2_f32_bf16 v32, v45, v45, v32
    s_nop 2
    v_permlane16_swap_b32 v31, v32
    v_add_f32 v31, v31, v32
    v_mov_b32 v32, v31
    s_nop 1
    v_permlane32_swap_b32 v31, v32
    buffer_load_dwordx4 v[208:211], v1, s[4:7], s33 offen offset:2048
    v_add_f32 v34, v31, v32
    s_mov_b64 exec, s[36:37]
    buffer_store_dword v34, v28, s[4:7], s97 offen
    s_mov_b64 exec, -1
    s_waitcnt vmcnt(10)
poll_110:
    v_cmp_le_u32 vcc, 6, v29
    s_nop 0
    s_andn2_b64 s[56:57], s[36:37], vcc
    s_cbranch_scc1 pollr_109
    s_cmp_lg_u32 s28, 0
    s_cbranch_scc1 acq_111
polld_112:
    s_add_u32 m0, s82, 45056
    s_nop 0
    buffer_load_dwordx4 v1, s[12:15], m0 offen offset:0 sc1 lds
    s_add_u32 m0, s82, 46080
    s_nop 0
    buffer_load_dwordx4 v1, s[12:15], m0 offen offset:0 sc1 lds
    s_add_u32 m0, s82, 49152
    s_nop 0
    buffer_load_dwordx4 v1, s[12:15], m0 offen offset:0 sc1 lds
    s_add_u32 m0, s82, 50176
    s_nop 0
    buffer_load_dwordx4 v1, s[12:15], m0 offen offset:0 sc1 lds
    s_add_u32 s88, s98, 0
    buffer_load_dwordx4 v[144:147], v1, s[4:7], s88 offen sc1
    s_add_u32 m0, s82, 53248
    s_nop 0
    buffer_load_dwordx4 v1, s[12:15], m0 offen offset:0 sc1 lds
    v_mov_b32 v30, 6
    s_mov_b64 exec, 1
    s_cmp_lg_u32 s28, 0
    s_waitcnt vmcnt(6)
    s_cbranch_scc1 pubs_113
    buffer_store_dword v30, off, s[4:7], s32
pubd_114:
    s_mov_b64 exec, -1
    s_waitcnt vmcnt(3)
    s_barrier
    ds_read_b128 v[96:99], v9 offset:40960
    ds_read_b128 v[100:103], v9 offset:41472
    ds_read_b128 v[104:107], v9 offset:41984
    ds_read_b128 v[108:111], v9 offset:42496
    ds_read_b128 v[112:115], v9 offset:43008
    ds_read_b128 v[116:119], v9 offset:43520
    s_waitcnt lgkmcnt(4)
    v_mfma_f32_32x32x16_bf16 v[48:63], a[0:3], v[96:99], 0
    s_add_u32 m0, s82, 54272
    ds_read_b128 v[120:123], v9 offset:44032
    buffer_load_dwordx4 v1, s[12:15], m0 offen offset:0 sc1 lds
    v_mfma_f32_32x32x16_bf16 v[48:63], a[4:7], v[100:103], v[48:63]
    s_waitcnt lgkmcnt(3)
    ds_read_b128 v[124:127], v9 offset:44544
    s_add_u32 m0, s82, 57344
    s_nop 0
    buffer_load_dwordx4 v1, s[12:15], m0 offen offset:0 sc1 lds
    v_mfma_f32_32x32x16_bf16 v[48:63], a[8:11], v[104:107], v[48:63]
    s_add_u32 m0, s82, 58368
    ds_read_b128 v[96:99], v9 offset:45056
    buffer_load_dwordx4 v1, s[12:15], m0 offen offset:0 sc1 lds
    v_lshrrev_b32 v140, 3, v5
    v_and_b32 v140, 16, v140
    v_add_u32 v140, s0, v140
    v_mfma_f32_32x32x16_bf16 v[48:63], a[12:15], v[108:111], v[48:63]
    s_waitcnt lgkmcnt(3)
    ds_read_b128 v[100:103], v9 offset:45568
    s_add_u32 m0, s82, 61440
    s_nop 0
    buffer_load_dwordx4 v1, s[12:15], m0 offen offset:0 sc1 lds
    ds_read_b128 v[128:131], v140 offset:0
    v_mfma_f32_32x32x16_bf16 v[48:63], a[16:19], v[112:115], v[48:63]
    s_add_u32 m0, s82, 62464
    ds_read_b128 v[104:107], v9 offset:46080
    buffer_load_dwordx4 v1, s[12:15], m0 offen offset:0 sc1 lds
    ds_read_b128 v[132:135], v140 offset:32
    ds_read_b128 v[136:139], v140 offset:64
    ds_read_b128 v[140:143], v140 offset:96
    v_mfma_f32_32x32x16_bf16 v[48:63], a[20:23], v[116:119], v[48:63]
    s_waitcnt lgkmcnt(7)
    ds_read_b128 v[108:111], v9 offset:46592
    s_add_u32 m0, s82, 4096
    s_nop 0
    buffer_load_dwordx4 v1, s[12:15], m0 offen offset:0 sc1 lds
    v_and_b32 v154, 124, v5
    v_mfma_f32_32x32x16_bf16 v[48:63], a[24:27], v[120:123], v[48:63]
    s_add_u32 m0, s82, 5120
    ds_read_b128 v[112:115], v9 offset:47104
    buffer_load_dwordx4 v1, s[12:15], m0 offen offset:0 sc1 lds
    v_lshlrev_b32 v154, 1, v154
    v_add_u32 v154, 2048, v154
    v_mfma_f32_32x32x16_bf16 v[48:63], a[28:31], v[124:127], v[48:63]
    s_waitcnt lgkmcnt(7)
    ds_read_b128 v[116:119], v9 offset:47616
    s_add_u32 m0, s82, 8192
    s_nop 0
    buffer_load_dwordx4 v1, s[12:15], m0 offen offset:0 sc1 lds
    v_mfma_f32_32x32x16_bf16 v[48:63], a[32:35], v[96:99], v[48:63]
    s_add_u32 m0, s82, 9216
    ds_read_b128 v[120:123], v9 offset:48128
    buffer_load_dwordx4 v1, s[12:15], m0 offen offset:0 sc1 lds
    v_mfma_f32_32x32x16_bf16 v[48:63], a[36:39], v[100:103], v[48:63]
    s_waitcnt lgkmcnt(3)
    ds_read_b128 v[124:127], v9 offset:48640
    s_add_u32 m0, s82, 12288
    s_nop 0
    buffer_load_dwordx4 v1, s[12:15], m0 offen offset:0 sc1 lds
    v_mfma_f32_32x32x16_bf16 v[48:63], a[40:43], v[104:107], v[48:63]
    s_add_u32 m0, s82, 13312
    s_waitcnt vmcnt(5)
    s_barrier
    ds_read_b128 v[96:99], v9 offset:49152
    buffer_load_dwordx4 v1, s[12:15], m0 offen offset:0 sc1 lds
    v_mfma_f32_32x32x16_bf16 v[48:63], a[44:47], v[108:111], v[48:63]
    s_waitcnt lgkmcnt(3)
    ds_read_b128 v[100:103], v9 offset:49664
    s_add_u32 m0, s82, 16384
    s_nop 0
    buffer_load_dwordx4 v1, s[12:15], m0 offen offset:0 sc1 lds
    v_mfma_f32_32x32x16_bf16 v[48:63], a[48:51], v[112:115], v[48:63]
    s_add_u32 m0, s82, 17408
    ds_read_b128 v[104:107], v9 offset:50176
    buffer_load_dwordx4 v1, s[12:15], m0 offen offset:0 sc1 lds
    v_mfma_f32_32x32x16_bf16 v[48:63], a[52:55], v[116:119], v[48:63]
    s_waitcnt lgkmcnt(3)
    ds_read_b128 v[108:111], v9 offset:50688
    s_add_u32 m0, s82, 20480
    s_nop 0
    buffer_load_dwordx4 v1, s[12:15], m0 offen offset:0 sc1 lds
    v_mfma_f32_32x32x16_bf16 v[48:63], a[56:59], v[120:123], v[48:63]
    s_add_u32 m0, s82, 21504
    ds_read_b128 v[112:115], v9 offset:51200
    buffer_load_dwordx4 v1, s[12:15], m0 offen offset:0 sc1 lds
    v_add_f32 v144, v144, v146
    v_add_f32 v145, v145, v147
    s_nop 1
    v_permlane16_swap_b32 v144, v145
    v_mfma_f32_32x32x16_bf16 v[48:63], a[60:63], v[124:127], v[48:63]
    s_waitcnt lgkmcnt(3)
    ds_read_b128 v[116:119], v9 offset:51712
    v_add_f32 v144, v144, v145
    v_mov_b32 v145, v144
    s_nop 1
    v_permlane32_swap_b32 v144, v145
    v_mfma_f32_32x32x16_bf16 v[48:63], a[64:67], v[96:99], v[48:63]
    buffer_load_dword v29, v5, s[4:7], s31 offen sc1
    ds_read_b128 v[120:123], v9 offset:52224
    buffer_load_dwordx4 v[204:207], v1, s[4:7], s33 offen offset:3072
    v_add_f32 v144, v144, v145
    v_mfma_f32_32x32x16_bf16 v[48:63], a[68:71], v[100:103], v[48:63]
    s_waitcnt lgkmcnt(3)
    ds_read_b128 v[124:127], v9 offset:52736
    v_mov_b32 v145, v144
    s_nop 1
    v_permlane16_swap_b32 v144, v145
    v_mul_f32 v146, s64, v144
    v_mfma_f32_32x32x16_bf16 v[48:63], a[72:75], v[104:107], v[48:63]
    ds_read_b128 v[96:99], v9 offset:53248
    v_mul_f32 v145, s64, v145
    v_fma_f32 v145, -v146, v146, v145
    v_max_f32 v145, 0, v145
    v_add_f32 v145, s65, v145
    v_mfma_f32_32x32x16_bf16 v[48:63], a[76:79], v[108:111], v[48:63]
    s_waitcnt lgkmcnt(3)
    ds_read_b128 v[100:103], v9 offset:53760
    v_rsq_f32 v147, v145
    v_add_u32 v144, s0, v17
    ds_write_b64 v144, v[146:147] offset:0
    v_mfma_f32_32x32x16_bf16 v[48:63], a[80:83], v[112:115], v[48:63]
    ds_read_b128 v[104:107], v9 offset:54272
    v_mfma_f32_32x32x16_bf16 v[48:63], a[84:87], v[116:119], v[48:63]
    s_waitcnt lgkmcnt(4)
    ds_read_b128 v[108:111], v9 offset:54784
    buffer_load_dwordx4 v[200:203], v2, s[4:7], s33 offen offset:0
    v_mfma_f32_32x32x16_bf16 v[48:63], a[88:91], v[120:123], v[48:63]
    ds_read_b128 v[112:115], v9 offset:55296
    v_mfma_f32_32x32x16_bf16 v[48:63], a[92:95], v[124:127], v[48:63]
    s_waitcnt lgkmcnt(4)
    ds_read_b128 v[116:119], v9 offset:55808
    v_mfma_f32_32x32x16_bf16 v[48:63], a[96:99], v[96:99], v[48:63]
    ds_read_b128 v[120:123], v9 offset:56320
    v_mfma_f32_32x32x16_bf16 v[48:63], a[100:103], v[100:103], v[48:63]
    s_waitcnt lgkmcnt(3)
    ds_read_b128 v[124:127], v9 offset:56832
    v_mfma_f32_32x32x16_bf16 v[48:63], a[104:107], v[104:107], v[48:63]
    ds_read_b128 v[96:99], v9 offset:57344
    v_mfma_f32_32x32x16_bf16 v[48:63], a[108:111], v[108:111], v[48:63]
    s_waitcnt lgkmcnt(3)
    ds_read_b128 v[100:103], v9 offset:57856
    buffer_load_dwordx4 v[196:199], v2, s[4:7], s33 offen offset:1024
    v_mfma_f32_32x32x16_bf16 v[48:63], a[112:115], v[112:115], v[48:63]
    ds_read_b128 v[104:107], v9 offset:58368
    v_mfma_f32_32x32x16_bf16 v[48:63], a[116:119], v[116:119], v[48:63]
    s_waitcnt lgkmcnt(3)
    ds_read_b128 v[108:111], v9 offset:58880
    v_mfma_f32_32x32x16_bf16 v[48:63], a[120:123], v[120:123], v[48:63]
    ds_read_b128 v[112:115], v9 offset:59392
    v_mfma_f32_32x32x16_bf16 v[48:63], a[124:127], v[124:127], v[48:63]
    s_waitcnt lgkmcnt(3)
    ds_read_b128 v[116:119], v9 offset:59904
    v_mfma_f32_32x32x16_bf16 v[48:63], a[128:131], v[96:99], v[48:63]
    ds_read_b128 v[120:123], v9 offset:60416
    v_mfma_f32_32x32x16_bf16 v[48:63], a[132:135], v[100:103], v[48:63]
    s_waitcnt lgkmcnt(3)
    ds_read_b128 v[124:127], v9 offset:60928
    buffer_load_dwordx4 v[192:195], v2, s[4:7], s33 offen offset:2048
    v_mfma_f32_32x32x16_bf16 v[48:63], a[136:139], v[104:107], v[48:63]
    s_waitcnt vmcnt(5)
    s_barrier
    s_waitcnt vmcnt(4)
poll_116:
    v_cmp_le_u32 vcc, 6, v29
    s_nop 0
    s_andn2_b64 s[56:57], s[38:39], vcc
    s_cbranch_scc1 pollr_115
    s_cmp_lg_u32 s28, 0
    s_cbranch_scc1 acq_117
polld_118:
    ds_read_b128 v[96:99], v9 offset:0
    v_mfma_f32_32x32x16_bf16 v[48:63], a[140:143], v[108:111], v[48:63]
    s_waitcnt lgkmcnt(3)
    ds_read_b128 v[100:103], v9 offset:512
    s_add_u32 s88, s98, 65536
    buffer_load_dwordx4 v[144:147], v1, s[4:7], s88 offen sc1
    v_mfma_f32_32x32x16_bf16 v[48:63], a[144:147], v[112:115], v[48:63]
    s_add_u32 m0, s82, 45056
    ds_read_b128 v[104:107], v9 offset:1024
    s_add_u32 s88, s82, 4096
    buffer_load_dwordx4 v1, s[16:19], s88 offen offset:0 sc1 lds
    v_mfma_f32_32x32x16_bf16 v[48:63], a[148:151], v[116:119], v[48:63]
    s_waitcnt lgkmcnt(3)
    ds_read_b128 v[108:111], v9 offset:1536
    s_add_u32 m0, s82, 46080
    s_add_u32 s88, s82, 5120
    buffer_load_dwordx4 v1, s[16:19], s88 offen offset:0 sc1 lds
    v_mfma_f32_32x32x16_bf16 v[48:63], a[152:155], v[120:123], v[48:63]
    s_add_u32 m0, s82, 49152
    ds_read_b128 v[112:115], v9 offset:2048
    s_add_u32 s88, s82, 8192
    buffer_load_dwordx4 v1, s[16:19], s88 offen offset:0 sc1 lds
    v_mfma_f32_32x32x16_bf16 v[48:63], a[156:159], v[124:127], v[48:63]
    s_waitcnt lgkmcnt(3)
    ds_read_b128 v[116:119], v9 offset:2560
    s_add_u32 m0, s82, 50176
    s_add_u32 s88, s82, 9216
    buffer_load_dwordx4 v1, s[16:19], s88 offen offset:0 sc1 lds
    v_mfma_f32_32x32x16_bf16 v[64:79], a[0:3], v[96:99], 0
    s_add_u32 m0, s82, 53248
    ds_read_b128 v[120:123], v9 offset:3072
    s_add_u32 s88, s82, 12288
    buffer_load_dwordx4 v1, s[16:19], s88 offen offset:0 sc1 lds
    v_mfma_f32_32x32x16_bf16 v[64:79], a[4:7], v[100:103], v[64:79]
    s_waitcnt lgkmcnt(3)
    ds_read_b128 v[124:127], v9 offset:3584
    s_add_u32 m0, s82, 54272
    s_add_u32 s88, s82, 13312
    buffer_load_dwordx4 v1, s[16:19], s88 offen offset:0 sc1 lds
    v_mfma_f32_32x32x16_bf16 v[64:79], a[8:11], v[104:107], v[64:79]
    s_add_u32 m0, s82, 57344
    ds_read_b128 v[96:99], v9 offset:4096
    s_add_u32 s88, s82, 16384
    buffer_load_dwordx4 v1, s[16:19], s88 offen offset:0 sc1 lds
    v_mfma_f32_32x32x16_bf16 v[64:79], a[12:15], v[108:111], v[64:79]
    s_waitcnt lgkmcnt(3)
    ds_read_b128 v[100:103], v9 offset:4608
    s_add_u32 m0, s82, 58368
    s_add_u32 s88, s82, 17408
    buffer_load_dwordx4 v1, s[16:19], s88 offen offset:0 sc1 lds
    v_mfma_f32_32x32x16_bf16 v[64:79], a[16:19], v[112:115], v[64:79]
    ds_read_b128 v[104:107], v9 offset:5120
    v_mfma_f32_32x32x16_bf16 v[64:79], a[20:23], v[116:119], v[64:79]
    s_waitcnt lgkmcnt(3)
    ds_read_b128 v[108:111], v9 offset:5632
    buffer_load_dwordx4 v[188:191], v2, s[4:7], s33 offen offset:3072
    s_barrier
    v_mfma_f32_32x32x16_bf16 v[64:79], a[24:27], v[120:123], v[64:79]
    s_add_u32 m0, s82, 61440
    ds_read_b128 v[112:115], v9 offset:6144
    v_mfma_f32_32x32x16_bf16 v[64:79], a[28:31], v[124:127], v[64:79]
    s_waitcnt lgkmcnt(3)
    ds_read_b128 v[116:119], v9 offset:6656
    s_add_u32 s88, s82, 20480
    buffer_load_dwordx4 v1, s[16:19], s88 offen offset:0 sc1 lds
    v_mfma_f32_32x32x16_bf16 v[64:79], a[32:35], v[96:99], v[64:79]
    s_add_u32 m0, s82, 62464
    ds_read_b128 v[120:123], v9 offset:7168
    ds_read_b64 v[152:153], v154 offset:256
    v_mfma_f32_32x32x16_bf16 v[64:79], a[36:39], v[100:103], v[64:79]
    s_waitcnt lgkmcnt(4)
    ds_read_b128 v[124:127], v9 offset:7680
    s_add_u32 s88, s82, 21504
    buffer_load_dwordx4 v1, s[16:19], s88 offen offset:0 sc1 lds
    v_mfma_f32_32x32x16_bf16 v[64:79], a[40:43], v[104:107], v[64:79]
    ds_read_b128 v[96:99], v9 offset:8192
    v_mfma_f32_32x32x16_bf16 v[64:79], a[44:47], v[108:111], v[64:79]
    s_waitcnt lgkmcnt(4)
    ds_read_b128 v[100:103], v9 offset:8704
    buffer_load_dwordx4 v[184:187], v3, s[4:7], s33 offen offset:0
    v_mfma_f32_32x32x16_bf16 v[64:79], a[48:51], v[112:115], v[64:79]
    ds_read_b128 v[104:107], v9 offset:9216
    v_mfma_f32_32x32x16_bf16 v[64:79], a[52:55], v[116:119], v[64:79]
    s_waitcnt lgkmcnt(3)
    ds_read_b128 v[108:111], v9 offset:9728
    v_fma_f32 v48, -v128, v152, v48
    v_fma_f32 v49, -v129, v152, v49
    v_fma_f32 v50, -v130, v152, v50
    v_fma_f32 v51, -v131, v152, v51
    v_mul_f32 v48, v48, v153
    v_mfma_f32_32x32x16_bf16 v[64:79], a[56:59], v[120:123], v[64:79]
    ds_read_b128 v[112:115], v9 offset:10240
    v_mul_f32 v49, v49, v153
    v_mul_f32 v50, v50, v153
    v_mul_f32 v51, v51, v153
    v_cvt_pk_bf16_f32 v48, v48, v49
    v_cvt_pk_bf16_f32 v49, v50, v51
    v_mfma_f32_32x32x16_bf16 v[64:79], a[60:63], v[124:127], v[64:79]
    s_waitcnt lgkmcnt(3)
    ds_read_b128 v[116:119], v9 offset:10752
    ds_write_b64 v8, v[48:49] offset:29568
    v_fma_f32 v52, -v132, v152, v52
    v_mfma_f32_32x32x16_bf16 v[64:79], a[64:67], v[96:99], v[64:79]
    ds_read_b128 v[120:123], v9 offset:11264
    buffer_load_dwordx4 v[180:183], v3, s[4:7], s33 offen offset:1024
    v_fma_f32 v53, -v133, v152, v53
    v_fma_f32 v54, -v134, v152, v54
    v_fma_f32 v55, -v135, v152, v55
    v_mfma_f32_32x32x16_bf16 v[64:79], a[68:71], v[100:103], v[64:79]
    s_waitcnt lgkmcnt(4)
    ds_read_b128 v[124:127], v9 offset:11776
    v_mul_f32 v52, v52, v153
    v_mul_f32 v53, v53, v153
    v_mul_f32 v54, v54, v153
    v_mul_f32 v55, v55, v153
    v_cvt_pk_bf16_f32 v52, v52, v53
    v_mfma_f32_32x32x16_bf16 v[64:79], a[72:75], v[104:107], v[64:79]
    ds_read_b128 v[96:99], v9 offset:12288
    v_cvt_pk_bf16_f32 v53, v54, v55
    ds_write_b64 v8, v[52:53] offset:29584
    v_mfma_f32_32x32x16_bf16 v[64:79], a[76:79], v[108:111], v[64:79]
    s_waitcnt lgkmcnt(5)
    ds_read_b128 v[100:103], v9 offset:12800
    v_fma_f32 v56, -v136, v152, v56
    v_fma_f32 v57, -v137, v152, v57
    v_fma_f32 v58, -v138, v152, v58
    v_fma_f32 v59, -v139, v152, v59
    v_mul_f32 v56, v56, v153
    v_mfma_f32_32x32x16_bf16 v[64:79], a[80:83], v[112:115], v[64:79]
    ds_read_b128 v[104:107], v9 offset:13312
    v_mul_f32 v57, v57, v153
    v_mul_f32 v58, v58, v153
    v_mul_f32 v59, v59, v153
    v_cvt_pk_bf16_f32 v56, v56, v57
    v_cvt_pk_bf16_f32 v57, v58, v59
    v_mfma_f32_32x32x16_bf16 v[64:79], a[84:87], v[116:119], v[64:79]
    s_waitcnt lgkmcnt(4)
    ds_read_b128 v[108:111], v9 offset:13824
    ds_write_b64 v8, v[56:57] offset:29600
    v_fma_f32 v60, -v140, v152, v60
    v_mfma_f32_32x32x16_bf16 v[64:79], a[88:91], v[120:123], v[64:79]
    ds_read_b128 v[112:115], v9 offset:14336
    buffer_load_dwordx4 v[176:179], v3, s[4:7], s33 offen offset:2048
    v_fma_f32 v61, -v141, v152, v61
    v_fma_f32 v62, -v142, v152, v62
    v_fma_f32 v63, -v143, v152, v63
    v_mfma_f32_32x32x16_bf16 v[64:79], a[92:95], v[124:127], v[64:79]
    s_waitcnt lgkmcnt(4)
    ds_read_b128 v[116:119], v9 offset:14848
    v_mul_f32 v60, v60, v153
    v_mul_f32 v61, v61, v153
    v_mul_f32 v62, v62, v153
    v_mul_f32 v63, v63, v153
    v_cvt_pk_bf16_f32 v60, v60, v61
    v_mfma_f32_32x32x16_bf16 v[64:79], a[96:99], v[96:99], v[64:79]
    ds_read_b128 v[120:123], v9 offset:15360
    v_cvt_pk_bf16_f32 v61, v62, v63
    ds_write_b64 v8, v[60:61] offset:29616
    v_mfma_f32_32x32x16_bf16 v[64:79], a[100:103], v[100:103], v[64:79]
    s_waitcnt lgkmcnt(5)
    ds_read_b128 v[124:127], v9 offset:15872
    v_mfma_f32_32x32x16_bf16 v[64:79], a[104:107], v[104:107], v[64:79]
    ds_read_b128 v[96:99], v9 offset:16384
    v_mfma_f32_32x32x16_bf16 v[64:79], a[108:111], v[108:111], v[64:79]
    s_waitcnt lgkmcnt(4)
    ds_read_b128 v[100:103], v9 offset:16896
    s_waitcnt lgkmcnt(3)
    s_barrier
    v_add_u32 v156, 33792, v4
    ds_read2_b64 v[156:159], v156 offset1:1
    s_add_u32 s91, s85, 1048576
    v_mfma_f32_32x32x16_bf16 v[64:79], a[112:115], v[112:115], v[64:79]
    ds_read_b128 v[104:107], v9 offset:17408
    buffer_load_dwordx4 a[160:163], v3, s[4:7], s33 offen offset:3072
    v_mfma_f32_32x32x16_bf16 v[64:79], a[116:119], v[116:119], v[64:79]
    s_waitcnt lgkmcnt(4)
    ds_read_b128 v[108:111], v9 offset:17920
    v_mfma_f32_32x32x16_bf16 v[64:79], a[120:123], v[120:123], v[64:79]
    s_add_u32 s33, s61, 12288
    ds_read_b128 v[112:115], v9 offset:18432
    v_mfma_f32_32x32x16_bf16 v[64:79], a[124:127], v[124:127], v[64:79]
    s_waitcnt lgkmcnt(4)
    ds_read_b128 v[116:119], v9 offset:18944
    v_mfma_f32_32x32x16_bf16 v[64:79], a[128:131], v[96:99], v[64:79]
    s_waitcnt lgkmcnt(4)
    ds_read_b128 v[120:123], v9 offset:19456
    buffer_store_dwordx4 v[156:159], v1, s[4:7], s91 offen sc1
    s_waitcnt vmcnt(16)
    v_add_f32 v144, v144, v146
    v_add_f32 v145, v145, v147
    v_mfma_f32_32x32x16_bf16 v[64:79], a[132:135], v[100:103], v[64:79]
    s_waitcnt lgkmcnt(3)
    ds_read_b128 v[124:127], v9 offset:19968
    v_permlane16_swap_b32 v144, v145
    v_add_f32 v144, v144, v145
    v_mov_b32 v145, v144
    s_nop 1
    v_permlane32_swap_b32 v144, v145
    v_mfma_f32_32x32x16_bf16 v[64:79], a[136:139], v[104:107], v[64:79]
    v_add_f32 v144, v144, v145
    v_mov_b32 v145, v144
    s_nop 1
    v_permlane16_swap_b32 v144, v145
    v_mul_f32 v146, s64, v144
    v_mul_f32 v145, s64, v145
    v_fma_f32 v145, -v146, v146, v145
    v_max_f32 v145, 0, v145
    v_add_f32 v145, s65, v145
    v_rsq_f32 v147, v145
    v_add_u32 v144, s0, v17
    ds_write_b64 v144, v[146:147] offset:512
    s_waitcnt vmcnt(5)
    s_waitcnt lgkmcnt(0)
    s_barrier
    ds_read_b128 v[96:99], v9 offset:40960
    v_mfma_f32_32x32x16_bf16 v[64:79], a[140:143], v[108:111], v[64:79]
    s_add_u32 m0, s82, 4096
    ds_read_b128 v[100:103], v9 offset:41472
    s_add_u32 s88, s82, 45056
    buffer_load_dwordx4 v1, s[16:19], s88 offen offset:0 sc1 lds
    v_mfma_f32_32x32x16_bf16 v[64:79], a[144:147], v[112:115], v[64:79]
    s_add_u32 m0, s82, 5120
    ds_read_b128 v[104:107], v9 offset:41984
    s_add_u32 s88, s82, 46080
    buffer_load_dwordx4 v1, s[16:19], s88 offen offset:0 sc1 lds
    v_mfma_f32_32x32x16_bf16 v[64:79], a[148:151], v[116:119], v[64:79]
    s_add_u32 m0, s82, 8192
    ds_read_b128 v[108:111], v9 offset:42496
    s_add_u32 s88, s82, 49152
    buffer_load_dwordx4 v1, s[16:19], s88 offen offset:0 sc1 lds
    v_mfma_f32_32x32x16_bf16 v[64:79], a[152:155], v[120:123], v[64:79]
    s_add_u32 m0, s82, 9216
    ds_read_b128 v[112:115], v9 offset:43008
    s_add_u32 s88, s82, 50176
    buffer_load_dwordx4 v1, s[16:19], s88 offen offset:0 sc1 lds
    v_mfma_f32_32x32x16_bf16 v[64:79], a[156:159], v[124:127], v[64:79]
    s_waitcnt lgkmcnt(3)
    ds_read_b128 v[116:119], v9 offset:43520
    s_add_u32 m0, s82, 12288
    s_add_u32 s88, s82, 53248
    buffer_load_dwordx4 v1, s[16:19], s88 offen offset:0 sc1 lds
    v_mfma_f32_32x32x16_bf16 v[80:95], a[0:3], v[96:99], 0
    s_add_u32 m0, s82, 13312
    ds_read_b128 v[120:123], v9 offset:44032
    s_add_u32 s88, s82, 54272
    buffer_load_dwordx4 v1, s[16:19], s88 offen offset:0 sc1 lds
    v_mfma_f32_32x32x16_bf16 v[80:95], a[4:7], v[100:103], v[80:95]
    s_waitcnt lgkmcnt(3)
    ds_read_b128 v[124:127], v9 offset:44544
    s_add_u32 m0, s82, 16384
    s_add_u32 s88, s82, 57344
    buffer_load_dwordx4 v1, s[16:19], s88 offen offset:0 sc1 lds
    v_mfma_f32_32x32x16_bf16 v[80:95], a[8:11], v[104:107], v[80:95]
    s_add_u32 m0, s82, 17408
    ds_read_b128 v[96:99], v9 offset:45056
    s_add_u32 s88, s82, 58368
    buffer_load_dwordx4 v1, s[16:19], s88 offen offset:0 sc1 lds
    v_mfma_f32_32x32x16_bf16 v[80:95], a[12:15], v[108:111], v[80:95]
    s_waitcnt lgkmcnt(3)
    ds_read_b128 v[100:103], v9 offset:45568
    v_mfma_f32_32x32x16_bf16 v[80:95], a[16:19], v[112:115], v[80:95]
    ds_read_b128 v[104:107], v9 offset:46080
    buffer_load_dwordx4 a[164:167], v1, s[4:7], s33 offen offset:0
    v_mfma_f32_32x32x16_bf16 v[80:95], a[20:23], v[116:119], v[80:95]
    s_waitcnt lgkmcnt(3)
    ds_read_b128 v[108:111], v9 offset:46592
    s_barrier
    v_mfma_f32_32x32x16_bf16 v[80:95], a[24:27], v[120:123], v[80:95]
    s_add_u32 m0, s82, 20480
    ds_read_b128 v[112:115], v9 offset:47104
    s_add_u32 s88, s82, 61440
    buffer_load_dwordx4 v1, s[16:19], s88 offen offset:0 sc1 lds
    v_mfma_f32_32x32x16_bf16 v[80:95], a[28:31], v[124:127], v[80:95]
    s_waitcnt lgkmcnt(3)
    ds_read_b128 v[116:119], v9 offset:47616
    v_mfma_f32_32x32x16_bf16 v[80:95], a[32:35], v[96:99], v[80:95]
    s_add_u32 m0, s82, 21504
    ds_read_b128 v[120:123], v9 offset:48128
    s_add_u32 s88, s82, 62464
    buffer_load_dwordx4 v1, s[16:19], s88 offen offset:0 sc1 lds
    v_mfma_f32_32x32x16_bf16 v[80:95], a[36:39], v[100:103], v[80:95]
    s_waitcnt lgkmcnt(3)
    ds_read_b128 v[124:127], v9 offset:48640
    v_mfma_f32_32x32x16_bf16 v[80:95], a[40:43], v[104:107], v[80:95]
    ds_read_b128 v[96:99], v9 offset:49152
    buffer_load_dwordx4 a[168:171], v1, s[4:7], s33 offen offset:1024
    v_mfma_f32_32x32x16_bf16 v[80:95], a[44:47], v[108:111], v[80:95]
    s_waitcnt lgkmcnt(3)
    ds_read_b128 v[100:103], v9 offset:49664
    v_mfma_f32_32x32x16_bf16 v[80:95], a[48:51], v[112:115], v[80:95]
    ds_read_b128 v[104:107], v9 offset:50176
    v_mfma_f32_32x32x16_bf16 v[80:95], a[52:55], v[116:119], v[80:95]
    s_waitcnt lgkmcnt(3)
    ds_read_b128 v[108:111], v9 offset:50688
    v_mfma_f32_32x32x16_bf16 v[80:95], a[56:59], v[120:123], v[80:95]
    ds_read_b128 v[112:115], v9 offset:51200
    v_mfma_f32_32x32x16_bf16 v[80:95], a[60:63], v[124:127], v[80:95]
    s_waitcnt lgkmcnt(3)
    ds_read_b128 v[116:119], v9 offset:51712
    buffer_load_dwordx4 a[172:175], v1, s[4:7], s33 offen offset:2048
    v_mfma_f32_32x32x16_bf16 v[80:95], a[64:67], v[96:99], v[80:95]
    ds_read_b128 v[120:123], v9 offset:52224
    v_mfma_f32_32x32x16_bf16 v[80:95], a[68:71], v[100:103], v[80:95]
    s_waitcnt lgkmcnt(3)
    ds_read_b128 v[124:127], v9 offset:52736
    v_mfma_f32_32x32x16_bf16 v[80:95], a[72:75], v[104:107], v[80:95]
    ds_read_b128 v[96:99], v9 offset:53248
    ds_read_b64 v[152:153], v154 offset:0
    v_mfma_f32_32x32x16_bf16 v[80:95], a[76:79], v[108:111], v[80:95]
    s_waitcnt lgkmcnt(4)
    ds_read_b128 v[100:103], v9 offset:53760
    v_mfma_f32_32x32x16_bf16 v[80:95], a[80:83], v[112:115], v[80:95]
    ds_read_b128 v[104:107], v9 offset:54272
    buffer_load_dwordx4 a[176:179], v1, s[4:7], s33 offen offset:3072
    v_mfma_f32_32x32x16_bf16 v[80:95], a[84:87], v[116:119], v[80:95]
    s_waitcnt lgkmcnt(4)
    ds_read_b128 v[108:111], v9 offset:54784
    v_mfma_f32_32x32x16_bf16 v[80:95], a[88:91], v[120:123], v[80:95]
    ds_read_b128 v[112:115], v9 offset:55296
    buffer_load_dwordx4 a[180:183], v2, s[4:7], s33 offen offset:0
    v_mfma_f32_32x32x16_bf16 v[80:95], a[92:95], v[124:127], v[80:95]
    s_waitcnt lgkmcnt(3)
    ds_read_b128 v[116:119], v9 offset:55808
    v_fma_f32 v64, -v128, v152, v64
    v_fma_f32 v65, -v129, v152, v65
    v_fma_f32 v66, -v130, v152, v66
    v_fma_f32 v67, -v131, v152, v67
    v_mul_f32 v64, v64, v153
    v_mfma_f32_32x32x16_bf16 v[80:95], a[96:99], v[96:99], v[80:95]
    ds_read_b128 v[120:123], v9 offset:56320
    v_mul_f32 v65, v65, v153
    v_mul_f32 v66, v66, v153
    v_mul_f32 v67, v67, v153
    v_cvt_pk_bf16_f32 v64, v64, v65
    v_cvt_pk_bf16_f32 v65, v66, v67
    v_mfma_f32_32x32x16_bf16 v[80:95], a[100:103], v[100:103], v[80:95]
    s_waitcnt lgkmcnt(3)
    ds_read_b128 v[124:127], v9 offset:56832
    buffer_load_dwordx4 a[184:187], v2, s[4:7], s33 offen offset:1024
    ds_write_b64 v8, v[64:65] offset:21120
    v_mfma_f32_32x32x16_bf16 v[80:95], a[104:107], v[104:107], v[80:95]
    ds_read_b128 v[96:99], v9 offset:57344
    v_fma_f32 v68, -v132, v152, v68
    v_fma_f32 v69, -v133, v152, v69
    v_fma_f32 v70, -v134, v152, v70
    v_fma_f32 v71, -v135, v152, v71
    v_mul_f32 v68, v68, v153
    v_mfma_f32_32x32x16_bf16 v[80:95], a[108:111], v[108:111], v[80:95]
    s_waitcnt lgkmcnt(4)
    ds_read_b128 v[100:103], v9 offset:57856
    v_mul_f32 v69, v69, v153
    v_mul_f32 v70, v70, v153
    v_mul_f32 v71, v71, v153
    v_cvt_pk_bf16_f32 v68, v68, v69
    v_cvt_pk_bf16_f32 v69, v70, v71
    v_mfma_f32_32x32x16_bf16 v[80:95], a[112:115], v[112:115], v[80:95]
    v_mov_b32 v30, 2
    s_mov_b64 exec, 1
    s_waitcnt vmcnt(16)
    buffer_store_dword v30, off, s[4:7], s3 sc1
    s_mov_b64 exec, -1
    ds_read_b128 v[104:107], v9 offset:58368
    v_mfma_f32_32x32x16_bf16 v[80:95], a[116:119], v[116:119], v[80:95]
    s_waitcnt lgkmcnt(4)
    ds_read_b128 v[108:111], v9 offset:58880
    v_lshrrev_b32 v32, 2, v5
    v_and_b32 v31, 31, v32
    v_min_u32 v31, 23, v31
    v_lshlrev_b32 v31, 7, v31
    v_lshrrev_b32 v32, 5, v32
    s_mov_b32 s88, 3145728
    v_mad_u32_u24 v31, v32, s88, v31
    s_mul_i32 s88, s26, 1792
    s_add_u32 s88, s88, s93
    buffer_load_dword v0, v31, s[4:7], s88 offen offset:0
    v_mfma_f32_32x32x16_bf16 v[80:95], a[120:123], v[120:123], v[80:95]
    s_lshl_b32 s88, s27, 2
    ds_read_b128 v[112:115], v9 offset:59392
    ds_write_b64 v8, v[68:69] offset:21136
    v_fma_f32 v72, -v136, v152, v72
    v_mfma_f32_32x32x16_bf16 v[80:95], a[124:127], v[124:127], v[80:95]
    s_waitcnt lgkmcnt(4)
    ds_read_b128 v[116:119], v9 offset:59904
    s_add_u32 s88, s88, s24
    s_lshl_b32 s88, s88, 11
    v_lshlrev_b32 v31, 5, v5
    v_and_b32 v31, 0x780, v31
    buffer_load_dword v0, v31, s[20:23], s88 offen
    v_mfma_f32_32x32x16_bf16 v[80:95], a[128:131], v[96:99], v[80:95]
    ds_read_b128 v[120:123], v9 offset:60416
    v_fma_f32 v73, -v137, v152, v73
    v_fma_f32 v74, -v138, v152, v74
    v_fma_f32 v75, -v139, v152, v75
    v_mul_f32 v72, v72, v153
    v_mul_f32 v73, v73, v153
    v_mfma_f32_32x32x16_bf16 v[80:95], a[132:135], v[100:103], v[80:95]
    s_waitcnt lgkmcnt(4)
    ds_read_b128 v[124:127], v9 offset:60928
    buffer_load_dwordx4 a[188:191], v2, s[4:7], s33 offen offset:2048
    v_mul_f32 v74, v74, v153
    v_mul_f32 v75, v75, v153
    v_cvt_pk_bf16_f32 v72, v72, v73
    v_mfma_f32_32x32x16_bf16 v[80:95], a[136:139], v[104:107], v[80:95]
    s_waitcnt vmcnt(9)
    s_barrier
    ds_read_b128 v[96:99], v9 offset:0
    v_cvt_pk_bf16_f32 v73, v74, v75
    ds_write_b64 v8, v[72:73] offset:21152
    v_mfma_f32_32x32x16_bf16 v[80:95], a[140:143], v[108:111], v[80:95]
    s_waitcnt lgkmcnt(4)
    ds_read_b128 v[100:103], v9 offset:512
    v_fma_f32 v76, -v140, v152, v76
    v_fma_f32 v77, -v141, v152, v77
    v_fma_f32 v78, -v142, v152, v78
    v_fma_f32 v79, -v143, v152, v79
    v_mul_f32 v76, v76, v153
    v_mfma_f32_32x32x16_bf16 v[80:95], a[144:147], v[112:115], v[80:95]
    ds_read_b128 v[104:107], v9 offset:1024
    v_mul_f32 v77, v77, v153
    v_mul_f32 v78, v78, v153
    v_mul_f32 v79, v79, v153
    v_cvt_pk_bf16_f32 v76, v76, v77
    v_cvt_pk_bf16_f32 v77, v78, v79
    v_mfma_f32_32x32x16_bf16 v[80:95], a[148:151], v[116:119], v[80:95]
    s_waitcnt lgkmcnt(4)
    ds_read_b128 v[108:111], v9 offset:1536
    ds_write_b64 v8, v[76:77] offset:21168
    v_mfma_f32_32x32x16_bf16 v[80:95], a[152:155], v[120:123], v[80:95]
    ds_read_b128 v[112:115], v9 offset:2048
    v_mfma_f32_32x32x16_bf16 v[80:95], a[156:159], v[124:127], v[80:95]
    s_waitcnt lgkmcnt(4)
    ds_read_b128 v[116:119], v9 offset:2560
    v_mfma_f32_32x32x16_bf16 v[48:63], a[0:3], v[96:99], 0
    ds_read_b128 v[120:123], v9 offset:3072
    buffer_load_dwordx4 a[0:3], v2, s[4:7], s33 offen offset:3072
    ds_read_b64 v[152:153], v154 offset:512
    v_mfma_f32_32x32x16_bf16 v[48:63], a[4:7], v[100:103], v[48:63]
    s_waitcnt lgkmcnt(5)
    ds_read_b128 v[124:127], v9 offset:3584
    buffer_load_dword v29, v5, s[4:7], s87 offen sc1
    v_mfma_f32_32x32x16_bf16 v[48:63], a[8:11], v[104:107], v[48:63]
    ds_read_b128 v[96:99], v9 offset:4096
    buffer_load_dwordx4 a[4:7], v3, s[4:7], s33 offen offset:0
    v_mfma_f32_32x32x16_bf16 v[48:63], a[12:15], v[108:111], v[48:63]
    s_waitcnt lgkmcnt(4)
    ds_read_b128 v[100:103], v9 offset:4608
    v_mfma_f32_32x32x16_bf16 v[48:63], a[16:19], v[112:115], v[48:63]
    ds_read_b128 v[104:107], v9 offset:5120
    buffer_load_dwordx4 a[8:11], v3, s[4:7], s33 offen offset:1024
    v_mfma_f32_32x32x16_bf16 v[48:63], a[20:23], v[116:119], v[48:63]
    s_waitcnt lgkmcnt(3)
    ds_read_b128 v[108:111], v9 offset:5632
    v_fma_f32 v80, -v128, v152, v80
    v_fma_f32 v81, -v129, v152, v81
    v_fma_f32 v82, -v130, v152, v82
    v_fma_f32 v83, -v131, v152, v83
    v_mul_f32 v80, v80, v153
    v_mul_f32 v81, v81, v153
    v_mul_f32 v82, v82, v153
    v_mfma_f32_32x32x16_bf16 v[48:63], a[24:27], v[120:123], v[48:63]
    ds_read_b128 v[112:115], v9 offset:6144
    buffer_load_dwordx4 a[12:15], v3, s[4:7], s33 offen offset:2048
    v_mul_f32 v83, v83, v153
    v_cvt_pk_bf16_f32 v80, v80, v81
    v_cvt_pk_bf16_f32 v81, v82, v83
    ds_write_b64 v8, v[80:81] offset:12672
    v_mfma_f32_32x32x16_bf16 v[48:63], a[28:31], v[124:127], v[48:63]
    s_waitcnt lgkmcnt(4)
    ds_read_b128 v[116:119], v9 offset:6656
    v_fma_f32 v84, -v132, v152, v84
    v_fma_f32 v85, -v133, v152, v85
    v_fma_f32 v86, -v134, v152, v86
    v_fma_f32 v87, -v135, v152, v87
    v_mul_f32 v84, v84, v153
    v_mul_f32 v85, v85, v153
    v_mul_f32 v86, v86, v153
    v_mfma_f32_32x32x16_bf16 v[48:63], a[32:35], v[96:99], v[48:63]
    ds_read_b128 v[120:123], v9 offset:7168
    buffer_load_dwordx4 a[16:19], v3, s[4:7], s33 offen offset:3072
    v_mul_f32 v87, v87, v153
    v_cvt_pk_bf16_f32 v84, v84, v85
    v_cvt_pk_bf16_f32 v85, v86, v87
    ds_write_b64 v8, v[84:85] offset:12688
    v_mfma_f32_32x32x16_bf16 v[48:63], a[36:39], v[100:103], v[48:63]
    s_waitcnt lgkmcnt(5)
    ds_read_b128 v[124:127], v9 offset:7680
    v_fma_f32 v88, -v136, v152, v88
    v_fma_f32 v89, -v137, v152, v89
    v_fma_f32 v90, -v138, v152, v90
    v_fma_f32 v91, -v139, v152, v91
    v_mul_f32 v88, v88, v153
    v_mul_f32 v89, v89, v153
    v_mul_f32 v90, v90, v153
    v_mfma_f32_32x32x16_bf16 v[48:63], a[40:43], v[104:107], v[48:63]
    s_add_u32 s33, s61, 24576
    ds_read_b128 v[96:99], v9 offset:8192
    buffer_load_dwordx4 a[20:23], v1, s[4:7], s33 offen offset:0
    v_mul_f32 v91, v91, v153
    v_cvt_pk_bf16_f32 v88, v88, v89
    v_cvt_pk_bf16_f32 v89, v90, v91
    ds_write_b64 v8, v[88:89] offset:12704
    v_mfma_f32_32x32x16_bf16 v[48:63], a[44:47], v[108:111], v[48:63]
    s_waitcnt lgkmcnt(5)
    ds_read_b128 v[100:103], v9 offset:8704
    v_fma_f32 v92, -v140, v152, v92
    v_fma_f32 v93, -v141, v152, v93
    v_fma_f32 v94, -v142, v152, v94
    v_fma_f32 v95, -v143, v152, v95
    v_mul_f32 v92, v92, v153
    v_mul_f32 v93, v93, v153
    v_mul_f32 v94, v94, v153
    v_mfma_f32_32x32x16_bf16 v[48:63], a[48:51], v[112:115], v[48:63]
    ds_read_b128 v[104:107], v9 offset:9216
    buffer_load_dwordx4 a[24:27], v1, s[4:7], s33 offen offset:1024
    v_mul_f32 v95, v95, v153
    v_cvt_pk_bf16_f32 v92, v92, v93
    v_cvt_pk_bf16_f32 v93, v94, v95
    ds_write_b64 v8, v[92:93] offset:12720
    v_mfma_f32_32x32x16_bf16 v[48:63], a[52:55], v[116:119], v[48:63]
    s_waitcnt lgkmcnt(5)
    ds_read_b128 v[108:111], v9 offset:9728
    v_mfma_f32_32x32x16_bf16 v[48:63], a[56:59], v[120:123], v[48:63]
    ds_read_b128 v[112:115], v9 offset:10240
    buffer_load_dwordx4 a[28:31], v1, s[4:7], s33 offen offset:2048
    v_mfma_f32_32x32x16_bf16 v[48:63], a[60:63], v[124:127], v[48:63]
    s_waitcnt lgkmcnt(4)
    ds_read_b128 v[116:119], v9 offset:10752
    s_waitcnt lgkmcnt(3)
    s_barrier
    ds_read2_b64 v[160:163], v11 offset0:10 offset1:14
    ds_read2_b64 v[164:167], v10 offset0:0 offset1:4
    ds_read2_b64 v[168:171], v11 offset0:0 offset1:4
    ds_read2_b64 v[172:175], v11 offset0:15 offset1:19
    ds_read2_b64 v[80:83], v10 offset0:5 offset1:9
    v_mfma_f32_32x32x16_bf16 v[48:63], a[64:67], v[96:99], v[48:63]
    ds_read_b128 v[120:123], v9 offset:11264
    ds_read2_b64 v[84:87], v11 offset0:5 offset1:9
    s_add_u32 s89, s93, 0
    v_mfma_f32_32x32x16_bf16 v[48:63], a[68:71], v[100:103], v[48:63]
    s_waitcnt lgkmcnt(9)
    ds_read_b128 v[124:127], v9 offset:11776
    buffer_load_dwordx4 a[32:35], v1, s[4:7], s33 offen offset:3072
    v_mfma_f32_32x32x16_bf16 v[48:63], a[72:75], v[104:107], v[48:63]
    ds_read_b128 v[96:99], v9 offset:12288
    v_mfma_f32_32x32x16_bf16 v[48:63], a[76:79], v[108:111], v[48:63]
    s_waitcnt lgkmcnt(9)
    ds_read_b128 v[100:103], v9 offset:12800
    s_waitcnt vmcnt(8)
poll_120:
    v_cmp_le_u32 vcc, 2, v29
    s_nop 0
    s_andn2_b64 s[56:57], s[40:41], vcc
    s_cbranch_scc1 pollr_119
    s_add_u32 s91, s86, 1048576
    buffer_load_dwordx4 v[156:159], v1, s[4:7], s91 offen sc1
    v_mfma_f32_32x32x16_bf16 v[48:63], a[80:83], v[112:115], v[48:63]
    ds_read_b128 v[104:107], v9 offset:13312
    buffer_load_dwordx4 a[36:39], v2, s[4:7], s33 offen offset:0
    v_mfma_f32_32x32x16_bf16 v[48:63], a[84:87], v[116:119], v[48:63]
    s_waitcnt lgkmcnt(3)
    ds_read_b128 v[108:111], v9 offset:13824
    v_cndmask_b32 v162, 0, v162, s[50:51]
    v_cndmask_b32 v163, 0, v163, s[50:51]
    v_cndmask_b32 v174, 0, v174, s[50:51]
    v_cndmask_b32 v175, 0, v175, s[50:51]
    v_mfma_f32_16x16x32_bf16 v[88:91], v[164:167], v[160:163], 0
    v_mfma_f32_16x16x32_bf16 v[92:95], v[168:171], v[160:163], 0
    v_mfma_f32_16x16x32_bf16 v[160:163], v[80:83], v[172:175], 0
    v_mfma_f32_16x16x32_bf16 v[164:167], v[84:87], v[172:175], 0
    ds_read_b64_tr_b16 v[80:81], v12 offset:0
    ds_read_b64_tr_b16 v[82:83], v12 offset:4224
    ds_read_b64_tr_b16 v[84:85], v12 offset:32
    ds_read_b64_tr_b16 v[86:87], v12 offset:4256
    s_nop 0
    v_cndmask_b32 v88, v88, v89, s[44:45]
    v_cndmask_b32 v90, v90, v91, s[44:45]
    v_cndmask_b32 v92, v92, v93, s[44:45]
    v_mfma_f32_32x32x16_bf16 v[48:63], a[88:91], v[120:123], v[48:63]
    ds_read_b128 v[112:115], v9 offset:14336
    v_cndmask_b32 v94, v94, v95, s[44:45]
    v_cndmask_b32 v168, v92, v88, s[46:47]
    v_cndmask_b32 v169, v94, v90, s[48:49]
    v_max_f32 v172, v168, v169
    v_cndmask_b32 v160, v160, v161, s[44:45]
    v_cndmask_b32 v162, v162, v163, s[44:45]
    v_cndmask_b32 v164, v164, v165, s[44:45]
    v_mfma_f32_32x32x16_bf16 v[48:63], a[92:95], v[124:127], v[48:63]
    s_waitcnt lgkmcnt(7)
    ds_read_b128 v[116:119], v9 offset:14848
    v_cndmask_b32 v166, v166, v167, s[44:45]
    v_cndmask_b32 v170, v164, v160, s[46:47]
    v_cndmask_b32 v171, v166, v162, s[48:49]
    v_max_f32 v173, v170, v171
    s_nop 1
    v_permlane16_swap_b32 v172, v173
    v_mfma_f32_32x32x16_bf16 v[48:63], a[96:99], v[96:99], v[48:63]
    ds_read_b128 v[120:123], v9 offset:15360
    buffer_load_dwordx4 a[40:43], v2, s[4:7], s33 offen offset:1024
    v_max_f32 v172, v172, v173
    v_mov_b32 v173, v172
    ds_read_b64_tr_b16 v[88:89], v12 offset:40
    ds_read_b64_tr_b16 v[90:91], v12 offset:4264
    v_permlane32_swap_b32 v172, v173
    v_mfma_f32_32x32x16_bf16 v[48:63], a[100:103], v[100:103], v[48:63]
    s_waitcnt lgkmcnt(9)
    ds_read_b128 v[124:127], v9 offset:15872
    v_max_f32 v172, v172, v173
    v_mov_b32 v173, v172
    ds_read_b64_tr_b16 v[92:93], v12 offset:72
    ds_read_b64_tr_b16 v[94:95], v12 offset:4296
    v_permlane16_swap_b32 v172, v173
    v_mul_f32 v172, s63, v172
    v_mul_f32 v173, s63, v173
    v_mfma_f32_32x32x16_bf16 v[48:63], a[104:107], v[104:107], v[48:63]
    s_add_u32 s33, s62, 0
    ds_read_b128 v[96:99], v9 offset:16384
    buffer_load_dwordx4 a[44:47], v1, s[4:7], s33 offen offset:0
    v_fma_f32 v168, v168, s63, -v172
    v_fma_f32 v169, v169, s63, -v172
    v_fma_f32 v170, v170, s63, -v173
    v_fma_f32 v171, v171, s63, -v173
    v_mfma_f32_32x32x16_bf16 v[48:63], a[108:111], v[108:111], v[48:63]
    s_waitcnt lgkmcnt(7)
    ds_read_b128 v[100:103], v9 offset:16896
    v_exp_f32 v168, v168
    v_exp_f32 v169, v169
    v_exp_f32 v170, v170
    v_mfma_f32_32x32x16_bf16 v[48:63], a[112:115], v[112:115], v[48:63]
    ds_read_b128 v[104:107], v9 offset:17408
    buffer_load_dwordx4 a[48:51], v1, s[4:7], s33 offen offset:1024
    v_exp_f32 v171, v171
    v_add_f32 v172, v168, v169
    v_add_f32 v173, v170, v171
    s_nop 1
    v_permlane16_swap_b32 v172, v173
    v_mfma_f32_32x32x16_bf16 v[48:63], a[116:119], v[116:119], v[48:63]
    s_waitcnt lgkmcnt(5)
    ds_read_b128 v[108:111], v9 offset:17920
    v_add_f32 v172, v172, v173
    v_mov_b32 v173, v172
    v_add_u32 v10, s1, v10
    v_add_u32 v11, s1, v11
    v_permlane32_swap_b32 v172, v173
    v_add_f32 v172, v172, v173
    v_mov_b32 v173, v172
    v_mfma_f32_32x32x16_bf16 v[48:63], a[120:123], v[120:123], v[48:63]
    ds_read_b128 v[112:115], v9 offset:18432
    buffer_load_dwordx4 a[52:55], v1, s[4:7], s33 offen offset:2048
    v_add_u32 v12, s1, v12
    v_permlane16_swap_b32 v172, v173
    v_rcp_f32 v172, v172
    v_mfma_f32_32x32x16_bf16 v[48:63], a[124:127], v[124:127], v[48:63]
    s_waitcnt lgkmcnt(3)
    ds_read_b128 v[116:119], v9 offset:18944
    v_rcp_f32 v173, v173
    v_mul_f32 v168, v168, v172
    v_mul_f32 v169, v169, v172
    v_mul_f32 v170, v170, v173
    v_mul_f32 v171, v171, v173
    v_cvt_pk_bf16_f32 v168, v168, v168
    v_mfma_f32_32x32x16_bf16 v[48:63], a[128:131], v[96:99], v[48:63]
    ds_read_b128 v[120:123], v9 offset:19456
    buffer_load_dwordx4 a[56:59], v1, s[4:7], s33 offen offset:3072
    v_cvt_pk_bf16_f32 v169, v169, v169
    v_and_b32 v160, v13, v168
    v_and_b32 v161, v14, v169
    v_and_b32 v162, v15, v168
    v_mfma_f32_32x32x16_bf16 v[48:63], a[132:135], v[100:103], v[48:63]
    s_waitcnt lgkmcnt(3)
    ds_read_b128 v[124:127], v9 offset:19968
    v_and_b32 v163, v16, v169
    v_cvt_pk_bf16_f32 v170, v170, v170
    v_cvt_pk_bf16_f32 v171, v171, v171
    v_and_b32 v164, v13, v170
    v_and_b32 v165, v14, v171
    v_and_b32 v166, v15, v170
    v_mfma_f32_32x32x16_bf16 v[48:63], a[136:139], v[104:107], v[48:63]
    buffer_load_dwordx4 a[60:63], v2, s[4:7], s33 offen offset:0
    v_and_b32 v167, v16, v171
    v_mfma_f32_16x16x32_bf16 v[168:171], v[80:83], v[160:163], 0
    v_mfma_f32_16x16x32_bf16 v[172:175], v[84:87], v[160:163], 0
    v_mfma_f32_16x16x32_bf16 v[80:83], v[88:91], v[164:167], 0
    v_mfma_f32_16x16x32_bf16 v[84:87], v[92:95], v[164:167], 0
    v_mfma_f32_32x32x16_bf16 v[48:63], a[140:143], v[108:111], v[48:63]
    s_waitcnt lgkmcnt(2)
    v_mfma_f32_32x32x16_bf16 v[48:63], a[144:147], v[112:115], v[48:63]
    buffer_load_dwordx4 a[64:67], v2, s[4:7], s33 offen offset:1024
    v_mfma_f32_32x32x16_bf16 v[48:63], a[148:151], v[116:119], v[48:63]
    s_waitcnt lgkmcnt(0)
    v_cvt_pk_bf16_f32 v88, v168, v169
    v_cvt_pk_bf16_f32 v89, v170, v171
    v_cvt_pk_bf16_f32 v90, v80, v81
    v_cvt_pk_bf16_f32 v91, v82, v83
    buffer_store_dwordx4 v[88:91], v1, s[4:7], s89 offen
    v_mfma_f32_32x32x16_bf16 v[48:63], a[152:155], v[120:123], v[48:63]
    v_cvt_pk_bf16_f32 v92, v172, v173
    v_cvt_pk_bf16_f32 v93, v174, v175
    v_cvt_pk_bf16_f32 v94, v84, v85
    v_cvt_pk_bf16_f32 v95, v86, v87
    v_mfma_f32_32x32x16_bf16 v[48:63], a[156:159], v[124:127], v[48:63]
    s_mov_b64 exec, s[42:43]
    buffer_store_dwordx4 v[92:95], v1, s[4:7], s89 offen offset:1024
    s_mov_b64 exec, -1
    buffer_load_dwordx4 a[68:71], v2, s[4:7], s33 offen offset:2048
    ds_read_b64 v[152:153], v154 offset:768
    s_waitcnt lgkmcnt(0)
    s_nop 5
    v_pk_fma_f32 v[48:49], v[128:129], v[152:153], v[48:49] op_sel_hi:[1,0,1] neg_lo:[0,1,0] neg_hi:[0,1,0]
    v_pk_fma_f32 v[50:51], v[130:131], v[152:153], v[50:51] op_sel_hi:[1,0,1] neg_lo:[0,1,0] neg_hi:[0,1,0]
    v_pk_mul_f32 v[48:49], v[48:49], v[152:153] op_sel:[0,1] op_sel_hi:[1,1]
    v_pk_mul_f32 v[50:51], v[50:51], v[152:153] op_sel:[0,1] op_sel_hi:[1,1]
    v_cvt_pk_bf16_f32 v48, v48, v49
    v_cvt_pk_bf16_f32 v49, v50, v51
    ds_write_b64 v8, v[48:49] offset:4224
    buffer_load_dwordx4 a[72:75], v2, s[4:7], s33 offen offset:3072
    v_pk_fma_f32 v[52:53], v[132:133], v[152:153], v[52:53] op_sel_hi:[1,0,1] neg_lo:[0,1,0] neg_hi:[0,1,0]
    v_pk_fma_f32 v[54:55], v[134:135], v[152:153], v[54:55] op_sel_hi:[1,0,1] neg_lo:[0,1,0] neg_hi:[0,1,0]
    v_pk_mul_f32 v[52:53], v[52:53], v[152:153] op_sel:[0,1] op_sel_hi:[1,1]
    v_pk_mul_f32 v[54:55], v[54:55], v[152:153] op_sel:[0,1] op_sel_hi:[1,1]
    v_cvt_pk_bf16_f32 v52, v52, v53
    v_cvt_pk_bf16_f32 v53, v54, v55
    ds_write_b64 v8, v[52:53] offset:4240
    v_pk_fma_f32 v[56:57], v[136:137], v[152:153], v[56:57] op_sel_hi:[1,0,1] neg_lo:[0,1,0] neg_hi:[0,1,0]
    v_pk_fma_f32 v[58:59], v[138:139], v[152:153], v[58:59] op_sel_hi:[1,0,1] neg_lo:[0,1,0] neg_hi:[0,1,0]
    v_pk_mul_f32 v[56:57], v[56:57], v[152:153] op_sel:[0,1] op_sel_hi:[1,1]
    v_pk_mul_f32 v[58:59], v[58:59], v[152:153] op_sel:[0,1] op_sel_hi:[1,1]
    buffer_load_dwordx4 a[76:79], v3, s[4:7], s33 offen offset:0
    v_cvt_pk_bf16_f32 v56, v56, v57
    v_cvt_pk_bf16_f32 v57, v58, v59
    ds_write_b64 v8, v[56:57] offset:4256
    v_pk_fma_f32 v[60:61], v[140:141], v[152:153], v[60:61] op_sel_hi:[1,0,1] neg_lo:[0,1,0] neg_hi:[0,1,0]
    v_pk_fma_f32 v[62:63], v[142:143], v[152:153], v[62:63] op_sel_hi:[1,0,1] neg_lo:[0,1,0] neg_hi:[0,1,0]
    v_pk_mul_f32 v[60:61], v[60:61], v[152:153] op_sel:[0,1] op_sel_hi:[1,1]
    v_pk_mul_f32 v[62:63], v[62:63], v[152:153] op_sel:[0,1] op_sel_hi:[1,1]
    v_cvt_pk_bf16_f32 v60, v60, v61
    v_cvt_pk_bf16_f32 v61, v62, v63
    ds_write_b64 v8, v[60:61] offset:4272
    buffer_load_dwordx4 a[80:83], v3, s[4:7], s33 offen offset:1024
    s_waitcnt vmcnt(14)
    ds_write2_b64 v4, v[156:157], v[158:159] offset1:1
    v_mov_b32 v30, 7
    s_mov_b64 exec, 1
    s_cmp_lg_u32 s28, 0
    s_waitcnt vmcnt(4)
    s_cbranch_scc1 pubs_123
    buffer_store_dword v30, off, s[4:7], s32
pubd_124:
    s_mov_b64 exec, -1
    s_waitcnt lgkmcnt(0)
    s_barrier
    ds_read2_b64 v[160:163], v11 offset0:10 offset1:14
    ds_read2_b64 v[164:167], v10 offset0:0 offset1:4
    ds_read2_b64 v[168:171], v11 offset0:0 offset1:4
    ds_read2_b64 v[172:175], v11 offset0:15 offset1:19
    ds_read2_b64 v[80:83], v10 offset0:5 offset1:9
    ds_read2_b64 v[84:87], v11 offset0:5 offset1:9
    s_add_u32 s89, s93, 3145728
    s_waitcnt lgkmcnt(5)
    v_cndmask_b32 v162, 0, v162, s[50:51]
    v_cndmask_b32 v163, 0, v163, s[50:51]
    s_waitcnt lgkmcnt(2)
    v_cndmask_b32 v174, 0, v174, s[50:51]
    v_cndmask_b32 v175, 0, v175, s[50:51]
    s_waitcnt lgkmcnt(0)
    v_mfma_f32_16x16x32_bf16 v[88:91], v[164:167], v[160:163], 0
    buffer_load_dwordx4 a[84:87], v3, s[4:7], s33 offen offset:2048
    v_mfma_f32_16x16x32_bf16 v[92:95], v[168:171], v[160:163], 0
    v_mfma_f32_16x16x32_bf16 v[160:163], v[80:83], v[172:175], 0
    v_mfma_f32_16x16x32_bf16 v[164:167], v[84:87], v[172:175], 0
    ds_read_b64_tr_b16 v[80:81], v12 offset:0
    ds_read_b64_tr_b16 v[82:83], v12 offset:4224
    ds_read_b64_tr_b16 v[84:85], v12 offset:32
    ds_read_b64_tr_b16 v[86:87], v12 offset:4256
    v_mov_b32 v174, s66
    v_cndmask_b32 v88, v88, v89, s[44:45]
    v_cndmask_b32 v90, v90, v91, s[44:45]
    v_cndmask_b32 v92, v92, v93, s[44:45]
    v_cndmask_b32 v94, v94, v95, s[44:45]
    v_cndmask_b32 v168, v92, v88, s[46:47]
    v_cndmask_b32 v169, v94, v90, s[48:49]
    v_cndmask_b32 v168, v168, v174, s[52:53]
    v_cndmask_b32 v169, v169, v174, s[54:55]
    v_max_f32 v172, v168, v169
    v_cndmask_b32 v160, v160, v161, s[44:45]
    v_cndmask_b32 v162, v162, v163, s[44:45]
    v_cndmask_b32 v164, v164, v165, s[44:45]
    v_cndmask_b32 v166, v166, v167, s[44:45]
    v_cndmask_b32 v170, v164, v160, s[46:47]
    v_cndmask_b32 v171, v166, v162, s[48:49]
    v_cndmask_b32 v170, v170, v174, s[52:53]
    v_cndmask_b32 v171, v171, v174, s[54:55]
    v_max_f32 v173, v170, v171
    s_nop 1
    v_permlane16_swap_b32 v172, v173
    v_max_f32 v172, v172, v173
    v_mov_b32 v173, v172
    ds_read_b64_tr_b16 v[88:89], v12 offset:40
    ds_read_b64_tr_b16 v[90:91], v12 offset:4264
    v_permlane32_swap_b32 v172, v173
    v_max_f32 v172, v172, v173
    v_mov_b32 v173, v172
    ds_read_b64_tr_b16 v[92:93], v12 offset:72
    ds_read_b64_tr_b16 v[94:95], v12 offset:4296
    v_permlane16_swap_b32 v172, v173
    v_mul_f32 v172, s63, v172
    v_mul_f32 v173, s63, v173
    v_fma_f32 v168, v168, s63, -v172
    v_fma_f32 v169, v169, s63, -v172
    v_fma_f32 v170, v170, s63, -v173
    v_fma_f32 v171, v171, s63, -v173
    v_exp_f32 v168, v168
    v_exp_f32 v169, v169
    v_exp_f32 v170, v170
    v_exp_f32 v171, v171
    v_add_f32 v172, v168, v169
    v_add_f32 v173, v170, v171
    s_nop 1
    v_permlane16_swap_b32 v172, v173
    v_add_f32 v172, v172, v173
    v_mov_b32 v173, v172
    v_subrev_u32 v10, s1, v10
    v_subrev_u32 v11, s1, v11
    v_permlane32_swap_b32 v172, v173
    v_add_f32 v172, v172, v173
    v_mov_b32 v173, v172
    v_subrev_u32 v12, s1, v12
    s_nop 0
    v_permlane16_swap_b32 v172, v173
    v_rcp_f32 v172, v172
    v_rcp_f32 v173, v173
    v_mul_f32 v168, v168, v172
    v_mul_f32 v169, v169, v172
    v_mul_f32 v170, v170, v173
    v_mul_f32 v171, v171, v173
    v_cvt_pk_bf16_f32 v168, v168, v168
    v_cvt_pk_bf16_f32 v169, v169, v169
    v_and_b32 v160, v13, v168
    v_and_b32 v161, v14, v169
    v_and_b32 v162, v15, v168
    v_and_b32 v163, v16, v169
    v_cvt_pk_bf16_f32 v170, v170, v170
    v_cvt_pk_bf16_f32 v171, v171, v171
    v_and_b32 v164, v13, v170
    v_and_b32 v165, v14, v171
    v_and_b32 v166, v15, v170
    v_and_b32 v167, v16, v171
    s_waitcnt lgkmcnt(0)
    v_mfma_f32_16x16x32_bf16 v[168:171], v[80:83], v[160:163], 0
    v_mfma_f32_16x16x32_bf16 v[172:175], v[84:87], v[160:163], 0
    v_mfma_f32_16x16x32_bf16 v[80:83], v[88:91], v[164:167], 0
    v_mfma_f32_16x16x32_bf16 v[84:87], v[92:95], v[164:167], 0
    s_nop 4
    v_cvt_pk_bf16_f32 v88, v168, v169
    v_cvt_pk_bf16_f32 v89, v170, v171
    v_cvt_pk_bf16_f32 v90, v80, v81
    v_cvt_pk_bf16_f32 v91, v82, v83
    buffer_store_dwordx4 v[88:91], v1, s[4:7], s89 offen
    v_cvt_pk_bf16_f32 v92, v172, v173
    v_cvt_pk_bf16_f32 v93, v174, v175
    v_cvt_pk_bf16_f32 v94, v84, v85
    v_cvt_pk_bf16_f32 v95, v86, v87
    s_mov_b64 exec, s[42:43]
    buffer_store_dwordx4 v[92:95], v1, s[4:7], s89 offen offset:1024
    s_mov_b64 exec, -1
    v_mov_b32 v30, 8
    s_mov_b64 exec, 1
    s_cmp_lg_u32 s28, 0
    s_waitcnt vmcnt(0)
    s_cbranch_scc1 pubs_125
    buffer_store_dword v30, off, s[4:7], s32
pubd_126:
    s_mov_b64 exec, -1
    s_barrier
    buffer_load_dword v29, v5, s[4:7], s31 offen sc1
    s_waitcnt vmcnt(0)
poll_128:
    v_cmp_le_u32 vcc, 8, v29
    s_nop 0
    s_andn2_b64 s[56:57], s[34:35], vcc
    s_cbranch_scc1 pollr_127
    s_cmp_lg_u32 s28, 0
    s_cbranch_scc1 acq_129
polld_130:
    s_add_u32 m0, s83, 4096
    s_nop 0
    buffer_load_dwordx4 v1, s[4:7], s75 offen offset:0 sc1 lds
    s_add_u32 m0, s83, 4096
    s_nop 0
    buffer_load_dwordx4 v1, s[4:7], s75 offen offset:1024 sc1 lds
    s_add_u32 m0, s83, 4096
    s_nop 0
    buffer_load_dwordx4 v1, s[4:7], s75 offen offset:2048 sc1 lds
    s_add_u32 m0, s83, 4096
    s_nop 0
    buffer_load_dwordx4 v1, s[4:7], s75 offen offset:3072 sc1 lds
    s_add_u32 m0, s83, 8192
    s_nop 0
    buffer_load_dwordx4 v2, s[4:7], s75 offen offset:0 sc1 lds
    s_add_u32 m0, s83, 9216
    s_nop 0
    buffer_load_dwordx4 v1, s[4:7], s76 offen offset:0 sc1 lds
    s_add_u32 m0, s83, 9216
    s_nop 0
    buffer_load_dwordx4 v1, s[4:7], s76 offen offset:1024 sc1 lds
    s_add_u32 m0, s83, 9216
    s_nop 0
    buffer_load_dwordx4 v1, s[4:7], s76 offen offset:2048 sc1 lds
    s_waitcnt vmcnt(7)
    ds_read_b128 v[128:131], v33 offset:0
    s_waitcnt vmcnt(6)
    ds_read_b128 v[132:135], v33 offset:1024
    s_waitcnt vmcnt(5)
    ds_read_b128 v[136:139], v33 offset:2048
    s_waitcnt lgkmcnt(2)
    v_mfma_f32_16x16x32_bf16 v[68:71], a[244:247], v[128:131], 0
    s_add_u32 m0, s83, 9216
    s_waitcnt vmcnt(4)
    ds_read_b128 v[140:143], v33 offset:3072
    v_mfma_f32_16x16x32_bf16 v[72:75], a[248:251], v[128:131], 0
    buffer_load_dwordx4 v1, s[4:7], s76 offen offset:3072 sc1 lds
    v_mfma_f32_16x16x32_bf16 v[76:79], a[252:255], v[128:131], 0
    s_add_u32 m0, s83, 13312
    s_nop 0
    buffer_load_dwordx4 v2, s[4:7], s76 offen offset:0 sc1 lds
    v_mfma_f32_16x16x32_bf16 v[80:83], v[252:255], v[128:131], 0
    s_add_u32 m0, s83, 14336
    v_lshlrev_b32 v48, 16, v36
    v_and_b32 v49, 0xffff0000, v36
    v_mfma_f32_16x16x32_bf16 v[84:87], a[192:195], v[128:131], 0
    s_waitcnt lgkmcnt(2)
    buffer_load_dwordx4 v1, s[4:7], s77 offen offset:0 sc1 lds
    v_mfma_f32_16x16x32_bf16 v[68:71], a[196:199], v[132:135], v[68:71]
    s_add_u32 m0, s83, 14336
    s_waitcnt vmcnt(6)
    ds_read_b128 v[128:131], v33 offset:4096
    v_mfma_f32_16x16x32_bf16 v[72:75], a[200:203], v[132:135], v[72:75]
    buffer_load_dwordx4 v1, s[4:7], s77 offen offset:1024 sc1 lds
    v_mfma_f32_16x16x32_bf16 v[76:79], a[204:207], v[132:135], v[76:79]
    s_add_u32 m0, s83, 14336
    s_nop 0
    buffer_load_dwordx4 v1, s[4:7], s77 offen offset:2048 sc1 lds
    v_mfma_f32_16x16x32_bf16 v[80:83], a[208:211], v[132:135], v[80:83]
    s_add_u32 m0, s83, 14336
    v_lshlrev_b32 v50, 16, v37
    v_and_b32 v51, 0xffff0000, v37
    v_mfma_f32_16x16x32_bf16 v[84:87], a[212:215], v[132:135], v[84:87]
    s_waitcnt lgkmcnt(2)
    v_lshlrev_b32 v52, 16, v38
    v_and_b32 v53, 0xffff0000, v38
    v_mfma_f32_16x16x32_bf16 v[68:71], a[216:219], v[136:139], v[68:71]
    s_waitcnt vmcnt(7)
    ds_read_b128 v[132:135], v33 offset:5120
    v_lshlrev_b32 v54, 16, v39
    v_mfma_f32_16x16x32_bf16 v[72:75], a[220:223], v[136:139], v[72:75]
    buffer_load_dwordx4 v1, s[4:7], s77 offen offset:3072 sc1 lds
    v_mfma_f32_16x16x32_bf16 v[76:79], a[224:227], v[136:139], v[76:79]
    s_add_u32 m0, s83, 18432
    v_and_b32 v55, 0xffff0000, v39
    v_lshlrev_b32 v56, 16, v40
    v_mfma_f32_16x16x32_bf16 v[80:83], a[228:231], v[136:139], v[80:83]
    v_and_b32 v57, 0xffff0000, v40
    v_lshlrev_b32 v58, 16, v41
    v_mfma_f32_16x16x32_bf16 v[84:87], a[232:235], v[136:139], v[84:87]
    s_waitcnt lgkmcnt(2)
    buffer_load_dwordx4 v2, s[4:7], s77 offen offset:0 sc1 lds
    v_mfma_f32_16x16x32_bf16 v[68:71], a[236:239], v[140:143], v[68:71]
    s_add_u32 m0, s83, 19456
    s_waitcnt vmcnt(8)
    ds_read_b128 v[136:139], v33 offset:6144
    v_mfma_f32_16x16x32_bf16 v[72:75], a[240:243], v[140:143], v[72:75]
    v_and_b32 v59, 0xffff0000, v41
    v_lshlrev_b32 v60, 16, v42
    v_mfma_f32_16x16x32_bf16 v[76:79], v[248:251], v[140:143], v[76:79]
    buffer_load_dwordx4 v1, s[4:7], s74 offen offset:0 sc1 lds
    v_mfma_f32_16x16x32_bf16 v[80:83], v[244:247], v[140:143], v[80:83]
    s_add_u32 m0, s83, 19456
    v_and_b32 v61, 0xffff0000, v42
    v_lshlrev_b32 v62, 16, v43
    v_mfma_f32_16x16x32_bf16 v[84:87], v[240:243], v[140:143], v[84:87]
    s_waitcnt lgkmcnt(2)
    v_and_b32 v63, 0xffff0000, v43
    v_lshlrev_b32 v64, 16, v44
    v_mfma_f32_16x16x32_bf16 v[68:71], v[236:239], v[128:131], v[68:71]
    s_waitcnt vmcnt(8)
    ds_read_b128 v[140:143], v33 offset:7168
    v_and_b32 v65, 0xffff0000, v44
    v_mfma_f32_16x16x32_bf16 v[72:75], v[232:235], v[128:131], v[72:75]
    buffer_load_dwordx4 v1, s[4:7], s74 offen offset:1024 sc1 lds
    v_mfma_f32_16x16x32_bf16 v[76:79], v[228:231], v[128:131], v[76:79]
    s_add_u32 m0, s83, 19456
    v_lshlrev_b32 v66, 16, v45
    v_and_b32 v67, 0xffff0000, v45
    v_mfma_f32_16x16x32_bf16 v[80:83], v[224:227], v[128:131], v[80:83]
    v_mfma_f32_16x16x32_bf16 v[84:87], v[220:223], v[128:131], v[84:87]
    s_waitcnt lgkmcnt(2)
    buffer_load_dwordx4 v1, s[4:7], s74 offen offset:2048 sc1 lds
    v_mfma_f32_16x16x32_bf16 v[88:91], a[244:247], v[132:135], 0
    s_add_u32 m0, s83, 19456
    s_waitcnt vmcnt(9)
    ds_read_b128 v[128:131], v33 offset:8192
    v_mfma_f32_16x16x32_bf16 v[92:95], a[248:251], v[132:135], 0
    v_mfma_f32_16x16x32_bf16 v[96:99], a[252:255], v[132:135], 0
    ds_write_b128 v20, v[68:71] offset:0
    v_mfma_f32_16x16x32_bf16 v[100:103], v[252:255], v[132:135], 0
    buffer_load_dwordx4 v1, s[4:7], s74 offen offset:3072 sc1 lds
    v_mfma_f32_16x16x32_bf16 v[104:107], a[192:195], v[132:135], 0
    s_waitcnt lgkmcnt(3)
    v_mfma_f32_16x16x32_bf16 v[88:91], a[196:199], v[136:139], v[88:91]
    s_add_u32 m0, s83, 23552
    s_waitcnt vmcnt(9)
    ds_read_b128 v[132:135], v33 offset:9216
    v_mfma_f32_16x16x32_bf16 v[92:95], a[200:203], v[136:139], v[92:95]
    buffer_load_dwordx4 v2, s[4:7], s74 offen offset:0 sc1 lds
    v_mfma_f32_16x16x32_bf16 v[96:99], a[204:207], v[136:139], v[96:99]
    ds_write_b128 v20, v[72:75] offset:1024
    v_mfma_f32_16x16x32_bf16 v[100:103], a[208:211], v[136:139], v[100:103]
    v_mfma_f32_16x16x32_bf16 v[104:107], a[212:215], v[136:139], v[104:107]
    s_waitcnt lgkmcnt(4)
    v_mfma_f32_16x16x32_bf16 v[88:91], a[216:219], v[140:143], v[88:91]
    s_waitcnt vmcnt(9)
    ds_read_b128 v[136:139], v33 offset:10240
    v_mfma_f32_16x16x32_bf16 v[92:95], a[220:223], v[140:143], v[92:95]
    buffer_load_dwordx4 v[164:167], v3, s[4:7], s33 offen offset:3072
    v_mfma_f32_16x16x32_bf16 v[96:99], a[224:227], v[140:143], v[96:99]
    s_add_u32 s33, s62, 12288
    ds_write_b128 v20, v[76:79] offset:2048
    v_mfma_f32_16x16x32_bf16 v[100:103], a[228:231], v[140:143], v[100:103]
    v_mfma_f32_16x16x32_bf16 v[104:107], a[232:235], v[140:143], v[104:107]
    s_waitcnt lgkmcnt(5)
    buffer_load_dwordx4 v[168:171], v1, s[4:7], s33 offen offset:0
    v_mfma_f32_16x16x32_bf16 v[88:91], a[236:239], v[128:131], v[88:91]
    s_waitcnt vmcnt(10)
    ds_read_b128 v[140:143], v33 offset:11264
    v_mfma_f32_16x16x32_bf16 v[92:95], a[240:243], v[128:131], v[92:95]
    ds_write_b128 v20, v[80:83] offset:3072
    v_mfma_f32_16x16x32_bf16 v[96:99], v[248:251], v[128:131], v[96:99]
    buffer_load_dwordx4 v[172:175], v1, s[4:7], s33 offen offset:1024
    v_mfma_f32_16x16x32_bf16 v[100:103], v[244:247], v[128:131], v[100:103]
    v_mfma_f32_16x16x32_bf16 v[104:107], v[240:243], v[128:131], v[104:107]
    s_waitcnt lgkmcnt(5)
    ds_write_b128 v20, v[84:87] offset:4096
    v_mfma_f32_16x16x32_bf16 v[88:91], v[236:239], v[132:135], v[88:91]
    s_waitcnt vmcnt(10)
    ds_read_b128 v[128:131], v33 offset:12288
    v_mfma_f32_16x16x32_bf16 v[92:95], v[232:235], v[132:135], v[92:95]
    buffer_load_dwordx4 a[88:91], v1, s[4:7], s33 offen offset:2048
    v_mfma_f32_16x16x32_bf16 v[96:99], v[228:231], v[132:135], v[96:99]
    v_mfma_f32_16x16x32_bf16 v[100:103], v[224:227], v[132:135], v[100:103]
    v_mfma_f32_16x16x32_bf16 v[104:107], v[220:223], v[132:135], v[104:107]
    s_waitcnt lgkmcnt(5)
    buffer_load_dwordx4 a[92:95], v1, s[4:7], s33 offen offset:3072
    v_mfma_f32_16x16x32_bf16 v[108:111], a[244:247], v[136:139], 0
    s_waitcnt vmcnt(11)
    ds_read_b128 v[132:135], v33 offset:13312
    v_mfma_f32_16x16x32_bf16 v[112:115], a[248:251], v[136:139], 0
    v_mfma_f32_16x16x32_bf16 v[116:119], a[252:255], v[136:139], 0
    ds_write_b128 v21, v[88:91] offset:0
    v_mfma_f32_16x16x32_bf16 v[120:123], v[252:255], v[136:139], 0
    buffer_load_dwordx4 a[96:99], v2, s[4:7], s33 offen offset:0
    v_mfma_f32_16x16x32_bf16 v[124:127], a[192:195], v[136:139], 0
    s_waitcnt lgkmcnt(5)
    v_mfma_f32_16x16x32_bf16 v[108:111], a[196:199], v[140:143], v[108:111]
    s_waitcnt vmcnt(11)
    ds_read_b128 v[136:139], v33 offset:14336
    v_mfma_f32_16x16x32_bf16 v[112:115], a[200:203], v[140:143], v[112:115]
    buffer_load_dwordx4 a[100:103], v2, s[4:7], s33 offen offset:1024
    v_mfma_f32_16x16x32_bf16 v[116:119], a[204:207], v[140:143], v[116:119]
    ds_write_b128 v21, v[92:95] offset:1024
    v_mfma_f32_16x16x32_bf16 v[120:123], a[208:211], v[140:143], v[120:123]
    v_mfma_f32_16x16x32_bf16 v[124:127], a[212:215], v[140:143], v[124:127]
    s_waitcnt lgkmcnt(4)
    v_mfma_f32_16x16x32_bf16 v[108:111], a[216:219], v[128:131], v[108:111]
    s_waitcnt vmcnt(11)
    ds_read_b128 v[140:143], v33 offset:15360
    v_mfma_f32_16x16x32_bf16 v[112:115], a[220:223], v[128:131], v[112:115]
    buffer_load_dwordx4 a[104:107], v2, s[4:7], s33 offen offset:2048
    v_mfma_f32_16x16x32_bf16 v[116:119], a[224:227], v[128:131], v[116:119]
    ds_write_b128 v21, v[96:99] offset:2048
    v_mfma_f32_16x16x32_bf16 v[120:123], a[228:231], v[128:131], v[120:123]
    v_mfma_f32_16x16x32_bf16 v[124:127], a[232:235], v[128:131], v[124:127]
    s_waitcnt lgkmcnt(5)
    buffer_load_dwordx4 a[108:111], v2, s[4:7], s33 offen offset:3072
    v_mfma_f32_16x16x32_bf16 v[108:111], a[236:239], v[132:135], v[108:111]
    s_waitcnt vmcnt(12)
    ds_read_b128 v[128:131], v33 offset:16384
    v_mfma_f32_16x16x32_bf16 v[112:115], a[240:243], v[132:135], v[112:115]
    ds_write_b128 v21, v[100:103] offset:3072
    v_mfma_f32_16x16x32_bf16 v[116:119], v[248:251], v[132:135], v[116:119]
    buffer_load_dwordx4 a[112:115], v3, s[4:7], s33 offen offset:0
    v_mfma_f32_16x16x32_bf16 v[120:123], v[244:247], v[132:135], v[120:123]
    v_mfma_f32_16x16x32_bf16 v[124:127], v[240:243], v[132:135], v[124:127]
    s_waitcnt lgkmcnt(5)
    ds_write_b128 v21, v[104:107] offset:4096
    v_mfma_f32_16x16x32_bf16 v[108:111], v[236:239], v[136:139], v[108:111]
    s_waitcnt vmcnt(12)
    ds_read_b128 v[132:135], v33 offset:17408
    v_mfma_f32_16x16x32_bf16 v[112:115], v[232:235], v[136:139], v[112:115]
    buffer_load_dwordx4 a[116:119], v3, s[4:7], s33 offen offset:1024
    v_mfma_f32_16x16x32_bf16 v[116:119], v[228:231], v[136:139], v[116:119]
    v_mfma_f32_16x16x32_bf16 v[120:123], v[224:227], v[136:139], v[120:123]
    v_mfma_f32_16x16x32_bf16 v[124:127], v[220:223], v[136:139], v[124:127]
    s_waitcnt lgkmcnt(5)
    buffer_load_dwordx4 a[120:123], v3, s[4:7], s33 offen offset:2048
    s_waitcnt lgkmcnt(1)
    s_barrier
    v_mfma_f32_16x16x32_bf16 v[48:51], a[244:247], v[140:143], v[48:51]
    s_waitcnt vmcnt(13)
    ds_read_b128 v[136:139], v33 offset:18432
    ds_read_b128 v[68:71], v23 offset:0
    v_mfma_f32_16x16x32_bf16 v[52:55], a[248:251], v[140:143], v[52:55]
    ds_read_b128 v[88:91], v23 offset:5120
    v_mfma_f32_16x16x32_bf16 v[56:59], a[252:255], v[140:143], v[56:59]
    ds_write_b128 v22, v[108:111] offset:0
    v_mfma_f32_16x16x32_bf16 v[60:63], v[252:255], v[140:143], v[60:63]
    buffer_load_dwordx4 a[124:127], v3, s[4:7], s33 offen offset:3072
    v_mfma_f32_16x16x32_bf16 v[64:67], a[192:195], v[140:143], v[64:67]
    s_add_u32 s33, s62, 24576
    ds_read_b128 v[72:75], v23 offset:1024
    ds_read_b128 v[92:95], v23 offset:6144
    v_mfma_f32_16x16x32_bf16 v[48:51], a[196:199], v[128:131], v[48:51]
    s_waitcnt vmcnt(13)
    ds_read_b128 v[140:143], v33 offset:19456
    v_mfma_f32_16x16x32_bf16 v[52:55], a[200:203], v[128:131], v[52:55]
    buffer_load_dwordx4 a[128:131], v1, s[4:7], s33 offen offset:0
    v_mfma_f32_16x16x32_bf16 v[56:59], a[204:207], v[128:131], v[56:59]
    ds_write_b128 v22, v[112:115] offset:1024
    v_mfma_f32_16x16x32_bf16 v[60:63], a[208:211], v[128:131], v[60:63]
    ds_read_b128 v[76:79], v23 offset:2048
    ds_read_b128 v[96:99], v23 offset:7168
    v_mfma_f32_16x16x32_bf16 v[64:67], a[212:215], v[128:131], v[64:67]
    s_waitcnt lgkmcnt(10)
    ds_write_b128 v22, v[116:119] offset:2048
    v_mfma_f32_16x16x32_bf16 v[48:51], a[216:219], v[132:135], v[48:51]
    buffer_load_dwordx4 a[132:135], v1, s[4:7], s33 offen offset:1024
    v_mfma_f32_16x16x32_bf16 v[52:55], a[220:223], v[132:135], v[52:55]
    ds_read_b128 v[80:83], v23 offset:3072
    ds_read_b128 v[100:103], v23 offset:8192
    v_mfma_f32_16x16x32_bf16 v[56:59], a[224:227], v[132:135], v[56:59]
    ds_write_b128 v22, v[120:123] offset:3072
    v_mfma_f32_16x16x32_bf16 v[60:63], a[228:231], v[132:135], v[60:63]
    ds_read_b128 v[84:87], v23 offset:4096
    ds_read_b128 v[104:107], v23 offset:9216
    v_mfma_f32_16x16x32_bf16 v[64:67], a[232:235], v[132:135], v[64:67]
    s_waitcnt lgkmcnt(15)
    buffer_load_dwordx4 a[136:139], v1, s[4:7], s33 offen offset:2048
    v_mfma_f32_16x16x32_bf16 v[48:51], a[236:239], v[136:139], v[48:51]
    ds_write_b128 v22, v[124:127] offset:4096
    v_mfma_f32_16x16x32_bf16 v[52:55], a[240:243], v[136:139], v[52:55]
    s_waitcnt lgkmcnt(14)
    v_add_f32 v68, v68, v88
    v_add_f32 v69, v69, v89
    v_mfma_f32_16x16x32_bf16 v[56:59], v[248:251], v[136:139], v[56:59]
    buffer_load_dwordx4 a[140:143], v1, s[4:7], s33 offen offset:3072
    v_mfma_f32_16x16x32_bf16 v[60:63], v[244:247], v[136:139], v[60:63]
    v_add_f32 v70, v70, v90
    v_add_f32 v71, v71, v91
    v_mfma_f32_16x16x32_bf16 v[64:67], v[240:243], v[136:139], v[64:67]
    s_waitcnt lgkmcnt(10)
    v_add_f32 v72, v72, v92
    v_add_f32 v73, v73, v93
    v_mfma_f32_16x16x32_bf16 v[48:51], v[236:239], v[140:143], v[48:51]
    v_add_f32 v74, v74, v94
    v_add_f32 v75, v75, v95
    v_mfma_f32_16x16x32_bf16 v[52:55], v[232:235], v[140:143], v[52:55]
    s_waitcnt lgkmcnt(7)
    buffer_load_dwordx4 a[144:147], v2, s[4:7], s33 offen offset:0
    v_mfma_f32_16x16x32_bf16 v[56:59], v[228:231], v[140:143], v[56:59]
    v_add_f32 v76, v76, v96
    v_add_f32 v77, v77, v97
    v_mfma_f32_16x16x32_bf16 v[60:63], v[224:227], v[140:143], v[60:63]
    v_add_f32 v78, v78, v98
    v_add_f32 v79, v79, v99
    v_mfma_f32_16x16x32_bf16 v[64:67], v[220:223], v[140:143], v[64:67]
    s_waitcnt lgkmcnt(4)
    buffer_load_dwordx4 a[148:151], v2, s[4:7], s33 offen offset:1024
    s_waitcnt lgkmcnt(0)
    s_barrier
    ds_read_b128 v[108:111], v23 offset:10240
    ds_read_b128 v[112:115], v23 offset:11264
    ds_read_b128 v[116:119], v23 offset:12288
    ds_read_b128 v[120:123], v23 offset:13312
    ds_read_b128 v[124:127], v23 offset:14336
    buffer_load_dword v29, v5, s[4:7], s31 offen sc1
    v_add_f32 v80, v80, v100
    v_add_f32 v81, v81, v101
    v_add_f32 v82, v82, v102
    v_add_f32 v83, v83, v103
    v_add_f32 v84, v84, v104
    v_add_f32 v85, v85, v105
    v_add_f32 v86, v86, v106
    v_add_f32 v87, v87, v107
    v_pk_add_f32 v[48:49], v[48:49], v[68:69]
    v_pk_add_f32 v[50:51], v[50:51], v[70:71]
    v_pk_add_f32 v[52:53], v[52:53], v[72:73]
    v_pk_add_f32 v[54:55], v[54:55], v[74:75]
    buffer_load_dwordx4 a[152:155], v2, s[4:7], s33 offen offset:2048
    v_pk_add_f32 v[56:57], v[56:57], v[76:77]
    v_pk_add_f32 v[58:59], v[58:59], v[78:79]
    v_pk_add_f32 v[60:61], v[60:61], v[80:81]
    v_pk_add_f32 v[62:63], v[62:63], v[82:83]
    v_pk_add_f32 v[64:65], v[64:65], v[84:85]
    v_pk_add_f32 v[66:67], v[66:67], v[86:87]
    s_waitcnt lgkmcnt(4)
    v_pk_add_f32 v[48:49], v[48:49], v[108:109]
    v_pk_add_f32 v[50:51], v[50:51], v[110:111]
    v_cvt_pk_bf16_f32 v36, v48, v49
    v_cvt_pk_bf16_f32 v37, v50, v51
    s_waitcnt lgkmcnt(3)
    v_pk_add_f32 v[52:53], v[52:53], v[112:113]
    v_pk_add_f32 v[54:55], v[54:55], v[114:115]
    buffer_load_dwordx4 a[156:159], v2, s[4:7], s33 offen offset:3072
    v_cvt_pk_bf16_f32 v38, v52, v53
    v_cvt_pk_bf16_f32 v39, v54, v55
    buffer_store_dwordx4 v[36:39], v1, s[4:7], s95 offen
    s_waitcnt lgkmcnt(2)
    v_pk_add_f32 v[56:57], v[56:57], v[116:117]
    v_pk_add_f32 v[58:59], v[58:59], v[118:119]
    v_cvt_pk_bf16_f32 v40, v56, v57
    v_cvt_pk_bf16_f32 v41, v58, v59
    s_waitcnt lgkmcnt(1)
    v_pk_add_f32 v[60:61], v[60:61], v[120:121]
    v_pk_add_f32 v[62:63], v[62:63], v[122:123]
    v_cvt_pk_bf16_f32 v42, v60, v61
    v_cvt_pk_bf16_f32 v43, v62, v63
    buffer_store_dwordx4 v[40:43], v1, s[4:7], s95 offen offset:1024
    s_waitcnt lgkmcnt(0)
    v_pk_add_f32 v[64:65], v[64:65], v[124:125]
    v_pk_add_f32 v[66:67], v[66:67], v[126:127]
    v_cvt_pk_bf16_f32 v44, v64, v65
    buffer_load_dwordx4 a[244:247], v3, s[4:7], s33 offen offset:0
    v_cvt_pk_bf16_f32 v45, v66, v67
    buffer_store_dwordx2 v[44:45], v25, s[4:7], s96 offen
    v_dot2_f32_bf16 v31, v36, s30, 0
    v_dot2_f32_bf16 v32, v36, v36, 0
    v_dot2_f32_bf16 v31, v37, s30, v31
    v_dot2_f32_bf16 v32, v37, v37, v32
    v_dot2_f32_bf16 v31, v38, s30, v31
    v_dot2_f32_bf16 v32, v38, v38, v32
    v_dot2_f32_bf16 v31, v39, s30, v31
    v_dot2_f32_bf16 v32, v39, v39, v32
    v_dot2_f32_bf16 v31, v40, s30, v31
    v_dot2_f32_bf16 v32, v40, v40, v32
    v_dot2_f32_bf16 v31, v41, s30, v31
    v_dot2_f32_bf16 v32, v41, v41, v32
    buffer_load_dwordx4 a[248:251], v3, s[4:7], s33 offen offset:1024
    v_dot2_f32_bf16 v31, v42, s30, v31
    v_dot2_f32_bf16 v32, v42, v42, v32
    v_dot2_f32_bf16 v31, v43, s30, v31
    v_dot2_f32_bf16 v32, v43, v43, v32
    v_dot2_f32_bf16 v31, v44, s30, v31
    v_dot2_f32_bf16 v32, v44, v44, v32
    v_dot2_f32_bf16 v31, v45, s30, v31
    v_dot2_f32_bf16 v32, v45, v45, v32
    s_nop 2
    v_permlane16_swap_b32 v31, v32
    v_add_f32 v31, v31, v32
    v_mov_b32 v32, v31
    s_nop 1
    v_permlane32_swap_b32 v31, v32
    v_add_f32 v34, v31, v32
    buffer_load_dwordx4 a[252:255], v3, s[4:7], s33 offen offset:2048
    s_mov_b64 exec, s[36:37]
    buffer_store_dword v34, v28, s[4:7], s97 offen
    s_mov_b64 exec, -1
    s_waitcnt vmcnt(9)
poll_132:
    v_cmp_le_u32 vcc, 9, v29
    s_nop 0
    s_andn2_b64 s[56:57], s[36:37], vcc
    s_cbranch_scc1 pollr_131
    s_cmp_lg_u32 s28, 0
    s_cbranch_scc1 acq_133
polld_134:
    s_add_u32 m0, s72, 4096
    s_nop 0
    buffer_load_dwordx4 v1, s[12:15], m0 offen offset:0 sc1 lds
    s_add_u32 m0, s72, 8192
    s_nop 0
    buffer_load_dwordx4 v1, s[12:15], m0 offen offset:0 sc1 lds
    s_add_u32 m0, s72, 12288
    s_nop 0
    buffer_load_dwordx4 v1, s[12:15], m0 offen offset:0 sc1 lds
    s_add_u32 m0, s72, 16384
    s_nop 0
    buffer_load_dwordx4 v1, s[12:15], m0 offen offset:0 sc1 lds
    s_add_u32 m0, s72, 20480
    s_nop 0
    buffer_load_dwordx4 v1, s[12:15], m0 offen offset:0 sc1 lds
    s_add_u32 s88, s98, 0
    buffer_load_dwordx4 v[144:147], v1, s[4:7], s88 offen sc1
    v_mov_b32 v30, 9
    s_mov_b64 exec, 1
    s_cmp_lg_u32 s28, 0
    s_waitcnt vmcnt(6)
    s_cbranch_scc1 pubs_135
    buffer_store_dword v30, off, s[4:7], s32
pubd_136:
    s_mov_b64 exec, -1
    s_waitcnt vmcnt(2)
    s_barrier
    ds_read_b128 v[96:99], v7 offset:0
    ds_read_b128 v[100:103], v7 offset:2048
    ds_read_b128 v[104:107], v7 offset:4096
    ds_read_b128 v[108:111], v7 offset:6144
    ds_read_b128 v[112:115], v7 offset:8192
    s_waitcnt lgkmcnt(3)
    v_mfma_f32_16x16x32_bf16 v[72:75], v[216:219], v[96:99], 0
    s_add_u32 m0, s73, 4096
    ds_read_b128 v[116:119], v7 offset:10240
    v_mfma_f32_16x16x32_bf16 v[76:79], v[212:215], v[96:99], 0
    buffer_load_dwordx4 v1, s[12:15], m0 offen offset:0 sc1 lds
    v_mfma_f32_16x16x32_bf16 v[80:83], v[208:211], v[96:99], 0
    s_add_u32 m0, s73, 8192
    v_mfma_f32_16x16x32_bf16 v[72:75], v[204:207], v[100:103], v[72:75]
    s_lshr_b32 s92, s24, 1
    ds_read_b128 v[120:123], v7 offset:12288
    s_mul_i32 s92, s92, 192
    v_mfma_f32_16x16x32_bf16 v[76:79], v[200:203], v[100:103], v[76:79]
    buffer_load_dwordx4 v1, s[12:15], m0 offen offset:0 sc1 lds
    v_mfma_f32_16x16x32_bf16 v[80:83], v[196:199], v[100:103], v[80:83]
    s_waitcnt lgkmcnt(3)
    v_add_u32 v156, s92, v24
    ds_read_b128 v[128:131], v156 offset:480
    v_mfma_f32_16x16x32_bf16 v[72:75], v[192:195], v[104:107], v[72:75]
    s_add_u32 m0, s73, 12288
    ds_read_b128 v[124:127], v7 offset:14336
    ds_read_b128 v[132:135], v156 offset:864
    v_mfma_f32_16x16x32_bf16 v[76:79], v[188:191], v[104:107], v[76:79]
    buffer_load_dwordx4 v1, s[12:15], m0 offen offset:0 sc1 lds
    v_mfma_f32_16x16x32_bf16 v[80:83], v[184:187], v[104:107], v[80:83]
    s_add_u32 m0, s73, 16384
    s_nop 0
    buffer_load_dwordx4 v1, s[12:15], m0 offen offset:0 sc1 lds
    v_mfma_f32_16x16x32_bf16 v[72:75], v[180:183], v[108:111], v[72:75]
    s_add_u32 m0, s73, 20480
    ds_read_b128 v[96:99], v7 offset:16384
    ds_read_b128 v[136:139], v156 offset:544
    v_mfma_f32_16x16x32_bf16 v[76:79], v[176:179], v[108:111], v[76:79]
    buffer_load_dwordx4 v1, s[12:15], m0 offen offset:0 sc1 lds
    v_mfma_f32_16x16x32_bf16 v[80:83], a[160:163], v[108:111], v[80:83]
    s_waitcnt lgkmcnt(6)
    ds_read_b128 v[140:143], v156 offset:928
    ds_read_b128 v[148:151], v156 offset:608
    v_mfma_f32_16x16x32_bf16 v[72:75], a[164:167], v[112:115], v[72:75]
    s_add_u32 m0, s70, 4096
    ds_read_b128 v[100:103], v7 offset:18432
    ds_read_b128 v[152:155], v156 offset:992
    v_mfma_f32_16x16x32_bf16 v[76:79], a[168:171], v[112:115], v[76:79]
    buffer_load_dwordx4 v1, s[12:15], m0 offen offset:0 sc1 lds
    v_mfma_f32_16x16x32_bf16 v[80:83], a[172:175], v[112:115], v[80:83]
    s_add_u32 m0, s70, 8192
    s_nop 0
    buffer_load_dwordx4 v1, s[12:15], m0 offen offset:0 sc1 lds
    v_mfma_f32_16x16x32_bf16 v[72:75], a[176:179], v[116:119], v[72:75]
    s_add_u32 m0, s70, 12288
    s_waitcnt vmcnt(2)
    s_barrier
    ds_read_b128 v[104:107], v7 offset:20480
    v_mfma_f32_16x16x32_bf16 v[76:79], a[180:183], v[116:119], v[76:79]
    buffer_load_dwordx4 v1, s[12:15], m0 offen offset:0 sc1 lds
    v_mfma_f32_16x16x32_bf16 v[80:83], a[184:187], v[116:119], v[80:83]
    s_waitcnt lgkmcnt(8)
    v_mfma_f32_16x16x32_bf16 v[72:75], a[188:191], v[120:123], v[72:75]
    s_add_u32 m0, s70, 16384
    ds_read_b128 v[108:111], v7 offset:22528
    v_mfma_f32_16x16x32_bf16 v[76:79], a[0:3], v[120:123], v[76:79]
    buffer_load_dwordx4 v1, s[12:15], m0 offen offset:0 sc1 lds
    v_mfma_f32_16x16x32_bf16 v[80:83], a[4:7], v[120:123], v[80:83]
    s_add_u32 m0, s70, 20480
    s_nop 0
    buffer_load_dwordx4 v1, s[12:15], m0 offen offset:0 sc1 lds
    v_mfma_f32_16x16x32_bf16 v[72:75], a[8:11], v[124:127], v[72:75]
    s_add_u32 m0, s71, 4096
    ds_read_b128 v[112:115], v7 offset:24576
    v_mfma_f32_16x16x32_bf16 v[76:79], a[12:15], v[124:127], v[76:79]
    buffer_load_dwordx4 v1, s[12:15], m0 offen offset:0 sc1 lds
    v_mfma_f32_16x16x32_bf16 v[80:83], a[16:19], v[124:127], v[80:83]
    s_waitcnt lgkmcnt(4)
    v_mfma_f32_16x16x32_bf16 v[72:75], a[20:23], v[96:99], v[72:75]
    s_add_u32 m0, s71, 8192
    ds_read_b128 v[116:119], v7 offset:26624
    v_mfma_f32_16x16x32_bf16 v[76:79], a[24:27], v[96:99], v[76:79]
    buffer_load_dword v29, v5, s[4:7], s31 offen sc1
    v_mfma_f32_16x16x32_bf16 v[80:83], a[28:31], v[96:99], v[80:83]
    buffer_load_dwordx4 v1, s[12:15], m0 offen offset:0 sc1 lds
    v_mfma_f32_16x16x32_bf16 v[72:75], a[32:35], v[100:103], v[72:75]
    s_add_u32 m0, s71, 12288
    ds_read_b128 v[120:123], v7 offset:28672
    v_add_f32 v144, v144, v146
    v_mfma_f32_16x16x32_bf16 v[76:79], a[36:39], v[100:103], v[76:79]
    buffer_load_dwordx4 v1, s[12:15], m0 offen offset:0 sc1 lds
    v_mfma_f32_16x16x32_bf16 v[80:83], a[40:43], v[100:103], v[80:83]
    s_waitcnt lgkmcnt(3)
    v_add_f32 v145, v145, v147
    v_mfma_f32_16x16x32_bf16 v[84:87], v[216:219], v[104:107], 0
    s_add_u32 m0, s71, 16384
    ds_read_b128 v[124:127], v7 offset:30720
    v_permlane16_swap_b32 v144, v145
    v_mfma_f32_16x16x32_bf16 v[88:91], v[212:215], v[104:107], 0
    buffer_load_dwordx4 v1, s[12:15], m0 offen offset:0 sc1 lds
    v_mfma_f32_16x16x32_bf16 v[92:95], v[208:211], v[104:107], 0
    s_add_u32 m0, s71, 20480
    s_nop 0
    buffer_load_dwordx4 v1, s[12:15], m0 offen offset:0 sc1 lds
    v_mfma_f32_16x16x32_bf16 v[84:87], v[204:207], v[108:111], v[84:87]
    ds_read_b128 v[96:99], v7 offset:32768
    v_add_f32 v144, v144, v145
    v_mfma_f32_16x16x32_bf16 v[88:91], v[200:203], v[108:111], v[88:91]
    v_mov_b32 v145, v144
    v_mfma_f32_16x16x32_bf16 v[92:95], v[196:199], v[108:111], v[92:95]
    s_waitcnt lgkmcnt(3)
    buffer_load_dwordx4 v[252:255], v3, s[4:7], s33 offen offset:3072
    v_mfma_f32_16x16x32_bf16 v[84:87], v[192:195], v[112:115], v[84:87]
    s_add_u32 s33, s62, 36864
    ds_read_b128 v[100:103], v7 offset:34816
    v_permlane32_swap_b32 v144, v145
    v_mfma_f32_16x16x32_bf16 v[88:91], v[188:191], v[112:115], v[88:91]
    v_add_f32 v144, v144, v145
    v_mov_b32 v145, v144
    v_mfma_f32_16x16x32_bf16 v[92:95], v[184:187], v[112:115], v[92:95]
    s_nop 0
    v_permlane16_swap_b32 v144, v145
    v_mul_f32 v146, s64, v144
    v_mfma_f32_16x16x32_bf16 v[84:87], v[180:183], v[116:119], v[84:87]
    ds_read_b128 v[104:107], v7 offset:36864
    v_mul_f32 v145, s64, v145
    v_mfma_f32_16x16x32_bf16 v[88:91], v[176:179], v[116:119], v[88:91]
    buffer_load_dwordx4 a[192:195], v1, s[4:7], s33 offen offset:0
    v_mfma_f32_16x16x32_bf16 v[92:95], a[160:163], v[116:119], v[92:95]
    s_waitcnt lgkmcnt(3)
    v_fma_f32 v145, -v146, v146, v145
    v_max_f32 v145, 0, v145
    v_mfma_f32_16x16x32_bf16 v[84:87], a[164:167], v[120:123], v[84:87]
    ds_read_b128 v[108:111], v7 offset:38912
    v_add_f32 v145, s65, v145
    v_mfma_f32_16x16x32_bf16 v[88:91], a[168:171], v[120:123], v[88:91]
    buffer_load_dwordx4 a[196:199], v1, s[4:7], s33 offen offset:1024
    v_mfma_f32_16x16x32_bf16 v[92:95], a[172:175], v[120:123], v[92:95]
    v_rsq_f32 v147, v145
    v_mfma_f32_16x16x32_bf16 v[84:87], a[176:179], v[124:127], v[84:87]
    s_waitcnt vmcnt(9)
    s_barrier
    ds_read_b128 v[112:115], v6 offset:0
    v_mfma_f32_16x16x32_bf16 v[88:91], a[180:183], v[124:127], v[88:91]
    buffer_load_dwordx4 a[200:203], v1, s[4:7], s33 offen offset:2048
    v_mfma_f32_16x16x32_bf16 v[92:95], a[184:187], v[124:127], v[92:95]
    s_waitcnt lgkmcnt(3)
    v_add_u32 v144, s0, v17
    v_mfma_f32_16x16x32_bf16 v[84:87], a[188:191], v[96:99], v[84:87]
    ds_read_b128 v[116:119], v6 offset:2048
    v_mfma_f32_16x16x32_bf16 v[88:91], a[0:3], v[96:99], v[88:91]
    ds_write_b64 v144, v[146:147] offset:0
    v_mfma_f32_16x16x32_bf16 v[92:95], a[4:7], v[96:99], v[92:95]
    buffer_load_dwordx4 a[204:207], v1, s[4:7], s33 offen offset:3072
    v_mfma_f32_16x16x32_bf16 v[84:87], a[8:11], v[100:103], v[84:87]
    ds_read_b128 v[120:123], v6 offset:4096
    v_mfma_f32_16x16x32_bf16 v[88:91], a[12:15], v[100:103], v[88:91]
    v_mfma_f32_16x16x32_bf16 v[92:95], a[16:19], v[100:103], v[92:95]
    s_waitcnt lgkmcnt(4)
    buffer_load_dwordx4 a[208:211], v2, s[4:7], s33 offen offset:0
    v_mfma_f32_16x16x32_bf16 v[84:87], a[20:23], v[104:107], v[84:87]
    ds_read_b128 v[124:127], v6 offset:6144
    v_mfma_f32_16x16x32_bf16 v[88:91], a[24:27], v[104:107], v[88:91]
    ds_write_b128 v18, v[72:75] offset:0
    v_mfma_f32_16x16x32_bf16 v[92:95], a[28:31], v[104:107], v[92:95]
    v_mfma_f32_16x16x32_bf16 v[84:87], a[32:35], v[108:111], v[84:87]
    ds_read_b128 v[96:99], v6 offset:8192
    v_mfma_f32_16x16x32_bf16 v[88:91], a[36:39], v[108:111], v[88:91]
    buffer_load_dwordx4 a[212:215], v2, s[4:7], s33 offen offset:1024
    v_mfma_f32_16x16x32_bf16 v[92:95], a[40:43], v[108:111], v[92:95]
    s_waitcnt lgkmcnt(5)
    ds_write_b128 v18, v[76:79] offset:1024
    ds_write_b128 v18, v[80:83] offset:2048
    v_mfma_f32_16x16x32_bf16 v[48:51], v[216:219], v[112:115], 0
    ds_read_b128 v[100:103], v6 offset:10240
    v_mfma_f32_16x16x32_bf16 v[52:55], v[212:215], v[112:115], 0
    s_waitcnt vmcnt(11)
poll_138:
    v_cmp_le_u32 vcc, 9, v29
    s_nop 0
    s_andn2_b64 s[56:57], s[38:39], vcc
    s_cbranch_scc1 pollr_137
    s_cmp_lg_u32 s28, 0
    s_cbranch_scc1 acq_139
polld_140:
    v_mfma_f32_16x16x32_bf16 v[56:59], v[208:211], v[112:115], 0
    s_add_u32 m0, s72, 4096
    s_nop 0
    buffer_load_dwordx4 v1, s[16:19], m0 offen offset:0 sc1 lds
    v_mfma_f32_16x16x32_bf16 v[48:51], v[204:207], v[116:119], v[48:51]
    s_add_u32 m0, s72, 8192
    ds_read_b128 v[104:107], v6 offset:12288
    v_mfma_f32_16x16x32_bf16 v[52:55], v[200:203], v[116:119], v[52:55]
    ds_write_b128 v18, v[84:87] offset:3072
    v_mfma_f32_16x16x32_bf16 v[56:59], v[196:199], v[116:119], v[56:59]
    s_waitcnt lgkmcnt(7)
    buffer_load_dwordx4 v1, s[16:19], m0 offen offset:0 sc1 lds
    v_mfma_f32_16x16x32_bf16 v[48:51], v[192:195], v[120:123], v[48:51]
    s_add_u32 m0, s72, 12288
    ds_read_b128 v[108:111], v6 offset:14336
    v_mfma_f32_16x16x32_bf16 v[52:55], v[188:191], v[120:123], v[52:55]
    ds_write_b128 v18, v[88:91] offset:4096
    v_mfma_f32_16x16x32_bf16 v[56:59], v[184:187], v[120:123], v[56:59]
    buffer_load_dwordx4 v1, s[16:19], m0 offen offset:0 sc1 lds
    v_mfma_f32_16x16x32_bf16 v[48:51], v[180:183], v[124:127], v[48:51]
    s_add_u32 m0, s72, 16384
    ds_read_b128 v[112:115], v6 offset:16384
    v_mfma_f32_16x16x32_bf16 v[52:55], v[176:179], v[124:127], v[52:55]
    ds_write_b128 v18, v[92:95] offset:5120
    v_mfma_f32_16x16x32_bf16 v[56:59], a[160:163], v[124:127], v[56:59]
    s_waitcnt lgkmcnt(6)
    v_mfma_f32_16x16x32_bf16 v[48:51], a[164:167], v[96:99], v[48:51]
    ds_read_b128 v[116:119], v6 offset:18432
    v_mfma_f32_16x16x32_bf16 v[52:55], a[168:171], v[96:99], v[52:55]
    buffer_load_dwordx4 v1, s[16:19], m0 offen offset:0 sc1 lds
    v_mfma_f32_16x16x32_bf16 v[56:59], a[172:175], v[96:99], v[56:59]
    s_add_u32 m0, s72, 20480
    v_mfma_f32_16x16x32_bf16 v[48:51], a[176:179], v[100:103], v[48:51]
    s_waitcnt lgkmcnt(1)
    s_waitcnt vmcnt(11)
    s_barrier
    ds_read_b128 v[120:123], v6 offset:20480
    v_mfma_f32_16x16x32_bf16 v[52:55], a[180:183], v[100:103], v[52:55]
    buffer_load_dwordx4 v1, s[16:19], m0 offen offset:0 sc1 lds
    v_add_u32 v46, s69, v17
    v_mfma_f32_16x16x32_bf16 v[56:59], a[184:187], v[100:103], v[56:59]
    s_add_u32 s88, s98, 65536
    ds_read_b64 v[46:47], v46 offset:0
    ds_read_b128 v[72:75], v19 offset:0
    ds_read_b128 v[76:79], v19 offset:1024
    v_mfma_f32_16x16x32_bf16 v[48:51], a[188:191], v[104:107], v[48:51]
    ds_read_b128 v[124:127], v6 offset:22528
    ds_read_b128 v[80:83], v19 offset:2048
    v_add_u32 v162, s69, v17
    v_mfma_f32_16x16x32_bf16 v[52:55], a[0:3], v[104:107], v[52:55]
    buffer_load_dwordx4 v[144:147], v1, s[4:7], s88 offen sc1
    ds_read_b64 v[162:163], v162 offset:128
    v_mfma_f32_16x16x32_bf16 v[56:59], a[4:7], v[104:107], v[56:59]
    s_add_u32 m0, s73, 4096
    ds_read_b128 v[84:87], v19 offset:3072
    ds_read_b128 v[88:91], v19 offset:4096
    ds_read_b128 v[92:95], v19 offset:5120
    v_mfma_f32_16x16x32_bf16 v[48:51], a[8:11], v[108:111], v[48:51]
    ds_read_b128 v[96:99], v6 offset:24576
    v_mfma_f32_16x16x32_bf16 v[52:55], a[12:15], v[108:111], v[52:55]
    v_mfma_f32_16x16x32_bf16 v[56:59], a[16:19], v[108:111], v[56:59]
    s_waitcnt lgkmcnt(11)
    buffer_load_dwordx4 v1, s[16:19], m0 offen offset:0 sc1 lds
    v_mfma_f32_16x16x32_bf16 v[48:51], a[20:23], v[112:115], v[48:51]
    s_add_u32 m0, s73, 8192
    ds_read_b128 v[100:103], v6 offset:26624
    v_mfma_f32_16x16x32_bf16 v[52:55], a[24:27], v[112:115], v[52:55]
    s_waitcnt lgkmcnt(6)
    v_fma_f32 v72, -v128, v46, v72
    v_fma_f32 v73, -v129, v46, v73
    v_fma_f32 v74, -v130, v46, v74
    v_mfma_f32_16x16x32_bf16 v[56:59], a[28:31], v[112:115], v[56:59]
    buffer_load_dwordx4 v1, s[16:19], m0 offen offset:0 sc1 lds
    v_fma_f32 v75, -v131, v46, v75
    v_mfma_f32_16x16x32_bf16 v[48:51], a[32:35], v[116:119], v[48:51]
    s_add_u32 m0, s73, 12288
    ds_read_b128 v[104:107], v6 offset:28672
    v_fma_f32 v72, v72, v47, v132
    v_mfma_f32_16x16x32_bf16 v[52:55], a[36:39], v[116:119], v[52:55]
    v_fma_f32 v73, v73, v47, v133
    v_fma_f32 v74, v74, v47, v134
    v_mfma_f32_16x16x32_bf16 v[56:59], a[40:43], v[116:119], v[56:59]
    v_fma_f32 v75, v75, v47, v135
    v_fma_f32 v76, -v136, v46, v76
    v_mfma_f32_16x16x32_bf16 v[60:63], v[216:219], v[120:123], 0
    ds_read_b128 v[108:111], v6 offset:30720
    v_fma_f32 v77, -v137, v46, v77
    v_mfma_f32_16x16x32_bf16 v[64:67], v[212:215], v[120:123], 0
    buffer_load_dwordx4 v1, s[16:19], m0 offen offset:0 sc1 lds
    v_mfma_f32_16x16x32_bf16 v[68:71], v[208:211], v[120:123], 0
    s_add_u32 m0, s73, 16384
    v_fma_f32 v78, -v138, v46, v78
    v_fma_f32 v79, -v139, v46, v79
    v_mfma_f32_16x16x32_bf16 v[60:63], v[204:207], v[124:127], v[60:63]
    ds_read_b128 v[112:115], v6 offset:32768
    v_fma_f32 v76, v76, v47, v140
    v_fma_f32 v77, v77, v47, v141
    v_mfma_f32_16x16x32_bf16 v[64:67], v[200:203], v[124:127], v[64:67]
    buffer_load_dwordx4 v1, s[16:19], m0 offen offset:0 sc1 lds
    v_fma_f32 v78, v78, v47, v142
    v_mfma_f32_16x16x32_bf16 v[68:71], v[196:199], v[124:127], v[68:71]
    s_waitcnt lgkmcnt(3)
    v_fma_f32 v79, v79, v47, v143
    v_fma_f32 v80, -v148, v46, v80
    v_fma_f32 v81, -v149, v46, v81
    v_mfma_f32_16x16x32_bf16 v[60:63], v[192:195], v[96:99], v[60:63]
    s_add_u32 m0, s73, 20480
    ds_read_b128 v[116:119], v6 offset:34816
    v_fma_f32 v82, -v150, v46, v82
    v_fma_f32 v83, -v151, v46, v83
    v_mfma_f32_16x16x32_bf16 v[64:67], v[188:191], v[96:99], v[64:67]
    buffer_load_dwordx4 v1, s[16:19], m0 offen offset:0 sc1 lds
    v_fma_f32 v80, v80, v47, v152
    v_mfma_f32_16x16x32_bf16 v[68:71], v[184:187], v[96:99], v[68:71]
    v_fma_f32 v81, v81, v47, v153
    v_fma_f32 v82, v82, v47, v154
    v_fma_f32 v83, v83, v47, v155
    v_mfma_f32_16x16x32_bf16 v[60:63], v[180:183], v[100:103], v[60:63]
    ds_read_b128 v[120:123], v6 offset:36864
    v_fma_f32 v84, -v128, v162, v84
    v_fma_f32 v85, -v129, v162, v85
    v_mfma_f32_16x16x32_bf16 v[64:67], v[176:179], v[100:103], v[64:67]
    v_fma_f32 v86, -v130, v162, v86
    v_fma_f32 v87, -v131, v162, v87
    v_fma_f32 v84, v84, v163, v132
    v_mfma_f32_16x16x32_bf16 v[68:71], a[160:163], v[100:103], v[68:71]
    s_waitcnt lgkmcnt(3)
    buffer_load_dwordx4 a[216:219], v2, s[4:7], s33 offen offset:2048
    v_fma_f32 v85, v85, v163, v133
    v_mfma_f32_16x16x32_bf16 v[60:63], a[164:167], v[104:107], v[60:63]
    ds_read_b128 v[124:127], v6 offset:38912
    v_fma_f32 v86, v86, v163, v134
    v_fma_f32 v87, v87, v163, v135
    v_mfma_f32_16x16x32_bf16 v[64:67], a[168:171], v[104:107], v[64:67]
    v_fma_f32 v88, -v136, v162, v88
    v_fma_f32 v89, -v137, v162, v89
    v_fma_f32 v90, -v138, v162, v90
    v_mfma_f32_16x16x32_bf16 v[68:71], a[172:175], v[104:107], v[68:71]
    buffer_load_dwordx4 a[220:223], v2, s[4:7], s33 offen offset:3072
    v_fma_f32 v91, -v139, v162, v91
    v_mfma_f32_16x16x32_bf16 v[60:63], a[176:179], v[108:111], v[60:63]
    s_waitcnt vmcnt(8)
    s_barrier
    ds_read_b128 v[96:99], v7 offset:0
    v_fma_f32 v88, v88, v163, v140
    v_mfma_f32_16x16x32_bf16 v[64:67], a[180:183], v[108:111], v[64:67]
    s_add_u32 m0, s70, 4096
    v_fma_f32 v89, v89, v163, v141
    v_fma_f32 v90, v90, v163, v142
    v_fma_f32 v91, v91, v163, v143
    v_mfma_f32_16x16x32_bf16 v[68:71], a[184:187], v[108:111], v[68:71]
    s_waitcnt lgkmcnt(3)
    v_fma_f32 v92, -v148, v162, v92
    v_fma_f32 v93, -v149, v162, v93
    v_fma_f32 v94, -v150, v162, v94
    v_mfma_f32_16x16x32_bf16 v[60:63], a[188:191], v[112:115], v[60:63]
    ds_read_b128 v[100:103], v7 offset:2048
    buffer_load_dwordx4 v1, s[16:19], m0 offen offset:0 sc1 lds
    v_mfma_f32_16x16x32_bf16 v[64:67], a[0:3], v[112:115], v[64:67]
    s_add_u32 m0, s70, 8192
    v_fma_f32 v95, -v151, v162, v95
    v_fma_f32 v92, v92, v163, v152
    v_fma_f32 v93, v93, v163, v153
    v_mfma_f32_16x16x32_bf16 v[68:71], a[4:7], v[112:115], v[68:71]
    v_fma_f32 v94, v94, v163, v154
    v_fma_f32 v95, v95, v163, v155
    v_mfma_f32_16x16x32_bf16 v[60:63], a[8:11], v[116:119], v[60:63]
    s_add_u32 s90, s94, 0
    ds_read_b128 v[104:107], v7 offset:4096
    v_fma_f32 v48, v48, v47, v72
    v_mfma_f32_16x16x32_bf16 v[64:67], a[12:15], v[116:119], v[64:67]
    buffer_load_dwordx4 v1, s[16:19], m0 offen offset:0 sc1 lds
    v_mfma_f32_16x16x32_bf16 v[68:71], a[16:19], v[116:119], v[68:71]
    s_waitcnt lgkmcnt(3)
    v_fma_f32 v49, v49, v47, v73
    v_fma_f32 v50, v50, v47, v74
    v_mfma_f32_16x16x32_bf16 v[60:63], a[20:23], v[120:123], v[60:63]
    s_add_u32 m0, s70, 12288
    ds_read_b128 v[108:111], v7 offset:6144
    v_fma_f32 v51, v51, v47, v75
    v_mfma_f32_16x16x32_bf16 v[64:67], a[24:27], v[120:123], v[64:67]
    buffer_load_dwordx4 v1, s[16:19], m0 offen offset:0 sc1 lds
    v_mfma_f32_16x16x32_bf16 v[68:71], a[28:31], v[120:123], v[68:71]
    s_add_u32 m0, s70, 16384
    v_fma_f32 v52, v52, v47, v76
    v_fma_f32 v53, v53, v47, v77
    v_mfma_f32_16x16x32_bf16 v[60:63], a[32:35], v[124:127], v[60:63]
    ds_read_b128 v[112:115], v7 offset:8192
    v_fma_f32 v54, v54, v47, v78
    v_mfma_f32_16x16x32_bf16 v[64:67], a[36:39], v[124:127], v[64:67]
    v_fma_f32 v55, v55, v47, v79
    v_fma_f32 v56, v56, v47, v80
    v_mfma_f32_16x16x32_bf16 v[68:71], a[40:43], v[124:127], v[68:71]
    s_waitcnt lgkmcnt(3)
    buffer_load_dwordx4 v1, s[16:19], m0 offen offset:0 sc1 lds
    v_fma_f32 v57, v57, v47, v81
    v_fma_f32 v58, v58, v47, v82
    v_fma_f32 v59, v59, v47, v83
    v_mfma_f32_16x16x32_bf16 v[72:75], v[216:219], v[96:99], 0
    s_add_u32 m0, s70, 20480
    ds_read_b128 v[116:119], v7 offset:10240
    v_mul_f32 v48, v48, abs(v48)
    v_mfma_f32_16x16x32_bf16 v[76:79], v[212:215], v[96:99], 0
    v_mul_f32 v49, v49, abs(v49)
    v_mul_f32 v50, v50, abs(v50)
    v_mfma_f32_16x16x32_bf16 v[80:83], v[208:211], v[96:99], 0
    buffer_load_dwordx4 v1, s[16:19], m0 offen offset:0 sc1 lds
    v_mfma_f32_16x16x32_bf16 v[72:75], v[204:207], v[100:103], v[72:75]
    ds_read_b128 v[120:123], v7 offset:12288
    v_mul_f32 v51, v51, abs(v51)
    v_cvt_pk_bf16_f32 v156, v48, v49
    v_mfma_f32_16x16x32_bf16 v[76:79], v[200:203], v[100:103], v[76:79]
    v_cvt_pk_bf16_f32 v157, v50, v51
    v_pk_max_i16 v156, v156, 0
    v_pk_max_i16 v157, v157, 0
    v_mfma_f32_16x16x32_bf16 v[80:83], v[196:199], v[100:103], v[80:83]
    s_waitcnt lgkmcnt(3)
    v_mul_f32 v52, v52, abs(v52)
    v_mul_f32 v53, v53, abs(v53)
    v_mul_f32 v54, v54, abs(v54)
    v_mfma_f32_16x16x32_bf16 v[72:75], v[192:195], v[104:107], v[72:75]
    ds_read_b128 v[124:127], v7 offset:14336
    buffer_load_dwordx4 a[224:227], v3, s[4:7], s33 offen offset:0
    v_mfma_f32_16x16x32_bf16 v[76:79], v[188:191], v[104:107], v[76:79]
    v_mul_f32 v55, v55, abs(v55)
    v_cvt_pk_bf16_f32 v158, v52, v53
    v_cvt_pk_bf16_f32 v159, v54, v55
    v_mfma_f32_16x16x32_bf16 v[80:83], v[184:187], v[104:107], v[80:83]
    v_pk_max_i16 v158, v158, 0
    v_pk_max_i16 v159, v159, 0
    buffer_store_dwordx4 v[156:159], v27, s[4:7], s90 offen
    v_mfma_f32_16x16x32_bf16 v[72:75], v[180:183], v[108:111], v[72:75]
    ds_read_b128 v[96:99], v7 offset:16384
    buffer_load_dwordx4 a[228:231], v3, s[4:7], s33 offen offset:1024
    v_mfma_f32_16x16x32_bf16 v[76:79], v[176:179], v[108:111], v[76:79]
    v_mul_f32 v56, v56, abs(v56)
    v_mul_f32 v57, v57, abs(v57)
    v_mul_f32 v58, v58, abs(v58)
    v_mfma_f32_16x16x32_bf16 v[80:83], a[160:163], v[108:111], v[80:83]
    s_waitcnt lgkmcnt(3)
    v_mul_f32 v59, v59, abs(v59)
    v_cvt_pk_bf16_f32 v160, v56, v57
    v_cvt_pk_bf16_f32 v161, v58, v59
    v_mfma_f32_16x16x32_bf16 v[72:75], a[164:167], v[112:115], v[72:75]
    ds_read_b128 v[100:103], v7 offset:18432
    v_pk_max_i16 v160, v160, 0
    v_mfma_f32_16x16x32_bf16 v[76:79], a[168:171], v[112:115], v[76:79]
    buffer_load_dwordx4 a[232:235], v3, s[4:7], s33 offen offset:2048
    v_mfma_f32_16x16x32_bf16 v[80:83], a[172:175], v[112:115], v[80:83]
    v_pk_max_i16 v161, v161, 0
    buffer_store_dwordx2 v[160:161], v26, s[4:7], s90 offen offset:1024
    v_mfma_f32_16x16x32_bf16 v[72:75], a[176:179], v[116:119], v[72:75]
    s_add_u32 s90, s94, 49152
    s_waitcnt vmcnt(12)
    s_barrier
    ds_read_b128 v[104:107], v7 offset:20480
    v_mfma_f32_16x16x32_bf16 v[76:79], a[180:183], v[116:119], v[76:79]
    s_add_u32 m0, s71, 4096
    s_nop 0
    buffer_load_dwordx4 v1, s[16:19], m0 offen offset:0 sc1 lds
    v_mfma_f32_16x16x32_bf16 v[80:83], a[184:187], v[116:119], v[80:83]
    s_waitcnt lgkmcnt(3)
    v_fma_f32 v60, v60, v163, v84
    v_fma_f32 v61, v61, v163, v85
    v_mfma_f32_16x16x32_bf16 v[72:75], a[188:191], v[120:123], v[72:75]
    s_add_u32 m0, s71, 8192
    ds_read_b128 v[108:111], v7 offset:22528
    v_fma_f32 v62, v62, v163, v86
    v_mfma_f32_16x16x32_bf16 v[76:79], a[0:3], v[120:123], v[76:79]
    buffer_load_dwordx4 v1, s[16:19], m0 offen offset:0 sc1 lds
    v_mfma_f32_16x16x32_bf16 v[80:83], a[4:7], v[120:123], v[80:83]
    s_add_u32 m0, s71, 12288
    s_nop 0
    buffer_load_dwordx4 v1, s[16:19], m0 offen offset:0 sc1 lds
    v_mfma_f32_16x16x32_bf16 v[72:75], a[8:11], v[124:127], v[72:75]
    s_add_u32 m0, s71, 16384
    ds_read_b128 v[112:115], v7 offset:24576
    v_fma_f32 v63, v63, v163, v87
    v_mfma_f32_16x16x32_bf16 v[76:79], a[12:15], v[124:127], v[76:79]
    buffer_load_dwordx4 v1, s[16:19], m0 offen offset:0 sc1 lds
    v_mfma_f32_16x16x32_bf16 v[80:83], a[16:19], v[124:127], v[80:83]
    s_waitcnt lgkmcnt(3)
    v_fma_f32 v64, v64, v163, v88
    v_fma_f32 v65, v65, v163, v89
    v_mfma_f32_16x16x32_bf16 v[72:75], a[20:23], v[96:99], v[72:75]
    s_add_u32 m0, s71, 20480
    ds_read_b128 v[116:119], v7 offset:26624
    v_fma_f32 v66, v66, v163, v90
    v_mfma_f32_16x16x32_bf16 v[76:79], a[24:27], v[96:99], v[76:79]
    buffer_load_dwordx4 v1, s[16:19], m0 offen offset:0 sc1 lds
    v_mfma_f32_16x16x32_bf16 v[80:83], a[28:31], v[96:99], v[80:83]
    s_lshl_b32 s88, s27, 2
    v_fma_f32 v67, v67, v163, v91
    v_fma_f32 v68, v68, v163, v92
    v_mfma_f32_16x16x32_bf16 v[72:75], a[32:35], v[100:103], v[72:75]
    s_add_u32 s88, s88, s24
    ds_read_b128 v[120:123], v7 offset:28672
    v_fma_f32 v69, v69, v163, v93
    v_mfma_f32_16x16x32_bf16 v[76:79], a[36:39], v[100:103], v[76:79]
    s_lshl_b32 s88, s88, 11
    v_fma_f32 v70, v70, v163, v94
    v_fma_f32 v71, v71, v163, v95
    v_mfma_f32_16x16x32_bf16 v[80:83], a[40:43], v[100:103], v[80:83]
    s_waitcnt lgkmcnt(3)
    v_lshlrev_b32 v31, 5, v5
    v_and_b32 v31, 0x780, v31
    buffer_load_dword v0, v31, s[20:23], s88 offen
    v_mfma_f32_16x16x32_bf16 v[84:87], v[216:219], v[104:107], 0
    ds_read_b128 v[124:127], v7 offset:30720
    v_mul_f32 v60, v60, abs(v60)
    v_mfma_f32_16x16x32_bf16 v[88:91], v[212:215], v[104:107], 0
    v_mul_f32 v61, v61, abs(v61)
    v_mul_f32 v62, v62, abs(v62)
    v_mfma_f32_16x16x32_bf16 v[92:95], v[208:211], v[104:107], 0
    buffer_load_dwordx4 a[236:239], v3, s[4:7], s33 offen offset:3072
    v_mfma_f32_16x16x32_bf16 v[84:87], v[204:207], v[108:111], v[84:87]
    s_add_u32 s33, s62, 49152
    ds_read_b128 v[96:99], v7 offset:32768
    v_mul_f32 v63, v63, abs(v63)
    v_mfma_f32_16x16x32_bf16 v[88:91], v[200:203], v[108:111], v[88:91]
    v_cvt_pk_bf16_f32 v156, v60, v61
    v_cvt_pk_bf16_f32 v157, v62, v63
    v_mfma_f32_16x16x32_bf16 v[92:95], v[196:199], v[108:111], v[92:95]
    s_waitcnt lgkmcnt(3)
    buffer_load_dwordx4 a[240:243], v1, s[4:7], s33 offen offset:0
    v_mfma_f32_16x16x32_bf16 v[84:87], v[192:195], v[112:115], v[84:87]
    ds_read_b128 v[100:103], v7 offset:34816
    v_pk_max_i16 v156, v156, 0
    v_mfma_f32_16x16x32_bf16 v[88:91], v[188:191], v[112:115], v[88:91]
    v_pk_max_i16 v157, v157, 0
    v_mul_f32 v64, v64, abs(v64)
    v_mfma_f32_16x16x32_bf16 v[92:95], v[184:187], v[112:115], v[92:95]
    v_mul_f32 v65, v65, abs(v65)
    v_mul_f32 v66, v66, abs(v66)
    v_mfma_f32_16x16x32_bf16 v[84:87], v[180:183], v[116:119], v[84:87]
    ds_read_b128 v[104:107], v7 offset:36864
    v_mul_f32 v67, v67, abs(v67)
    v_mfma_f32_16x16x32_bf16 v[88:91], v[176:179], v[116:119], v[88:91]
    buffer_load_dwordx4 v[248:251], v1, s[4:7], s33 offen offset:1024
    v_mfma_f32_16x16x32_bf16 v[92:95], a[160:163], v[116:119], v[92:95]
    s_waitcnt lgkmcnt(3)
    v_cvt_pk_bf16_f32 v158, v64, v65
    v_cvt_pk_bf16_f32 v159, v66, v67
    v_mfma_f32_16x16x32_bf16 v[84:87], a[164:167], v[120:123], v[84:87]
    ds_read_b128 v[108:111], v7 offset:38912
    v_pk_max_i16 v158, v158, 0
    v_mfma_f32_16x16x32_bf16 v[88:91], a[168:171], v[120:123], v[88:91]
    buffer_load_dwordx4 v[244:247], v1, s[4:7], s33 offen offset:2048
    v_mfma_f32_16x16x32_bf16 v[92:95], a[172:175], v[120:123], v[92:95]
    v_pk_max_i16 v159, v159, 0
    buffer_store_dwordx4 v[156:159], v27, s[4:7], s90 offen
    v_mfma_f32_16x16x32_bf16 v[84:87], a[176:179], v[124:127], v[84:87]
    s_waitcnt vmcnt(16)
    s_barrier
    ds_read_b128 v[112:115], v6 offset:0
    v_mfma_f32_16x16x32_bf16 v[88:91], a[180:183], v[124:127], v[88:91]
    buffer_load_dwordx4 v[240:243], v1, s[4:7], s33 offen offset:3072
    v_mfma_f32_16x16x32_bf16 v[92:95], a[184:187], v[124:127], v[92:95]
    s_waitcnt lgkmcnt(3)
    v_mul_f32 v68, v68, abs(v68)
    v_mul_f32 v69, v69, abs(v69)
    v_mfma_f32_16x16x32_bf16 v[84:87], a[188:191], v[96:99], v[84:87]
    ds_read_b128 v[116:119], v6 offset:2048
    v_mul_f32 v70, v70, abs(v70)
    v_mfma_f32_16x16x32_bf16 v[88:91], a[0:3], v[96:99], v[88:91]
    v_mul_f32 v71, v71, abs(v71)
    v_cvt_pk_bf16_f32 v160, v68, v69
    v_mfma_f32_16x16x32_bf16 v[92:95], a[4:7], v[96:99], v[92:95]
    buffer_load_dwordx4 v[236:239], v2, s[4:7], s33 offen offset:0
    v_mfma_f32_16x16x32_bf16 v[84:87], a[8:11], v[100:103], v[84:87]
    ds_read_b128 v[120:123], v6 offset:4096
    v_cvt_pk_bf16_f32 v161, v70, v71
    v_mfma_f32_16x16x32_bf16 v[88:91], a[12:15], v[100:103], v[88:91]
    v_pk_max_i16 v160, v160, 0
    v_pk_max_i16 v161, v161, 0
    v_mfma_f32_16x16x32_bf16 v[92:95], a[16:19], v[100:103], v[92:95]
    s_waitcnt lgkmcnt(3)
    buffer_load_dwordx4 v[232:235], v2, s[4:7], s33 offen offset:1024
    v_mfma_f32_16x16x32_bf16 v[84:87], a[20:23], v[104:107], v[84:87]
    ds_read_b128 v[124:127], v6 offset:6144
    v_mfma_f32_16x16x32_bf16 v[88:91], a[24:27], v[104:107], v[88:91]
    ds_write_b128 v18, v[72:75] offset:0
    v_mfma_f32_16x16x32_bf16 v[92:95], a[28:31], v[104:107], v[92:95]
    v_mfma_f32_16x16x32_bf16 v[84:87], a[32:35], v[108:111], v[84:87]
    ds_read_b128 v[96:99], v6 offset:8192
    v_mfma_f32_16x16x32_bf16 v[88:91], a[36:39], v[108:111], v[88:91]
    buffer_load_dwordx4 v[228:231], v2, s[4:7], s33 offen offset:2048
    v_mfma_f32_16x16x32_bf16 v[92:95], a[40:43], v[108:111], v[92:95]
    s_waitcnt lgkmcnt(4)
    ds_write_b128 v18, v[76:79] offset:1024
    ds_write_b128 v18, v[80:83] offset:2048
    v_mfma_f32_16x16x32_bf16 v[48:51], v[216:219], v[112:115], 0
    ds_read_b128 v[100:103], v6 offset:10240
    v_mfma_f32_16x16x32_bf16 v[52:55], v[212:215], v[112:115], 0
    buffer_load_dwordx4 v[224:227], v2, s[4:7], s33 offen offset:3072
    v_mfma_f32_16x16x32_bf16 v[56:59], v[208:211], v[112:115], 0
    v_mfma_f32_16x16x32_bf16 v[48:51], v[204:207], v[116:119], v[48:51]
    ds_read_b128 v[104:107], v6 offset:12288
    v_mfma_f32_16x16x32_bf16 v[52:55], v[200:203], v[116:119], v[52:55]
    buffer_load_dwordx4 v[220:223], v3, s[4:7], s33 offen offset:0
    v_mfma_f32_16x16x32_bf16 v[56:59], v[196:199], v[116:119], v[56:59]
    s_waitcnt lgkmcnt(6)
    ds_write_b128 v18, v[84:87] offset:3072
    ds_write_b128 v18, v[88:91] offset:4096
    ds_write_b128 v18, v[92:95] offset:5120
    buffer_store_dwordx2 v[160:161], v26, s[4:7], s90 offen offset:1024
    v_mfma_f32_16x16x32_bf16 v[48:51], v[192:195], v[120:123], v[48:51]
    ds_read_b128 v[108:111], v6 offset:14336
    v_mfma_f32_16x16x32_bf16 v[52:55], v[188:191], v[120:123], v[52:55]
    v_mov_b32 v30, 10
    s_mov_b64 exec, 1
    s_cmp_lg_u32 s28, 0
    s_waitcnt vmcnt(0)
    s_cbranch_scc1 pubs_141
    buffer_store_dword v30, off, s[4:7], s32
pubd_142:
    s_mov_b64 exec, -1
    v_mfma_f32_16x16x32_bf16 v[56:59], v[184:187], v[120:123], v[56:59]
    v_add_f32 v144, v144, v146
    v_add_f32 v145, v145, v147
    v_mfma_f32_16x16x32_bf16 v[48:51], v[180:183], v[124:127], v[48:51]
    ds_read_b128 v[112:115], v6 offset:16384
    v_permlane16_swap_b32 v144, v145
    v_mfma_f32_16x16x32_bf16 v[52:55], v[176:179], v[124:127], v[52:55]
    v_add_f32 v144, v144, v145
    v_mov_b32 v145, v144
    v_mfma_f32_16x16x32_bf16 v[56:59], a[160:163], v[124:127], v[56:59]
    s_waitcnt lgkmcnt(6)
    v_permlane32_swap_b32 v144, v145
    v_add_f32 v144, v144, v145
    v_mfma_f32_16x16x32_bf16 v[48:51], a[164:167], v[96:99], v[48:51]
    ds_read_b128 v[116:119], v6 offset:18432
    v_mov_b32 v145, v144
    v_mfma_f32_16x16x32_bf16 v[52:55], a[168:171], v[96:99], v[52:55]
    s_nop 0
    v_permlane16_swap_b32 v144, v145
    v_mul_f32 v146, s64, v144
    v_mfma_f32_16x16x32_bf16 v[56:59], a[172:175], v[96:99], v[56:59]
    v_mul_f32 v145, s64, v145
    v_fma_f32 v145, -v146, v146, v145
    v_mfma_f32_16x16x32_bf16 v[48:51], a[176:179], v[100:103], v[48:51]
    v_max_f32 v145, 0, v145
    v_add_f32 v145, s65, v145
    v_rsq_f32 v147, v145
    v_add_u32 v144, s0, v17
    ds_write_b64 v144, v[146:147] offset:512
    s_waitcnt lgkmcnt(0)
    s_barrier
    ds_read_b128 v[120:123], v6 offset:20480
    v_mfma_f32_16x16x32_bf16 v[52:55], a[180:183], v[100:103], v[52:55]
    v_add_u32 v46, s69, v17
    ds_read_b64 v[46:47], v46 offset:512
    ds_read_b128 v[72:75], v19 offset:0
    v_mfma_f32_16x16x32_bf16 v[56:59], a[184:187], v[100:103], v[56:59]
    ds_read_b128 v[76:79], v19 offset:1024
    ds_read_b128 v[80:83], v19 offset:2048
    v_add_u32 v162, s69, v17
    v_mfma_f32_16x16x32_bf16 v[48:51], a[188:191], v[104:107], v[48:51]
    ds_read_b128 v[124:127], v6 offset:22528
    ds_read_b64 v[162:163], v162 offset:640
    ds_read_b128 v[84:87], v19 offset:3072
    v_mfma_f32_16x16x32_bf16 v[52:55], a[0:3], v[104:107], v[52:55]
    ds_read_b128 v[88:91], v19 offset:4096
    ds_read_b128 v[92:95], v19 offset:5120
    v_mfma_f32_16x16x32_bf16 v[56:59], a[4:7], v[104:107], v[56:59]
    v_mfma_f32_16x16x32_bf16 v[48:51], a[8:11], v[108:111], v[48:51]
    ds_read_b128 v[96:99], v6 offset:24576
    v_mfma_f32_16x16x32_bf16 v[52:55], a[12:15], v[108:111], v[52:55]
    v_mfma_f32_16x16x32_bf16 v[56:59], a[16:19], v[108:111], v[56:59]
    v_mfma_f32_16x16x32_bf16 v[48:51], a[20:23], v[112:115], v[48:51]
    s_waitcnt lgkmcnt(6)
    ds_read_b128 v[100:103], v6 offset:26624
    v_fma_f32 v72, -v128, v46, v72
    v_fma_f32 v73, -v129, v46, v73
    v_mfma_f32_16x16x32_bf16 v[52:55], a[24:27], v[112:115], v[52:55]
    v_fma_f32 v74, -v130, v46, v74
    v_fma_f32 v75, -v131, v46, v75
    v_fma_f32 v72, v72, v47, v132
    v_mfma_f32_16x16x32_bf16 v[56:59], a[28:31], v[112:115], v[56:59]
    v_fma_f32 v73, v73, v47, v133
    v_fma_f32 v74, v74, v47, v134
    v_mfma_f32_16x16x32_bf16 v[48:51], a[32:35], v[116:119], v[48:51]
    ds_read_b128 v[104:107], v6 offset:28672
    v_fma_f32 v75, v75, v47, v135
    v_mfma_f32_16x16x32_bf16 v[52:55], a[36:39], v[116:119], v[52:55]
    v_fma_f32 v76, -v136, v46, v76
    v_fma_f32 v77, -v137, v46, v77
    v_mfma_f32_16x16x32_bf16 v[56:59], a[40:43], v[116:119], v[56:59]
    s_waitcnt lgkmcnt(7)
    v_fma_f32 v78, -v138, v46, v78
    v_fma_f32 v79, -v139, v46, v79
    v_mfma_f32_16x16x32_bf16 v[60:63], v[216:219], v[120:123], 0
    ds_read_b128 v[108:111], v6 offset:30720
    v_fma_f32 v76, v76, v47, v140
    v_mfma_f32_16x16x32_bf16 v[64:67], v[212:215], v[120:123], 0
    v_fma_f32 v77, v77, v47, v141
    v_fma_f32 v78, v78, v47, v142
    v_mfma_f32_16x16x32_bf16 v[68:71], v[208:211], v[120:123], 0
    buffer_load_dwordx4 v[216:219], v3, s[4:7], s33 offen offset:1024
    v_mfma_f32_16x16x32_bf16 v[60:63], v[204:207], v[124:127], v[60:63]
    ds_read_b128 v[112:115], v6 offset:32768
    v_fma_f32 v79, v79, v47, v143
    v_fma_f32 v80, -v148, v46, v80
    v_mfma_f32_16x16x32_bf16 v[64:67], v[200:203], v[124:127], v[64:67]
    v_fma_f32 v81, -v149, v46, v81
    v_fma_f32 v82, -v150, v46, v82
    v_fma_f32 v83, -v151, v46, v83
    v_mfma_f32_16x16x32_bf16 v[68:71], v[196:199], v[124:127], v[68:71]
    s_waitcnt lgkmcnt(3)
    buffer_load_dwordx4 v[212:215], v3, s[4:7], s33 offen offset:2048
    v_fma_f32 v80, v80, v47, v152
    v_mfma_f32_16x16x32_bf16 v[60:63], v[192:195], v[96:99], v[60:63]
    ds_read_b128 v[116:119], v6 offset:34816
    v_fma_f32 v81, v81, v47, v153
    v_fma_f32 v82, v82, v47, v154
    v_mfma_f32_16x16x32_bf16 v[64:67], v[188:191], v[96:99], v[64:67]
    v_fma_f32 v83, v83, v47, v155
    v_fma_f32 v84, -v128, v162, v84
    v_fma_f32 v85, -v129, v162, v85
    v_mfma_f32_16x16x32_bf16 v[68:71], v[184:187], v[96:99], v[68:71]
    buffer_load_dwordx4 v[208:211], v3, s[4:7], s33 offen offset:3072
    v_fma_f32 v86, -v130, v162, v86
    v_mfma_f32_16x16x32_bf16 v[60:63], v[180:183], v[100:103], v[60:63]
    ds_read_b128 v[120:123], v6 offset:36864
    v_fma_f32 v87, -v131, v162, v87
    v_fma_f32 v84, v84, v163, v132
    v_mfma_f32_16x16x32_bf16 v[64:67], v[176:179], v[100:103], v[64:67]
    v_fma_f32 v85, v85, v163, v133
    v_fma_f32 v86, v86, v163, v134
    v_fma_f32 v87, v87, v163, v135
    v_mfma_f32_16x16x32_bf16 v[68:71], a[160:163], v[100:103], v[68:71]
    s_waitcnt lgkmcnt(3)
    v_fma_f32 v88, -v136, v162, v88
    v_fma_f32 v89, -v137, v162, v89
    v_fma_f32 v90, -v138, v162, v90
    v_mfma_f32_16x16x32_bf16 v[60:63], a[164:167], v[104:107], v[60:63]
    ds_read_b128 v[124:127], v6 offset:38912
    v_fma_f32 v91, -v139, v162, v91
    v_fma_f32 v88, v88, v163, v140
    v_mfma_f32_16x16x32_bf16 v[64:67], a[168:171], v[104:107], v[64:67]
    v_fma_f32 v89, v89, v163, v141
    v_fma_f32 v90, v90, v163, v142
    v_fma_f32 v91, v91, v163, v143
    v_mfma_f32_16x16x32_bf16 v[68:71], a[172:175], v[104:107], v[68:71]
    v_fma_f32 v92, -v148, v162, v92
    v_fma_f32 v93, -v149, v162, v93
    v_fma_f32 v94, -v150, v162, v94
    v_mfma_f32_16x16x32_bf16 v[60:63], a[176:179], v[108:111], v[60:63]
    v_fma_f32 v95, -v151, v162, v95
    v_fma_f32 v92, v92, v163, v152
    v_fma_f32 v93, v93, v163, v153
    v_mfma_f32_16x16x32_bf16 v[64:67], a[180:183], v[108:111], v[64:67]
    v_fma_f32 v94, v94, v163, v154
    v_fma_f32 v95, v95, v163, v155
    v_mfma_f32_16x16x32_bf16 v[68:71], a[184:187], v[108:111], v[68:71]
    s_waitcnt lgkmcnt(2)
    s_add_u32 s90, s94, 3145728
    v_fma_f32 v48, v48, v47, v72
    v_mfma_f32_16x16x32_bf16 v[60:63], a[188:191], v[112:115], v[60:63]
    v_fma_f32 v49, v49, v47, v73
    v_fma_f32 v50, v50, v47, v74
    v_mfma_f32_16x16x32_bf16 v[64:67], a[0:3], v[112:115], v[64:67]
    v_fma_f32 v51, v51, v47, v75
    v_fma_f32 v52, v52, v47, v76
    v_mfma_f32_16x16x32_bf16 v[68:71], a[4:7], v[112:115], v[68:71]
    v_fma_f32 v53, v53, v47, v77
    v_fma_f32 v54, v54, v47, v78
    v_mfma_f32_16x16x32_bf16 v[60:63], a[8:11], v[116:119], v[60:63]
    v_fma_f32 v55, v55, v47, v79
    v_fma_f32 v56, v56, v47, v80
    v_mfma_f32_16x16x32_bf16 v[64:67], a[12:15], v[116:119], v[64:67]
    v_fma_f32 v57, v57, v47, v81
    v_fma_f32 v58, v58, v47, v82
    v_mfma_f32_16x16x32_bf16 v[68:71], a[16:19], v[116:119], v[68:71]
    s_waitcnt lgkmcnt(0)
    v_fma_f32 v59, v59, v47, v83
    v_mul_f32 v48, v48, abs(v48)
    v_mfma_f32_16x16x32_bf16 v[60:63], a[20:23], v[120:123], v[60:63]
    v_mul_f32 v49, v49, abs(v49)
    v_mul_f32 v50, v50, abs(v50)
    v_mfma_f32_16x16x32_bf16 v[64:67], a[24:27], v[120:123], v[64:67]
    v_mul_f32 v51, v51, abs(v51)
    v_cvt_pk_bf16_f32 v156, v48, v49
    v_mfma_f32_16x16x32_bf16 v[68:71], a[28:31], v[120:123], v[68:71]
    v_cvt_pk_bf16_f32 v157, v50, v51
    v_pk_max_i16 v156, v156, 0
    v_mfma_f32_16x16x32_bf16 v[60:63], a[32:35], v[124:127], v[60:63]
    v_pk_max_i16 v157, v157, 0
    v_mul_f32 v52, v52, abs(v52)
    v_mfma_f32_16x16x32_bf16 v[64:67], a[36:39], v[124:127], v[64:67]
    v_mul_f32 v53, v53, abs(v53)
    v_mul_f32 v54, v54, abs(v54)
    v_mfma_f32_16x16x32_bf16 v[68:71], a[40:43], v[124:127], v[68:71]
    v_mul_f32 v55, v55, abs(v55)
    v_cvt_pk_bf16_f32 v158, v52, v53
    v_cvt_pk_bf16_f32 v159, v54, v55
    v_pk_max_i16 v158, v158, 0
    v_pk_max_i16 v159, v159, 0
    buffer_store_dwordx4 v[156:159], v27, s[4:7], s90 offen
    v_mul_f32 v56, v56, abs(v56)
    v_mul_f32 v57, v57, abs(v57)
    v_mul_f32 v58, v58, abs(v58)
    v_mul_f32 v59, v59, abs(v59)
    v_cvt_pk_bf16_f32 v160, v56, v57
    v_cvt_pk_bf16_f32 v161, v58, v59
    v_pk_max_i16 v160, v160, 0
    v_pk_max_i16 v161, v161, 0
    buffer_store_dwordx2 v[160:161], v26, s[4:7], s90 offen offset:1024
    s_add_u32 s90, s94, 3194880
    v_pk_fma_f32 v[60:61], v[60:61], v[162:163], v[84:85] op_sel:[0,1,0] op_sel_hi:[1,1,1]
    v_pk_fma_f32 v[62:63], v[62:63], v[162:163], v[86:87] op_sel:[0,1,0] op_sel_hi:[1,1,1]
    v_pk_fma_f32 v[64:65], v[64:65], v[162:163], v[88:89] op_sel:[0,1,0] op_sel_hi:[1,1,1]
    v_pk_fma_f32 v[66:67], v[66:67], v[162:163], v[90:91] op_sel:[0,1,0] op_sel_hi:[1,1,1]
    v_pk_fma_f32 v[68:69], v[68:69], v[162:163], v[92:93] op_sel:[0,1,0] op_sel_hi:[1,1,1]
    v_pk_fma_f32 v[70:71], v[70:71], v[162:163], v[94:95] op_sel:[0,1,0] op_sel_hi:[1,1,1]
    v_mul_f32 v60, v60, abs(v60)
    v_mul_f32 v61, v61, abs(v61)
    v_mul_f32 v62, v62, abs(v62)
    v_mul_f32 v63, v63, abs(v63)
    v_cvt_pk_bf16_f32 v156, v60, v61
    v_cvt_pk_bf16_f32 v157, v62, v63
    v_pk_max_i16 v156, v156, 0
    v_pk_max_i16 v157, v157, 0
    v_mul_f32 v64, v64, abs(v64)
    v_mul_f32 v65, v65, abs(v65)
    v_mul_f32 v66, v66, abs(v66)
    v_mul_f32 v67, v67, abs(v67)
    v_cvt_pk_bf16_f32 v158, v64, v65
    v_cvt_pk_bf16_f32 v159, v66, v67
    v_pk_max_i16 v158, v158, 0
    v_pk_max_i16 v159, v159, 0
    buffer_store_dwordx4 v[156:159], v27, s[4:7], s90 offen
    v_mul_f32 v68, v68, abs(v68)
    v_mul_f32 v69, v69, abs(v69)
    v_mul_f32 v70, v70, abs(v70)
    v_mul_f32 v71, v71, abs(v71)
    v_cvt_pk_bf16_f32 v160, v68, v69
    v_cvt_pk_bf16_f32 v161, v70, v71
    v_pk_max_i16 v160, v160, 0
    v_pk_max_i16 v161, v161, 0
    buffer_store_dwordx2 v[160:161], v26, s[4:7], s90 offen offset:1024
    v_mov_b32 v30, 11
    s_mov_b64 exec, 1
    s_cmp_lg_u32 s28, 0
    s_waitcnt vmcnt(0)
    s_cbranch_scc1 pubs_143
    buffer_store_dword v30, off, s[4:7], s32
pubd_144:
    s_mov_b64 exec, -1
    s_barrier
    buffer_load_dword v29, v5, s[4:7], s31 offen sc1
    s_waitcnt vmcnt(0)
poll_146:
    v_cmp_le_u32 vcc, 11, v29
    s_nop 0
    s_andn2_b64 s[56:57], s[34:35], vcc
    s_cbranch_scc1 pollr_145
    s_cmp_lg_u32 s28, 0
    s_cbranch_scc1 acq_147
polld_148:
    s_add_u32 m0, s83, 4096
    s_nop 0
    buffer_load_dwordx4 v1, s[4:7], s79 offen offset:0 sc1 lds
    s_add_u32 m0, s83, 5120
    s_nop 0
    buffer_load_dwordx4 v1, s[4:7], s80 offen offset:0 sc1 lds
    s_add_u32 m0, s83, 6144
    s_nop 0
    buffer_load_dwordx4 v1, s[4:7], s81 offen offset:0 sc1 lds
    s_add_u32 m0, s83, 6144
    s_nop 0
    buffer_load_dwordx4 v1, s[4:7], s79 offen offset:1024 sc1 lds
    s_add_u32 m0, s83, 7168
    s_nop 0
    buffer_load_dwordx4 v1, s[4:7], s80 offen offset:1024 sc1 lds
    s_add_u32 m0, s83, 8192
    s_nop 0
    buffer_load_dwordx4 v1, s[4:7], s81 offen offset:1024 sc1 lds
    s_add_u32 m0, s83, 10240
    s_nop 0
    buffer_load_dwordx4 v1, s[4:7], s78 offen offset:0 sc1 lds
    s_add_u32 m0, s83, 10240
    s_nop 0
    buffer_load_dwordx4 v1, s[4:7], s78 offen offset:1024 sc1 lds
    s_waitcnt vmcnt(7)
    ds_read_b128 v[128:131], v33 offset:0
    s_waitcnt vmcnt(6)
    ds_read_b128 v[132:135], v33 offset:1024
    s_waitcnt vmcnt(5)
    ds_read_b128 v[136:139], v33 offset:2048
    s_waitcnt lgkmcnt(2)
    v_mfma_f32_16x16x32_bf16 v[68:71], a[44:47], v[128:131], 0
    s_add_u32 m0, s83, 10240
    s_waitcnt vmcnt(4)
    ds_read_b128 v[140:143], v33 offset:3072
    v_mfma_f32_16x16x32_bf16 v[72:75], a[48:51], v[128:131], 0
    buffer_load_dwordx4 v1, s[4:7], s79 offen offset:2048 sc1 lds
    v_mfma_f32_16x16x32_bf16 v[76:79], a[52:55], v[128:131], 0
    s_add_u32 m0, s83, 11264
    s_nop 0
    buffer_load_dwordx4 v1, s[4:7], s80 offen offset:2048 sc1 lds
    v_mfma_f32_16x16x32_bf16 v[80:83], a[56:59], v[128:131], 0
    s_add_u32 m0, s83, 12288
    ds_read_b128 v[144:147], v24 offset:1536
    ds_read_b128 v[148:151], v24 offset:1600
    v_mfma_f32_16x16x32_bf16 v[84:87], a[60:63], v[128:131], 0
    s_waitcnt lgkmcnt(4)
    buffer_load_dwordx4 v1, s[4:7], s81 offen offset:2048 sc1 lds
    v_mfma_f32_16x16x32_bf16 v[88:91], a[44:47], v[132:135], 0
    s_add_u32 m0, s83, 13312
    s_waitcnt vmcnt(6)
    ds_read_b128 v[128:131], v33 offset:4096
    v_mfma_f32_16x16x32_bf16 v[92:95], a[48:51], v[132:135], 0
    buffer_load_dwordx4 v1, s[4:7], s78 offen offset:2048 sc1 lds
    v_mfma_f32_16x16x32_bf16 v[96:99], a[52:55], v[132:135], 0
    s_add_u32 m0, s83, 13312
    s_nop 0
    buffer_load_dwordx4 v1, s[4:7], s79 offen offset:3072 sc1 lds
    v_mfma_f32_16x16x32_bf16 v[100:103], a[56:59], v[132:135], 0
    s_add_u32 m0, s83, 14336
    ds_read_b128 v[152:155], v24 offset:1664
    ds_read_b128 v[156:159], v24 offset:1728
    v_mfma_f32_16x16x32_bf16 v[104:107], a[60:63], v[132:135], 0
    s_waitcnt lgkmcnt(6)
    ds_read_b128 v[160:163], v24 offset:1792
    v_lshlrev_b32 v48, 16, v36
    v_mfma_f32_16x16x32_bf16 v[108:111], a[44:47], v[136:139], 0
    s_waitcnt vmcnt(7)
    ds_read_b128 v[132:135], v33 offset:5120
    v_and_b32 v49, 0xffff0000, v36
    v_mfma_f32_16x16x32_bf16 v[112:115], a[48:51], v[136:139], 0
    buffer_load_dwordx4 v1, s[4:7], s80 offen offset:3072 sc1 lds
    v_mfma_f32_16x16x32_bf16 v[116:119], a[52:55], v[136:139], 0
    s_add_u32 m0, s83, 15360
    v_lshlrev_b32 v50, 16, v37
    v_and_b32 v51, 0xffff0000, v37
    v_mfma_f32_16x16x32_bf16 v[120:123], a[56:59], v[136:139], 0
    v_lshlrev_b32 v52, 16, v38
    v_and_b32 v53, 0xffff0000, v38
    v_mfma_f32_16x16x32_bf16 v[124:127], a[60:63], v[136:139], 0
    s_waitcnt lgkmcnt(7)
    buffer_load_dwordx4 v1, s[4:7], s81 offen offset:3072 sc1 lds
    v_mfma_f32_16x16x32_bf16 v[68:71], a[64:67], v[140:143], v[68:71]
    s_add_u32 m0, s83, 16384
    s_waitcnt vmcnt(8)
    ds_read_b128 v[136:139], v33 offset:6144
    v_mfma_f32_16x16x32_bf16 v[72:75], a[68:71], v[140:143], v[72:75]
    v_lshlrev_b32 v54, 16, v39
    v_and_b32 v55, 0xffff0000, v39
    v_mfma_f32_16x16x32_bf16 v[76:79], a[72:75], v[140:143], v[76:79]
    buffer_load_dwordx4 v1, s[4:7], s78 offen offset:3072 sc1 lds
    v_mfma_f32_16x16x32_bf16 v[80:83], a[76:79], v[140:143], v[80:83]
    s_add_u32 m0, s83, 20480
    v_lshlrev_b32 v56, 16, v40
    v_and_b32 v57, 0xffff0000, v40
    v_mfma_f32_16x16x32_bf16 v[84:87], a[80:83], v[140:143], v[84:87]
    s_waitcnt lgkmcnt(5)
    v_lshlrev_b32 v58, 16, v41
    v_and_b32 v59, 0xffff0000, v41
    v_mfma_f32_16x16x32_bf16 v[88:91], a[64:67], v[128:131], v[88:91]
    s_waitcnt vmcnt(8)
    ds_read_b128 v[140:143], v33 offset:7168
    v_lshlrev_b32 v60, 16, v42
    v_mfma_f32_16x16x32_bf16 v[92:95], a[68:71], v[128:131], v[92:95]
    buffer_load_dwordx4 v2, s[4:7], s79 offen offset:0 sc1 lds
    v_mfma_f32_16x16x32_bf16 v[96:99], a[72:75], v[128:131], v[96:99]
    s_add_u32 m0, s83, 21504
    v_and_b32 v61, 0xffff0000, v42
    v_lshlrev_b32 v62, 16, v43
    v_mfma_f32_16x16x32_bf16 v[100:103], a[76:79], v[128:131], v[100:103]
    v_and_b32 v63, 0xffff0000, v43
    v_lshlrev_b32 v64, 16, v44
    v_mfma_f32_16x16x32_bf16 v[104:107], a[80:83], v[128:131], v[104:107]
    s_waitcnt lgkmcnt(2)
    buffer_load_dwordx4 v2, s[4:7], s80 offen offset:0 sc1 lds
    v_mfma_f32_16x16x32_bf16 v[108:111], a[64:67], v[132:135], v[108:111]
    s_add_u32 m0, s83, 22528
    s_waitcnt vmcnt(9)
    ds_read_b128 v[128:131], v33 offset:8192
    v_mfma_f32_16x16x32_bf16 v[112:115], a[68:71], v[132:135], v[112:115]
    v_and_b32 v65, 0xffff0000, v44
    v_lshlrev_b32 v66, 16, v45
    v_mfma_f32_16x16x32_bf16 v[116:119], a[72:75], v[132:135], v[116:119]
    v_and_b32 v67, 0xffff0000, v45
    v_add_f32 v48, v48, v144
    v_mfma_f32_16x16x32_bf16 v[120:123], a[76:79], v[132:135], v[120:123]
    buffer_load_dwordx4 v2, s[4:7], s81 offen offset:0 sc1 lds
    v_mfma_f32_16x16x32_bf16 v[124:127], a[80:83], v[132:135], v[124:127]
    s_waitcnt lgkmcnt(2)
    v_add_f32 v49, v49, v145
    v_add_f32 v50, v50, v146
    v_add_f32 v51, v51, v147
    v_add_f32 v52, v52, v148
    v_add_f32 v53, v53, v149
    v_add_f32 v54, v54, v150
    v_add_f32 v55, v55, v151
    v_add_f32 v56, v56, v152
    v_add_f32 v57, v57, v153
    v_add_f32 v58, v58, v154
    v_add_f32 v59, v59, v155
    v_add_f32 v60, v60, v156
    v_add_f32 v61, v61, v157
    v_add_f32 v62, v62, v158
    v_add_f32 v63, v63, v159
    v_add_f32 v64, v64, v160
    v_add_f32 v65, v65, v161
    v_add_f32 v66, v66, v162
    v_add_f32 v67, v67, v163
    v_mfma_f32_16x16x32_bf16 v[48:51], a[44:47], v[136:139], v[48:51]
    s_add_u32 m0, s83, 23552
    s_waitcnt vmcnt(9)
    ds_read_b128 v[132:135], v33 offset:9216
    v_mfma_f32_16x16x32_bf16 v[52:55], a[48:51], v[136:139], v[52:55]
    buffer_load_dwordx4 v2, s[4:7], s78 offen offset:0 sc1 lds
    v_mfma_f32_16x16x32_bf16 v[56:59], a[52:55], v[136:139], v[56:59]
    s_add_u32 m0, s83, 3072
    v_lshrrev_b32 v144, 2, v5
    v_and_b32 v144, 15, v144
    v_mfma_f32_16x16x32_bf16 v[60:63], a[56:59], v[136:139], v[60:63]
    v_mul_u32_u24 v144, 1280, v144
    v_add_u32 v144, v144, v24
    v_mfma_f32_16x16x32_bf16 v[64:67], a[60:63], v[136:139], v[64:67]
    s_waitcnt lgkmcnt(2)
    v_sub_u32 v145, v25, v1
    v_add_u32 v145, v145, v144
    v_mfma_f32_16x16x32_bf16 v[48:51], a[64:67], v[140:143], v[48:51]
    s_add_u32 s89, s68, s24
    s_waitcnt vmcnt(9)
    ds_read_b128 v[136:139], v33 offset:10240
    v_mfma_f32_16x16x32_bf16 v[52:55], a[68:71], v[140:143], v[52:55]
    s_mul_i32 s90, s89, 20480
    buffer_load_dwordx4 v2, s[4:7], s79 offen offset:1024 sc1 lds
    v_mfma_f32_16x16x32_bf16 v[56:59], a[72:75], v[140:143], v[56:59]
    s_add_u32 m0, s83, 4096
    s_add_u32 s90, s90, 7372800
    s_add_u32 s89, s24, 2
    v_mfma_f32_16x16x32_bf16 v[60:63], a[76:79], v[140:143], v[60:63]
    s_and_b32 s89, s89, 3
    s_lshl_b32 s91, s25, 3
    s_add_u32 s89, s89, s91
    v_mfma_f32_16x16x32_bf16 v[64:67], a[80:83], v[140:143], v[64:67]
    s_waitcnt lgkmcnt(2)
    buffer_load_dwordx4 v2, s[4:7], s80 offen offset:1024 sc1 lds
    v_mfma_f32_16x16x32_bf16 v[68:71], a[84:87], v[128:131], v[68:71]
    s_add_u32 m0, s83, 5120
    s_waitcnt vmcnt(10)
    ds_read_b128 v[140:143], v33 offset:11264
    v_mfma_f32_16x16x32_bf16 v[72:75], v[164:167], v[128:131], v[72:75]
    s_mul_i32 s89, s89, 20480
    s_sub_u32 s91, s95, s90
    s_lshr_b32 s91, s91, 4
    v_mfma_f32_16x16x32_bf16 v[76:79], v[168:171], v[128:131], v[76:79]
    s_add_u32 s91, s91, s89
    buffer_load_dwordx4 v2, s[4:7], s81 offen offset:1024 sc1 lds
    v_mfma_f32_16x16x32_bf16 v[80:83], v[172:175], v[128:131], v[80:83]
    s_add_u32 m0, s83, 6144
    s_sub_u32 s92, s96, s90
    s_lshr_b32 s92, s92, 4
    v_mfma_f32_16x16x32_bf16 v[84:87], a[88:91], v[128:131], v[84:87]
    s_waitcnt lgkmcnt(2)
    s_add_u32 s92, s92, s89
    v_mfma_f32_16x16x32_bf16 v[88:91], a[84:87], v[132:135], v[88:91]
    s_waitcnt vmcnt(10)
    ds_read_b128 v[128:131], v33 offset:12288
    v_mfma_f32_16x16x32_bf16 v[92:95], v[164:167], v[132:135], v[92:95]
    buffer_load_dwordx4 v2, s[4:7], s78 offen offset:1024 sc1 lds
    v_mfma_f32_16x16x32_bf16 v[96:99], v[168:171], v[132:135], v[96:99]
    s_add_u32 m0, s83, 6144
    v_mfma_f32_16x16x32_bf16 v[100:103], v[172:175], v[132:135], v[100:103]
    v_mfma_f32_16x16x32_bf16 v[104:107], a[88:91], v[132:135], v[104:107]
    s_waitcnt lgkmcnt(2)
    buffer_load_dwordx4 v2, s[4:7], s79 offen offset:2048 sc1 lds
    v_mfma_f32_16x16x32_bf16 v[108:111], a[84:87], v[136:139], v[108:111]
    s_add_u32 m0, s83, 7168
    s_waitcnt vmcnt(11)
    ds_read_b128 v[132:135], v33 offset:13312
    v_mfma_f32_16x16x32_bf16 v[112:115], v[164:167], v[136:139], v[112:115]
    v_mfma_f32_16x16x32_bf16 v[116:119], v[168:171], v[136:139], v[116:119]
    v_mfma_f32_16x16x32_bf16 v[120:123], v[172:175], v[136:139], v[120:123]
    buffer_load_dwordx4 v2, s[4:7], s80 offen offset:2048 sc1 lds
    v_mfma_f32_16x16x32_bf16 v[124:127], a[88:91], v[136:139], v[124:127]
    s_waitcnt lgkmcnt(2)
    v_mfma_f32_16x16x32_bf16 v[48:51], a[84:87], v[140:143], v[48:51]
    s_add_u32 m0, s83, 8192
    s_waitcnt vmcnt(11)
    ds_read_b128 v[136:139], v33 offset:14336
    v_mfma_f32_16x16x32_bf16 v[52:55], v[164:167], v[140:143], v[52:55]
    buffer_load_dwordx4 v2, s[4:7], s81 offen offset:2048 sc1 lds
    v_mfma_f32_16x16x32_bf16 v[56:59], v[168:171], v[140:143], v[56:59]
    s_add_u32 m0, s83, 9216
    v_mfma_f32_16x16x32_bf16 v[60:63], v[172:175], v[140:143], v[60:63]
    v_mfma_f32_16x16x32_bf16 v[64:67], a[88:91], v[140:143], v[64:67]
    s_waitcnt lgkmcnt(2)
    v_mfma_f32_16x16x32_bf16 v[68:71], a[92:95], v[128:131], v[68:71]
    s_waitcnt vmcnt(11)
    ds_read_b128 v[140:143], v33 offset:15360
    v_mfma_f32_16x16x32_bf16 v[72:75], a[96:99], v[128:131], v[72:75]
    buffer_load_dwordx4 v2, s[4:7], s78 offen offset:2048 sc1 lds
    v_mfma_f32_16x16x32_bf16 v[76:79], a[100:103], v[128:131], v[76:79]
    s_add_u32 m0, s83, 9216
    v_mfma_f32_16x16x32_bf16 v[80:83], a[104:107], v[128:131], v[80:83]
    v_mfma_f32_16x16x32_bf16 v[84:87], a[108:111], v[128:131], v[84:87]
    s_waitcnt lgkmcnt(2)
    buffer_load_dwordx4 v2, s[4:7], s79 offen offset:3072 sc1 lds
    v_mfma_f32_16x16x32_bf16 v[88:91], a[92:95], v[132:135], v[88:91]
    s_add_u32 m0, s83, 10240
    s_waitcnt vmcnt(12)
    ds_read_b128 v[128:131], v33 offset:16384
    v_mfma_f32_16x16x32_bf16 v[92:95], a[96:99], v[132:135], v[92:95]
    v_mfma_f32_16x16x32_bf16 v[96:99], a[100:103], v[132:135], v[96:99]
    buffer_load_dwordx4 v2, s[4:7], s80 offen offset:3072 sc1 lds
    v_mfma_f32_16x16x32_bf16 v[100:103], a[104:107], v[132:135], v[100:103]
    s_add_u32 m0, s83, 11264
    v_mfma_f32_16x16x32_bf16 v[104:107], a[108:111], v[132:135], v[104:107]
    s_waitcnt lgkmcnt(2)
    v_mfma_f32_16x16x32_bf16 v[108:111], a[92:95], v[136:139], v[108:111]
    s_waitcnt vmcnt(12)
    ds_read_b128 v[132:135], v33 offset:17408
    v_mfma_f32_16x16x32_bf16 v[112:115], a[96:99], v[136:139], v[112:115]
    buffer_load_dwordx4 v2, s[4:7], s81 offen offset:3072 sc1 lds
    v_mfma_f32_16x16x32_bf16 v[116:119], a[100:103], v[136:139], v[116:119]
    s_add_u32 m0, s83, 12288
    v_mfma_f32_16x16x32_bf16 v[120:123], a[104:107], v[136:139], v[120:123]
    v_mfma_f32_16x16x32_bf16 v[124:127], a[108:111], v[136:139], v[124:127]
    s_waitcnt lgkmcnt(2)
    buffer_load_dwordx4 v2, s[4:7], s78 offen offset:3072 sc1 lds
    v_mfma_f32_16x16x32_bf16 v[48:51], a[92:95], v[140:143], v[48:51]
    s_add_u32 m0, s83, 16384
    s_waitcnt vmcnt(13)
    ds_read_b128 v[136:139], v33 offset:18432
    v_mfma_f32_16x16x32_bf16 v[52:55], a[96:99], v[140:143], v[52:55]
    v_mfma_f32_16x16x32_bf16 v[56:59], a[100:103], v[140:143], v[56:59]
    v_mfma_f32_16x16x32_bf16 v[60:63], a[104:107], v[140:143], v[60:63]
    buffer_load_dwordx4 v3, s[4:7], s79 offen offset:0 sc1 lds
    v_mfma_f32_16x16x32_bf16 v[64:67], a[108:111], v[140:143], v[64:67]
    s_waitcnt lgkmcnt(2)
    v_mfma_f32_16x16x32_bf16 v[68:71], a[112:115], v[128:131], v[68:71]
    s_add_u32 m0, s83, 16384
    s_waitcnt vmcnt(13)
    ds_read_b128 v[140:143], v33 offset:19456
    v_mfma_f32_16x16x32_bf16 v[72:75], a[116:119], v[128:131], v[72:75]
    buffer_load_dwordx4 v3, s[4:7], s79 offen offset:1024 sc1 lds
    v_mfma_f32_16x16x32_bf16 v[76:79], a[120:123], v[128:131], v[76:79]
    s_add_u32 m0, s83, 16384
    v_mfma_f32_16x16x32_bf16 v[80:83], a[124:127], v[128:131], v[80:83]
    v_mfma_f32_16x16x32_bf16 v[84:87], a[128:131], v[128:131], v[84:87]
    s_waitcnt lgkmcnt(2)
    v_mfma_f32_16x16x32_bf16 v[88:91], a[112:115], v[132:135], v[88:91]
    s_waitcnt vmcnt(13)
    ds_read_b128 v[128:131], v33 offset:0
    v_mfma_f32_16x16x32_bf16 v[92:95], a[116:119], v[132:135], v[92:95]
    buffer_load_dwordx4 v3, s[4:7], s79 offen offset:2048 sc1 lds
    v_mfma_f32_16x16x32_bf16 v[96:99], a[120:123], v[132:135], v[96:99]
    s_add_u32 m0, s83, 16384
    v_mfma_f32_16x16x32_bf16 v[100:103], a[124:127], v[132:135], v[100:103]
    v_mfma_f32_16x16x32_bf16 v[104:107], a[128:131], v[132:135], v[104:107]
    s_waitcnt lgkmcnt(2)
    buffer_load_dwordx4 v3, s[4:7], s79 offen offset:3072 sc1 lds
    v_mfma_f32_16x16x32_bf16 v[108:111], a[112:115], v[136:139], v[108:111]
    s_add_u32 m0, s83, 20480
    s_waitcnt vmcnt(14)
    ds_read_b128 v[132:135], v33 offset:1024
    v_mfma_f32_16x16x32_bf16 v[112:115], a[116:119], v[136:139], v[112:115]
    v_mfma_f32_16x16x32_bf16 v[116:119], a[120:123], v[136:139], v[116:119]
    buffer_load_dwordx4 v3, s[4:7], s80 offen offset:0 sc1 lds
    v_mfma_f32_16x16x32_bf16 v[120:123], a[124:127], v[136:139], v[120:123]
    s_add_u32 m0, s83, 20480
    v_mfma_f32_16x16x32_bf16 v[124:127], a[128:131], v[136:139], v[124:127]
    s_waitcnt lgkmcnt(2)
    v_mfma_f32_16x16x32_bf16 v[48:51], a[112:115], v[140:143], v[48:51]
    s_waitcnt vmcnt(14)
    ds_read_b128 v[136:139], v33 offset:2048
    v_mfma_f32_16x16x32_bf16 v[52:55], a[116:119], v[140:143], v[52:55]
    buffer_load_dwordx4 v3, s[4:7], s80 offen offset:1024 sc1 lds
    v_mfma_f32_16x16x32_bf16 v[56:59], a[120:123], v[140:143], v[56:59]
    s_add_u32 m0, s83, 20480
    v_mfma_f32_16x16x32_bf16 v[60:63], a[124:127], v[140:143], v[60:63]
    v_mfma_f32_16x16x32_bf16 v[64:67], a[128:131], v[140:143], v[64:67]
    s_waitcnt lgkmcnt(2)
    buffer_load_dwordx4 v3, s[4:7], s80 offen offset:2048 sc1 lds
    v_mfma_f32_16x16x32_bf16 v[68:71], a[132:135], v[128:131], v[68:71]
    s_add_u32 m0, s83, 20480
    s_waitcnt vmcnt(15)
    ds_read_b128 v[140:143], v33 offset:3072
    v_mfma_f32_16x16x32_bf16 v[72:75], a[136:139], v[128:131], v[72:75]
    v_mfma_f32_16x16x32_bf16 v[76:79], a[140:143], v[128:131], v[76:79]
    v_mfma_f32_16x16x32_bf16 v[80:83], a[144:147], v[128:131], v[80:83]
    buffer_load_dwordx4 v3, s[4:7], s80 offen offset:3072 sc1 lds
    v_mfma_f32_16x16x32_bf16 v[84:87], a[148:151], v[128:131], v[84:87]
    s_waitcnt lgkmcnt(2)
    v_mfma_f32_16x16x32_bf16 v[88:91], a[132:135], v[132:135], v[88:91]
    s_add_u32 m0, s83, 4096
    s_waitcnt vmcnt(15)
    ds_read_b128 v[128:131], v33 offset:4096
    v_mfma_f32_16x16x32_bf16 v[92:95], a[136:139], v[132:135], v[92:95]
    buffer_load_dwordx4 v3, s[4:7], s81 offen offset:0 sc1 lds
    v_mfma_f32_16x16x32_bf16 v[96:99], a[140:143], v[132:135], v[96:99]
    s_add_u32 m0, s83, 4096
    v_mfma_f32_16x16x32_bf16 v[100:103], a[144:147], v[132:135], v[100:103]
    v_mfma_f32_16x16x32_bf16 v[104:107], a[148:151], v[132:135], v[104:107]
    s_waitcnt lgkmcnt(2)
    v_mfma_f32_16x16x32_bf16 v[108:111], a[132:135], v[136:139], v[108:111]
    s_waitcnt vmcnt(15)
    ds_read_b128 v[132:135], v33 offset:5120
    v_mfma_f32_16x16x32_bf16 v[112:115], a[136:139], v[136:139], v[112:115]
    buffer_load_dwordx4 v3, s[4:7], s81 offen offset:1024 sc1 lds
    v_mfma_f32_16x16x32_bf16 v[116:119], a[140:143], v[136:139], v[116:119]
    s_add_u32 m0, s83, 4096
    v_mfma_f32_16x16x32_bf16 v[120:123], a[144:147], v[136:139], v[120:123]
    v_mfma_f32_16x16x32_bf16 v[124:127], a[148:151], v[136:139], v[124:127]
    s_waitcnt lgkmcnt(2)
    buffer_load_dwordx4 v3, s[4:7], s81 offen offset:2048 sc1 lds
    v_mfma_f32_16x16x32_bf16 v[48:51], a[132:135], v[140:143], v[48:51]
    s_add_u32 m0, s83, 4096
    s_waitcnt vmcnt(16)
    ds_read_b128 v[136:139], v33 offset:6144
    v_mfma_f32_16x16x32_bf16 v[52:55], a[136:139], v[140:143], v[52:55]
    v_mfma_f32_16x16x32_bf16 v[56:59], a[140:143], v[140:143], v[56:59]
    buffer_load_dwordx4 v3, s[4:7], s81 offen offset:3072 sc1 lds
    v_mfma_f32_16x16x32_bf16 v[60:63], a[144:147], v[140:143], v[60:63]
    v_mfma_f32_16x16x32_bf16 v[64:67], a[148:151], v[140:143], v[64:67]
    s_waitcnt lgkmcnt(2)
    v_mfma_f32_16x16x32_bf16 v[68:71], a[152:155], v[128:131], v[68:71]
    s_add_u32 m0, s83, 8192
    s_waitcnt vmcnt(16)
    ds_read_b128 v[140:143], v33 offset:7168
    v_mfma_f32_16x16x32_bf16 v[72:75], a[156:159], v[128:131], v[72:75]
    buffer_load_dwordx4 v3, s[4:7], s78 offen offset:0 sc1 lds
    v_mfma_f32_16x16x32_bf16 v[76:79], a[244:247], v[128:131], v[76:79]
    v_mfma_f32_16x16x32_bf16 v[80:83], a[248:251], v[128:131], v[80:83]
    v_mfma_f32_16x16x32_bf16 v[84:87], a[252:255], v[128:131], v[84:87]
    s_waitcnt lgkmcnt(2)
    v_mfma_f32_16x16x32_bf16 v[88:91], a[152:155], v[132:135], v[88:91]
    s_add_u32 m0, s83, 8192
    s_waitcnt vmcnt(16)
    ds_read_b128 v[128:131], v33 offset:8192
    v_mfma_f32_16x16x32_bf16 v[92:95], a[156:159], v[132:135], v[92:95]
    buffer_load_dwordx4 v3, s[4:7], s78 offen offset:1024 sc1 lds
    v_mfma_f32_16x16x32_bf16 v[96:99], a[244:247], v[132:135], v[96:99]
    v_mfma_f32_16x16x32_bf16 v[100:103], a[248:251], v[132:135], v[100:103]
    v_mfma_f32_16x16x32_bf16 v[104:107], a[252:255], v[132:135], v[104:107]
    s_waitcnt lgkmcnt(2)
    v_mfma_f32_16x16x32_bf16 v[108:111], a[152:155], v[136:139], v[108:111]
    s_add_u32 m0, s83, 8192
    s_waitcnt vmcnt(16)
    ds_read_b128 v[132:135], v33 offset:9216
    v_mfma_f32_16x16x32_bf16 v[112:115], a[156:159], v[136:139], v[112:115]
    buffer_load_dwordx4 v3, s[4:7], s78 offen offset:2048 sc1 lds
    v_mfma_f32_16x16x32_bf16 v[116:119], a[244:247], v[136:139], v[116:119]
    v_mfma_f32_16x16x32_bf16 v[120:123], a[248:251], v[136:139], v[120:123]
    v_mfma_f32_16x16x32_bf16 v[124:127], a[252:255], v[136:139], v[124:127]
    s_waitcnt lgkmcnt(2)
    v_mfma_f32_16x16x32_bf16 v[48:51], a[152:155], v[140:143], v[48:51]
    s_add_u32 m0, s83, 8192
    s_waitcnt vmcnt(16)
    ds_read_b128 v[136:139], v33 offset:10240
    v_mfma_f32_16x16x32_bf16 v[52:55], a[156:159], v[140:143], v[52:55]
    buffer_load_dwordx4 v3, s[4:7], s78 offen offset:3072 sc1 lds
    v_mfma_f32_16x16x32_bf16 v[56:59], a[244:247], v[140:143], v[56:59]
    v_mfma_f32_16x16x32_bf16 v[60:63], a[248:251], v[140:143], v[60:63]
    v_mfma_f32_16x16x32_bf16 v[64:67], a[252:255], v[140:143], v[64:67]
    s_waitcnt lgkmcnt(2)
    v_mfma_f32_16x16x32_bf16 v[68:71], v[252:255], v[128:131], v[68:71]
    s_waitcnt vmcnt(16)
    ds_read_b128 v[140:143], v33 offset:11264
    v_mfma_f32_16x16x32_bf16 v[72:75], a[192:195], v[128:131], v[72:75]
    v_mfma_f32_16x16x32_bf16 v[76:79], a[196:199], v[128:131], v[76:79]
    v_mfma_f32_16x16x32_bf16 v[80:83], a[200:203], v[128:131], v[80:83]
    v_mfma_f32_16x16x32_bf16 v[84:87], a[204:207], v[128:131], v[84:87]
    s_waitcnt lgkmcnt(2)
    v_mfma_f32_16x16x32_bf16 v[88:91], v[252:255], v[132:135], v[88:91]
    s_waitcnt vmcnt(15)
    ds_read_b128 v[128:131], v33 offset:12288
    v_mfma_f32_16x16x32_bf16 v[92:95], a[192:195], v[132:135], v[92:95]
    v_mfma_f32_16x16x32_bf16 v[96:99], a[196:199], v[132:135], v[96:99]
    v_mfma_f32_16x16x32_bf16 v[100:103], a[200:203], v[132:135], v[100:103]
    v_mfma_f32_16x16x32_bf16 v[104:107], a[204:207], v[132:135], v[104:107]
    s_waitcnt lgkmcnt(2)
    v_mfma_f32_16x16x32_bf16 v[108:111], v[252:255], v[136:139], v[108:111]
    s_waitcnt vmcnt(14)
    ds_read_b128 v[132:135], v33 offset:13312
    v_mfma_f32_16x16x32_bf16 v[112:115], a[192:195], v[136:139], v[112:115]
    v_mfma_f32_16x16x32_bf16 v[116:119], a[196:199], v[136:139], v[116:119]
    v_mfma_f32_16x16x32_bf16 v[120:123], a[200:203], v[136:139], v[120:123]
    v_mfma_f32_16x16x32_bf16 v[124:127], a[204:207], v[136:139], v[124:127]
    s_waitcnt lgkmcnt(2)
    v_mfma_f32_16x16x32_bf16 v[48:51], v[252:255], v[140:143], v[48:51]
    s_waitcnt vmcnt(13)
    ds_read_b128 v[136:139], v33 offset:14336
    v_mfma_f32_16x16x32_bf16 v[52:55], a[192:195], v[140:143], v[52:55]
    v_mfma_f32_16x16x32_bf16 v[56:59], a[196:199], v[140:143], v[56:59]
    v_mfma_f32_16x16x32_bf16 v[60:63], a[200:203], v[140:143], v[60:63]
    v_mfma_f32_16x16x32_bf16 v[64:67], a[204:207], v[140:143], v[64:67]
    s_waitcnt lgkmcnt(2)
    v_mfma_f32_16x16x32_bf16 v[68:71], a[208:211], v[128:131], v[68:71]
    s_waitcnt vmcnt(12)
    ds_read_b128 v[140:143], v33 offset:15360
    v_mfma_f32_16x16x32_bf16 v[72:75], a[212:215], v[128:131], v[72:75]
    v_mfma_f32_16x16x32_bf16 v[76:79], a[216:219], v[128:131], v[76:79]
    v_mfma_f32_16x16x32_bf16 v[80:83], a[220:223], v[128:131], v[80:83]
    v_mfma_f32_16x16x32_bf16 v[84:87], a[224:227], v[128:131], v[84:87]
    s_waitcnt lgkmcnt(2)
    v_mfma_f32_16x16x32_bf16 v[68:71], a[228:231], v[132:135], v[68:71]
    s_waitcnt vmcnt(11)
    ds_read_b128 v[128:131], v33 offset:16384
    v_mfma_f32_16x16x32_bf16 v[72:75], a[232:235], v[132:135], v[72:75]
    v_mfma_f32_16x16x32_bf16 v[76:79], a[236:239], v[132:135], v[76:79]
    v_mfma_f32_16x16x32_bf16 v[80:83], a[240:243], v[132:135], v[80:83]
    v_mfma_f32_16x16x32_bf16 v[84:87], v[248:251], v[132:135], v[84:87]
    s_waitcnt lgkmcnt(2)
    v_mfma_f32_16x16x32_bf16 v[68:71], v[244:247], v[136:139], v[68:71]
    s_waitcnt vmcnt(10)
    ds_read_b128 v[132:135], v33 offset:17408
    v_mfma_f32_16x16x32_bf16 v[72:75], v[240:243], v[136:139], v[72:75]
    v_mfma_f32_16x16x32_bf16 v[76:79], v[236:239], v[136:139], v[76:79]
    v_mfma_f32_16x16x32_bf16 v[80:83], v[232:235], v[136:139], v[80:83]
    v_mfma_f32_16x16x32_bf16 v[84:87], v[228:231], v[136:139], v[84:87]
    s_waitcnt lgkmcnt(2)
    v_mfma_f32_16x16x32_bf16 v[68:71], v[224:227], v[140:143], v[68:71]
    s_waitcnt vmcnt(9)
    ds_read_b128 v[136:139], v33 offset:18432
    v_mfma_f32_16x16x32_bf16 v[72:75], v[220:223], v[140:143], v[72:75]
    v_mfma_f32_16x16x32_bf16 v[76:79], v[216:219], v[140:143], v[76:79]
    v_mfma_f32_16x16x32_bf16 v[80:83], v[212:215], v[140:143], v[80:83]
    v_mfma_f32_16x16x32_bf16 v[84:87], v[208:211], v[140:143], v[84:87]
    s_waitcnt lgkmcnt(2)
    v_mfma_f32_16x16x32_bf16 v[88:91], a[208:211], v[128:131], v[88:91]
    s_waitcnt vmcnt(8)
    ds_read_b128 v[140:143], v33 offset:19456
    v_mfma_f32_16x16x32_bf16 v[92:95], a[212:215], v[128:131], v[92:95]
    v_mfma_f32_16x16x32_bf16 v[96:99], a[216:219], v[128:131], v[96:99]
    ds_write_b128 v20, v[68:71] offset:0
    v_mfma_f32_16x16x32_bf16 v[100:103], a[220:223], v[128:131], v[100:103]
    v_mfma_f32_16x16x32_bf16 v[104:107], a[224:227], v[128:131], v[104:107]
    s_waitcnt lgkmcnt(3)
    v_mfma_f32_16x16x32_bf16 v[88:91], a[228:231], v[132:135], v[88:91]
    s_waitcnt vmcnt(7)
    ds_read_b128 v[128:131], v33 offset:0
    v_mfma_f32_16x16x32_bf16 v[92:95], a[232:235], v[132:135], v[92:95]
    ds_write_b128 v20, v[72:75] offset:1024
    v_mfma_f32_16x16x32_bf16 v[96:99], a[236:239], v[132:135], v[96:99]
    v_mfma_f32_16x16x32_bf16 v[100:103], a[240:243], v[132:135], v[100:103]
    v_mfma_f32_16x16x32_bf16 v[104:107], v[248:251], v[132:135], v[104:107]
    s_waitcnt lgkmcnt(4)
    ds_write_b128 v20, v[76:79] offset:2048
    v_mfma_f32_16x16x32_bf16 v[88:91], v[244:247], v[136:139], v[88:91]
    s_waitcnt vmcnt(6)
    ds_read_b128 v[132:135], v33 offset:1024
    v_mfma_f32_16x16x32_bf16 v[92:95], v[240:243], v[136:139], v[92:95]
    v_mfma_f32_16x16x32_bf16 v[96:99], v[236:239], v[136:139], v[96:99]
    ds_write_b128 v20, v[80:83] offset:3072
    v_mfma_f32_16x16x32_bf16 v[100:103], v[232:235], v[136:139], v[100:103]
    v_mfma_f32_16x16x32_bf16 v[104:107], v[228:231], v[136:139], v[104:107]
    s_waitcnt lgkmcnt(6)
    v_mfma_f32_16x16x32_bf16 v[88:91], v[224:227], v[140:143], v[88:91]
    s_waitcnt vmcnt(5)
    ds_read_b128 v[136:139], v33 offset:2048
    v_mfma_f32_16x16x32_bf16 v[92:95], v[220:223], v[140:143], v[92:95]
    ds_write_b128 v20, v[84:87] offset:4096
    v_mfma_f32_16x16x32_bf16 v[96:99], v[216:219], v[140:143], v[96:99]
    v_mfma_f32_16x16x32_bf16 v[100:103], v[212:215], v[140:143], v[100:103]
    v_mfma_f32_16x16x32_bf16 v[104:107], v[208:211], v[140:143], v[104:107]
    s_waitcnt lgkmcnt(6)
    v_mfma_f32_16x16x32_bf16 v[108:111], a[208:211], v[128:131], v[108:111]
    s_waitcnt vmcnt(4)
    ds_read_b128 v[140:143], v33 offset:3072
    v_mfma_f32_16x16x32_bf16 v[112:115], a[212:215], v[128:131], v[112:115]
    v_mfma_f32_16x16x32_bf16 v[116:119], a[216:219], v[128:131], v[116:119]
    ds_write_b128 v21, v[88:91] offset:0
    v_mfma_f32_16x16x32_bf16 v[120:123], a[220:223], v[128:131], v[120:123]
    v_mfma_f32_16x16x32_bf16 v[124:127], a[224:227], v[128:131], v[124:127]
    s_waitcnt lgkmcnt(5)
    v_mfma_f32_16x16x32_bf16 v[108:111], a[228:231], v[132:135], v[108:111]
    s_waitcnt vmcnt(3)
    ds_read_b128 v[128:131], v33 offset:4096
    v_mfma_f32_16x16x32_bf16 v[112:115], a[232:235], v[132:135], v[112:115]
    ds_write_b128 v21, v[92:95] offset:1024
    v_mfma_f32_16x16x32_bf16 v[116:119], a[236:239], v[132:135], v[116:119]
    v_mfma_f32_16x16x32_bf16 v[120:123], a[240:243], v[132:135], v[120:123]
    v_mfma_f32_16x16x32_bf16 v[124:127], v[248:251], v[132:135], v[124:127]
    s_waitcnt lgkmcnt(5)
    ds_write_b128 v21, v[96:99] offset:2048
    v_mfma_f32_16x16x32_bf16 v[108:111], v[244:247], v[136:139], v[108:111]
    s_waitcnt vmcnt(2)
    ds_read_b128 v[132:135], v33 offset:5120
    v_mfma_f32_16x16x32_bf16 v[112:115], v[240:243], v[136:139], v[112:115]
    v_mfma_f32_16x16x32_bf16 v[116:119], v[236:239], v[136:139], v[116:119]
    ds_write_b128 v21, v[100:103] offset:3072
    v_mfma_f32_16x16x32_bf16 v[120:123], v[232:235], v[136:139], v[120:123]
    v_mfma_f32_16x16x32_bf16 v[124:127], v[228:231], v[136:139], v[124:127]
    s_waitcnt lgkmcnt(6)
    v_mfma_f32_16x16x32_bf16 v[108:111], v[224:227], v[140:143], v[108:111]
    s_waitcnt vmcnt(1)
    ds_read_b128 v[136:139], v33 offset:6144
    v_mfma_f32_16x16x32_bf16 v[112:115], v[220:223], v[140:143], v[112:115]
    ds_write_b128 v21, v[104:107] offset:4096
    v_mfma_f32_16x16x32_bf16 v[116:119], v[216:219], v[140:143], v[116:119]
    v_mfma_f32_16x16x32_bf16 v[120:123], v[212:215], v[140:143], v[120:123]
    v_mfma_f32_16x16x32_bf16 v[124:127], v[208:211], v[140:143], v[124:127]
    s_waitcnt lgkmcnt(6)
    s_waitcnt lgkmcnt(0)
    s_barrier
    v_mfma_f32_16x16x32_bf16 v[48:51], a[208:211], v[128:131], v[48:51]
    s_waitcnt vmcnt(0)
    ds_read_b128 v[140:143], v33 offset:7168
    ds_read_b128 v[68:71], v23 offset:0
    v_mfma_f32_16x16x32_bf16 v[52:55], a[212:215], v[128:131], v[52:55]
    ds_read_b128 v[88:91], v23 offset:5120
    v_mfma_f32_16x16x32_bf16 v[56:59], a[216:219], v[128:131], v[56:59]
    ds_write_b128 v22, v[108:111] offset:0
    v_mfma_f32_16x16x32_bf16 v[60:63], a[220:223], v[128:131], v[60:63]
    ds_read_b128 v[72:75], v23 offset:1024
    ds_read_b128 v[92:95], v23 offset:6144
    v_mfma_f32_16x16x32_bf16 v[64:67], a[224:227], v[128:131], v[64:67]
    ds_write_b128 v22, v[112:115] offset:1024
    v_mfma_f32_16x16x32_bf16 v[48:51], a[228:231], v[132:135], v[48:51]
    ds_read_b128 v[76:79], v23 offset:2048
    ds_read_b128 v[96:99], v23 offset:7168
    v_mfma_f32_16x16x32_bf16 v[52:55], a[232:235], v[132:135], v[52:55]
    ds_write_b128 v22, v[116:119] offset:2048
    v_mfma_f32_16x16x32_bf16 v[56:59], a[236:239], v[132:135], v[56:59]
    ds_read_b128 v[80:83], v23 offset:3072
    ds_read_b128 v[100:103], v23 offset:8192
    v_mfma_f32_16x16x32_bf16 v[60:63], a[240:243], v[132:135], v[60:63]
    ds_write_b128 v22, v[120:123] offset:3072
    v_mfma_f32_16x16x32_bf16 v[64:67], v[248:251], v[132:135], v[64:67]
    ds_read_b128 v[84:87], v23 offset:4096
    ds_read_b128 v[104:107], v23 offset:9216
    v_mfma_f32_16x16x32_bf16 v[48:51], v[244:247], v[136:139], v[48:51]
    ds_write_b128 v22, v[124:127] offset:4096
    v_mfma_f32_16x16x32_bf16 v[52:55], v[240:243], v[136:139], v[52:55]
    s_waitcnt lgkmcnt(13)
    v_add_f32 v68, v68, v88
    v_add_f32 v69, v69, v89
    v_mfma_f32_16x16x32_bf16 v[56:59], v[236:239], v[136:139], v[56:59]
    v_add_f32 v70, v70, v90
    v_add_f32 v71, v71, v91
    v_mfma_f32_16x16x32_bf16 v[60:63], v[232:235], v[136:139], v[60:63]
    s_waitcnt lgkmcnt(10)
    v_add_f32 v72, v72, v92
    v_add_f32 v73, v73, v93
    v_mfma_f32_16x16x32_bf16 v[64:67], v[228:231], v[136:139], v[64:67]
    v_add_f32 v74, v74, v94
    v_add_f32 v75, v75, v95
    v_mfma_f32_16x16x32_bf16 v[48:51], v[224:227], v[140:143], v[48:51]
    s_waitcnt lgkmcnt(7)
    v_add_f32 v76, v76, v96
    v_add_f32 v77, v77, v97
    v_mfma_f32_16x16x32_bf16 v[52:55], v[220:223], v[140:143], v[52:55]
    v_add_f32 v78, v78, v98
    v_add_f32 v79, v79, v99
    v_mfma_f32_16x16x32_bf16 v[56:59], v[216:219], v[140:143], v[56:59]
    s_waitcnt lgkmcnt(4)
    v_add_f32 v80, v80, v100
    v_add_f32 v81, v81, v101
    v_mfma_f32_16x16x32_bf16 v[60:63], v[212:215], v[140:143], v[60:63]
    v_add_f32 v82, v82, v102
    v_add_f32 v83, v83, v103
    v_mfma_f32_16x16x32_bf16 v[64:67], v[208:211], v[140:143], v[64:67]
    s_waitcnt lgkmcnt(1)
    v_add_f32 v84, v84, v104
    v_add_f32 v85, v85, v105
    s_waitcnt lgkmcnt(0)
    s_barrier
    ds_read_b128 v[108:111], v23 offset:10240
    ds_read_b128 v[112:115], v23 offset:11264
    ds_read_b128 v[116:119], v23 offset:12288
    ds_read_b128 v[120:123], v23 offset:13312
    ds_read_b128 v[124:127], v23 offset:14336
    v_add_f32 v86, v86, v106
    v_add_f32 v87, v87, v107
    v_pk_add_f32 v[48:49], v[48:49], v[68:69]
    v_pk_add_f32 v[50:51], v[50:51], v[70:71]
    v_pk_add_f32 v[52:53], v[52:53], v[72:73]
    v_pk_add_f32 v[54:55], v[54:55], v[74:75]
    v_pk_add_f32 v[56:57], v[56:57], v[76:77]
    v_pk_add_f32 v[58:59], v[58:59], v[78:79]
    v_pk_add_f32 v[60:61], v[60:61], v[80:81]
    v_pk_add_f32 v[62:63], v[62:63], v[82:83]
    v_pk_add_f32 v[64:65], v[64:65], v[84:85]
    v_pk_add_f32 v[66:67], v[66:67], v[86:87]
    s_waitcnt lgkmcnt(4)
    v_pk_add_f32 v[48:49], v[48:49], v[108:109]
    v_pk_add_f32 v[50:51], v[50:51], v[110:111]
    v_cvt_pk_bf16_f32 v36, v48, v49
    v_cvt_pk_bf16_f32 v37, v50, v51
    s_waitcnt lgkmcnt(3)
    v_pk_add_f32 v[52:53], v[52:53], v[112:113]
    v_pk_add_f32 v[54:55], v[54:55], v[114:115]
    v_cvt_pk_bf16_f32 v38, v52, v53
    v_cvt_pk_bf16_f32 v39, v54, v55
    buffer_store_dwordx4 v[36:39], v144, s[8:11], s91 offen
    s_waitcnt lgkmcnt(2)
    v_pk_add_f32 v[56:57], v[56:57], v[116:117]
    v_pk_add_f32 v[58:59], v[58:59], v[118:119]
    v_cvt_pk_bf16_f32 v40, v56, v57
    v_cvt_pk_bf16_f32 v41, v58, v59
    s_waitcnt lgkmcnt(1)
    v_pk_add_f32 v[60:61], v[60:61], v[120:121]
    v_pk_add_f32 v[62:63], v[62:63], v[122:123]
    v_cvt_pk_bf16_f32 v42, v60, v61
    v_cvt_pk_bf16_f32 v43, v62, v63
    buffer_store_dwordx4 v[40:43], v144, s[8:11], s91 offen offset:64
    s_waitcnt lgkmcnt(0)
    v_pk_add_f32 v[64:65], v[64:65], v[124:125]
    v_pk_add_f32 v[66:67], v[66:67], v[126:127]
    v_cvt_pk_bf16_f32 v44, v64, v65
    v_cvt_pk_bf16_f32 v45, v66, v67
    buffer_store_dwordx2 v[44:45], v145, s[8:11], s92 offen
    s_endpgm
pollr_75:
    buffer_load_dword v29, v5, s[4:7], s101 offen sc1
    s_sub_u32 s29, s29, 1
    s_waitcnt vmcnt(0)
    s_cbranch_scc0 poll_76
    s_endpgm
pollr_79:
    buffer_load_dword v29, v5, s[4:7], s87 offen sc1
    s_sub_u32 s29, s29, 1
    s_waitcnt vmcnt(0)
    s_cbranch_scc0 poll_80
    s_endpgm
pubs_83:
    buffer_wbl2 sc1
    s_waitcnt vmcnt(0)
    buffer_store_dword v30, off, s[4:7], s32 sc1
    s_branch pubd_84
pubs_85:
    buffer_wbl2 sc1
    s_waitcnt vmcnt(0)
    buffer_store_dword v30, off, s[4:7], s32 sc1
    s_branch pubd_86
pollr_87:
    buffer_load_dword v29, v5, s[4:7], s31 offen sc1
    s_sub_u32 s29, s29, 1
    s_waitcnt vmcnt(0)
    s_cbranch_scc0 poll_88
    s_endpgm
acq_89:
    buffer_inv sc1
    s_waitcnt vmcnt(0)
    s_branch polld_90
pollr_91:
    buffer_load_dword v29, v5, s[4:7], s31 offen sc1
    s_sub_u32 s29, s29, 1
    s_waitcnt vmcnt(0)
    s_cbranch_scc0 poll_92
    s_endpgm
acq_93:
    buffer_inv sc1
    s_waitcnt vmcnt(0)
    s_branch polld_94
pubs_95:
    buffer_wbl2 sc1
    s_waitcnt vmcnt(0)
    buffer_store_dword v30, off, s[4:7], s32 sc1
    s_branch pubd_96
pollr_97:
    buffer_load_dword v29, v5, s[4:7], s31 offen sc1
    s_sub_u32 s29, s29, 1
    s_waitcnt vmcnt(0)
    s_cbranch_scc0 poll_98
    s_endpgm
acq_99:
    buffer_inv sc1
    s_waitcnt vmcnt(0)
    s_branch polld_100
pubs_101:
    buffer_wbl2 sc1
    s_waitcnt vmcnt(0)
    buffer_store_dword v30, off, s[4:7], s32 sc1
    s_branch pubd_102
pubs_103:
    buffer_wbl2 sc1
    s_waitcnt vmcnt(0)
    buffer_store_dword v30, off, s[4:7], s32 sc1
    s_branch pubd_104
pollr_105:
    buffer_load_dword v29, v5, s[4:7], s31 offen sc1
    s_sub_u32 s29, s29, 1
    s_waitcnt vmcnt(0)
    s_cbranch_scc0 poll_106
    s_endpgm
acq_107:
    buffer_inv sc1
    s_waitcnt vmcnt(0)
    s_branch polld_108
pollr_109:
    buffer_load_dword v29, v5, s[4:7], s31 offen sc1
    s_sub_u32 s29, s29, 1
    s_waitcnt vmcnt(0)
    s_cbranch_scc0 poll_110
    s_endpgm
acq_111:
    buffer_inv sc1
    s_waitcnt vmcnt(0)
    s_branch polld_112
pubs_113:
    buffer_wbl2 sc1
    s_waitcnt vmcnt(0)
    buffer_store_dword v30, off, s[4:7], s32 sc1
    s_branch pubd_114
pollr_115:
    buffer_load_dword v29, v5, s[4:7], s31 offen sc1
    s_sub_u32 s29, s29, 1
    s_waitcnt vmcnt(0)
    s_cbranch_scc0 poll_116
    s_endpgm
acq_117:
    buffer_inv sc1
    s_waitcnt vmcnt(0)
    s_branch polld_118
pollr_119:
    buffer_load_dword v29, v5, s[4:7], s87 offen sc1
    s_sub_u32 s29, s29, 1
    s_waitcnt vmcnt(0)
    s_cbranch_scc0 poll_120
    s_endpgm
pubs_123:
    buffer_wbl2 sc1
    s_waitcnt vmcnt(0)
    buffer_store_dword v30, off, s[4:7], s32 sc1
    s_branch pubd_124
pubs_125:
    buffer_wbl2 sc1
    s_waitcnt vmcnt(0)
    buffer_store_dword v30, off, s[4:7], s32 sc1
    s_branch pubd_126
pollr_127:
    buffer_load_dword v29, v5, s[4:7], s31 offen sc1
    s_sub_u32 s29, s29, 1
    s_waitcnt vmcnt(0)
    s_cbranch_scc0 poll_128
    s_endpgm
acq_129:
    buffer_inv sc1
    s_waitcnt vmcnt(0)
    s_branch polld_130
pollr_131:
    buffer_load_dword v29, v5, s[4:7], s31 offen sc1
    s_sub_u32 s29, s29, 1
    s_waitcnt vmcnt(0)
    s_cbranch_scc0 poll_132
    s_endpgm
acq_133:
    buffer_inv sc1
    s_waitcnt vmcnt(0)
    s_branch polld_134
pubs_135:
    buffer_wbl2 sc1
    s_waitcnt vmcnt(0)
    buffer_store_dword v30, off, s[4:7], s32 sc1
    s_branch pubd_136
pollr_137:
    buffer_load_dword v29, v5, s[4:7], s31 offen sc1
    s_sub_u32 s29, s29, 1
    s_waitcnt vmcnt(0)
    s_cbranch_scc0 poll_138
    s_endpgm
acq_139:
    buffer_inv sc1
    s_waitcnt vmcnt(0)
    s_branch polld_140
pubs_141:
    buffer_wbl2 sc1
    s_waitcnt vmcnt(0)
    buffer_store_dword v30, off, s[4:7], s32 sc1
    s_branch pubd_142
pubs_143:
    buffer_wbl2 sc1
    s_waitcnt vmcnt(0)
    buffer_store_dword v30, off, s[4:7], s32 sc1
    s_branch pubd_144
pollr_145:
    buffer_load_dword v29, v5, s[4:7], s31 offen sc1
    s_sub_u32 s29, s29, 1
    s_waitcnt vmcnt(0)
    s_cbranch_scc0 poll_146
    s_endpgm
acq_147:
    buffer_inv sc1
    s_waitcnt vmcnt(0)
    s_branch polld_148
main_end:
.section .rodata,"a"
.p2align 6
.amdhsa_kernel prep_kernel
  .amdhsa_next_free_vgpr 72
  .amdhsa_next_free_sgpr 102
  .amdhsa_accum_offset 72
  .amdhsa_group_segment_fixed_size 0
  .amdhsa_kernarg_size 88
  .amdhsa_user_sgpr_count 2
  .amdhsa_user_sgpr_kernarg_segment_ptr 1
  .amdhsa_system_sgpr_workgroup_id_x 1
  .amdhsa_float_denorm_mode_32 3
  .amdhsa_float_denorm_mode_16_64 3
.end_amdhsa_kernel
.p2align 6
.amdhsa_kernel main_kernel
  .amdhsa_next_free_vgpr 512
  .amdhsa_next_free_sgpr 102
  .amdhsa_accum_offset 256
  .amdhsa_group_segment_fixed_size 0
  .amdhsa_kernarg_size 88
  .amdhsa_user_sgpr_count 2
  .amdhsa_user_sgpr_kernarg_segment_ptr 1
  .amdhsa_system_sgpr_workgroup_id_x 1
  .amdhsa_float_denorm_mode_32 3
  .amdhsa_float_denorm_mode_16_64 3
.end_amdhsa_kernel
```
